```python
import torch

def _softmax(x, axis=-1):
    return torch.softmax(x, dim=axis)
def _gelu(x):
    return torch.nn.functional.gelu(x, approximate="tanh")
def _silu(x):
    return torch.nn.functional.silu(x)
def _sigmoid(x):
    return torch.sigmoid(x)
def _layernorm(x, axis=-1, eps=1e-5):
    m = x.mean(dim=axis, keepdim=True)
    v = x.var(dim=axis, keepdim=True, unbiased=False)
    return (x - m) / torch.sqrt(v + eps)
def _scatter_add(tgt, idx, src, axis=0):
    return tgt.clone().index_add_(axis, idx, src)
def _segment_sum(src, seg, n):
    out = torch.zeros((n,) + src.shape[1:], dtype=src.dtype)
    return out.index_add_(0, seg, src)
def _pad(x, pw):
    flat = tuple(v for pair in reversed(pw) for v in pair)
    return torch.nn.functional.pad(x, flat)

kernel_name = 'recurrent_scan__mha_block_cached__glu_gated_glu__prompt'

def setup_inputs():

    _w = (lambda a: (lambda t: t.to(torch.bfloat16) if t.is_floating_point() else t)(torch.as_tensor(a)))
    def _A_setup():
        B, Sq, D = 1, 2048, 448
        H, Sk, Dh = 16, 2048, 256
        return {
            "x": _w((lambda *s: torch.randn(*s, dtype=torch.bfloat16) * 0.05)(B, Sq, D)),
            "k_cache": _w((lambda *s: torch.randn(*s, dtype=torch.bfloat16) * 1.6)(B, H, Sk, Dh)),
            "v_cache": _w((lambda *s: torch.randn(*s, dtype=torch.bfloat16) * 0.2)(B, H, Sk, Dh)),
            "wq": _w((lambda *s: torch.randn(*s, dtype=torch.bfloat16) * 1.6)(D, H * Dh) * (D ** -0.5)),
            "wo": _w((lambda *s: torch.randn(*s, dtype=torch.bfloat16) * 0.2)(H * Dh, D) * ((H * Dh) ** -0.5)),
        }
    _A_in = _A_setup()

    def _B_setup():
        B, S, D, F = 1, 2048, 448, 1792
        return {
            "x": _w((lambda *s: torch.randn(*s, dtype=torch.bfloat16) * 0.05)(B, S, D)),
            "w_gate": _w((lambda *s: torch.randn(*s, dtype=torch.bfloat16) * 0.2)(D, F)),
            "w_up": _w((lambda *s: torch.randn(*s, dtype=torch.bfloat16) * 0.1)(D, F)),
            "w_down": _w((lambda *s: torch.randn(*s, dtype=torch.bfloat16) * 0.1)(F, D)),
        }
    _B_in = _B_setup()

    return {
        "A_x": _A_in["x"],
        "A_k_cache": _A_in["k_cache"],
        "A_v_cache": _A_in["v_cache"],
        "A_wq": _A_in["wq"],
        "A_wo": _A_in["wo"],
        "B_x": _B_in["x"],
        "B_w_gate": _B_in["w_gate"],
        "B_w_up": _B_in["w_up"],
        "B_w_down": _B_in["w_down"],
    }

def reference(A_x, A_k_cache, A_v_cache, A_wq, A_wo, B_x, B_w_gate, B_w_up, B_w_down):
    def _A_ref(x, k_cache, v_cache, wq, wo):
        B, Sq, D = x.shape
        H, Dh = 16, 256
        q = (lambda x, *d: x.permute(*d))((x @ wq).reshape(B, Sq, H, Dh), 0, 2, 1, 3)
        scores = torch.einsum("bhqd,bhkd->bhqk", q, k_cache) * (Dh ** -0.5)
        p = _softmax(scores, axis=-1)
        o = torch.einsum("bhqk,bhkd->bhqd", p, v_cache)
        return (lambda x, *d: x.permute(*d))(o, 0, 2, 1, 3).reshape(B, Sq, H * Dh) @ wo

    def _B_ref(x, w_gate, w_up, w_down):
        g = torch.einsum("bsd,df->bsf", x, w_gate)
        u = torch.einsum("bsd,df->bsf", x, w_up)
        h = _sigmoid(g) * u
        return torch.einsum("bsf,fd->bsd", h, w_down)

    x = A_x
    xn = _layernorm(x, axis=-1)
    s = _A_ref(xn, A_k_cache, A_v_cache, A_wq, A_wo)
    g = _silu(_B_ref(xn, B_w_gate, B_w_up, B_w_down))
    return x + s * g
```

```asm
; @launch grid=(256,1,1) block=(256,1,1) lds=163840
.amdgcn_target "amdgcn-amd-amdhsa--gfx950"
.text
.globl recurrent_scan__mha_block_cached__glu_gated_glu__prompt_kernel
.p2align 8
.type recurrent_scan__mha_block_cached__glu_gated_glu__prompt_kernel,@function
recurrent_scan__mha_block_cached__glu_gated_glu__prompt_kernel:
    s_load_dwordx16 s[4:19], s[0:1], 0
    s_load_dwordx8 s[20:27], s[0:1], 64
    s_cmp_ge_u32 s2, 256
    s_cbranch_scc1 L_end
    s_getpc_b64 s[90:91]
L_pc0:
    s_lshr_b32 s97, s2, 3
    s_and_b32 s96, s97, 15
    s_lshl_b32 s96, s96, 13
    v_lshl_add_u32 v200, v0, 5, s96
    v_min_u32 v200, L_k1_last-L_pc0, v200
    global_load_dword v202, v200, s[90:91]
    v_lshrrev_b32 v211, 6, v0
    v_and_b32 v204, 63, v0
    v_readfirstlane_b32 s66, v211
    v_lshrrev_b32 v206, 4, v204
    v_lshrrev_b32 v213, 3, v204
    v_lshl_add_u32 v213, v211, 5, v213
    v_mul_u32_u24 v215, 896, v213
    v_and_b32 v211, 7, v204
    v_xor_b32 v211, v211, v206
    v_lshl_add_u32 v216, v211, 4, v215
    v_xor_b32 v217, 64, v216
    v_add_u32 v218, 12288, v216
    v_add_u32 v219, 18432, v217
    v_add_u32 v217, 6144, v217
    s_lshr_b32 s65, s2, 4
    s_mul_i32 s88, s66, 28672
    s_add_u32 m0, s88, 49152
    s_mul_i32 s96, s65, 114688
    s_mov_b32 s30, 114688
    s_mov_b32 s31, 131072
    s_waitcnt lgkmcnt(0)
    s_add_u32 s28, s4, s96
    s_addc_u32 s29, s5, 0
    s_and_b32 s29, s29, 65535
    s_mov_b32 s0, 0
    buffer_load_dwordx4 v216, s[28:31], s0 offen offset:0 lds
    buffer_load_dwordx4 v217, s[28:31], s0 offen offset:1024 lds
    buffer_load_dwordx4 v218, s[28:31], s0 offen offset:2048 lds
    buffer_load_dwordx4 v219, s[28:31], s0 offen offset:3072 lds
    s_addk_i32 m0, 4096
    s_addk_i32 s0, 128
    buffer_load_dwordx4 v216, s[28:31], s0 offen offset:0 lds
    buffer_load_dwordx4 v217, s[28:31], s0 offen offset:1024 lds
    buffer_load_dwordx4 v218, s[28:31], s0 offen offset:2048 lds
    buffer_load_dwordx4 v219, s[28:31], s0 offen offset:3072 lds
    v_and_b32 v205, 15, v204
    v_lshrrev_b32 v207, 2, v205
    v_and_b32 v208, 3, v204
    v_lshrrev_b32 v209, 5, v204
    v_and_b32 v210, 31, v204
    s_and_b32 s3, s2, 7
    s_lshl_b32 s3, s3, 1
    s_and_b32 s64, s97, 1
    s_add_u32 s64, s64, s3
    s_and_b32 s97, s65, 15
    s_lshl_b32 s97, s97, 2
    s_add_u32 s97, s97, s66
    s_lshl_b32 s67, s66, 12
    s_lshl_b32 s68, s66, 11
    s_lshr_b32 s92, s66, 1
    s_and_b32 s93, s66, 1
    s_lshl_b32 s94, s92, 5
    s_lshl_b32 s95, s93, 3
    s_add_u32 s94, s94, s95
    s_lshl_b32 s69, s94, 8
    s_lshl_b32 s95, s93, 2
    v_or_b32 v214, s95, v206
    v_lshrrev_b32 v211, 1, v205
    v_xor_b32 v211, v211, v214
    v_and_b32 v212, 1, v204
    v_lshlrev_b32 v212, 4, v212
    v_lshl_add_u32 v212, v211, 5, v212
    s_lshl_b32 s95, s66, 3
    v_add_u32 v213, s95, v206
    v_mul_u32_u24 v213, 3584, v213
    v_add_u32 v213, v213, v212
    v_cmp_eq_u32 vcc, 7, v211
    v_mov_b32 v199, 1073741824
    v_add_u32 v211, s94, v206
    v_cndmask_b32 v0, v213, v199, vcc
    v_lshl_add_u32 v1, v211, 13, v212
    s_mul_i32 s96, s64, 224
    s_add_u32 s32, s16, s96
    s_addc_u32 s33, s17, 0
    s_and_b32 s33, s33, 65535
    s_sub_u32 s34, 1605632, s96
    s_mov_b32 s35, 131072
    s_mul_i32 s96, s64, 224
    s_add_u32 s36, s18, s96
    s_addc_u32 s37, s19, 0
    s_and_b32 s37, s37, 65535
    s_sub_u32 s38, 1605632, s96
    s_mov_b32 s39, 131072
    s_add_u32 m0, s68, 0
    s_mov_b32 s72, 0
    buffer_load_dwordx4 v0, s[32:35], s72 offen offset:0 lds
    s_mov_b32 s73, 13312
    buffer_load_dwordx4 v0, s[32:35], s73 offen offset:1024 lds
    s_add_u32 m0, s68, 8192
    s_nop 0
    buffer_load_dwordx4 v0, s[36:39], s72 offen offset:0 lds
    buffer_load_dwordx4 v0, s[36:39], s73 offen offset:1024 lds
    v_lshl_add_u32 v211, v204, 6, s97
    v_lshrrev_b32 v212, 2, v211
    v_and_b32 v211, 3, v211
    v_mul_u32_u24 v213, 3584, v212
    v_mul_u32_u24 v203, 72, v211
    v_add_u32 v203, v203, v213
    v_lshl_add_u32 v211, v204, 6, s97
    v_lshrrev_b32 v212, 1, v211
    v_and_b32 v211, 1, v211
    v_cmp_lt_u32 vcc, 6, v204
    v_lshlrev_b32 v211, 7, v211
    v_lshl_add_u32 v211, v212, 13, v211
    v_cndmask_b32 v21, v211, v199, vcc
    s_lshl_b32 s97, s97, 10
    v_lshl_add_u32 v23, v204, 4, s97
    buffer_load_dword v22, v203, s[32:35], 0 offen
    buffer_load_dword v22, v203, s[36:39], 0 offen
    s_mul_i32 s96, s64, 512
    s_add_u32 s40, s10, s96
    s_addc_u32 s41, s11, 0
    s_and_b32 s41, s41, 65535
    s_sub_u32 s42, 3670016, s96
    s_mov_b32 s43, 131072
    s_mul_i32 s96, s64, 100352
    s_add_u32 s44, s20, s96
    s_addc_u32 s45, s21, 0
    s_and_b32 s45, s45, 65535
    s_mov_b32 s46, 100352
    s_mov_b32 s47, 131072
    s_mul_i32 s96, s64, 1048576
    s_add_u32 s48, s6, s96
    s_addc_u32 s49, s7, 0
    s_and_b32 s49, s49, 65535
    s_mov_b32 s50, 1048576
    s_mov_b32 s51, 131072
    s_mul_i32 s96, s64, 1048576
    s_add_u32 s52, s8, s96
    s_addc_u32 s53, s9, 0
    s_and_b32 s53, s53, 65535
    s_mov_b32 s54, 1048576
    s_mov_b32 s55, 131072
    s_mul_i32 s96, s64, 229376
    s_add_u32 s56, s12, s96
    s_addc_u32 s57, s13, 0
    s_and_b32 s57, s57, 65535
    s_mov_b32 s58, 229376
    s_mov_b32 s59, 131072
    s_lshl_b32 s97, s64, 4
    s_add_u32 s97, s97, s65
    s_mul_i32 s96, s97, 114944
    s_add_u32 s60, s26, s96
    s_addc_u32 s61, s27, 0
    s_and_b32 s61, s61, 65535
    s_mov_b32 s62, 114944
    s_mov_b32 s63, 131072
    s_mov_b32 s70, 4294950912
    s_mov_b32 s71, 4294950912
    s_mov_b32 s77, 1317011456
    v_bfe_u32 v211, v204, 1, 2
    v_xor_b32 v211, v211, v206
    v_and_b32 v212, 1, v204
    v_lshlrev_b32 v212, 4, v212
    v_lshl_add_u32 v212, v211, 5, v212
    v_add_u32 v2, v215, v212
    v_lshrrev_b32 v211, 1, v205
    v_xor_b32 v211, v211, v206
    v_lshlrev_b32 v211, 4, v211
    v_lshl_add_u32 v211, v205, 7, v211
    s_add_u32 s95, s88, 49152
    v_add_u32 v198, s95, v211
    v_xor_b32 v199, 64, v198
    v_lshl_add_u32 v3, v204, 4, s88
    v_and_b32 v211, 7, v204
    v_lshlrev_b32 v211, 1, v211
    v_lshrrev_b32 v212, 3, v205
    v_or_b32 v211, v211, v212
    v_and_b32 v212, 1, v206
    v_lshl_or_b32 v212, v212, 1, v209
    v_xor_b32 v211, v211, v212
    v_lshlrev_b32 v211, 4, v211
    s_lshl_b32 s95, s93, 14
    v_add_u32 v211, s95, v211
    v_lshl_add_u32 v4, v205, 9, v211
    v_lshl_add_u32 v211, v206, 2, v207
    v_and_b32 v212, 7, v211
    v_lshlrev_b32 v212, 5, v212
    v_lshl_add_u32 v211, v211, 9, v212
    v_lshlrev_b32 v212, 3, v208
    v_lshlrev_b32 v213, 4, v209
    v_xor_b32 v212, v212, v213
    v_add3_u32 v5, v211, v212, s95
    v_lshl_or_b32 v211, v209, 1, s93
    v_xor_b32 v211, v211, v210
    v_lshlrev_b32 v211, 4, v211
    v_lshl_add_u32 v211, v209, 9, v211
    v_add_u32 v6, s67, v211
    v_lshl_add_u32 v211, v206, 2, v207
    v_bfe_u32 v212, v211, 1, 2
    v_lshlrev_b32 v212, 5, v212
    v_lshl_add_u32 v211, v211, 7, v212
    v_lshl_add_u32 v7, v208, 3, v211
    v_and_b32 v211, 1, v206
    v_lshl_or_b32 v211, v211, 2, v207
    v_lshlrev_b32 v211, 5, v211
    v_lshl_add_u32 v211, v208, 3, v211
    v_lshl_add_u32 v212, v206, 3, v207
    v_lshl_add_u32 v8, v212, 8, v211
    v_xor_b32 v9, 32, v8
    v_xor_b32 v10, 64, v8
    v_xor_b32 v11, 96, v8
    v_xor_b32 v12, 128, v8
    v_xor_b32 v13, 160, v8
    v_xor_b32 v14, 192, v8
    v_xor_b32 v15, 224, v8
    v_cmp_eq_u32 s[80:81], 1, v208
    v_cmp_eq_u32 s[82:83], 2, v208
    v_cmp_eq_u32 s[84:85], 3, v208
    v_cmp_eq_u32 s[86:87], v207, v206
    s_mul_i32 s96, s65, 114944
    s_add_u32 s8, s26, s96
    s_addc_u32 s9, s27, 0
    s_and_b32 s9, s9, 65535
    s_sub_u32 s10, 29425664, s96
    s_mov_b32 s11, 131072
    s_mul_i32 s96, s65, 114688
    s_add_u32 s12, s22, s96
    s_addc_u32 s13, s23, 0
    s_and_b32 s13, s13, 65535
    s_mov_b32 s14, 114688
    s_mov_b32 s15, 131072
    s_mov_b32 s4, s24
    s_and_b32 s5, s25, 65535
    s_mov_b32 s6, 256
    s_mov_b32 s7, 131072
    s_cmp_eq_u32 s66, 3
    s_cselect_b32 s97, 1073741824, 0
    s_lshl_b32 s96, s66, 7
    s_and_b32 s3, s64, 1
    s_lshl_b32 s3, s3, 6
    s_add_u32 s96, s96, s3
    s_lshr_b32 s3, s64, 1
    s_mul_i32 s3, s3, 14336
    s_add_u32 s93, s96, s3
    s_lshr_b32 s3, s64, 2
    s_mul_i32 s3, s3, 28672
    s_add_u32 s92, s67, s3
    s_and_b32 s3, s64, 3
    s_lshl_b32 s3, s3, 10
    s_add_u32 s92, s92, s3
    s_sub_u32 s92, s92, s88
    s_lshl_b32 s94, 1, s64
    s_lshl_b32 s95, s65, 4
    s_add_u32 s26, s26, 29425664
    s_addc_u32 s27, s27, 0
    s_mul_i32 s96, s65, 4096
    s_add_u32 s16, s26, s96
    s_addc_u32 s17, s27, 0
    s_and_b32 s17, s17, 65535
    s_mov_b32 s18, 4096
    s_mov_b32 s19, 131072
    v_lshlrev_b32 v200, 4, v3
    v_mov_b32 v197, 0
    s_lshl_b32 s89, s64, 2
    s_mov_b32 s3, s2
    s_mul_i32 s96, s3, 13108
    s_lshr_b32 s96, s96, 16
    s_mul_i32 s96, s96, 5
    s_sub_u32 s3, s3, s96
    s_sub_u32 s26, 12, s3
    s_mov_b32 s1, s95
    s_mov_b32 s27, 0
    s_mov_b32 s76, 13
    s_mul_i32 s3, s66, 7327744
    s_mul_i32 s96, s64, 7168
    s_add_u32 s3, s3, s96
    v_mov_b32 v220, 1065369472
    v_mov_b32 v221, 1065369472
    v_mov_b32 v222, 1065369472
    v_mov_b32 v223, 1065369472
    v_and_b32 v211, 1, v204
    v_lshlrev_b32 v211, 4, v211
    v_mov_b32 v212, 16256
    v_lshlrev_b32 v211, v211, v212
    v_cndmask_b32 v211, 0, v211, s[86:87]
    v_cmp_gt_u32 vcc, 2, v208
    s_nop 1
    v_cndmask_b32 v240, 0, v211, vcc
    v_cndmask_b32 v241, v211, 0, vcc
    s_add_u32 m0, s88, 57344
    s_mov_b32 s0, 256
    buffer_load_dwordx4 v216, s[28:31], s0 offen offset:0 lds
    buffer_load_dwordx4 v217, s[28:31], s0 offen offset:1024 lds
    buffer_load_dwordx4 v218, s[28:31], s0 offen offset:2048 lds
    buffer_load_dwordx4 v219, s[28:31], s0 offen offset:3072 lds
    s_addk_i32 m0, 4096
    s_addk_i32 s0, 128
    buffer_load_dwordx4 v216, s[28:31], s0 offen offset:0 lds
    buffer_load_dwordx4 v217, s[28:31], s0 offen offset:1024 lds
    buffer_load_dwordx4 v218, s[28:31], s0 offen offset:2048 lds
    buffer_load_dwordx4 v219, s[28:31], s0 offen offset:3072 lds
    s_addk_i32 m0, 4096
    s_addk_i32 s0, 128
    buffer_load_dwordx4 v216, s[28:31], s0 offen offset:0 lds
    buffer_load_dwordx4 v217, s[28:31], s0 offen offset:1024 lds
    buffer_load_dwordx4 v218, s[28:31], s0 offen offset:2048 lds
    buffer_load_dwordx4 v219, s[28:31], s0 offen offset:3072 lds
    s_addk_i32 m0, 4096
    s_addk_i32 s0, 128
    buffer_load_dwordx4 v216, s[28:31], s0 offen offset:0 lds
    buffer_load_dwordx4 v217, s[28:31], s0 offen offset:1024 lds
    buffer_load_dwordx4 v218, s[28:31], s0 offen offset:2048 lds
    buffer_load_dwordx4 v219, s[28:31], s0 offen offset:3072 lds
    s_addk_i32 m0, 4096
    s_addk_i32 s0, 128
    buffer_load_dwordx4 v216, s[28:31], s0 offen offset:0 lds
    buffer_load_dwordx4 v217, s[28:31], s0 offen offset:1024 lds
    buffer_load_dwordx4 v218, s[28:31], s0 offen offset:2048 lds
    buffer_load_dwordx4 v219, s[28:31], s0 offen offset:3072 lds
    s_add_u32 m0, s68, 16384
    s_mov_b32 s74, 114688
    buffer_load_dwordx4 v0, s[32:35], s74 offen offset:0 lds
    s_mov_b32 s75, 128000
    buffer_load_dwordx4 v0, s[32:35], s75 offen offset:1024 lds
    s_add_u32 m0, s68, 24576
    s_nop 0
    buffer_load_dwordx4 v0, s[36:39], s74 offen offset:0 lds
    buffer_load_dwordx4 v0, s[36:39], s75 offen offset:1024 lds
    s_waitcnt vmcnt(34)
    ds_read_b128 v[32:35], v198 offset:0
    ds_read_b128 v[36:39], v198 offset:2048
    ds_read_b128 v[40:43], v199 offset:0
    ds_read_b128 v[44:47], v199 offset:2048
    s_waitcnt vmcnt(30)
    ds_read_b128 v[48:51], v198 offset:4096
    ds_read_b128 v[52:55], v198 offset:6144
    ds_read_b128 v[56:59], v199 offset:4096
    ds_read_b128 v[60:63], v199 offset:6144
    s_waitcnt vmcnt(20)
    s_waitcnt lgkmcnt(7)
    v_mfma_f32_16x16x32_bf16 v[224:227], v[220:223], v[32:35], 0
    s_waitcnt lgkmcnt(6)
    s_add_u32 m0, s68, 32768
    ds_read_b128 v[64:67], v198 offset:8192
    v_mfma_f32_16x16x32_bf16 v[228:231], v[220:223], v[36:39], 0
    s_waitcnt lgkmcnt(6)
    s_mov_b32 s72, 229376
    ds_read_b128 v[68:71], v198 offset:10240
    v_mfma_f32_16x16x32_bf16 v[224:227], v[220:223], v[40:43], v[224:227]
    s_waitcnt lgkmcnt(6)
    ds_read_b128 v[72:75], v199 offset:8192
    buffer_load_dwordx4 v0, s[32:35], s72 offen offset:0 lds
    v_mfma_f32_16x16x32_bf16 v[228:231], v[220:223], v[44:47], v[228:231]
    s_waitcnt lgkmcnt(6)
    s_waitcnt vmcnt(17)
    ds_read_b128 v[76:79], v199 offset:10240
    v_mfma_f32_16x16x32_bf16 v[224:227], v[220:223], v[48:51], v[224:227]
    s_waitcnt lgkmcnt(6)
    s_mov_b32 s73, 242688
    ds_read_b128 v[80:83], v198 offset:12288
    v_mfma_f32_16x16x32_bf16 v[228:231], v[220:223], v[52:55], v[228:231]
    s_waitcnt lgkmcnt(6)
    ds_read_b128 v[84:87], v198 offset:14336
    buffer_load_dwordx4 v0, s[32:35], s73 offen offset:1024 lds
    v_mfma_f32_16x16x32_bf16 v[224:227], v[220:223], v[56:59], v[224:227]
    s_waitcnt lgkmcnt(6)
    ds_read_b128 v[88:91], v199 offset:12288
    v_mfma_f32_16x16x32_bf16 v[228:231], v[220:223], v[60:63], v[228:231]
    s_waitcnt lgkmcnt(6)
    s_waitcnt vmcnt(14)
    s_add_u32 m0, s68, 40960
    ds_read_b128 v[92:95], v199 offset:14336
    v_mfma_f32_16x16x32_bf16 v[224:227], v[220:223], v[64:67], v[224:227]
    s_waitcnt lgkmcnt(6)
    ds_read_b128 v[96:99], v198 offset:16384
    buffer_load_dwordx4 v0, s[36:39], s72 offen offset:0 lds
    v_mfma_f32_16x16x32_bf16 v[228:231], v[220:223], v[68:71], v[228:231]
    s_waitcnt lgkmcnt(6)
    ds_read_b128 v[100:103], v198 offset:18432
    v_mfma_f32_16x16x32_bf16 v[224:227], v[220:223], v[72:75], v[224:227]
    s_waitcnt lgkmcnt(6)
    ds_read_b128 v[104:107], v199 offset:16384
    v_mfma_f32_16x16x32_bf16 v[228:231], v[220:223], v[76:79], v[228:231]
    s_waitcnt lgkmcnt(6)
    s_waitcnt vmcnt(11)
    ds_read_b128 v[108:111], v199 offset:18432
    buffer_load_dwordx4 v0, s[36:39], s73 offen offset:1024 lds
    v_mfma_f32_16x16x32_bf16 v[224:227], v[220:223], v[80:83], v[224:227]
    s_waitcnt lgkmcnt(6)
    ds_read_b128 v[112:115], v198 offset:20480
    v_mfma_f32_16x16x32_bf16 v[228:231], v[220:223], v[84:87], v[228:231]
    s_waitcnt lgkmcnt(6)
    ds_read_b128 v[116:119], v198 offset:22528
    v_mfma_f32_16x16x32_bf16 v[224:227], v[220:223], v[88:91], v[224:227]
    s_waitcnt lgkmcnt(6)
    ds_read_b128 v[120:123], v199 offset:20480
    buffer_store_dword v197, v200, s[16:19], s89 offen sc1
    v_mfma_f32_16x16x32_bf16 v[228:231], v[220:223], v[92:95], v[228:231]
    s_waitcnt lgkmcnt(6)
    s_waitcnt vmcnt(9)
    ds_read_b128 v[124:127], v199 offset:22528
    v_mfma_f32_16x16x32_bf16 v[224:227], v[220:223], v[96:99], v[224:227]
    s_waitcnt lgkmcnt(6)
    ds_read_b128 v[128:131], v198 offset:24576
    v_mfma_f32_16x16x32_bf16 v[228:231], v[220:223], v[100:103], v[228:231]
    s_waitcnt lgkmcnt(6)
    ds_read_b128 v[132:135], v198 offset:26624
    v_mfma_f32_16x16x32_bf16 v[224:227], v[220:223], v[104:107], v[224:227]
    s_waitcnt lgkmcnt(6)
    ds_read_b128 v[136:139], v199 offset:24576
    v_mfma_f32_16x16x32_bf16 v[228:231], v[220:223], v[108:111], v[228:231]
    s_waitcnt lgkmcnt(6)
    ds_read_b128 v[140:143], v199 offset:26624
    v_mfma_f32_16x16x32_bf16 v[224:227], v[220:223], v[112:115], v[224:227]
    s_waitcnt lgkmcnt(6)
    v_mfma_f32_16x16x32_bf16 v[228:231], v[220:223], v[116:119], v[228:231]
    s_waitcnt lgkmcnt(5)
    v_mfma_f32_16x16x32_bf16 v[224:227], v[220:223], v[120:123], v[224:227]
    s_waitcnt lgkmcnt(4)
    v_mfma_f32_16x16x32_bf16 v[228:231], v[220:223], v[124:127], v[228:231]
    s_waitcnt lgkmcnt(3)
    v_mfma_f32_16x16x32_bf16 v[224:227], v[220:223], v[128:131], v[224:227]
    s_waitcnt lgkmcnt(2)
    v_mfma_f32_16x16x32_bf16 v[228:231], v[220:223], v[132:135], v[228:231]
    s_waitcnt lgkmcnt(1)
    v_mfma_f32_16x16x32_bf16 v[224:227], v[220:223], v[136:139], v[224:227]
    s_waitcnt lgkmcnt(0)
    v_mfma_f32_16x16x32_bf16 v[228:231], v[220:223], v[140:143], v[228:231]
    s_barrier
    s_nop 4
    v_mul_f32 v24, 991054117, v224
    s_nop 0
    v_mul_f32 v25, 991054117, v228
    v_cvt_pk_bf16_f32 v26, v24, v25
    v_lshlrev_b32 v16, 16, v26
    v_and_b32 v17, 4294901760, v26
    v_sub_f32 v232, 0, v16
    v_sub_f32 v233, 0, v16
    v_sub_f32 v234, 0, v16
    v_sub_f32 v235, 0, v16
    v_sub_f32 v236, 0, v17
    v_sub_f32 v237, 0, v17
    v_sub_f32 v238, 0, v17
    v_sub_f32 v239, 0, v17
    v_mfma_f32_16x16x16_bf16 v[184:187], v[240:241], v[32:33], v[232:235]
    s_add_u32 m0, s68, 49152
    v_sub_f32 v18, v24, v16
    v_sub_f32 v19, v25, v17
    v_mfma_f32_16x16x16_bf16 v[188:191], v[240:241], v[34:35], v[232:235]
    s_mov_b32 s74, 344064
    v_mfma_f32_16x16x16_bf16 v[176:179], v[240:241], v[36:37], v[236:239]
    buffer_load_dwordx4 v0, s[32:35], s74 offen offset:0 lds
    v_mfma_f32_16x16x16_bf16 v[180:183], v[240:241], v[38:39], v[236:239]
    v_mfma_f32_16x16x16_bf16 v[168:171], v[240:241], v[40:41], v[232:235]
    s_mov_b32 s75, 357376
    v_cvt_pk_bf16_f32 v32, v184, v185
    v_cvt_pk_bf16_f32 v33, v186, v187
    v_mfma_f32_16x16x16_bf16 v[172:175], v[240:241], v[42:43], v[232:235]
    buffer_load_dwordx4 v0, s[32:35], s75 offen offset:1024 lds
    v_cvt_pk_bf16_f32 v34, v188, v189
    v_cvt_pk_bf16_f32 v35, v190, v191
    v_mfma_f32_16x16x16_bf16 v[160:163], v[240:241], v[44:45], v[236:239]
    v_cvt_pk_bf16_f32 v36, v176, v177
    v_cvt_pk_bf16_f32 v37, v178, v179
    v_mfma_f32_16x16x16_bf16 v[164:167], v[240:241], v[46:47], v[236:239]
    s_add_u32 m0, s68, 57344
    v_cvt_pk_bf16_f32 v38, v180, v181
    v_cvt_pk_bf16_f32 v39, v182, v183
    v_mfma_f32_16x16x16_bf16 v[152:155], v[240:241], v[48:49], v[232:235]
    buffer_load_dwordx4 v0, s[36:39], s74 offen offset:0 lds
    v_cvt_pk_bf16_f32 v40, v168, v169
    v_cvt_pk_bf16_f32 v41, v170, v171
    v_mfma_f32_16x16x16_bf16 v[156:159], v[240:241], v[50:51], v[232:235]
    v_cvt_pk_bf16_f32 v42, v172, v173
    v_cvt_pk_bf16_f32 v43, v174, v175
    v_mfma_f32_16x16x16_bf16 v[184:187], v[240:241], v[52:53], v[236:239]
    v_cvt_pk_bf16_f32 v44, v160, v161
    v_cvt_pk_bf16_f32 v45, v162, v163
    v_mfma_f32_16x16x16_bf16 v[188:191], v[240:241], v[54:55], v[236:239]
    buffer_load_dwordx4 v0, s[36:39], s75 offen offset:1024 lds
    v_cvt_pk_bf16_f32 v46, v164, v165
    v_cvt_pk_bf16_f32 v47, v166, v167
    v_mfma_f32_16x16x16_bf16 v[176:179], v[240:241], v[56:57], v[232:235]
    s_add_u32 m0, s68, 65536
    v_cvt_pk_bf16_f32 v48, v152, v153
    v_cvt_pk_bf16_f32 v49, v154, v155
    v_mfma_f32_16x16x16_bf16 v[180:183], v[240:241], v[58:59], v[232:235]
    s_mov_b32 s72, 458752
    v_cvt_pk_bf16_f32 v50, v156, v157
    v_cvt_pk_bf16_f32 v51, v158, v159
    v_mfma_f32_16x16x16_bf16 v[168:171], v[240:241], v[60:61], v[236:239]
    buffer_load_dwordx4 v0, s[32:35], s72 offen offset:0 lds
    v_cvt_pk_bf16_f32 v52, v184, v185
    v_cvt_pk_bf16_f32 v53, v186, v187
    v_mfma_f32_16x16x16_bf16 v[172:175], v[240:241], v[62:63], v[236:239]
    v_cvt_pk_bf16_f32 v54, v188, v189
    v_cvt_pk_bf16_f32 v55, v190, v191
    v_mfma_f32_16x16x16_bf16 v[160:163], v[240:241], v[64:65], v[232:235]
    s_mov_b32 s73, 472064
    v_cvt_pk_bf16_f32 v56, v176, v177
    v_cvt_pk_bf16_f32 v57, v178, v179
    v_mfma_f32_16x16x16_bf16 v[164:167], v[240:241], v[66:67], v[232:235]
    buffer_load_dwordx4 v0, s[32:35], s73 offen offset:1024 lds
    v_cvt_pk_bf16_f32 v58, v180, v181
    v_cvt_pk_bf16_f32 v59, v182, v183
    v_mfma_f32_16x16x16_bf16 v[152:155], v[240:241], v[68:69], v[236:239]
    v_cvt_pk_bf16_f32 v60, v168, v169
    v_cvt_pk_bf16_f32 v61, v170, v171
    v_mfma_f32_16x16x16_bf16 v[156:159], v[240:241], v[70:71], v[236:239]
    s_add_u32 m0, s68, 73728
    s_waitcnt vmcnt(37)
    v_cvt_pk_bf16_f32 v62, v172, v173
    v_cvt_pk_bf16_f32 v63, v174, v175
    v_mfma_f32_16x16x16_bf16 v[184:187], v[240:241], v[72:73], v[232:235]
    s_barrier
    buffer_load_dwordx4 v0, s[36:39], s72 offen offset:0 lds
    v_cvt_pk_bf16_f32 v64, v160, v161
    v_cvt_pk_bf16_f32 v65, v162, v163
    v_mfma_f32_16x16x16_bf16 v[188:191], v[240:241], v[74:75], v[232:235]
    v_cvt_pk_bf16_f32 v66, v164, v165
    v_cvt_pk_bf16_f32 v67, v166, v167
    v_mfma_f32_16x16x16_bf16 v[176:179], v[240:241], v[76:77], v[236:239]
    v_cvt_pk_bf16_f32 v68, v152, v153
    v_cvt_pk_bf16_f32 v69, v154, v155
    v_mfma_f32_16x16x16_bf16 v[180:183], v[240:241], v[78:79], v[236:239]
    ds_read_b64_tr_b16 a[0:1], v8 offset:0
    buffer_load_dwordx4 v0, s[36:39], s73 offen offset:1024 lds
    v_cvt_pk_bf16_f32 v70, v156, v157
    v_cvt_pk_bf16_f32 v71, v158, v159
    v_mfma_f32_16x16x16_bf16 v[168:171], v[240:241], v[80:81], v[232:235]
    s_add_u32 m0, s68, 81920
    ds_read_b64_tr_b16 a[2:3], v8 offset:1024
    v_cvt_pk_bf16_f32 v72, v184, v185
    v_cvt_pk_bf16_f32 v73, v186, v187
    v_mfma_f32_16x16x16_bf16 v[172:175], v[240:241], v[82:83], v[232:235]
    s_mov_b32 s74, 573440
    ds_read_b64_tr_b16 a[4:5], v8 offset:8192
    v_cvt_pk_bf16_f32 v74, v188, v189
    v_cvt_pk_bf16_f32 v75, v190, v191
    v_mfma_f32_16x16x16_bf16 v[160:163], v[240:241], v[84:85], v[236:239]
    ds_read_b64_tr_b16 a[6:7], v8 offset:9216
    buffer_load_dwordx4 v0, s[32:35], s74 offen offset:0 lds
    v_cvt_pk_bf16_f32 v76, v176, v177
    v_cvt_pk_bf16_f32 v77, v178, v179
    v_mfma_f32_16x16x16_bf16 v[164:167], v[240:241], v[86:87], v[236:239]
    ds_read_b64_tr_b16 a[8:9], v9 offset:0
    v_cvt_pk_bf16_f32 v78, v180, v181
    v_cvt_pk_bf16_f32 v79, v182, v183
    v_mfma_f32_16x16x16_bf16 v[152:155], v[240:241], v[88:89], v[232:235]
    s_mov_b32 s75, 586752
    ds_read_b64_tr_b16 a[10:11], v9 offset:1024
    v_cvt_pk_bf16_f32 v80, v168, v169
    v_cvt_pk_bf16_f32 v81, v170, v171
    v_mfma_f32_16x16x16_bf16 v[156:159], v[240:241], v[90:91], v[232:235]
    ds_read_b64_tr_b16 a[12:13], v9 offset:8192
    buffer_load_dwordx4 v0, s[32:35], s75 offen offset:1024 lds
    v_cvt_pk_bf16_f32 v82, v172, v173
    v_cvt_pk_bf16_f32 v83, v174, v175
    v_mfma_f32_16x16x16_bf16 v[24:27], v[240:241], v[92:93], v[236:239]
    ds_read_b64_tr_b16 a[14:15], v9 offset:9216
    v_cvt_pk_bf16_f32 v84, v160, v161
    v_cvt_pk_bf16_f32 v85, v162, v163
    v_mfma_f32_16x16x16_bf16 v[28:31], v[240:241], v[94:95], v[236:239]
    s_add_u32 m0, s68, 90112
    ds_read_b64_tr_b16 a[16:17], v10 offset:0
    v_cvt_pk_bf16_f32 v86, v164, v165
    v_cvt_pk_bf16_f32 v87, v166, v167
    v_mfma_f32_16x16x32_bf16 a[192:195], v[32:35], v[32:35], 0
    ds_read_b64_tr_b16 a[18:19], v10 offset:1024
    buffer_load_dwordx4 v0, s[36:39], s74 offen offset:0 lds
    v_cvt_pk_bf16_f32 v88, v152, v153
    v_cvt_pk_bf16_f32 v89, v154, v155
    v_mfma_f32_16x16x32_bf16 a[196:199], v[36:39], v[36:39], 0
    s_waitcnt lgkmcnt(6)
    ds_read_b64_tr_b16 a[20:21], v10 offset:8192
    v_cvt_pk_bf16_f32 v90, v156, v157
    v_cvt_pk_bf16_f32 v91, v158, v159
    v_mfma_f32_16x16x32_bf16 v[144:147], a[0:3], v[32:35], 0
    s_waitcnt vmcnt(12)
    ds_read_b64_tr_b16 a[22:23], v10 offset:9216
    v_cvt_pk_bf16_f32 v92, v24, v25
    v_cvt_pk_bf16_f32 v93, v26, v27
    v_mfma_f32_16x16x32_bf16 v[152:155], a[0:3], v[36:39], 0
    s_barrier
    ds_read_b64_tr_b16 a[24:25], v11 offset:0
    buffer_load_dwordx4 v0, s[36:39], s75 offen offset:1024 lds
    v_cvt_pk_bf16_f32 v94, v28, v29
    v_cvt_pk_bf16_f32 v95, v30, v31
    v_mfma_f32_16x16x32_bf16 v[148:151], a[4:7], v[32:35], 0
    s_add_u32 m0, s68, 98304
    ds_read_b64_tr_b16 a[26:27], v11 offset:1024
    v_mfma_f32_16x16x32_bf16 v[156:159], a[4:7], v[36:39], 0
    s_waitcnt lgkmcnt(6)
    s_mov_b32 s72, 688128
    ds_read_b64_tr_b16 a[28:29], v11 offset:8192
    v_mfma_f32_16x16x32_bf16 v[160:163], a[8:11], v[32:35], 0
    ds_read_b64_tr_b16 a[30:31], v11 offset:9216
    buffer_load_dwordx4 v0, s[32:35], s72 offen offset:0 lds
    v_mfma_f32_16x16x32_bf16 v[168:171], a[8:11], v[36:39], 0
    ds_read_b64_tr_b16 a[32:33], v12 offset:0
    v_lshlrev_b32 v24, 16, v96
    v_mfma_f32_16x16x32_bf16 v[164:167], a[12:15], v[32:35], 0
    s_mov_b32 s73, 701440
    ds_read_b64_tr_b16 a[34:35], v12 offset:1024
    v_and_b32 v25, 4294901760, v96
    v_mfma_f32_16x16x32_bf16 v[172:175], a[12:15], v[36:39], 0
    s_waitcnt lgkmcnt(6)
    ds_read_b64_tr_b16 a[36:37], v12 offset:8192
    buffer_load_dwordx4 v0, s[32:35], s73 offen offset:1024 lds
    v_mfma_f32_16x16x32_bf16 v[176:179], a[16:19], v[32:35], 0
    ds_read_b64_tr_b16 a[38:39], v12 offset:9216
    v_mfma_f32_16x16x32_bf16 v[184:187], a[16:19], v[36:39], 0
    s_add_u32 m0, s68, 106496
    ds_read_b64_tr_b16 a[40:41], v13 offset:0
    v_lshlrev_b32 v26, 16, v97
    v_mfma_f32_16x16x32_bf16 v[180:183], a[20:23], v[32:35], 0
    ds_read_b64_tr_b16 a[42:43], v13 offset:1024
    buffer_load_dwordx4 v0, s[36:39], s72 offen offset:0 lds
    v_mfma_f32_16x16x32_bf16 v[188:191], a[20:23], v[36:39], 0
    s_waitcnt lgkmcnt(6)
    ds_read_b64_tr_b16 a[44:45], v13 offset:8192
    v_and_b32 v27, 4294901760, v97
    v_mfma_f32_16x16x32_bf16 v[192:195], a[24:27], v[32:35], 0
    ds_read_b64_tr_b16 a[46:47], v13 offset:9216
    v_mfma_f32_16x16x32_bf16 v[200:203], a[24:27], v[36:39], 0
    s_waitcnt lgkmcnt(6)
    ds_read_b64_tr_b16 a[48:49], v14 offset:0
    buffer_load_dwordx4 v0, s[36:39], s73 offen offset:1024 lds
    v_mfma_f32_16x16x32_bf16 v[196:199], a[28:31], v[32:35], 0
    s_add_u32 m0, s68, 114688
    ds_read_b64_tr_b16 a[50:51], v14 offset:1024
    v_lshlrev_b32 v28, 16, v98
    v_mfma_f32_16x16x32_bf16 v[204:207], a[28:31], v[36:39], 0
    s_mov_b32 s74, 802816
    ds_read_b64_tr_b16 a[52:53], v14 offset:8192
    v_and_b32 v29, 4294901760, v98
    v_mfma_f32_16x16x32_bf16 v[208:211], a[32:35], v[32:35], 0
    ds_read_b64_tr_b16 a[54:55], v14 offset:9216
    buffer_load_dwordx4 v0, s[32:35], s74 offen offset:0 lds
    v_mfma_f32_16x16x32_bf16 v[216:219], a[32:35], v[36:39], 0
    s_waitcnt lgkmcnt(6)
    v_lshlrev_b32 v30, 16, v99
    v_mfma_f32_16x16x32_bf16 v[212:215], a[36:39], v[32:35], 0
    s_mov_b32 s75, 816128
    v_and_b32 v31, 4294901760, v99
    v_sub_f32 v24, v24, v16
    v_mfma_f32_16x16x32_bf16 v[220:223], a[36:39], v[36:39], 0
    ds_read_b64_tr_b16 a[56:57], v8 offset:16384
    buffer_load_dwordx4 v0, s[32:35], s75 offen offset:1024 lds
    v_mfma_f32_16x16x32_bf16 v[224:227], a[40:43], v[32:35], 0
    s_waitcnt lgkmcnt(4)
    ds_read_b64_tr_b16 a[58:59], v8 offset:17408
    v_sub_f32 v25, v25, v16
    v_mfma_f32_16x16x32_bf16 v[232:235], a[40:43], v[36:39], 0
    s_add_u32 m0, s68, 122880
    ds_read_b64_tr_b16 a[60:61], v8 offset:24576
    v_mfma_f32_16x16x32_bf16 v[228:231], a[44:47], v[32:35], 0
    ds_read_b64_tr_b16 a[62:63], v8 offset:25600
    buffer_load_dwordx4 v0, s[36:39], s74 offen offset:0 lds
    v_mfma_f32_16x16x32_bf16 v[236:239], a[44:47], v[36:39], 0
    s_waitcnt lgkmcnt(4)
    ds_read_b64_tr_b16 a[0:1], v9 offset:16384
    v_sub_f32 v26, v26, v16
    v_mfma_f32_16x16x32_bf16 v[240:243], a[48:51], v[32:35], 0
    ds_read_b64_tr_b16 a[2:3], v9 offset:17408
    v_sub_f32 v27, v27, v16
    v_mfma_f32_16x16x32_bf16 v[248:251], a[48:51], v[36:39], 0
    ds_read_b64_tr_b16 a[4:5], v9 offset:24576
    buffer_load_dwordx4 v0, s[36:39], s75 offen offset:1024 lds
    v_mfma_f32_16x16x32_bf16 v[244:247], a[52:55], v[32:35], 0
    ds_read_b64_tr_b16 a[6:7], v9 offset:25600
    v_mfma_f32_16x16x32_bf16 v[252:255], a[52:55], v[36:39], 0
    ds_read_b64_tr_b16 a[8:9], v10 offset:16384
    v_sub_f32 v28, v28, v16
    v_mfma_f32_16x16x32_bf16 a[192:195], v[40:43], v[40:43], a[192:195]
    ds_read_b64_tr_b16 a[10:11], v10 offset:17408
    v_sub_f32 v29, v29, v16
    v_mfma_f32_16x16x32_bf16 a[196:199], v[44:47], v[44:47], a[196:199]
    s_waitcnt lgkmcnt(6)
    ds_read_b64_tr_b16 a[12:13], v10 offset:24576
    v_mfma_f32_16x16x32_bf16 v[144:147], a[56:59], v[40:43], v[144:147]
    ds_read_b64_tr_b16 a[14:15], v10 offset:25600
    v_sub_f32 v30, v30, v16
    v_mfma_f32_16x16x32_bf16 v[152:155], a[56:59], v[44:47], v[152:155]
    ds_read_b64_tr_b16 a[16:17], v11 offset:16384
    v_sub_f32 v31, v31, v16
    v_mfma_f32_16x16x32_bf16 v[148:151], a[60:63], v[40:43], v[148:151]
    ds_read_b64_tr_b16 a[18:19], v11 offset:17408
    v_mfma_f32_16x16x32_bf16 v[156:159], a[60:63], v[44:47], v[156:159]
    s_waitcnt lgkmcnt(6)
    ds_read_b64_tr_b16 a[20:21], v11 offset:24576
    v_cvt_pk_bf16_f32 v96, v24, v25
    v_mfma_f32_16x16x32_bf16 v[160:163], a[0:3], v[40:43], v[160:163]
    ds_read_b64_tr_b16 a[22:23], v11 offset:25600
    v_cvt_pk_bf16_f32 v97, v26, v27
    v_mfma_f32_16x16x32_bf16 v[168:171], a[0:3], v[44:47], v[168:171]
    ds_read_b64_tr_b16 a[24:25], v12 offset:16384
    v_mfma_f32_16x16x32_bf16 v[164:167], a[4:7], v[40:43], v[164:167]
    ds_read_b64_tr_b16 a[26:27], v12 offset:17408
    v_cvt_pk_bf16_f32 v98, v28, v29
    v_mfma_f32_16x16x32_bf16 v[172:175], a[4:7], v[44:47], v[172:175]
    s_waitcnt lgkmcnt(6)
    ds_read_b64_tr_b16 a[28:29], v12 offset:24576
    v_cvt_pk_bf16_f32 v99, v30, v31
    v_mfma_f32_16x16x32_bf16 v[176:179], a[8:11], v[40:43], v[176:179]
    ds_read_b64_tr_b16 a[30:31], v12 offset:25600
    v_mfma_f32_16x16x32_bf16 v[184:187], a[8:11], v[44:47], v[184:187]
    ds_read_b64_tr_b16 a[32:33], v13 offset:16384
    v_lshlrev_b32 v24, 16, v100
    v_mfma_f32_16x16x32_bf16 v[180:183], a[12:15], v[40:43], v[180:183]
    ds_read_b64_tr_b16 a[34:35], v13 offset:17408
    v_and_b32 v25, 4294901760, v100
    v_mfma_f32_16x16x32_bf16 v[188:191], a[12:15], v[44:47], v[188:191]
    s_waitcnt lgkmcnt(6)
    ds_read_b64_tr_b16 a[36:37], v13 offset:24576
    v_mfma_f32_16x16x32_bf16 v[192:195], a[16:19], v[40:43], v[192:195]
    ds_read_b64_tr_b16 a[38:39], v13 offset:25600
    v_lshlrev_b32 v26, 16, v101
    v_mfma_f32_16x16x32_bf16 v[200:203], a[16:19], v[44:47], v[200:203]
    ds_read_b64_tr_b16 a[40:41], v14 offset:16384
    v_and_b32 v27, 4294901760, v101
    v_mfma_f32_16x16x32_bf16 v[196:199], a[20:23], v[40:43], v[196:199]
    ds_read_b64_tr_b16 a[42:43], v14 offset:17408
    v_mfma_f32_16x16x32_bf16 v[204:207], a[20:23], v[44:47], v[204:207]
    s_waitcnt lgkmcnt(6)
    ds_read_b64_tr_b16 a[44:45], v14 offset:24576
    v_lshlrev_b32 v28, 16, v102
    v_mfma_f32_16x16x32_bf16 v[208:211], a[24:27], v[40:43], v[208:211]
    ds_read_b64_tr_b16 a[46:47], v14 offset:25600
    v_and_b32 v29, 4294901760, v102
    v_mfma_f32_16x16x32_bf16 v[216:219], a[24:27], v[44:47], v[216:219]
    v_lshlrev_b32 v30, 16, v103
    v_mfma_f32_16x16x32_bf16 v[212:215], a[28:31], v[40:43], v[212:215]
    v_and_b32 v31, 4294901760, v103
    v_sub_f32 v24, v24, v17
    v_mfma_f32_16x16x32_bf16 v[220:223], a[28:31], v[44:47], v[220:223]
    s_waitcnt lgkmcnt(4)
    ds_read_b64_tr_b16 a[48:49], v8 offset:32768
    v_sub_f32 v25, v25, v17
    v_mfma_f32_16x16x32_bf16 v[224:227], a[32:35], v[40:43], v[224:227]
    ds_read_b64_tr_b16 a[50:51], v8 offset:33792
    v_mfma_f32_16x16x32_bf16 v[232:235], a[32:35], v[44:47], v[232:235]
    ds_read_b64_tr_b16 a[52:53], v8 offset:40960
    v_sub_f32 v26, v26, v17
    v_mfma_f32_16x16x32_bf16 v[228:231], a[36:39], v[40:43], v[228:231]
    ds_read_b64_tr_b16 a[54:55], v8 offset:41984
    v_sub_f32 v27, v27, v17
    v_mfma_f32_16x16x32_bf16 v[236:239], a[36:39], v[44:47], v[236:239]
    s_waitcnt lgkmcnt(4)
    ds_read_b64_tr_b16 a[56:57], v9 offset:32768
    v_mfma_f32_16x16x32_bf16 v[240:243], a[40:43], v[40:43], v[240:243]
    ds_read_b64_tr_b16 a[58:59], v9 offset:33792
    v_sub_f32 v28, v28, v17
    v_mfma_f32_16x16x32_bf16 v[248:251], a[40:43], v[44:47], v[248:251]
    ds_read_b64_tr_b16 a[60:61], v9 offset:40960
    v_sub_f32 v29, v29, v17
    v_mfma_f32_16x16x32_bf16 v[244:247], a[44:47], v[40:43], v[244:247]
    ds_read_b64_tr_b16 a[62:63], v9 offset:41984
    v_mfma_f32_16x16x32_bf16 v[252:255], a[44:47], v[44:47], v[252:255]
    ds_read_b64_tr_b16 a[0:1], v10 offset:32768
    v_sub_f32 v30, v30, v17
    v_mfma_f32_16x16x32_bf16 a[192:195], v[48:51], v[48:51], a[192:195]
    ds_read_b64_tr_b16 a[2:3], v10 offset:33792
    v_sub_f32 v31, v31, v17
    v_mfma_f32_16x16x32_bf16 a[196:199], v[52:55], v[52:55], a[196:199]
    s_waitcnt lgkmcnt(6)
    ds_read_b64_tr_b16 a[4:5], v10 offset:40960
    v_mfma_f32_16x16x32_bf16 v[144:147], a[48:51], v[48:51], v[144:147]
    s_waitcnt vmcnt(12)
    ds_read_b64_tr_b16 a[6:7], v10 offset:41984
    v_cvt_pk_bf16_f32 v100, v24, v25
    v_mfma_f32_16x16x32_bf16 v[152:155], a[48:51], v[52:55], v[152:155]
    s_barrier
    ds_read_b64_tr_b16 a[8:9], v11 offset:32768
    v_cvt_pk_bf16_f32 v101, v26, v27
    v_mfma_f32_16x16x32_bf16 v[148:151], a[52:55], v[48:51], v[148:151]
    s_add_u32 m0, s68, 0
    ds_read_b64_tr_b16 a[10:11], v11 offset:33792
    v_mfma_f32_16x16x32_bf16 v[156:159], a[52:55], v[52:55], v[156:159]
    s_waitcnt lgkmcnt(6)
    s_mov_b32 s72, 917504
    ds_read_b64_tr_b16 a[12:13], v11 offset:40960
    v_cvt_pk_bf16_f32 v102, v28, v29
    v_mfma_f32_16x16x32_bf16 v[160:163], a[56:59], v[48:51], v[160:163]
    ds_read_b64_tr_b16 a[14:15], v11 offset:41984
    buffer_load_dwordx4 v0, s[32:35], s72 offen offset:0 lds
    v_mfma_f32_16x16x32_bf16 v[168:171], a[56:59], v[52:55], v[168:171]
    ds_read_b64_tr_b16 a[16:17], v12 offset:32768
    v_cvt_pk_bf16_f32 v103, v30, v31
    v_mfma_f32_16x16x32_bf16 v[164:167], a[60:63], v[48:51], v[164:167]
    s_waitcnt lgkmcnt(6)
    ds_read_b64_tr_b16 a[18:19], v12 offset:33792
    v_mfma_f32_16x16x32_bf16 v[172:175], a[60:63], v[52:55], v[172:175]
    s_mov_b32 s73, 930816
    ds_read_b64_tr_b16 a[20:21], v12 offset:40960
    v_lshlrev_b32 v24, 16, v104
    v_mfma_f32_16x16x32_bf16 v[176:179], a[0:3], v[48:51], v[176:179]
    ds_read_b64_tr_b16 a[22:23], v12 offset:41984
    buffer_load_dwordx4 v0, s[32:35], s73 offen offset:1024 lds
    v_mfma_f32_16x16x32_bf16 v[184:187], a[0:3], v[52:55], v[184:187]
    s_waitcnt lgkmcnt(6)
    ds_read_b64_tr_b16 a[24:25], v13 offset:32768
    v_and_b32 v25, 4294901760, v104
    v_mfma_f32_16x16x32_bf16 v[180:183], a[4:7], v[48:51], v[180:183]
    ds_read_b64_tr_b16 a[26:27], v13 offset:33792
    v_lshlrev_b32 v26, 16, v105
    v_mfma_f32_16x16x32_bf16 v[188:191], a[4:7], v[52:55], v[188:191]
    s_add_u32 m0, s68, 8192
    ds_read_b64_tr_b16 a[28:29], v13 offset:40960
    v_mfma_f32_16x16x32_bf16 v[192:195], a[8:11], v[48:51], v[192:195]
    ds_read_b64_tr_b16 a[30:31], v13 offset:41984
    buffer_load_dwordx4 v0, s[36:39], s72 offen offset:0 lds
    v_mfma_f32_16x16x32_bf16 v[200:203], a[8:11], v[52:55], v[200:203]
    s_waitcnt lgkmcnt(6)
    ds_read_b64_tr_b16 a[32:33], v14 offset:32768
    v_and_b32 v27, 4294901760, v105
    v_mfma_f32_16x16x32_bf16 v[196:199], a[12:15], v[48:51], v[196:199]
    ds_read_b64_tr_b16 a[34:35], v14 offset:33792
    v_lshlrev_b32 v28, 16, v106
    v_mfma_f32_16x16x32_bf16 v[204:207], a[12:15], v[52:55], v[204:207]
    ds_read_b64_tr_b16 a[36:37], v14 offset:40960
    v_and_b32 v29, 4294901760, v106
    v_mfma_f32_16x16x32_bf16 v[208:211], a[16:19], v[48:51], v[208:211]
    ds_read_b64_tr_b16 a[38:39], v14 offset:41984
    buffer_load_dwordx4 v0, s[36:39], s73 offen offset:1024 lds
    v_mfma_f32_16x16x32_bf16 v[216:219], a[16:19], v[52:55], v[216:219]
    s_waitcnt lgkmcnt(6)
    v_lshlrev_b32 v30, 16, v107
    v_mfma_f32_16x16x32_bf16 v[212:215], a[20:23], v[48:51], v[212:215]
    s_add_u32 m0, s68, 16384
    v_and_b32 v31, 4294901760, v107
    v_sub_f32 v24, v24, v16
    v_mfma_f32_16x16x32_bf16 v[220:223], a[20:23], v[52:55], v[220:223]
    s_mov_b32 s74, 1032192
    ds_read_b64_tr_b16 a[40:41], v8 offset:49152
    v_sub_f32 v25, v25, v16
    v_mfma_f32_16x16x32_bf16 v[224:227], a[24:27], v[48:51], v[224:227]
    ds_read_b64_tr_b16 a[42:43], v8 offset:50176
    buffer_load_dwordx4 v0, s[32:35], s74 offen offset:0 lds
    v_mfma_f32_16x16x32_bf16 v[232:235], a[24:27], v[52:55], v[232:235]
    s_waitcnt lgkmcnt(4)
    ds_read_b64_tr_b16 a[44:45], v8 offset:57344
    v_sub_f32 v26, v26, v16
    v_mfma_f32_16x16x32_bf16 v[228:231], a[28:31], v[48:51], v[228:231]
    ds_read_b64_tr_b16 a[46:47], v8 offset:58368
    v_mfma_f32_16x16x32_bf16 v[236:239], a[28:31], v[52:55], v[236:239]
    s_mov_b32 s75, 1045504
    ds_read_b64_tr_b16 a[48:49], v9 offset:49152
    v_sub_f32 v27, v27, v16
    v_mfma_f32_16x16x32_bf16 v[240:243], a[32:35], v[48:51], v[240:243]
    ds_read_b64_tr_b16 a[50:51], v9 offset:50176
    buffer_load_dwordx4 v0, s[32:35], s75 offen offset:1024 lds
    v_mfma_f32_16x16x32_bf16 v[248:251], a[32:35], v[52:55], v[248:251]
    s_waitcnt lgkmcnt(6)
    ds_read_b64_tr_b16 a[52:53], v9 offset:57344
    v_sub_f32 v28, v28, v16
    v_mfma_f32_16x16x32_bf16 v[244:247], a[36:39], v[48:51], v[244:247]
    ds_read_b64_tr_b16 a[54:55], v9 offset:58368
    v_sub_f32 v29, v29, v16
    v_mfma_f32_16x16x32_bf16 v[252:255], a[36:39], v[52:55], v[252:255]
    s_add_u32 m0, s68, 24576
    ds_read_b64_tr_b16 a[56:57], v10 offset:49152
    v_mfma_f32_16x16x32_bf16 a[192:195], v[56:59], v[56:59], a[192:195]
    ds_read_b64_tr_b16 a[58:59], v10 offset:50176
    buffer_load_dwordx4 v0, s[36:39], s74 offen offset:0 lds
    v_mfma_f32_16x16x32_bf16 a[196:199], v[60:63], v[60:63], a[196:199]
    s_waitcnt lgkmcnt(6)
    ds_read_b64_tr_b16 a[60:61], v10 offset:57344
    v_sub_f32 v30, v30, v16
    v_mfma_f32_16x16x32_bf16 v[144:147], a[40:43], v[56:59], v[144:147]
    ds_read_b64_tr_b16 a[62:63], v10 offset:58368
    v_sub_f32 v31, v31, v16
    v_mfma_f32_16x16x32_bf16 v[152:155], a[40:43], v[60:63], v[152:155]
    ds_read_b64_tr_b16 a[0:1], v11 offset:49152
    v_cvt_pk_bf16_f32 v104, v24, v25
    v_mfma_f32_16x16x32_bf16 v[148:151], a[44:47], v[56:59], v[148:151]
    ds_read_b64_tr_b16 a[2:3], v11 offset:50176
    buffer_load_dwordx4 v0, s[36:39], s75 offen offset:1024 lds
    v_mfma_f32_16x16x32_bf16 v[156:159], a[44:47], v[60:63], v[156:159]
    s_waitcnt lgkmcnt(6)
    ds_read_b64_tr_b16 a[4:5], v11 offset:57344
    v_mfma_f32_16x16x32_bf16 v[160:163], a[48:51], v[56:59], v[160:163]
    s_mov_b32 s96, 0
    ds_read_b64_tr_b16 a[6:7], v11 offset:58368
    v_cvt_pk_bf16_f32 v105, v26, v27
    v_mfma_f32_16x16x32_bf16 v[168:171], a[48:51], v[60:63], v[168:171]
    ds_read_b64_tr_b16 a[8:9], v12 offset:49152
    buffer_load_dword v22, v21, s[40:43], s96 offen
    v_cvt_pk_bf16_f32 v106, v28, v29
    v_mfma_f32_16x16x32_bf16 v[164:167], a[52:55], v[56:59], v[164:167]
    ds_read_b64_tr_b16 a[10:11], v12 offset:50176
    v_cvt_pk_bf16_f32 v107, v30, v31
    v_mfma_f32_16x16x32_bf16 v[172:175], a[52:55], v[60:63], v[172:175]
    s_waitcnt lgkmcnt(6)
    ds_read_b64_tr_b16 a[12:13], v12 offset:57344
    v_mfma_f32_16x16x32_bf16 v[176:179], a[56:59], v[56:59], v[176:179]
    ds_read_b64_tr_b16 a[14:15], v12 offset:58368
    v_lshlrev_b32 v24, 16, v108
    v_mfma_f32_16x16x32_bf16 v[184:187], a[56:59], v[60:63], v[184:187]
    ds_read_b64_tr_b16 a[16:17], v13 offset:49152
    v_and_b32 v25, 4294901760, v108
    v_mfma_f32_16x16x32_bf16 v[180:183], a[60:63], v[56:59], v[180:183]
    ds_read_b64_tr_b16 a[18:19], v13 offset:50176
    v_mfma_f32_16x16x32_bf16 v[188:191], a[60:63], v[60:63], v[188:191]
    s_waitcnt lgkmcnt(6)
    ds_read_b64_tr_b16 a[20:21], v13 offset:57344
    v_lshlrev_b32 v26, 16, v109
    v_mfma_f32_16x16x32_bf16 v[192:195], a[0:3], v[56:59], v[192:195]
    ds_read_b64_tr_b16 a[22:23], v13 offset:58368
    v_and_b32 v27, 4294901760, v109
    v_mfma_f32_16x16x32_bf16 v[200:203], a[0:3], v[60:63], v[200:203]
    ds_read_b64_tr_b16 a[24:25], v14 offset:49152
    v_lshlrev_b32 v28, 16, v110
    v_mfma_f32_16x16x32_bf16 v[196:199], a[4:7], v[56:59], v[196:199]
    ds_read_b64_tr_b16 a[26:27], v14 offset:50176
    v_mfma_f32_16x16x32_bf16 v[204:207], a[4:7], v[60:63], v[204:207]
    s_waitcnt lgkmcnt(6)
    ds_read_b64_tr_b16 a[28:29], v14 offset:57344
    v_and_b32 v29, 4294901760, v110
    v_mfma_f32_16x16x32_bf16 v[208:211], a[8:11], v[56:59], v[208:211]
    ds_read_b64_tr_b16 a[30:31], v14 offset:58368
    v_lshlrev_b32 v30, 16, v111
    v_mfma_f32_16x16x32_bf16 v[216:219], a[8:11], v[60:63], v[216:219]
    v_and_b32 v31, 4294901760, v111
    v_sub_f32 v24, v24, v17
    v_mfma_f32_16x16x32_bf16 v[212:215], a[12:15], v[56:59], v[212:215]
    v_xor_b32 v8, 65536, v8
    v_mfma_f32_16x16x32_bf16 v[220:223], a[12:15], v[60:63], v[220:223]
    s_waitcnt lgkmcnt(4)
    ds_read_b64_tr_b16 a[32:33], v8 offset:0
    v_sub_f32 v25, v25, v17
    v_mfma_f32_16x16x32_bf16 v[224:227], a[16:19], v[56:59], v[224:227]
    ds_read_b64_tr_b16 a[34:35], v8 offset:1024
    v_sub_f32 v26, v26, v17
    v_mfma_f32_16x16x32_bf16 v[232:235], a[16:19], v[60:63], v[232:235]
    ds_read_b64_tr_b16 a[36:37], v8 offset:8192
    v_sub_f32 v27, v27, v17
    v_mfma_f32_16x16x32_bf16 v[228:231], a[20:23], v[56:59], v[228:231]
    ds_read_b64_tr_b16 a[38:39], v8 offset:9216
    v_xor_b32 v9, 65536, v9
    v_mfma_f32_16x16x32_bf16 v[236:239], a[20:23], v[60:63], v[236:239]
    s_waitcnt lgkmcnt(4)
    ds_read_b64_tr_b16 a[40:41], v9 offset:0
    v_mfma_f32_16x16x32_bf16 v[240:243], a[24:27], v[56:59], v[240:243]
    ds_read_b64_tr_b16 a[42:43], v9 offset:1024
    v_sub_f32 v28, v28, v17
    v_mfma_f32_16x16x32_bf16 v[248:251], a[24:27], v[60:63], v[248:251]
    ds_read_b64_tr_b16 a[44:45], v9 offset:8192
    v_sub_f32 v29, v29, v17
    v_mfma_f32_16x16x32_bf16 v[244:247], a[28:31], v[56:59], v[244:247]
    ds_read_b64_tr_b16 a[46:47], v9 offset:9216
    v_xor_b32 v10, 65536, v10
    v_mfma_f32_16x16x32_bf16 v[252:255], a[28:31], v[60:63], v[252:255]
    ds_read_b64_tr_b16 a[48:49], v10 offset:0
    v_sub_f32 v30, v30, v17
    v_mfma_f32_16x16x32_bf16 a[192:195], v[64:67], v[64:67], a[192:195]
    ds_read_b64_tr_b16 a[50:51], v10 offset:1024
    v_mfma_f32_16x16x32_bf16 a[196:199], v[68:71], v[68:71], a[196:199]
    s_waitcnt lgkmcnt(6)
    ds_read_b64_tr_b16 a[52:53], v10 offset:8192
    v_sub_f32 v31, v31, v17
    v_mfma_f32_16x16x32_bf16 v[144:147], a[32:35], v[64:67], v[144:147]
    s_waitcnt vmcnt(13)
    ds_read_b64_tr_b16 a[54:55], v10 offset:9216
    v_xor_b32 v11, 65536, v11
    v_mfma_f32_16x16x32_bf16 v[152:155], a[32:35], v[68:71], v[152:155]
    s_barrier
    ds_read_b64_tr_b16 a[56:57], v11 offset:0
    v_cvt_pk_bf16_f32 v108, v24, v25
    v_mfma_f32_16x16x32_bf16 v[148:151], a[36:39], v[64:67], v[148:151]
    s_add_u32 m0, s68, 32768
    ds_read_b64_tr_b16 a[58:59], v11 offset:1024
    v_cvt_pk_bf16_f32 v109, v26, v27
    v_mfma_f32_16x16x32_bf16 v[156:159], a[36:39], v[68:71], v[156:159]
    s_waitcnt lgkmcnt(6)
    s_mov_b32 s72, 1146880
    ds_read_b64_tr_b16 a[60:61], v11 offset:8192
    v_mfma_f32_16x16x32_bf16 v[160:163], a[40:43], v[64:67], v[160:163]
    ds_read_b64_tr_b16 a[62:63], v11 offset:9216
    v_xor_b32 v12, 65536, v12
    v_mfma_f32_16x16x32_bf16 v[168:171], a[40:43], v[68:71], v[168:171]
    ds_read_b64_tr_b16 a[0:1], v12 offset:0
    buffer_load_dwordx4 v0, s[32:35], s72 offen offset:0 lds
    v_mfma_f32_16x16x32_bf16 v[164:167], a[44:47], v[64:67], v[164:167]
    s_waitcnt lgkmcnt(6)
    ds_read_b64_tr_b16 a[2:3], v12 offset:1024
    v_cvt_pk_bf16_f32 v110, v28, v29
    v_mfma_f32_16x16x32_bf16 v[172:175], a[44:47], v[68:71], v[172:175]
    s_mov_b32 s73, 1160192
    ds_read_b64_tr_b16 a[4:5], v12 offset:8192
    v_cvt_pk_bf16_f32 v111, v30, v31
    v_mfma_f32_16x16x32_bf16 v[176:179], a[48:51], v[64:67], v[176:179]
    ds_read_b64_tr_b16 a[6:7], v12 offset:9216
    v_xor_b32 v13, 65536, v13
    v_mfma_f32_16x16x32_bf16 v[184:187], a[48:51], v[68:71], v[184:187]
    s_waitcnt lgkmcnt(6)
    ds_read_b64_tr_b16 a[8:9], v13 offset:0
    buffer_load_dwordx4 v0, s[32:35], s73 offen offset:1024 lds
    v_mfma_f32_16x16x32_bf16 v[180:183], a[52:55], v[64:67], v[180:183]
    ds_read_b64_tr_b16 a[10:11], v13 offset:1024
    v_mfma_f32_16x16x32_bf16 v[188:191], a[52:55], v[68:71], v[188:191]
    s_add_u32 m0, s68, 40960
    ds_read_b64_tr_b16 a[12:13], v13 offset:8192
    v_lshlrev_b32 v24, 16, v112
    v_mfma_f32_16x16x32_bf16 v[192:195], a[56:59], v[64:67], v[192:195]
    ds_read_b64_tr_b16 a[14:15], v13 offset:9216
    v_xor_b32 v14, 65536, v14
    v_mfma_f32_16x16x32_bf16 v[200:203], a[56:59], v[68:71], v[200:203]
    s_waitcnt lgkmcnt(6)
    ds_read_b64_tr_b16 a[16:17], v14 offset:0
    buffer_load_dwordx4 v0, s[36:39], s72 offen offset:0 lds
    v_mfma_f32_16x16x32_bf16 v[196:199], a[60:63], v[64:67], v[196:199]
    ds_read_b64_tr_b16 a[18:19], v14 offset:1024
    v_and_b32 v25, 4294901760, v112
    v_mfma_f32_16x16x32_bf16 v[204:207], a[60:63], v[68:71], v[204:207]
    ds_read_b64_tr_b16 a[20:21], v14 offset:8192
    v_mfma_f32_16x16x32_bf16 v[208:211], a[0:3], v[64:67], v[208:211]
    ds_read_b64_tr_b16 a[22:23], v14 offset:9216
    buffer_load_dwordx4 v0, s[36:39], s73 offen offset:1024 lds
    v_mfma_f32_16x16x32_bf16 v[216:219], a[0:3], v[68:71], v[216:219]
    s_waitcnt lgkmcnt(6)
    v_lshlrev_b32 v26, 16, v113
    v_and_b32 v27, 4294901760, v113
    v_mfma_f32_16x16x32_bf16 v[212:215], a[4:7], v[64:67], v[212:215]
    s_add_u32 m0, s68, 49152
    v_lshlrev_b32 v28, 16, v114
    v_and_b32 v29, 4294901760, v114
    v_mfma_f32_16x16x32_bf16 v[220:223], a[4:7], v[68:71], v[220:223]
    s_mov_b32 s74, 1261568
    ds_read_b64_tr_b16 a[24:25], v8 offset:16384
    v_mfma_f32_16x16x32_bf16 v[224:227], a[8:11], v[64:67], v[224:227]
    ds_read_b64_tr_b16 a[26:27], v8 offset:17408
    buffer_load_dwordx4 v0, s[32:35], s74 offen offset:0 lds
    v_mfma_f32_16x16x32_bf16 v[232:235], a[8:11], v[68:71], v[232:235]
    s_waitcnt lgkmcnt(4)
    ds_read_b64_tr_b16 a[28:29], v8 offset:24576
    v_lshlrev_b32 v30, 16, v115
    v_mfma_f32_16x16x32_bf16 v[228:231], a[12:15], v[64:67], v[228:231]
    ds_read_b64_tr_b16 a[30:31], v8 offset:25600
    v_and_b32 v31, 4294901760, v115
    v_mfma_f32_16x16x32_bf16 v[236:239], a[12:15], v[68:71], v[236:239]
    s_mov_b32 s75, 1274880
    ds_read_b64_tr_b16 a[32:33], v9 offset:16384
    v_mfma_f32_16x16x32_bf16 v[240:243], a[16:19], v[64:67], v[240:243]
    ds_read_b64_tr_b16 a[34:35], v9 offset:17408
    buffer_load_dwordx4 v0, s[32:35], s75 offen offset:1024 lds
    v_mfma_f32_16x16x32_bf16 v[248:251], a[16:19], v[68:71], v[248:251]
    s_waitcnt lgkmcnt(6)
    ds_read_b64_tr_b16 a[36:37], v9 offset:24576
    v_sub_f32 v24, v24, v16
    v_mfma_f32_16x16x32_bf16 v[244:247], a[20:23], v[64:67], v[244:247]
    ds_read_b64_tr_b16 a[38:39], v9 offset:25600
    v_sub_f32 v25, v25, v16
    v_mfma_f32_16x16x32_bf16 v[252:255], a[20:23], v[68:71], v[252:255]
    s_add_u32 m0, s68, 57344
    ds_read_b64_tr_b16 a[40:41], v10 offset:16384
    v_mfma_f32_16x16x32_bf16 a[192:195], v[72:75], v[72:75], a[192:195]
    ds_read_b64_tr_b16 a[42:43], v10 offset:17408
    buffer_load_dwordx4 v0, s[36:39], s74 offen offset:0 lds
    v_mfma_f32_16x16x32_bf16 a[196:199], v[76:79], v[76:79], a[196:199]
    s_waitcnt lgkmcnt(6)
    ds_read_b64_tr_b16 a[44:45], v10 offset:24576
    v_sub_f32 v26, v26, v16
    v_mfma_f32_16x16x32_bf16 v[144:147], a[24:27], v[72:75], v[144:147]
    ds_read_b64_tr_b16 a[46:47], v10 offset:25600
    v_sub_f32 v27, v27, v16
    v_mfma_f32_16x16x32_bf16 v[152:155], a[24:27], v[76:79], v[152:155]
    ds_read_b64_tr_b16 a[48:49], v11 offset:16384
    v_mfma_f32_16x16x32_bf16 v[148:151], a[28:31], v[72:75], v[148:151]
    ds_read_b64_tr_b16 a[50:51], v11 offset:17408
    buffer_load_dwordx4 v0, s[36:39], s75 offen offset:1024 lds
    v_mfma_f32_16x16x32_bf16 v[156:159], a[28:31], v[76:79], v[156:159]
    s_waitcnt lgkmcnt(6)
    ds_read_b64_tr_b16 a[52:53], v11 offset:24576
    v_sub_f32 v28, v28, v16
    v_mfma_f32_16x16x32_bf16 v[160:163], a[32:35], v[72:75], v[160:163]
    s_mov_b32 s96, 1835008
    ds_read_b64_tr_b16 a[54:55], v11 offset:25600
    v_sub_f32 v29, v29, v16
    v_mfma_f32_16x16x32_bf16 v[168:171], a[32:35], v[76:79], v[168:171]
    ds_read_b64_tr_b16 a[56:57], v12 offset:16384
    buffer_load_dword v22, v21, s[40:43], s96 offen
    v_mfma_f32_16x16x32_bf16 v[164:167], a[36:39], v[72:75], v[164:167]
    ds_read_b64_tr_b16 a[58:59], v12 offset:17408
    v_sub_f32 v30, v30, v16
    v_mfma_f32_16x16x32_bf16 v[172:175], a[36:39], v[76:79], v[172:175]
    s_waitcnt lgkmcnt(6)
    ds_read_b64_tr_b16 a[60:61], v12 offset:24576
    v_sub_f32 v31, v31, v16
    v_mfma_f32_16x16x32_bf16 v[176:179], a[40:43], v[72:75], v[176:179]
    ds_read_b64_tr_b16 a[62:63], v12 offset:25600
    v_mfma_f32_16x16x32_bf16 v[184:187], a[40:43], v[76:79], v[184:187]
    ds_read_b64_tr_b16 a[0:1], v13 offset:16384
    v_cvt_pk_bf16_f32 v112, v24, v25
    v_mfma_f32_16x16x32_bf16 v[180:183], a[44:47], v[72:75], v[180:183]
    ds_read_b64_tr_b16 a[2:3], v13 offset:17408
    v_cvt_pk_bf16_f32 v113, v26, v27
    v_mfma_f32_16x16x32_bf16 v[188:191], a[44:47], v[76:79], v[188:191]
    s_waitcnt lgkmcnt(6)
    ds_read_b64_tr_b16 a[4:5], v13 offset:24576
    v_mfma_f32_16x16x32_bf16 v[192:195], a[48:51], v[72:75], v[192:195]
    ds_read_b64_tr_b16 a[6:7], v13 offset:25600
    v_cvt_pk_bf16_f32 v114, v28, v29
    v_mfma_f32_16x16x32_bf16 v[200:203], a[48:51], v[76:79], v[200:203]
    ds_read_b64_tr_b16 a[8:9], v14 offset:16384
    v_cvt_pk_bf16_f32 v115, v30, v31
    v_mfma_f32_16x16x32_bf16 v[196:199], a[52:55], v[72:75], v[196:199]
    ds_read_b64_tr_b16 a[10:11], v14 offset:17408
    v_mfma_f32_16x16x32_bf16 v[204:207], a[52:55], v[76:79], v[204:207]
    s_waitcnt lgkmcnt(6)
    ds_read_b64_tr_b16 a[12:13], v14 offset:24576
    v_lshlrev_b32 v24, 16, v116
    v_mfma_f32_16x16x32_bf16 v[208:211], a[56:59], v[72:75], v[208:211]
    ds_read_b64_tr_b16 a[14:15], v14 offset:25600
    v_and_b32 v25, 4294901760, v116
    v_mfma_f32_16x16x32_bf16 v[216:219], a[56:59], v[76:79], v[216:219]
    v_lshlrev_b32 v26, 16, v117
    v_mfma_f32_16x16x32_bf16 v[212:215], a[60:63], v[72:75], v[212:215]
    v_and_b32 v27, 4294901760, v117
    v_lshlrev_b32 v28, 16, v118
    v_mfma_f32_16x16x32_bf16 v[220:223], a[60:63], v[76:79], v[220:223]
    s_waitcnt lgkmcnt(4)
    ds_read_b64_tr_b16 a[16:17], v8 offset:32768
    v_and_b32 v29, 4294901760, v118
    v_mfma_f32_16x16x32_bf16 v[224:227], a[0:3], v[72:75], v[224:227]
    ds_read_b64_tr_b16 a[18:19], v8 offset:33792
    v_mfma_f32_16x16x32_bf16 v[232:235], a[0:3], v[76:79], v[232:235]
    ds_read_b64_tr_b16 a[20:21], v8 offset:40960
    v_lshlrev_b32 v30, 16, v119
    v_mfma_f32_16x16x32_bf16 v[228:231], a[4:7], v[72:75], v[228:231]
    ds_read_b64_tr_b16 a[22:23], v8 offset:41984
    v_and_b32 v31, 4294901760, v119
    v_mfma_f32_16x16x32_bf16 v[236:239], a[4:7], v[76:79], v[236:239]
    s_waitcnt lgkmcnt(4)
    ds_read_b64_tr_b16 a[24:25], v9 offset:32768
    v_mfma_f32_16x16x32_bf16 v[240:243], a[8:11], v[72:75], v[240:243]
    ds_read_b64_tr_b16 a[26:27], v9 offset:33792
    v_sub_f32 v24, v24, v17
    v_mfma_f32_16x16x32_bf16 v[248:251], a[8:11], v[76:79], v[248:251]
    ds_read_b64_tr_b16 a[28:29], v9 offset:40960
    v_sub_f32 v25, v25, v17
    v_mfma_f32_16x16x32_bf16 v[244:247], a[12:15], v[72:75], v[244:247]
    ds_read_b64_tr_b16 a[30:31], v9 offset:41984
    v_mfma_f32_16x16x32_bf16 v[252:255], a[12:15], v[76:79], v[252:255]
    ds_read_b64_tr_b16 a[32:33], v10 offset:32768
    v_sub_f32 v26, v26, v17
    v_mfma_f32_16x16x32_bf16 a[192:195], v[80:83], v[80:83], a[192:195]
    ds_read_b64_tr_b16 a[34:35], v10 offset:33792
    v_sub_f32 v27, v27, v17
    v_mfma_f32_16x16x32_bf16 a[196:199], v[84:87], v[84:87], a[196:199]
    s_waitcnt lgkmcnt(6)
    ds_read_b64_tr_b16 a[36:37], v10 offset:40960
    v_mfma_f32_16x16x32_bf16 v[144:147], a[16:19], v[80:83], v[144:147]
    s_waitcnt vmcnt(14)
    ds_read_b64_tr_b16 a[38:39], v10 offset:41984
    v_sub_f32 v28, v28, v17
    v_mfma_f32_16x16x32_bf16 v[152:155], a[16:19], v[84:87], v[152:155]
    s_barrier
    ds_read_b64_tr_b16 a[40:41], v11 offset:32768
    v_sub_f32 v29, v29, v17
    v_mfma_f32_16x16x32_bf16 v[148:151], a[20:23], v[80:83], v[148:151]
    s_add_u32 m0, s68, 65536
    ds_read_b64_tr_b16 a[42:43], v11 offset:33792
    v_mfma_f32_16x16x32_bf16 v[156:159], a[20:23], v[84:87], v[156:159]
    s_waitcnt lgkmcnt(6)
    s_mov_b32 s72, 1376256
    ds_read_b64_tr_b16 a[44:45], v11 offset:40960
    v_sub_f32 v30, v30, v17
    v_mfma_f32_16x16x32_bf16 v[160:163], a[24:27], v[80:83], v[160:163]
    ds_read_b64_tr_b16 a[46:47], v11 offset:41984
    buffer_load_dwordx4 v0, s[32:35], s72 offen offset:0 lds
    v_mfma_f32_16x16x32_bf16 v[168:171], a[24:27], v[84:87], v[168:171]
    ds_read_b64_tr_b16 a[48:49], v12 offset:32768
    v_sub_f32 v31, v31, v17
    v_mfma_f32_16x16x32_bf16 v[164:167], a[28:31], v[80:83], v[164:167]
    s_waitcnt lgkmcnt(6)
    ds_read_b64_tr_b16 a[50:51], v12 offset:33792
    v_mfma_f32_16x16x32_bf16 v[172:175], a[28:31], v[84:87], v[172:175]
    s_mov_b32 s73, 1389568
    ds_read_b64_tr_b16 a[52:53], v12 offset:40960
    v_cvt_pk_bf16_f32 v116, v24, v25
    v_mfma_f32_16x16x32_bf16 v[176:179], a[32:35], v[80:83], v[176:179]
    ds_read_b64_tr_b16 a[54:55], v12 offset:41984
    buffer_load_dwordx4 v0, s[32:35], s73 offen offset:1024 lds
    v_mfma_f32_16x16x32_bf16 v[184:187], a[32:35], v[84:87], v[184:187]
    s_waitcnt lgkmcnt(6)
    ds_read_b64_tr_b16 a[56:57], v13 offset:32768
    v_cvt_pk_bf16_f32 v117, v26, v27
    v_mfma_f32_16x16x32_bf16 v[180:183], a[36:39], v[80:83], v[180:183]
    ds_read_b64_tr_b16 a[58:59], v13 offset:33792
    v_mfma_f32_16x16x32_bf16 v[188:191], a[36:39], v[84:87], v[188:191]
    s_add_u32 m0, s68, 73728
    ds_read_b64_tr_b16 a[60:61], v13 offset:40960
    v_cvt_pk_bf16_f32 v118, v28, v29
    v_mfma_f32_16x16x32_bf16 v[192:195], a[40:43], v[80:83], v[192:195]
    ds_read_b64_tr_b16 a[62:63], v13 offset:41984
    buffer_load_dwordx4 v0, s[36:39], s72 offen offset:0 lds
    v_mfma_f32_16x16x32_bf16 v[200:203], a[40:43], v[84:87], v[200:203]
    s_waitcnt lgkmcnt(6)
    ds_read_b64_tr_b16 a[0:1], v14 offset:32768
    v_cvt_pk_bf16_f32 v119, v30, v31
    v_mfma_f32_16x16x32_bf16 v[196:199], a[44:47], v[80:83], v[196:199]
    ds_read_b64_tr_b16 a[2:3], v14 offset:33792
    v_mfma_f32_16x16x32_bf16 v[204:207], a[44:47], v[84:87], v[204:207]
    ds_read_b64_tr_b16 a[4:5], v14 offset:40960
    v_lshlrev_b32 v24, 16, v120
    v_mfma_f32_16x16x32_bf16 v[208:211], a[48:51], v[80:83], v[208:211]
    ds_read_b64_tr_b16 a[6:7], v14 offset:41984
    buffer_load_dwordx4 v0, s[36:39], s73 offen offset:1024 lds
    v_mfma_f32_16x16x32_bf16 v[216:219], a[48:51], v[84:87], v[216:219]
    s_waitcnt lgkmcnt(6)
    v_and_b32 v25, 4294901760, v120
    v_lshlrev_b32 v26, 16, v121
    v_mfma_f32_16x16x32_bf16 v[212:215], a[52:55], v[80:83], v[212:215]
    s_add_u32 m0, s68, 81920
    v_and_b32 v27, 4294901760, v121
    v_lshlrev_b32 v28, 16, v122
    v_mfma_f32_16x16x32_bf16 v[220:223], a[52:55], v[84:87], v[220:223]
    s_mov_b32 s74, 1490944
    ds_read_b64_tr_b16 a[8:9], v8 offset:49152
    v_mfma_f32_16x16x32_bf16 v[224:227], a[56:59], v[80:83], v[224:227]
    ds_read_b64_tr_b16 a[10:11], v8 offset:50176
    buffer_load_dwordx4 v0, s[32:35], s74 offen offset:0 lds
    v_mfma_f32_16x16x32_bf16 v[232:235], a[56:59], v[84:87], v[232:235]
    s_waitcnt lgkmcnt(4)
    ds_read_b64_tr_b16 a[12:13], v8 offset:57344
    v_and_b32 v29, 4294901760, v122
    v_mfma_f32_16x16x32_bf16 v[228:231], a[60:63], v[80:83], v[228:231]
    ds_read_b64_tr_b16 a[14:15], v8 offset:58368
    v_lshlrev_b32 v30, 16, v123
    v_mfma_f32_16x16x32_bf16 v[236:239], a[60:63], v[84:87], v[236:239]
    s_mov_b32 s75, 1504256
    ds_read_b64_tr_b16 a[16:17], v9 offset:49152
    v_and_b32 v31, 4294901760, v123
    v_mfma_f32_16x16x32_bf16 v[240:243], a[0:3], v[80:83], v[240:243]
    ds_read_b64_tr_b16 a[18:19], v9 offset:50176
    buffer_load_dwordx4 v0, s[32:35], s75 offen offset:1024 lds
    v_mfma_f32_16x16x32_bf16 v[248:251], a[0:3], v[84:87], v[248:251]
    s_waitcnt lgkmcnt(6)
    ds_read_b64_tr_b16 a[20:21], v9 offset:57344
    v_mfma_f32_16x16x32_bf16 v[244:247], a[4:7], v[80:83], v[244:247]
    ds_read_b64_tr_b16 a[22:23], v9 offset:58368
    v_sub_f32 v24, v24, v16
    v_mfma_f32_16x16x32_bf16 v[252:255], a[4:7], v[84:87], v[252:255]
    s_add_u32 m0, s68, 90112
    ds_read_b64_tr_b16 a[24:25], v10 offset:49152
    v_sub_f32 v25, v25, v16
    v_mfma_f32_16x16x32_bf16 a[192:195], v[88:91], v[88:91], a[192:195]
    ds_read_b64_tr_b16 a[26:27], v10 offset:50176
    buffer_load_dwordx4 v0, s[36:39], s74 offen offset:0 lds
    v_mfma_f32_16x16x32_bf16 a[196:199], v[92:95], v[92:95], a[196:199]
    s_waitcnt lgkmcnt(6)
    ds_read_b64_tr_b16 a[28:29], v10 offset:57344
    v_sub_f32 v26, v26, v16
    v_mfma_f32_16x16x32_bf16 v[144:147], a[8:11], v[88:91], v[144:147]
    ds_read_b64_tr_b16 a[30:31], v10 offset:58368
    v_mfma_f32_16x16x32_bf16 v[152:155], a[8:11], v[92:95], v[152:155]
    ds_read_b64_tr_b16 a[32:33], v11 offset:49152
    v_sub_f32 v27, v27, v16
    v_mfma_f32_16x16x32_bf16 v[148:151], a[12:15], v[88:91], v[148:151]
    ds_read_b64_tr_b16 a[34:35], v11 offset:50176
    buffer_load_dwordx4 v0, s[36:39], s75 offen offset:1024 lds
    v_mfma_f32_16x16x32_bf16 v[156:159], a[12:15], v[92:95], v[156:159]
    s_waitcnt lgkmcnt(6)
    ds_read_b64_tr_b16 a[36:37], v11 offset:57344
    v_sub_f32 v28, v28, v16
    v_mfma_f32_16x16x32_bf16 v[160:163], a[16:19], v[88:91], v[160:163]
    s_mov_b32 s96, 0
    ds_read_b64_tr_b16 a[38:39], v11 offset:58368
    v_sub_f32 v29, v29, v16
    v_mfma_f32_16x16x32_bf16 v[168:171], a[16:19], v[92:95], v[168:171]
    ds_read_b64_tr_b16 a[40:41], v12 offset:49152
    buffer_load_dword v22, v23, s[44:47], s96 offen
    v_mfma_f32_16x16x32_bf16 v[164:167], a[20:23], v[88:91], v[164:167]
    s_waitcnt lgkmcnt(6)
    ds_read_b64_tr_b16 a[42:43], v12 offset:50176
    v_sub_f32 v30, v30, v16
    v_mfma_f32_16x16x32_bf16 v[172:175], a[20:23], v[92:95], v[172:175]
    s_mov_b32 s96, 65536
    ds_read_b64_tr_b16 a[44:45], v12 offset:57344
    v_sub_f32 v31, v31, v16
    v_mfma_f32_16x16x32_bf16 v[176:179], a[24:27], v[88:91], v[176:179]
    ds_read_b64_tr_b16 a[46:47], v12 offset:58368
    buffer_load_dword v22, v23, s[44:47], s96 offen
    v_cvt_pk_bf16_f32 v120, v24, v25
    v_mfma_f32_16x16x32_bf16 v[184:187], a[24:27], v[92:95], v[184:187]
    s_waitcnt lgkmcnt(6)
    ds_read_b64_tr_b16 a[48:49], v13 offset:49152
    v_mfma_f32_16x16x32_bf16 v[180:183], a[28:31], v[88:91], v[180:183]
    ds_read_b64_tr_b16 a[50:51], v13 offset:50176
    v_cvt_pk_bf16_f32 v121, v26, v27
    v_mfma_f32_16x16x32_bf16 v[188:191], a[28:31], v[92:95], v[188:191]
    ds_read_b64_tr_b16 a[52:53], v13 offset:57344
    v_cvt_pk_bf16_f32 v122, v28, v29
    v_mfma_f32_16x16x32_bf16 v[192:195], a[32:35], v[88:91], v[192:195]
    ds_read_b64_tr_b16 a[54:55], v13 offset:58368
    v_cvt_pk_bf16_f32 v123, v30, v31
    v_mfma_f32_16x16x32_bf16 v[200:203], a[32:35], v[92:95], v[200:203]
    s_waitcnt lgkmcnt(6)
    ds_read_b64_tr_b16 a[56:57], v14 offset:49152
    v_mfma_f32_16x16x32_bf16 v[196:199], a[36:39], v[88:91], v[196:199]
    ds_read_b64_tr_b16 a[58:59], v14 offset:50176
    v_lshlrev_b32 v24, 16, v124
    v_mfma_f32_16x16x32_bf16 v[204:207], a[36:39], v[92:95], v[204:207]
    ds_read_b64_tr_b16 a[60:61], v14 offset:57344
    v_and_b32 v25, 4294901760, v124
    v_mfma_f32_16x16x32_bf16 v[208:211], a[40:43], v[88:91], v[208:211]
    ds_read_b64_tr_b16 a[62:63], v14 offset:58368
    v_lshlrev_b32 v26, 16, v125
    v_mfma_f32_16x16x32_bf16 v[216:219], a[40:43], v[92:95], v[216:219]
    s_waitcnt lgkmcnt(6)
    v_and_b32 v27, 4294901760, v125
    v_mfma_f32_16x16x32_bf16 v[212:215], a[44:47], v[88:91], v[212:215]
    v_xor_b32 v8, 65536, v8
    v_lshlrev_b32 v28, 16, v126
    v_mfma_f32_16x16x32_bf16 v[220:223], a[44:47], v[92:95], v[220:223]
    ds_read_b64_tr_b16 a[0:1], v8 offset:0
    v_and_b32 v29, 4294901760, v126
    v_mfma_f32_16x16x32_bf16 v[224:227], a[48:51], v[88:91], v[224:227]
    ds_read_b64_tr_b16 a[2:3], v8 offset:1024
    v_lshlrev_b32 v30, 16, v127
    v_mfma_f32_16x16x32_bf16 v[232:235], a[48:51], v[92:95], v[232:235]
    s_waitcnt lgkmcnt(4)
    ds_read_b64_tr_b16 a[4:5], v8 offset:8192
    v_mfma_f32_16x16x32_bf16 v[228:231], a[52:55], v[88:91], v[228:231]
    ds_read_b64_tr_b16 a[6:7], v8 offset:9216
    v_xor_b32 v9, 65536, v9
    v_mfma_f32_16x16x32_bf16 v[236:239], a[52:55], v[92:95], v[236:239]
    ds_read_b64_tr_b16 a[8:9], v9 offset:0
    v_and_b32 v31, 4294901760, v127
    v_mfma_f32_16x16x32_bf16 v[240:243], a[56:59], v[88:91], v[240:243]
    ds_read_b64_tr_b16 a[10:11], v9 offset:1024
    v_sub_f32 v24, v24, v17
    v_mfma_f32_16x16x32_bf16 v[248:251], a[56:59], v[92:95], v[248:251]
    s_waitcnt lgkmcnt(6)
    ds_read_b64_tr_b16 a[12:13], v9 offset:8192
    v_sub_f32 v25, v25, v17
    v_mfma_f32_16x16x32_bf16 v[244:247], a[60:63], v[88:91], v[244:247]
    ds_read_b64_tr_b16 a[14:15], v9 offset:9216
    v_xor_b32 v10, 65536, v10
    v_mfma_f32_16x16x32_bf16 v[252:255], a[60:63], v[92:95], v[252:255]
    ds_read_b64_tr_b16 a[16:17], v10 offset:0
    v_mfma_f32_16x16x32_bf16 a[192:195], v[96:99], v[96:99], a[192:195]
    ds_read_b64_tr_b16 a[18:19], v10 offset:1024
    v_sub_f32 v26, v26, v17
    v_mfma_f32_16x16x32_bf16 a[196:199], v[100:103], v[100:103], a[196:199]
    s_waitcnt lgkmcnt(6)
    ds_read_b64_tr_b16 a[20:21], v10 offset:8192
    v_sub_f32 v27, v27, v17
    v_mfma_f32_16x16x32_bf16 v[144:147], a[0:3], v[96:99], v[144:147]
    s_waitcnt vmcnt(15)
    ds_read_b64_tr_b16 a[22:23], v10 offset:9216
    v_xor_b32 v11, 65536, v11
    v_mfma_f32_16x16x32_bf16 v[152:155], a[0:3], v[100:103], v[152:155]
    s_barrier
    ds_read_b64_tr_b16 a[24:25], v11 offset:0
    v_sub_f32 v28, v28, v17
    v_mfma_f32_16x16x32_bf16 v[148:151], a[4:7], v[96:99], v[148:151]
    s_add_u32 m0, s69, 98304
    ds_read_b64_tr_b16 a[26:27], v11 offset:1024
    v_mfma_f32_16x16x32_bf16 v[156:159], a[4:7], v[100:103], v[156:159]
    s_waitcnt lgkmcnt(6)
    s_mov_b32 s72, 0
    ds_read_b64_tr_b16 a[28:29], v11 offset:8192
    v_sub_f32 v29, v29, v17
    v_mfma_f32_16x16x32_bf16 v[160:163], a[8:11], v[96:99], v[160:163]
    ds_read_b64_tr_b16 a[30:31], v11 offset:9216
    v_xor_b32 v12, 65536, v12
    v_mfma_f32_16x16x32_bf16 v[168:171], a[8:11], v[100:103], v[168:171]
    ds_read_b64_tr_b16 a[32:33], v12 offset:0
    buffer_load_dwordx4 v1, s[40:43], s72 offen offset:0 lds
    v_mfma_f32_16x16x32_bf16 v[164:167], a[12:15], v[96:99], v[164:167]
    s_waitcnt lgkmcnt(6)
    ds_read_b64_tr_b16 a[34:35], v12 offset:1024
    v_sub_f32 v30, v30, v17
    v_mfma_f32_16x16x32_bf16 v[172:175], a[12:15], v[100:103], v[172:175]
    s_mov_b32 s73, 31744
    ds_read_b64_tr_b16 a[36:37], v12 offset:8192
    v_sub_f32 v31, v31, v17
    v_mfma_f32_16x16x32_bf16 v[176:179], a[16:19], v[96:99], v[176:179]
    ds_read_b64_tr_b16 a[38:39], v12 offset:9216
    v_xor_b32 v13, 65536, v13
    v_mfma_f32_16x16x32_bf16 v[184:187], a[16:19], v[100:103], v[184:187]
    s_waitcnt lgkmcnt(6)
    ds_read_b64_tr_b16 a[40:41], v13 offset:0
    buffer_load_dwordx4 v1, s[40:43], s73 offen offset:1024 lds
    v_mfma_f32_16x16x32_bf16 v[180:183], a[20:23], v[96:99], v[180:183]
    s_add_u32 m0, s69, 102400
    ds_read_b64_tr_b16 a[42:43], v13 offset:1024
    v_mfma_f32_16x16x32_bf16 v[188:191], a[20:23], v[100:103], v[188:191]
    s_mov_b32 s74, 131072
    ds_read_b64_tr_b16 a[44:45], v13 offset:8192
    v_cvt_pk_bf16_f32 v124, v24, v25
    v_mfma_f32_16x16x32_bf16 v[192:195], a[24:27], v[96:99], v[192:195]
    ds_read_b64_tr_b16 a[46:47], v13 offset:9216
    v_xor_b32 v14, 65536, v14
    v_mfma_f32_16x16x32_bf16 v[200:203], a[24:27], v[100:103], v[200:203]
    s_waitcnt lgkmcnt(6)
    ds_read_b64_tr_b16 a[48:49], v14 offset:0
    buffer_load_dwordx4 v1, s[40:43], s74 offen offset:0 lds
    v_mfma_f32_16x16x32_bf16 v[196:199], a[28:31], v[96:99], v[196:199]
    ds_read_b64_tr_b16 a[50:51], v14 offset:1024
    v_cvt_pk_bf16_f32 v125, v26, v27
    v_mfma_f32_16x16x32_bf16 v[204:207], a[28:31], v[100:103], v[204:207]
    s_mov_b32 s75, 162816
    ds_read_b64_tr_b16 a[52:53], v14 offset:8192
    v_cvt_pk_bf16_f32 v126, v28, v29
    v_mfma_f32_16x16x32_bf16 v[208:211], a[32:35], v[96:99], v[208:211]
    ds_read_b64_tr_b16 a[54:55], v14 offset:9216
    buffer_load_dwordx4 v1, s[40:43], s75 offen offset:1024 lds
    v_mfma_f32_16x16x32_bf16 v[216:219], a[32:35], v[100:103], v[216:219]
    s_waitcnt lgkmcnt(6)
    v_cvt_pk_bf16_f32 v127, v30, v31
    v_mfma_f32_16x16x32_bf16 v[212:215], a[36:39], v[96:99], v[212:215]
    s_add_u32 m0, s69, 114688
    v_lshlrev_b32 v24, 16, v128
    v_and_b32 v25, 4294901760, v128
    v_mfma_f32_16x16x32_bf16 v[220:223], a[36:39], v[100:103], v[220:223]
    s_mov_b32 s72, 524288
    ds_read_b64_tr_b16 a[56:57], v8 offset:16384
    v_lshlrev_b32 v26, 16, v129
    v_mfma_f32_16x16x32_bf16 v[224:227], a[40:43], v[96:99], v[224:227]
    ds_read_b64_tr_b16 a[58:59], v8 offset:17408
    buffer_load_dwordx4 v1, s[40:43], s72 offen offset:0 lds
    v_mfma_f32_16x16x32_bf16 v[232:235], a[40:43], v[100:103], v[232:235]
    s_waitcnt lgkmcnt(4)
    ds_read_b64_tr_b16 a[60:61], v8 offset:24576
    v_mfma_f32_16x16x32_bf16 v[228:231], a[44:47], v[96:99], v[228:231]
    ds_read_b64_tr_b16 a[62:63], v8 offset:25600
    v_and_b32 v27, 4294901760, v129
    v_mfma_f32_16x16x32_bf16 v[236:239], a[44:47], v[100:103], v[236:239]
    s_mov_b32 s73, 556032
    ds_read_b64_tr_b16 a[0:1], v9 offset:16384
    v_lshlrev_b32 v28, 16, v130
    v_mfma_f32_16x16x32_bf16 v[240:243], a[48:51], v[96:99], v[240:243]
    ds_read_b64_tr_b16 a[2:3], v9 offset:17408
    buffer_load_dwordx4 v1, s[40:43], s73 offen offset:1024 lds
    v_mfma_f32_16x16x32_bf16 v[248:251], a[48:51], v[100:103], v[248:251]
    s_waitcnt lgkmcnt(6)
    ds_read_b64_tr_b16 a[4:5], v9 offset:24576
    v_mfma_f32_16x16x32_bf16 v[244:247], a[52:55], v[96:99], v[244:247]
    s_add_u32 m0, s69, 118784
    ds_read_b64_tr_b16 a[6:7], v9 offset:25600
    v_and_b32 v29, 4294901760, v130
    v_mfma_f32_16x16x32_bf16 v[252:255], a[52:55], v[100:103], v[252:255]
    s_mov_b32 s74, 655360
    ds_read_b64_tr_b16 a[8:9], v10 offset:16384
    v_lshlrev_b32 v30, 16, v131
    v_mfma_f32_16x16x32_bf16 a[192:195], v[104:107], v[104:107], a[192:195]
    ds_read_b64_tr_b16 a[10:11], v10 offset:17408
    buffer_load_dwordx4 v1, s[40:43], s74 offen offset:0 lds
    v_mfma_f32_16x16x32_bf16 a[196:199], v[108:111], v[108:111], a[196:199]
    s_waitcnt lgkmcnt(6)
    ds_read_b64_tr_b16 a[12:13], v10 offset:24576
    v_mfma_f32_16x16x32_bf16 v[144:147], a[56:59], v[104:107], v[144:147]
    ds_read_b64_tr_b16 a[14:15], v10 offset:25600
    v_and_b32 v31, 4294901760, v131
    v_mfma_f32_16x16x32_bf16 v[152:155], a[56:59], v[108:111], v[152:155]
    s_mov_b32 s75, 687104
    ds_read_b64_tr_b16 a[16:17], v11 offset:16384
    v_mfma_f32_16x16x32_bf16 v[148:151], a[60:63], v[104:107], v[148:151]
    ds_read_b64_tr_b16 a[18:19], v11 offset:17408
    buffer_load_dwordx4 v1, s[40:43], s75 offen offset:1024 lds
    v_mfma_f32_16x16x32_bf16 v[156:159], a[60:63], v[108:111], v[156:159]
    s_waitcnt lgkmcnt(6)
    ds_read_b64_tr_b16 a[20:21], v11 offset:24576
    v_sub_f32 v24, v24, v16
    v_mfma_f32_16x16x32_bf16 v[160:163], a[0:3], v[104:107], v[160:163]
    s_mov_b32 s96, 256
    ds_read_b64_tr_b16 a[22:23], v11 offset:25600
    v_sub_f32 v25, v25, v16
    v_mfma_f32_16x16x32_bf16 v[168:171], a[0:3], v[108:111], v[168:171]
    ds_read_b64_tr_b16 a[24:25], v12 offset:16384
    buffer_load_dword v22, v21, s[40:43], s96 offen
    v_mfma_f32_16x16x32_bf16 v[164:167], a[4:7], v[104:107], v[164:167]
    ds_read_b64_tr_b16 a[26:27], v12 offset:17408
    v_sub_f32 v26, v26, v16
    v_mfma_f32_16x16x32_bf16 v[172:175], a[4:7], v[108:111], v[172:175]
    s_waitcnt lgkmcnt(6)
    ds_read_b64_tr_b16 a[28:29], v12 offset:24576
    v_sub_f32 v27, v27, v16
    v_mfma_f32_16x16x32_bf16 v[176:179], a[8:11], v[104:107], v[176:179]
    ds_read_b64_tr_b16 a[30:31], v12 offset:25600
    v_mfma_f32_16x16x32_bf16 v[184:187], a[8:11], v[108:111], v[184:187]
    ds_read_b64_tr_b16 a[32:33], v13 offset:16384
    v_sub_f32 v28, v28, v16
    v_mfma_f32_16x16x32_bf16 v[180:183], a[12:15], v[104:107], v[180:183]
    ds_read_b64_tr_b16 a[34:35], v13 offset:17408
    v_sub_f32 v29, v29, v16
    v_mfma_f32_16x16x32_bf16 v[188:191], a[12:15], v[108:111], v[188:191]
    s_waitcnt lgkmcnt(6)
    ds_read_b64_tr_b16 a[36:37], v13 offset:24576
    v_mfma_f32_16x16x32_bf16 v[192:195], a[16:19], v[104:107], v[192:195]
    ds_read_b64_tr_b16 a[38:39], v13 offset:25600
    v_sub_f32 v30, v30, v16
    v_mfma_f32_16x16x32_bf16 v[200:203], a[16:19], v[108:111], v[200:203]
    ds_read_b64_tr_b16 a[40:41], v14 offset:16384
    v_mfma_f32_16x16x32_bf16 v[196:199], a[20:23], v[104:107], v[196:199]
    ds_read_b64_tr_b16 a[42:43], v14 offset:17408
    v_sub_f32 v31, v31, v16
    v_mfma_f32_16x16x32_bf16 v[204:207], a[20:23], v[108:111], v[204:207]
    s_waitcnt lgkmcnt(6)
    ds_read_b64_tr_b16 a[44:45], v14 offset:24576
    v_cvt_pk_bf16_f32 v128, v24, v25
    v_mfma_f32_16x16x32_bf16 v[208:211], a[24:27], v[104:107], v[208:211]
    ds_read_b64_tr_b16 a[46:47], v14 offset:25600
    v_mfma_f32_16x16x32_bf16 v[216:219], a[24:27], v[108:111], v[216:219]
    v_cvt_pk_bf16_f32 v129, v26, v27
    v_cvt_pk_bf16_f32 v130, v28, v29
    v_mfma_f32_16x16x32_bf16 v[212:215], a[28:31], v[104:107], v[212:215]
    v_cvt_pk_bf16_f32 v131, v30, v31
    v_lshlrev_b32 v24, 16, v132
    v_mfma_f32_16x16x32_bf16 v[220:223], a[28:31], v[108:111], v[220:223]
    s_waitcnt lgkmcnt(4)
    ds_read_b64_tr_b16 a[48:49], v8 offset:32768
    v_mfma_f32_16x16x32_bf16 v[224:227], a[32:35], v[104:107], v[224:227]
    ds_read_b64_tr_b16 a[50:51], v8 offset:33792
    v_and_b32 v25, 4294901760, v132
    v_mfma_f32_16x16x32_bf16 v[232:235], a[32:35], v[108:111], v[232:235]
    ds_read_b64_tr_b16 a[52:53], v8 offset:40960
    v_lshlrev_b32 v26, 16, v133
    v_mfma_f32_16x16x32_bf16 v[228:231], a[36:39], v[104:107], v[228:231]
    ds_read_b64_tr_b16 a[54:55], v8 offset:41984
    v_mfma_f32_16x16x32_bf16 v[236:239], a[36:39], v[108:111], v[236:239]
    s_waitcnt lgkmcnt(4)
    ds_read_b64_tr_b16 a[56:57], v9 offset:32768
    v_and_b32 v27, 4294901760, v133
    v_mfma_f32_16x16x32_bf16 v[240:243], a[40:43], v[104:107], v[240:243]
    ds_read_b64_tr_b16 a[58:59], v9 offset:33792
    v_mfma_f32_16x16x32_bf16 v[248:251], a[40:43], v[108:111], v[248:251]
    ds_read_b64_tr_b16 a[60:61], v9 offset:40960
    v_lshlrev_b32 v28, 16, v134
    v_mfma_f32_16x16x32_bf16 v[244:247], a[44:47], v[104:107], v[244:247]
    ds_read_b64_tr_b16 a[62:63], v9 offset:41984
    v_and_b32 v29, 4294901760, v134
    v_mfma_f32_16x16x32_bf16 v[252:255], a[44:47], v[108:111], v[252:255]
    ds_read_b64_tr_b16 a[0:1], v10 offset:32768
    v_mfma_f32_16x16x32_bf16 a[192:195], v[112:115], v[112:115], a[192:195]
    ds_read_b64_tr_b16 a[2:3], v10 offset:33792
    v_lshlrev_b32 v30, 16, v135
    v_mfma_f32_16x16x32_bf16 a[196:199], v[116:119], v[116:119], a[196:199]
    s_waitcnt lgkmcnt(6)
    ds_read_b64_tr_b16 a[4:5], v10 offset:40960
    v_and_b32 v31, 4294901760, v135
    v_mfma_f32_16x16x32_bf16 v[144:147], a[48:51], v[112:115], v[144:147]
    s_waitcnt vmcnt(15)
    ds_read_b64_tr_b16 a[6:7], v10 offset:41984
    v_mfma_f32_16x16x32_bf16 v[152:155], a[48:51], v[116:119], v[152:155]
    s_barrier
    ds_read_b64_tr_b16 a[8:9], v11 offset:32768
    v_sub_f32 v24, v24, v17
    v_mfma_f32_16x16x32_bf16 v[148:151], a[52:55], v[112:115], v[148:151]
    s_add_u32 m0, s69, 0
    ds_read_b64_tr_b16 a[10:11], v11 offset:33792
    v_sub_f32 v25, v25, v17
    v_mfma_f32_16x16x32_bf16 v[156:159], a[52:55], v[116:119], v[156:159]
    s_waitcnt lgkmcnt(6)
    s_mov_b32 s72, 1048576
    ds_read_b64_tr_b16 a[12:13], v11 offset:40960
    v_mfma_f32_16x16x32_bf16 v[160:163], a[56:59], v[112:115], v[160:163]
    ds_read_b64_tr_b16 a[14:15], v11 offset:41984
    buffer_load_dwordx4 v1, s[40:43], s72 offen offset:0 lds
    v_mfma_f32_16x16x32_bf16 v[168:171], a[56:59], v[116:119], v[168:171]
    ds_read_b64_tr_b16 a[16:17], v12 offset:32768
    v_sub_f32 v26, v26, v17
    v_mfma_f32_16x16x32_bf16 v[164:167], a[60:63], v[112:115], v[164:167]
    s_waitcnt lgkmcnt(6)
    ds_read_b64_tr_b16 a[18:19], v12 offset:33792
    v_mfma_f32_16x16x32_bf16 v[172:175], a[60:63], v[116:119], v[172:175]
    s_mov_b32 s73, 1080320
    ds_read_b64_tr_b16 a[20:21], v12 offset:40960
    v_sub_f32 v27, v27, v17
    v_mfma_f32_16x16x32_bf16 v[176:179], a[0:3], v[112:115], v[176:179]
    ds_read_b64_tr_b16 a[22:23], v12 offset:41984
    buffer_load_dwordx4 v1, s[40:43], s73 offen offset:1024 lds
    v_mfma_f32_16x16x32_bf16 v[184:187], a[0:3], v[116:119], v[184:187]
    s_waitcnt lgkmcnt(6)
    ds_read_b64_tr_b16 a[24:25], v13 offset:32768
    v_sub_f32 v28, v28, v17
    v_mfma_f32_16x16x32_bf16 v[180:183], a[4:7], v[112:115], v[180:183]
    s_add_u32 m0, s69, 4096
    ds_read_b64_tr_b16 a[26:27], v13 offset:33792
    v_mfma_f32_16x16x32_bf16 v[188:191], a[4:7], v[116:119], v[188:191]
    s_mov_b32 s74, 1179648
    ds_read_b64_tr_b16 a[28:29], v13 offset:40960
    v_sub_f32 v29, v29, v17
    v_mfma_f32_16x16x32_bf16 v[192:195], a[8:11], v[112:115], v[192:195]
    ds_read_b64_tr_b16 a[30:31], v13 offset:41984
    buffer_load_dwordx4 v1, s[40:43], s74 offen offset:0 lds
    v_mfma_f32_16x16x32_bf16 v[200:203], a[8:11], v[116:119], v[200:203]
    s_waitcnt lgkmcnt(6)
    ds_read_b64_tr_b16 a[32:33], v14 offset:32768
    v_sub_f32 v30, v30, v17
    v_mfma_f32_16x16x32_bf16 v[196:199], a[12:15], v[112:115], v[196:199]
    ds_read_b64_tr_b16 a[34:35], v14 offset:33792
    v_mfma_f32_16x16x32_bf16 v[204:207], a[12:15], v[116:119], v[204:207]
    s_mov_b32 s75, 1211392
    ds_read_b64_tr_b16 a[36:37], v14 offset:40960
    v_sub_f32 v31, v31, v17
    v_mfma_f32_16x16x32_bf16 v[208:211], a[16:19], v[112:115], v[208:211]
    ds_read_b64_tr_b16 a[38:39], v14 offset:41984
    buffer_load_dwordx4 v1, s[40:43], s75 offen offset:1024 lds
    v_mfma_f32_16x16x32_bf16 v[216:219], a[16:19], v[116:119], v[216:219]
    s_waitcnt lgkmcnt(6)
    v_cvt_pk_bf16_f32 v132, v24, v25
    v_cvt_pk_bf16_f32 v133, v26, v27
    v_mfma_f32_16x16x32_bf16 v[212:215], a[20:23], v[112:115], v[212:215]
    s_add_u32 m0, s69, 16384
    v_cvt_pk_bf16_f32 v134, v28, v29
    v_mfma_f32_16x16x32_bf16 v[220:223], a[20:23], v[116:119], v[220:223]
    s_mov_b32 s72, 1572864
    ds_read_b64_tr_b16 a[40:41], v8 offset:49152
    v_cvt_pk_bf16_f32 v135, v30, v31
    v_mfma_f32_16x16x32_bf16 v[224:227], a[24:27], v[112:115], v[224:227]
    ds_read_b64_tr_b16 a[42:43], v8 offset:50176
    buffer_load_dwordx4 v1, s[40:43], s72 offen offset:0 lds
    v_mfma_f32_16x16x32_bf16 v[232:235], a[24:27], v[116:119], v[232:235]
    s_waitcnt lgkmcnt(4)
    ds_read_b64_tr_b16 a[44:45], v8 offset:57344
    v_mfma_f32_16x16x32_bf16 v[228:231], a[28:31], v[112:115], v[228:231]
    ds_read_b64_tr_b16 a[46:47], v8 offset:58368
    v_lshlrev_b32 v24, 16, v136
    v_mfma_f32_16x16x32_bf16 v[236:239], a[28:31], v[116:119], v[236:239]
    s_mov_b32 s73, 1604608
    ds_read_b64_tr_b16 a[48:49], v9 offset:49152
    v_and_b32 v25, 4294901760, v136
    v_mfma_f32_16x16x32_bf16 v[240:243], a[32:35], v[112:115], v[240:243]
    ds_read_b64_tr_b16 a[50:51], v9 offset:50176
    buffer_load_dwordx4 v1, s[40:43], s73 offen offset:1024 lds
    v_mfma_f32_16x16x32_bf16 v[248:251], a[32:35], v[116:119], v[248:251]
    s_waitcnt lgkmcnt(6)
    ds_read_b64_tr_b16 a[52:53], v9 offset:57344
    v_lshlrev_b32 v26, 16, v137
    v_mfma_f32_16x16x32_bf16 v[244:247], a[36:39], v[112:115], v[244:247]
    s_add_u32 m0, s69, 20480
    ds_read_b64_tr_b16 a[54:55], v9 offset:58368
    v_and_b32 v27, 4294901760, v137
    v_mfma_f32_16x16x32_bf16 v[252:255], a[36:39], v[116:119], v[252:255]
    s_mov_b32 s74, 1703936
    ds_read_b64_tr_b16 a[56:57], v10 offset:49152
    v_mfma_f32_16x16x32_bf16 a[192:195], v[120:123], v[120:123], a[192:195]
    ds_read_b64_tr_b16 a[58:59], v10 offset:50176
    buffer_load_dwordx4 v1, s[40:43], s74 offen offset:0 lds
    v_mfma_f32_16x16x32_bf16 a[196:199], v[124:127], v[124:127], a[196:199]
    s_waitcnt lgkmcnt(6)
    ds_read_b64_tr_b16 a[60:61], v10 offset:57344
    v_lshlrev_b32 v28, 16, v138
    v_mfma_f32_16x16x32_bf16 v[144:147], a[40:43], v[120:123], v[144:147]
    ds_read_b64_tr_b16 a[62:63], v10 offset:58368
    v_and_b32 v29, 4294901760, v138
    v_mfma_f32_16x16x32_bf16 v[152:155], a[40:43], v[124:127], v[152:155]
    s_mov_b32 s75, 1735680
    ds_read_b64_tr_b16 a[0:1], v11 offset:49152
    v_lshlrev_b32 v30, 16, v139
    v_mfma_f32_16x16x32_bf16 v[148:151], a[44:47], v[120:123], v[148:151]
    ds_read_b64_tr_b16 a[2:3], v11 offset:50176
    buffer_load_dwordx4 v1, s[40:43], s75 offen offset:1024 lds
    v_mfma_f32_16x16x32_bf16 v[156:159], a[44:47], v[124:127], v[156:159]
    s_waitcnt lgkmcnt(6)
    ds_read_b64_tr_b16 a[4:5], v11 offset:57344
    v_mfma_f32_16x16x32_bf16 v[160:163], a[48:51], v[120:123], v[160:163]
    s_mov_b32 s96, 1835264
    ds_read_b64_tr_b16 a[6:7], v11 offset:58368
    v_and_b32 v31, 4294901760, v139
    v_mfma_f32_16x16x32_bf16 v[168:171], a[48:51], v[124:127], v[168:171]
    ds_read_b64_tr_b16 a[8:9], v12 offset:49152
    buffer_load_dword v22, v21, s[40:43], s96 offen
    v_sub_f32 v24, v24, v16
    v_mfma_f32_16x16x32_bf16 v[164:167], a[52:55], v[120:123], v[164:167]
    ds_read_b64_tr_b16 a[10:11], v12 offset:50176
    v_sub_f32 v25, v25, v16
    v_mfma_f32_16x16x32_bf16 v[172:175], a[52:55], v[124:127], v[172:175]
    s_waitcnt lgkmcnt(6)
    ds_read_b64_tr_b16 a[12:13], v12 offset:57344
    v_mfma_f32_16x16x32_bf16 v[176:179], a[56:59], v[120:123], v[176:179]
    ds_read_b64_tr_b16 a[14:15], v12 offset:58368
    v_sub_f32 v26, v26, v16
    v_mfma_f32_16x16x32_bf16 v[184:187], a[56:59], v[124:127], v[184:187]
    ds_read_b64_tr_b16 a[16:17], v13 offset:49152
    v_sub_f32 v27, v27, v16
    v_mfma_f32_16x16x32_bf16 v[180:183], a[60:63], v[120:123], v[180:183]
    ds_read_b64_tr_b16 a[18:19], v13 offset:50176
    v_sub_f32 v28, v28, v16
    v_mfma_f32_16x16x32_bf16 v[188:191], a[60:63], v[124:127], v[188:191]
    s_waitcnt lgkmcnt(6)
    ds_read_b64_tr_b16 a[20:21], v13 offset:57344
    v_mfma_f32_16x16x32_bf16 v[192:195], a[0:3], v[120:123], v[192:195]
    ds_read_b64_tr_b16 a[22:23], v13 offset:58368
    v_sub_f32 v29, v29, v16
    v_mfma_f32_16x16x32_bf16 v[200:203], a[0:3], v[124:127], v[200:203]
    ds_read_b64_tr_b16 a[24:25], v14 offset:49152
    v_sub_f32 v30, v30, v16
    v_mfma_f32_16x16x32_bf16 v[196:199], a[4:7], v[120:123], v[196:199]
    ds_read_b64_tr_b16 a[26:27], v14 offset:50176
    v_sub_f32 v31, v31, v16
    v_mfma_f32_16x16x32_bf16 v[204:207], a[4:7], v[124:127], v[204:207]
    s_waitcnt lgkmcnt(6)
    ds_read_b64_tr_b16 a[28:29], v14 offset:57344
    v_mfma_f32_16x16x32_bf16 v[208:211], a[8:11], v[120:123], v[208:211]
    ds_read_b64_tr_b16 a[30:31], v14 offset:58368
    v_cvt_pk_bf16_f32 v136, v24, v25
    v_mfma_f32_16x16x32_bf16 v[216:219], a[8:11], v[124:127], v[216:219]
    v_cvt_pk_bf16_f32 v137, v26, v27
    v_cvt_pk_bf16_f32 v138, v28, v29
    v_mfma_f32_16x16x32_bf16 v[212:215], a[12:15], v[120:123], v[212:215]
    v_xor_b32 v8, 65536, v8
    v_cvt_pk_bf16_f32 v139, v30, v31
    v_mfma_f32_16x16x32_bf16 v[220:223], a[12:15], v[124:127], v[220:223]
    s_waitcnt lgkmcnt(4)
    ds_read_b64_tr_b16 a[32:33], v8 offset:0
    v_mfma_f32_16x16x32_bf16 v[224:227], a[16:19], v[120:123], v[224:227]
    ds_read_b64_tr_b16 a[34:35], v8 offset:1024
    v_lshlrev_b32 v24, 16, v140
    v_mfma_f32_16x16x32_bf16 v[232:235], a[16:19], v[124:127], v[232:235]
    ds_read_b64_tr_b16 a[36:37], v8 offset:8192
    v_and_b32 v25, 4294901760, v140
    v_mfma_f32_16x16x32_bf16 v[228:231], a[20:23], v[120:123], v[228:231]
    ds_read_b64_tr_b16 a[38:39], v8 offset:9216
    v_xor_b32 v9, 65536, v9
    v_mfma_f32_16x16x32_bf16 v[236:239], a[20:23], v[124:127], v[236:239]
    s_waitcnt lgkmcnt(4)
    ds_read_b64_tr_b16 a[40:41], v9 offset:0
    v_lshlrev_b32 v26, 16, v141
    v_mfma_f32_16x16x32_bf16 v[240:243], a[24:27], v[120:123], v[240:243]
    ds_read_b64_tr_b16 a[42:43], v9 offset:1024
    v_mfma_f32_16x16x32_bf16 v[248:251], a[24:27], v[124:127], v[248:251]
    ds_read_b64_tr_b16 a[44:45], v9 offset:8192
    v_and_b32 v27, 4294901760, v141
    v_mfma_f32_16x16x32_bf16 v[244:247], a[28:31], v[120:123], v[244:247]
    ds_read_b64_tr_b16 a[46:47], v9 offset:9216
    v_xor_b32 v10, 65536, v10
    v_mfma_f32_16x16x32_bf16 v[252:255], a[28:31], v[124:127], v[252:255]
    ds_read_b64_tr_b16 a[48:49], v10 offset:0
    v_lshlrev_b32 v28, 16, v142
    v_mfma_f32_16x16x32_bf16 a[192:195], v[128:131], v[128:131], a[192:195]
    ds_read_b64_tr_b16 a[50:51], v10 offset:1024
    v_and_b32 v29, 4294901760, v142
    v_mfma_f32_16x16x32_bf16 a[196:199], v[132:135], v[132:135], a[196:199]
    s_waitcnt lgkmcnt(6)
    ds_read_b64_tr_b16 a[52:53], v10 offset:8192
    v_mfma_f32_16x16x32_bf16 v[144:147], a[32:35], v[128:131], v[144:147]
    s_waitcnt vmcnt(14)
    ds_read_b64_tr_b16 a[54:55], v10 offset:9216
    v_xor_b32 v11, 65536, v11
    v_mfma_f32_16x16x32_bf16 v[152:155], a[32:35], v[132:135], v[152:155]
    s_barrier
    ds_read_b64_tr_b16 a[56:57], v11 offset:0
    v_lshlrev_b32 v30, 16, v143
    v_mfma_f32_16x16x32_bf16 v[148:151], a[36:39], v[128:131], v[148:151]
    s_add_u32 m0, s69, 32768
    ds_read_b64_tr_b16 a[58:59], v11 offset:1024
    v_and_b32 v31, 4294901760, v143
    v_mfma_f32_16x16x32_bf16 v[156:159], a[36:39], v[132:135], v[156:159]
    s_waitcnt lgkmcnt(6)
    s_mov_b32 s72, 2097152
    ds_read_b64_tr_b16 a[60:61], v11 offset:8192
    v_sub_f32 v24, v24, v17
    v_mfma_f32_16x16x32_bf16 v[160:163], a[40:43], v[128:131], v[160:163]
    ds_read_b64_tr_b16 a[62:63], v11 offset:9216
    v_xor_b32 v12, 65536, v12
    v_mfma_f32_16x16x32_bf16 v[168:171], a[40:43], v[132:135], v[168:171]
    ds_read_b64_tr_b16 a[0:1], v12 offset:0
    buffer_load_dwordx4 v1, s[40:43], s72 offen offset:0 lds
    v_mfma_f32_16x16x32_bf16 v[164:167], a[44:47], v[128:131], v[164:167]
    s_waitcnt lgkmcnt(6)
    ds_read_b64_tr_b16 a[2:3], v12 offset:1024
    v_mfma_f32_16x16x32_bf16 v[172:175], a[44:47], v[132:135], v[172:175]
    s_mov_b32 s73, 2128896
    ds_read_b64_tr_b16 a[4:5], v12 offset:8192
    v_sub_f32 v25, v25, v17
    v_mfma_f32_16x16x32_bf16 v[176:179], a[48:51], v[128:131], v[176:179]
    ds_read_b64_tr_b16 a[6:7], v12 offset:9216
    v_xor_b32 v13, 65536, v13
    v_mfma_f32_16x16x32_bf16 v[184:187], a[48:51], v[132:135], v[184:187]
    s_waitcnt lgkmcnt(6)
    ds_read_b64_tr_b16 a[8:9], v13 offset:0
    buffer_load_dwordx4 v1, s[40:43], s73 offen offset:1024 lds
    v_mfma_f32_16x16x32_bf16 v[180:183], a[52:55], v[128:131], v[180:183]
    s_add_u32 m0, s69, 36864
    ds_read_b64_tr_b16 a[10:11], v13 offset:1024
    v_sub_f32 v26, v26, v17
    v_mfma_f32_16x16x32_bf16 v[188:191], a[52:55], v[132:135], v[188:191]
    s_mov_b32 s74, 2228224
    ds_read_b64_tr_b16 a[12:13], v13 offset:8192
    v_sub_f32 v27, v27, v17
    v_mfma_f32_16x16x32_bf16 v[192:195], a[56:59], v[128:131], v[192:195]
    ds_read_b64_tr_b16 a[14:15], v13 offset:9216
    v_xor_b32 v14, 65536, v14
    v_mfma_f32_16x16x32_bf16 v[200:203], a[56:59], v[132:135], v[200:203]
    s_waitcnt lgkmcnt(6)
    ds_read_b64_tr_b16 a[16:17], v14 offset:0
    buffer_load_dwordx4 v1, s[40:43], s74 offen offset:0 lds
    v_mfma_f32_16x16x32_bf16 v[196:199], a[60:63], v[128:131], v[196:199]
    ds_read_b64_tr_b16 a[18:19], v14 offset:1024
    v_mfma_f32_16x16x32_bf16 v[204:207], a[60:63], v[132:135], v[204:207]
    s_mov_b32 s75, 2259968
    ds_read_b64_tr_b16 a[20:21], v14 offset:8192
    v_sub_f32 v28, v28, v17
    v_mfma_f32_16x16x32_bf16 v[208:211], a[0:3], v[128:131], v[208:211]
    ds_read_b64_tr_b16 a[22:23], v14 offset:9216
    buffer_load_dwordx4 v1, s[40:43], s75 offen offset:1024 lds
    v_mfma_f32_16x16x32_bf16 v[216:219], a[0:3], v[132:135], v[216:219]
    s_waitcnt lgkmcnt(6)
    v_sub_f32 v29, v29, v17
    v_sub_f32 v30, v30, v17
    v_mfma_f32_16x16x32_bf16 v[212:215], a[4:7], v[128:131], v[212:215]
    s_add_u32 m0, s69, 49152
    v_sub_f32 v31, v31, v17
    v_cvt_pk_bf16_f32 v140, v24, v25
    v_mfma_f32_16x16x32_bf16 v[220:223], a[4:7], v[132:135], v[220:223]
    s_mov_b32 s72, 2621440
    ds_read_b64_tr_b16 a[24:25], v8 offset:16384
    v_mfma_f32_16x16x32_bf16 v[224:227], a[8:11], v[128:131], v[224:227]
    ds_read_b64_tr_b16 a[26:27], v8 offset:17408
    buffer_load_dwordx4 v1, s[40:43], s72 offen offset:0 lds
    v_mfma_f32_16x16x32_bf16 v[232:235], a[8:11], v[132:135], v[232:235]
    s_waitcnt lgkmcnt(4)
    ds_read_b64_tr_b16 a[28:29], v8 offset:24576
    v_cvt_pk_bf16_f32 v141, v26, v27
    v_mfma_f32_16x16x32_bf16 v[228:231], a[12:15], v[128:131], v[228:231]
    ds_read_b64_tr_b16 a[30:31], v8 offset:25600
    v_cvt_pk_bf16_f32 v142, v28, v29
    v_mfma_f32_16x16x32_bf16 v[236:239], a[12:15], v[132:135], v[236:239]
    s_mov_b32 s73, 2653184
    ds_read_b64_tr_b16 a[32:33], v9 offset:16384
    v_cvt_pk_bf16_f32 v143, v30, v31
    v_mfma_f32_16x16x32_bf16 v[240:243], a[16:19], v[128:131], v[240:243]
    ds_read_b64_tr_b16 a[34:35], v9 offset:17408
    buffer_load_dwordx4 v1, s[40:43], s73 offen offset:1024 lds
    v_mfma_f32_16x16x32_bf16 v[248:251], a[16:19], v[132:135], v[248:251]
    s_waitcnt lgkmcnt(6)
    ds_read_b64_tr_b16 a[36:37], v9 offset:24576
    v_mfma_f32_16x16x32_bf16 v[244:247], a[20:23], v[128:131], v[244:247]
    s_add_u32 m0, s69, 53248
    ds_read_b64_tr_b16 a[38:39], v9 offset:25600
    v_mfma_f32_16x16x32_bf16 v[252:255], a[20:23], v[132:135], v[252:255]
    s_mov_b32 s74, 2752512
    ds_read_b64_tr_b16 a[40:41], v10 offset:16384
    v_mfma_f32_16x16x32_bf16 a[192:195], v[136:139], v[136:139], a[192:195]
    ds_read_b64_tr_b16 a[42:43], v10 offset:17408
    buffer_load_dwordx4 v1, s[40:43], s74 offen offset:0 lds
    v_mfma_f32_16x16x32_bf16 a[196:199], v[140:143], v[140:143], a[196:199]
    s_waitcnt lgkmcnt(6)
    ds_read_b64_tr_b16 a[44:45], v10 offset:24576
    v_mfma_f32_16x16x32_bf16 v[144:147], a[24:27], v[136:139], v[144:147]
    ds_read_b64_tr_b16 a[46:47], v10 offset:25600
    v_mfma_f32_16x16x32_bf16 v[152:155], a[24:27], v[140:143], v[152:155]
    s_mov_b32 s75, 2784256
    ds_read_b64_tr_b16 a[48:49], v11 offset:16384
    v_mfma_f32_16x16x32_bf16 v[148:151], a[28:31], v[136:139], v[148:151]
    ds_read_b64_tr_b16 a[50:51], v11 offset:17408
    buffer_load_dwordx4 v1, s[40:43], s75 offen offset:1024 lds
    v_mfma_f32_16x16x32_bf16 v[156:159], a[28:31], v[140:143], v[156:159]
    s_waitcnt lgkmcnt(6)
    ds_read_b64_tr_b16 a[52:53], v11 offset:24576
    v_accvgpr_read_b32 v24, a192
    v_accvgpr_read_b32 v25, a193
    v_mfma_f32_16x16x32_bf16 v[160:163], a[32:35], v[136:139], v[160:163]
    s_mov_b32 s96, 0
    ds_read_b64_tr_b16 a[54:55], v11 offset:25600
    v_accvgpr_read_b32 v26, a194
    v_accvgpr_read_b32 v27, a195
    v_mfma_f32_16x16x32_bf16 v[168:171], a[32:35], v[140:143], v[168:171]
    ds_read_b64_tr_b16 a[56:57], v12 offset:16384
    buffer_load_dword v22, v23, s[48:51], s96 offen
    v_mfma_f32_16x16x32_bf16 v[164:167], a[36:39], v[136:139], v[164:167]
    ds_read_b64_tr_b16 a[58:59], v12 offset:17408
    v_cndmask_b32 v24, v24, v25, s[80:81]
    v_mfma_f32_16x16x32_bf16 v[172:175], a[36:39], v[140:143], v[172:175]
    s_waitcnt lgkmcnt(6)
    ds_read_b64_tr_b16 a[60:61], v12 offset:24576
    v_cndmask_b32 v24, v24, v26, s[82:83]
    v_cndmask_b32 v24, v24, v27, s[84:85]
    v_mfma_f32_16x16x32_bf16 v[176:179], a[40:43], v[136:139], v[176:179]
    ds_read_b64_tr_b16 a[62:63], v12 offset:25600
    v_cndmask_b32 v24, 0, v24, s[86:87]
    v_mov_b32 v25, v24
    v_mfma_f32_16x16x32_bf16 v[184:187], a[40:43], v[140:143], v[184:187]
    ds_read_b64_tr_b16 a[0:1], v13 offset:16384
    v_permlane32_swap_b32 v24, v25
    v_mfma_f32_16x16x32_bf16 v[180:183], a[44:47], v[136:139], v[180:183]
    ds_read_b64_tr_b16 a[2:3], v13 offset:17408
    v_add_f32 v24, v24, v25
    v_mov_b32 v25, v24
    v_mfma_f32_16x16x32_bf16 v[188:191], a[44:47], v[140:143], v[188:191]
    s_waitcnt lgkmcnt(6)
    ds_read_b64_tr_b16 a[4:5], v13 offset:24576
    v_permlane16_swap_b32 v24, v25
    v_add_f32 v24, v24, v25
    v_mfma_f32_16x16x32_bf16 v[192:195], a[48:51], v[136:139], v[192:195]
    ds_read_b64_tr_b16 a[6:7], v13 offset:25600
    v_mul_f32 v25, v18, v18
    v_mfma_f32_16x16x32_bf16 v[200:203], a[48:51], v[140:143], v[200:203]
    ds_read_b64_tr_b16 a[8:9], v14 offset:16384
    v_mul_f32 v24, 991054117, v24
    v_sub_f32 v24, v24, v25
    v_mfma_f32_16x16x32_bf16 v[196:199], a[52:55], v[136:139], v[196:199]
    ds_read_b64_tr_b16 a[10:11], v14 offset:17408
    v_max_f32 v24, 0, v24
    v_cvt_pk_bf16_f32 v24, v24, v24
    v_mfma_f32_16x16x32_bf16 v[204:207], a[52:55], v[140:143], v[204:207]
    s_waitcnt lgkmcnt(6)
    ds_read_b64_tr_b16 a[12:13], v14 offset:24576
    v_lshlrev_b32 v24, 16, v24
    v_mfma_f32_16x16x32_bf16 v[208:211], a[56:59], v[136:139], v[208:211]
    ds_read_b64_tr_b16 a[14:15], v14 offset:25600
    v_add_f32 v24, 925353388, v24
    v_cvt_pk_bf16_f32 v24, v24, v24
    v_mfma_f32_16x16x32_bf16 v[216:219], a[56:59], v[140:143], v[216:219]
    ds_read_b64_tr_b16 a[16:17], v8 offset:32768
    v_lshlrev_b32 v24, 16, v24
    v_sqrt_f32 v24, v24
    v_mfma_f32_16x16x32_bf16 v[212:215], a[60:63], v[136:139], v[212:215]
    ds_read_b64_tr_b16 a[18:19], v8 offset:33792
    v_cvt_pk_bf16_f32 v24, v24, v24
    v_mfma_f32_16x16x32_bf16 v[220:223], a[60:63], v[140:143], v[220:223]
    s_waitcnt lgkmcnt(6)
    ds_read_b64_tr_b16 a[20:21], v9 offset:32768
    v_lshlrev_b32 v20, 16, v24
    v_rcp_f32 v24, v20
    v_mfma_f32_16x16x32_bf16 v[224:227], a[0:3], v[136:139], v[224:227]
    ds_read_b64_tr_b16 a[22:23], v9 offset:33792
    v_mul_f32 v16, 1035512379, v24
    v_mul_f32 v18, 3216550459, v24
    v_mfma_f32_16x16x32_bf16 v[232:235], a[0:3], v[140:143], v[232:235]
    ds_read_b64_tr_b16 a[24:25], v10 offset:32768
    v_accvgpr_read_b32 v24, a196
    v_mfma_f32_16x16x32_bf16 v[228:231], a[4:7], v[136:139], v[228:231]
    ds_read_b64_tr_b16 a[26:27], v10 offset:33792
    v_accvgpr_read_b32 v25, a197
    v_accvgpr_read_b32 v26, a198
    v_mfma_f32_16x16x32_bf16 v[236:239], a[4:7], v[140:143], v[236:239]
    s_waitcnt lgkmcnt(6)
    ds_read_b64_tr_b16 a[28:29], v11 offset:32768
    v_accvgpr_read_b32 v27, a199
    v_cndmask_b32 v24, v24, v25, s[80:81]
    v_mfma_f32_16x16x32_bf16 v[240:243], a[8:11], v[136:139], v[240:243]
    ds_read_b64_tr_b16 a[30:31], v11 offset:33792
    v_cndmask_b32 v24, v24, v26, s[82:83]
    v_mfma_f32_16x16x32_bf16 v[248:251], a[8:11], v[140:143], v[248:251]
    ds_read_b64_tr_b16 a[32:33], v12 offset:32768
    v_cndmask_b32 v24, v24, v27, s[84:85]
    v_cndmask_b32 v24, 0, v24, s[86:87]
    v_mfma_f32_16x16x32_bf16 v[244:247], a[12:15], v[136:139], v[244:247]
    ds_read_b64_tr_b16 a[34:35], v12 offset:33792
    v_mov_b32 v25, v24
    s_nop 1
    v_permlane32_swap_b32 v24, v25
    v_mfma_f32_16x16x32_bf16 v[252:255], a[12:15], v[140:143], v[252:255]
    s_waitcnt lgkmcnt(6)
    ds_read_b64_tr_b16 a[36:37], v13 offset:32768
    v_add_f32 v24, v24, v25
    v_mfma_f32_16x16x32_bf16 a[128:131], a[16:19], v[32:35], 0
    ds_read_b64_tr_b16 a[38:39], v13 offset:33792
    v_mov_b32 v25, v24
    s_nop 1
    v_permlane16_swap_b32 v24, v25
    v_mfma_f32_16x16x32_bf16 a[132:135], a[16:19], v[36:39], 0
    s_waitcnt lgkmcnt(6)
    ds_read_b64_tr_b16 a[40:41], v14 offset:32768
    v_add_f32 v24, v24, v25
    v_mul_f32 v25, v19, v19
    v_mfma_f32_16x16x32_bf16 a[136:139], a[20:23], v[32:35], 0
    s_waitcnt vmcnt(14)
    ds_read_b64_tr_b16 a[42:43], v14 offset:33792
    v_xor_b32 v15, 65536, v15
    v_mfma_f32_16x16x32_bf16 a[140:143], a[20:23], v[36:39], 0
    s_barrier
    ds_read_b64_tr_b16 a[44:45], v15 offset:32768
    v_mul_f32 v24, 991054117, v24
    v_sub_f32 v24, v24, v25
    v_mfma_f32_16x16x32_bf16 a[144:147], a[24:27], v[32:35], 0
    s_add_u32 m0, s69, 65536
    ds_read_b64_tr_b16 a[46:47], v15 offset:33792
    v_max_f32 v24, 0, v24
    v_cvt_pk_bf16_f32 v24, v24, v24
    v_mfma_f32_16x16x32_bf16 a[148:151], a[24:27], v[36:39], 0
    s_waitcnt lgkmcnt(6)
    s_mov_b32 s72, 3145728
    ds_read_b64_tr_b16 a[48:49], v8 offset:40960
    v_lshlrev_b32 v24, 16, v24
    v_mfma_f32_16x16x32_bf16 a[152:155], a[28:31], v[32:35], 0
    ds_read_b64_tr_b16 a[50:51], v8 offset:41984
    buffer_load_dwordx4 v1, s[40:43], s72 offen offset:0 lds
    v_mfma_f32_16x16x32_bf16 a[156:159], a[28:31], v[36:39], 0
    ds_read_b64_tr_b16 a[52:53], v9 offset:40960
    v_add_f32 v24, 925353388, v24
    v_cvt_pk_bf16_f32 v24, v24, v24
    v_mfma_f32_16x16x32_bf16 a[160:163], a[32:35], v[32:35], 0
    s_waitcnt lgkmcnt(6)
    ds_read_b64_tr_b16 a[54:55], v9 offset:41984
    v_lshlrev_b32 v24, 16, v24
    v_sqrt_f32 v24, v24
    v_mfma_f32_16x16x32_bf16 a[164:167], a[32:35], v[36:39], 0
    s_mov_b32 s73, 3177472
    ds_read_b64_tr_b16 a[56:57], v10 offset:40960
    v_cvt_pk_bf16_f32 v24, v24, v24
    v_mfma_f32_16x16x32_bf16 a[168:171], a[36:39], v[32:35], 0
    ds_read_b64_tr_b16 a[58:59], v10 offset:41984
    buffer_load_dwordx4 v1, s[40:43], s73 offen offset:1024 lds
    v_mfma_f32_16x16x32_bf16 a[172:175], a[36:39], v[36:39], 0
    s_waitcnt lgkmcnt(6)
    ds_read_b64_tr_b16 a[60:61], v11 offset:40960
    v_lshlrev_b32 v21, 16, v24
    v_rcp_f32 v24, v21
    v_mfma_f32_16x16x32_bf16 a[176:179], a[40:43], v[32:35], 0
    s_add_u32 m0, s69, 69632
    ds_read_b64_tr_b16 a[62:63], v11 offset:41984
    v_mul_f32 v17, 1035512379, v24
    v_mul_f32 v19, 3216550459, v24
    v_mfma_f32_16x16x32_bf16 a[180:183], a[40:43], v[36:39], 0
    s_mov_b32 s74, 3276800
    ds_read_b64_tr_b16 a[0:1], v12 offset:40960
    v_mul_f32 v144, v18, v144
    v_mfma_f32_16x16x32_bf16 a[184:187], a[44:47], v[32:35], 0
    ds_read_b64_tr_b16 a[2:3], v12 offset:41984
    buffer_load_dwordx4 v1, s[40:43], s74 offen offset:0 lds
    v_mfma_f32_16x16x32_bf16 a[188:191], a[44:47], v[36:39], 0
    s_waitcnt lgkmcnt(6)
    ds_read_b64_tr_b16 a[4:5], v13 offset:40960
    v_mul_f32 v145, v18, v145
    v_mul_f32 v146, v18, v146
    v_mfma_f32_16x16x32_bf16 a[128:131], a[48:51], v[40:43], a[128:131]
    ds_read_b64_tr_b16 a[6:7], v13 offset:41984
    v_mul_f32 v147, v18, v147
    v_exp_f32 v144, v144
    v_mfma_f32_16x16x32_bf16 a[132:135], a[48:51], v[44:47], a[132:135]
    s_mov_b32 s75, 3308544
    ds_read_b64_tr_b16 a[8:9], v14 offset:40960
    v_exp_f32 v145, v145
    v_mfma_f32_16x16x32_bf16 a[136:139], a[52:55], v[40:43], a[136:139]
    ds_read_b64_tr_b16 a[10:11], v14 offset:41984
    buffer_load_dwordx4 v1, s[40:43], s75 offen offset:1024 lds
    v_mfma_f32_16x16x32_bf16 a[140:143], a[52:55], v[44:47], a[140:143]
    s_waitcnt lgkmcnt(6)
    ds_read_b64_tr_b16 a[12:13], v15 offset:40960
    v_exp_f32 v146, v146
    v_exp_f32 v147, v147
    v_mfma_f32_16x16x32_bf16 a[144:147], a[56:59], v[40:43], a[144:147]
    s_add_u32 m0, s69, 81920
    ds_read_b64_tr_b16 a[14:15], v15 offset:41984
    v_fma_f32 v144, v144, v20, v20
    v_fma_f32 v145, v145, v20, v20
    v_mfma_f32_16x16x32_bf16 a[148:151], a[56:59], v[44:47], a[148:151]
    s_mov_b32 s72, 256
    ds_read_b64_tr_b16 a[16:17], v8 offset:49152
    v_fma_f32 v146, v146, v20, v20
    v_mfma_f32_16x16x32_bf16 a[152:155], a[60:63], v[40:43], a[152:155]
    ds_read_b64_tr_b16 a[18:19], v8 offset:50176
    buffer_load_dwordx4 v1, s[40:43], s72 offen offset:0 lds
    v_mfma_f32_16x16x32_bf16 a[156:159], a[60:63], v[44:47], a[156:159]
    s_waitcnt lgkmcnt(6)
    ds_read_b64_tr_b16 a[20:21], v9 offset:49152
    v_fma_f32 v147, v147, v20, v20
    v_rcp_f32 v144, v144
    v_mfma_f32_16x16x32_bf16 a[160:163], a[0:3], v[40:43], a[160:163]
    ds_read_b64_tr_b16 a[22:23], v9 offset:50176
    v_rcp_f32 v145, v145
    v_rcp_f32 v146, v146
    v_mfma_f32_16x16x32_bf16 a[164:167], a[0:3], v[44:47], a[164:167]
    s_mov_b32 s73, 32000
    ds_read_b64_tr_b16 a[24:25], v10 offset:49152
    v_rcp_f32 v147, v147
    v_mfma_f32_16x16x32_bf16 a[168:171], a[4:7], v[40:43], a[168:171]
    ds_read_b64_tr_b16 a[26:27], v10 offset:50176
    buffer_load_dwordx4 v1, s[40:43], s73 offen offset:1024 lds
    v_mfma_f32_16x16x32_bf16 a[172:175], a[4:7], v[44:47], a[172:175]
    s_waitcnt lgkmcnt(6)
    ds_read_b64_tr_b16 a[28:29], v11 offset:49152
    v_mul_f32 v148, v144, v148
    v_mul_f32 v149, v145, v149
    v_mfma_f32_16x16x32_bf16 a[176:179], a[8:11], v[40:43], a[176:179]
    s_add_u32 m0, s69, 86016
    ds_read_b64_tr_b16 a[30:31], v11 offset:50176
    v_mul_f32 v150, v146, v150
    v_mul_f32 v151, v147, v151
    v_mfma_f32_16x16x32_bf16 a[180:183], a[8:11], v[44:47], a[180:183]
    s_mov_b32 s74, 131328
    ds_read_b64_tr_b16 a[32:33], v12 offset:49152
    v_cvt_pk_bf16_f32 v144, v148, v149
    v_mfma_f32_16x16x32_bf16 a[184:187], a[12:15], v[40:43], a[184:187]
    ds_read_b64_tr_b16 a[34:35], v12 offset:50176
    buffer_load_dwordx4 v1, s[40:43], s74 offen offset:0 lds
    v_mfma_f32_16x16x32_bf16 a[188:191], a[12:15], v[44:47], a[188:191]
    s_waitcnt lgkmcnt(6)
    ds_read_b64_tr_b16 a[36:37], v13 offset:49152
    v_cvt_pk_bf16_f32 v145, v150, v151
    v_mul_f32 v152, v19, v152
    v_mfma_f32_16x16x32_bf16 a[128:131], a[16:19], v[48:51], a[128:131]
    ds_read_b64_tr_b16 a[38:39], v13 offset:50176
    v_mul_f32 v153, v19, v153
    v_mul_f32 v154, v19, v154
    v_mfma_f32_16x16x32_bf16 a[132:135], a[16:19], v[52:55], a[132:135]
    s_mov_b32 s75, 163072
    ds_read_b64_tr_b16 a[40:41], v14 offset:49152
    v_mul_f32 v155, v19, v155
    v_mfma_f32_16x16x32_bf16 a[136:139], a[20:23], v[48:51], a[136:139]
    ds_read_b64_tr_b16 a[42:43], v14 offset:50176
    buffer_load_dwordx4 v1, s[40:43], s75 offen offset:1024 lds
    v_mfma_f32_16x16x32_bf16 a[140:143], a[20:23], v[52:55], a[140:143]
    s_waitcnt lgkmcnt(6)
    ds_read_b64_tr_b16 a[44:45], v15 offset:49152
    v_exp_f32 v152, v152
    v_exp_f32 v153, v153
    v_mfma_f32_16x16x32_bf16 a[144:147], a[24:27], v[48:51], a[144:147]
    s_mov_b32 s96, 0
    ds_read_b64_tr_b16 a[46:47], v15 offset:50176
    v_exp_f32 v154, v154
    v_exp_f32 v155, v155
    v_mfma_f32_16x16x32_bf16 a[148:151], a[24:27], v[52:55], a[148:151]
    ds_read_b64_tr_b16 a[48:49], v8 offset:57344
    buffer_load_dword v22, v23, s[52:55], s96 offen
    v_mfma_f32_16x16x32_bf16 a[152:155], a[28:31], v[48:51], a[152:155]
    ds_read_b64_tr_b16 a[50:51], v8 offset:58368
    v_fma_f32 v152, v152, v21, v21
    v_mfma_f32_16x16x32_bf16 a[156:159], a[28:31], v[52:55], a[156:159]
    s_waitcnt lgkmcnt(6)
    ds_read_b64_tr_b16 a[52:53], v9 offset:57344
    v_fma_f32 v153, v153, v21, v21
    v_fma_f32 v154, v154, v21, v21
    v_mfma_f32_16x16x32_bf16 a[160:163], a[32:35], v[48:51], a[160:163]
    ds_read_b64_tr_b16 a[54:55], v9 offset:58368
    v_fma_f32 v155, v155, v21, v21
    v_rcp_f32 v152, v152
    v_mfma_f32_16x16x32_bf16 a[164:167], a[32:35], v[52:55], a[164:167]
    ds_read_b64_tr_b16 a[56:57], v10 offset:57344
    v_rcp_f32 v153, v153
    v_mfma_f32_16x16x32_bf16 a[168:171], a[36:39], v[48:51], a[168:171]
    ds_read_b64_tr_b16 a[58:59], v10 offset:58368
    v_rcp_f32 v154, v154
    v_rcp_f32 v155, v155
    v_mfma_f32_16x16x32_bf16 a[172:175], a[36:39], v[52:55], a[172:175]
    s_waitcnt lgkmcnt(6)
    ds_read_b64_tr_b16 a[60:61], v11 offset:57344
    v_mul_f32 v156, v152, v156
    v_mul_f32 v157, v153, v157
    v_mfma_f32_16x16x32_bf16 a[176:179], a[40:43], v[48:51], a[176:179]
    ds_read_b64_tr_b16 a[62:63], v11 offset:58368
    v_mul_f32 v158, v154, v158
    v_mfma_f32_16x16x32_bf16 a[180:183], a[40:43], v[52:55], a[180:183]
    ds_read_b64_tr_b16 a[0:1], v12 offset:57344
    v_mul_f32 v159, v155, v159
    v_cvt_pk_bf16_f32 v152, v156, v157
    v_mfma_f32_16x16x32_bf16 a[184:187], a[44:47], v[48:51], a[184:187]
    ds_read_b64_tr_b16 a[2:3], v12 offset:58368
    v_cvt_pk_bf16_f32 v153, v158, v159
    v_mul_f32 v160, v18, v160
    v_mfma_f32_16x16x32_bf16 a[188:191], a[44:47], v[52:55], a[188:191]
    s_waitcnt lgkmcnt(6)
    ds_read_b64_tr_b16 a[4:5], v13 offset:57344
    v_mul_f32 v161, v18, v161
    v_mfma_f32_16x16x32_bf16 a[128:131], a[48:51], v[56:59], a[128:131]
    ds_read_b64_tr_b16 a[6:7], v13 offset:58368
    v_mul_f32 v162, v18, v162
    v_mul_f32 v163, v18, v163
    v_mfma_f32_16x16x32_bf16 a[132:135], a[48:51], v[60:63], a[132:135]
    ds_read_b64_tr_b16 a[8:9], v14 offset:57344
    v_exp_f32 v160, v160
    v_exp_f32 v161, v161
    v_mfma_f32_16x16x32_bf16 a[136:139], a[52:55], v[56:59], a[136:139]
    ds_read_b64_tr_b16 a[10:11], v14 offset:58368
    v_exp_f32 v162, v162
    v_mfma_f32_16x16x32_bf16 a[140:143], a[52:55], v[60:63], a[140:143]
    s_waitcnt lgkmcnt(6)
    ds_read_b64_tr_b16 a[12:13], v15 offset:57344
    v_exp_f32 v163, v163
    v_fma_f32 v160, v160, v20, v20
    v_mfma_f32_16x16x32_bf16 a[144:147], a[56:59], v[56:59], a[144:147]
    ds_read_b64_tr_b16 a[14:15], v15 offset:58368
    v_xor_b32 v8, 65536, v8
    v_fma_f32 v161, v161, v20, v20
    v_mfma_f32_16x16x32_bf16 a[148:151], a[56:59], v[60:63], a[148:151]
    ds_read_b64_tr_b16 a[16:17], v8 offset:0
    v_fma_f32 v162, v162, v20, v20
    v_mfma_f32_16x16x32_bf16 a[152:155], a[60:63], v[56:59], a[152:155]
    ds_read_b64_tr_b16 a[18:19], v8 offset:1024
    v_xor_b32 v9, 65536, v9
    v_fma_f32 v163, v163, v20, v20
    v_mfma_f32_16x16x32_bf16 a[156:159], a[60:63], v[60:63], a[156:159]
    s_waitcnt lgkmcnt(6)
    ds_read_b64_tr_b16 a[20:21], v9 offset:0
    v_rcp_f32 v160, v160
    v_rcp_f32 v161, v161
    v_mfma_f32_16x16x32_bf16 a[160:163], a[0:3], v[56:59], a[160:163]
    ds_read_b64_tr_b16 a[22:23], v9 offset:1024
    v_xor_b32 v10, 65536, v10
    v_mfma_f32_16x16x32_bf16 a[164:167], a[0:3], v[60:63], a[164:167]
    ds_read_b64_tr_b16 a[24:25], v10 offset:0
    v_rcp_f32 v162, v162
    v_rcp_f32 v163, v163
    v_mfma_f32_16x16x32_bf16 a[168:171], a[4:7], v[56:59], a[168:171]
    ds_read_b64_tr_b16 a[26:27], v10 offset:1024
    v_xor_b32 v11, 65536, v11
    v_mul_f32 v164, v160, v164
    v_mfma_f32_16x16x32_bf16 a[172:175], a[4:7], v[60:63], a[172:175]
    s_waitcnt lgkmcnt(6)
    ds_read_b64_tr_b16 a[28:29], v11 offset:0
    v_mul_f32 v165, v161, v165
    v_mfma_f32_16x16x32_bf16 a[176:179], a[8:11], v[56:59], a[176:179]
    ds_read_b64_tr_b16 a[30:31], v11 offset:1024
    v_xor_b32 v12, 65536, v12
    v_mul_f32 v166, v162, v166
    v_mfma_f32_16x16x32_bf16 a[180:183], a[8:11], v[60:63], a[180:183]
    ds_read_b64_tr_b16 a[32:33], v12 offset:0
    v_mul_f32 v167, v163, v167
    v_cvt_pk_bf16_f32 v146, v164, v165
    v_mfma_f32_16x16x32_bf16 a[184:187], a[12:15], v[56:59], a[184:187]
    ds_read_b64_tr_b16 a[34:35], v12 offset:1024
    v_xor_b32 v13, 65536, v13
    v_mfma_f32_16x16x32_bf16 a[188:191], a[12:15], v[60:63], a[188:191]
    s_waitcnt lgkmcnt(6)
    ds_read_b64_tr_b16 a[36:37], v13 offset:0
    v_cvt_pk_bf16_f32 v147, v166, v167
    v_mul_f32 v168, v19, v168
    v_mfma_f32_16x16x32_bf16 a[128:131], a[16:19], v[64:67], a[128:131]
    ds_read_b64_tr_b16 a[38:39], v13 offset:1024
    v_xor_b32 v14, 65536, v14
    v_mul_f32 v169, v19, v169
    v_mfma_f32_16x16x32_bf16 a[132:135], a[16:19], v[68:71], a[132:135]
    s_waitcnt lgkmcnt(6)
    ds_read_b64_tr_b16 a[40:41], v14 offset:0
    v_mul_f32 v170, v19, v170
    v_mfma_f32_16x16x32_bf16 a[136:139], a[20:23], v[64:67], a[136:139]
    s_waitcnt vmcnt(14)
    ds_read_b64_tr_b16 a[42:43], v14 offset:1024
    v_xor_b32 v15, 65536, v15
    v_mul_f32 v171, v19, v171
    v_mfma_f32_16x16x32_bf16 a[140:143], a[20:23], v[68:71], a[140:143]
    s_barrier
    ds_read_b64_tr_b16 a[44:45], v15 offset:0
    v_exp_f32 v168, v168
    v_exp_f32 v169, v169
    v_mfma_f32_16x16x32_bf16 a[144:147], a[24:27], v[64:67], a[144:147]
    s_add_u32 m0, s67, 98304
    ds_read_b64_tr_b16 a[46:47], v15 offset:1024
    v_exp_f32 v170, v170
    v_mfma_f32_16x16x32_bf16 a[148:151], a[24:27], v[68:71], a[148:151]
    s_waitcnt lgkmcnt(6)
    s_mov_b32 s72, 0
    ds_read_b64_tr_b16 a[48:49], v8 offset:8192
    v_exp_f32 v171, v171
    v_fma_f32 v168, v168, v21, v21
    v_mfma_f32_16x16x32_bf16 a[152:155], a[28:31], v[64:67], a[152:155]
    ds_read_b64_tr_b16 a[50:51], v8 offset:9216
    buffer_load_dwordx4 v2, s[44:47], s72 offen offset:0 lds
    v_mfma_f32_16x16x32_bf16 a[156:159], a[28:31], v[68:71], a[156:159]
    ds_read_b64_tr_b16 a[52:53], v9 offset:8192
    v_fma_f32 v169, v169, v21, v21
    v_fma_f32 v170, v170, v21, v21
    v_mfma_f32_16x16x32_bf16 a[160:163], a[32:35], v[64:67], a[160:163]
    s_waitcnt lgkmcnt(6)
    ds_read_b64_tr_b16 a[54:55], v9 offset:9216
    v_fma_f32 v171, v171, v21, v21
    v_mfma_f32_16x16x32_bf16 a[164:167], a[32:35], v[68:71], a[164:167]
    s_mov_b32 s73, 6144
    ds_read_b64_tr_b16 a[56:57], v10 offset:8192
    v_rcp_f32 v168, v168
    v_rcp_f32 v169, v169
    v_mfma_f32_16x16x32_bf16 a[168:171], a[36:39], v[64:67], a[168:171]
    ds_read_b64_tr_b16 a[58:59], v10 offset:9216
    buffer_load_dwordx4 v2, s[44:47], s73 offen offset:1024 lds
    v_mfma_f32_16x16x32_bf16 a[172:175], a[36:39], v[68:71], a[172:175]
    s_waitcnt lgkmcnt(6)
    ds_read_b64_tr_b16 a[60:61], v11 offset:8192
    v_rcp_f32 v170, v170
    v_rcp_f32 v171, v171
    v_mfma_f32_16x16x32_bf16 a[176:179], a[40:43], v[64:67], a[176:179]
    ds_read_b64_tr_b16 a[62:63], v11 offset:9216
    v_mul_f32 v172, v168, v172
    v_mfma_f32_16x16x32_bf16 a[180:183], a[40:43], v[68:71], a[180:183]
    s_mov_b32 s74, 12288
    ds_read_b64_tr_b16 a[0:1], v12 offset:8192
    v_mul_f32 v173, v169, v173
    v_mul_f32 v174, v170, v174
    v_mfma_f32_16x16x32_bf16 a[184:187], a[44:47], v[64:67], a[184:187]
    ds_read_b64_tr_b16 a[2:3], v12 offset:9216
    buffer_load_dwordx4 v2, s[44:47], s74 offen offset:2048 lds
    v_mfma_f32_16x16x32_bf16 a[188:191], a[44:47], v[68:71], a[188:191]
    s_waitcnt lgkmcnt(6)
    ds_read_b64_tr_b16 a[4:5], v13 offset:8192
    v_mul_f32 v175, v171, v175
    v_cvt_pk_bf16_f32 v154, v172, v173
    v_mfma_f32_16x16x32_bf16 a[128:131], a[48:51], v[72:75], a[128:131]
    ds_read_b64_tr_b16 a[6:7], v13 offset:9216
    v_cvt_pk_bf16_f32 v155, v174, v175
    v_mfma_f32_16x16x32_bf16 a[132:135], a[48:51], v[76:79], a[132:135]
    s_mov_b32 s75, 18432
    ds_read_b64_tr_b16 a[8:9], v14 offset:8192
    v_mul_f32 v176, v18, v176
    v_mul_f32 v177, v18, v177
    v_mfma_f32_16x16x32_bf16 a[136:139], a[52:55], v[72:75], a[136:139]
    ds_read_b64_tr_b16 a[10:11], v14 offset:9216
    buffer_load_dwordx4 v2, s[44:47], s75 offen offset:3072 lds
    v_mfma_f32_16x16x32_bf16 a[140:143], a[52:55], v[76:79], a[140:143]
    s_waitcnt lgkmcnt(6)
    ds_read_b64_tr_b16 a[12:13], v15 offset:8192
    v_mul_f32 v178, v18, v178
    v_mul_f32 v179, v18, v179
    v_mfma_f32_16x16x32_bf16 a[144:147], a[56:59], v[72:75], a[144:147]
    s_add_u32 m0, s69, 114688
    ds_read_b64_tr_b16 a[14:15], v15 offset:9216
    v_exp_f32 v176, v176
    v_mfma_f32_16x16x32_bf16 a[148:151], a[56:59], v[76:79], a[148:151]
    s_mov_b32 s72, 524544
    ds_read_b64_tr_b16 a[16:17], v8 offset:16384
    v_exp_f32 v177, v177
    v_exp_f32 v178, v178
    v_mfma_f32_16x16x32_bf16 a[152:155], a[60:63], v[72:75], a[152:155]
    ds_read_b64_tr_b16 a[18:19], v8 offset:17408
    buffer_load_dwordx4 v1, s[40:43], s72 offen offset:0 lds
    v_mfma_f32_16x16x32_bf16 a[156:159], a[60:63], v[76:79], a[156:159]
    s_waitcnt lgkmcnt(6)
    ds_read_b64_tr_b16 a[20:21], v9 offset:16384
    v_exp_f32 v179, v179
    v_fma_f32 v176, v176, v20, v20
    v_mfma_f32_16x16x32_bf16 a[160:163], a[0:3], v[72:75], a[160:163]
    ds_read_b64_tr_b16 a[22:23], v9 offset:17408
    v_fma_f32 v177, v177, v20, v20
    v_mfma_f32_16x16x32_bf16 a[164:167], a[0:3], v[76:79], a[164:167]
    s_mov_b32 s73, 556288
    ds_read_b64_tr_b16 a[24:25], v10 offset:16384
    v_fma_f32 v178, v178, v20, v20
    v_fma_f32 v179, v179, v20, v20
    v_mfma_f32_16x16x32_bf16 a[168:171], a[4:7], v[72:75], a[168:171]
    ds_read_b64_tr_b16 a[26:27], v10 offset:17408
    buffer_load_dwordx4 v1, s[40:43], s73 offen offset:1024 lds
    v_mfma_f32_16x16x32_bf16 a[172:175], a[4:7], v[76:79], a[172:175]
    s_waitcnt lgkmcnt(6)
    ds_read_b64_tr_b16 a[28:29], v11 offset:16384
    v_rcp_f32 v176, v176
    v_rcp_f32 v177, v177
    v_mfma_f32_16x16x32_bf16 a[176:179], a[8:11], v[72:75], a[176:179]
    s_add_u32 m0, s69, 118784
    ds_read_b64_tr_b16 a[30:31], v11 offset:17408
    v_rcp_f32 v178, v178
    v_mfma_f32_16x16x32_bf16 a[180:183], a[8:11], v[76:79], a[180:183]
    s_mov_b32 s74, 655616
    ds_read_b64_tr_b16 a[32:33], v12 offset:16384
    v_rcp_f32 v179, v179
    v_mul_f32 v180, v176, v180
    v_mfma_f32_16x16x32_bf16 a[184:187], a[12:15], v[72:75], a[184:187]
    ds_read_b64_tr_b16 a[34:35], v12 offset:17408
    buffer_load_dwordx4 v1, s[40:43], s74 offen offset:0 lds
    v_mfma_f32_16x16x32_bf16 a[188:191], a[12:15], v[76:79], a[188:191]
    s_waitcnt lgkmcnt(6)
    ds_read_b64_tr_b16 a[36:37], v13 offset:16384
    v_mul_f32 v181, v177, v181
    v_mul_f32 v182, v178, v182
    v_mfma_f32_16x16x32_bf16 a[128:131], a[16:19], v[80:83], a[128:131]
    ds_read_b64_tr_b16 a[38:39], v13 offset:17408
    v_mul_f32 v183, v179, v183
    v_mfma_f32_16x16x32_bf16 a[132:135], a[16:19], v[84:87], a[132:135]
    s_mov_b32 s75, 687360
    ds_read_b64_tr_b16 a[40:41], v14 offset:16384
    v_cvt_pk_bf16_f32 v176, v180, v181
    v_cvt_pk_bf16_f32 v177, v182, v183
    v_mfma_f32_16x16x32_bf16 a[136:139], a[20:23], v[80:83], a[136:139]
    ds_read_b64_tr_b16 a[42:43], v14 offset:17408
    buffer_load_dwordx4 v1, s[40:43], s75 offen offset:1024 lds
    v_mfma_f32_16x16x32_bf16 a[140:143], a[20:23], v[84:87], a[140:143]
    s_waitcnt lgkmcnt(6)
    ds_read_b64_tr_b16 a[44:45], v15 offset:16384
    v_mul_f32 v184, v19, v184
    v_mul_f32 v185, v19, v185
    v_mfma_f32_16x16x32_bf16 a[144:147], a[24:27], v[80:83], a[144:147]
    s_mov_b32 s96, 65536
    ds_read_b64_tr_b16 a[46:47], v15 offset:17408
    v_mul_f32 v186, v19, v186
    v_mfma_f32_16x16x32_bf16 a[148:151], a[24:27], v[84:87], a[148:151]
    ds_read_b64_tr_b16 a[48:49], v8 offset:24576
    buffer_load_dword v22, v23, s[48:51], s96 offen
    v_mfma_f32_16x16x32_bf16 a[152:155], a[28:31], v[80:83], a[152:155]
    ds_read_b64_tr_b16 a[50:51], v8 offset:25600
    v_mul_f32 v187, v19, v187
    v_exp_f32 v184, v184
    v_mfma_f32_16x16x32_bf16 a[156:159], a[28:31], v[84:87], a[156:159]
    s_waitcnt lgkmcnt(6)
    ds_read_b64_tr_b16 a[52:53], v9 offset:24576
    v_exp_f32 v185, v185
    v_exp_f32 v186, v186
    v_mfma_f32_16x16x32_bf16 a[160:163], a[32:35], v[80:83], a[160:163]
    ds_read_b64_tr_b16 a[54:55], v9 offset:25600
    v_exp_f32 v187, v187
    v_mfma_f32_16x16x32_bf16 a[164:167], a[32:35], v[84:87], a[164:167]
    ds_read_b64_tr_b16 a[56:57], v10 offset:24576
    v_fma_f32 v184, v184, v21, v21
    v_fma_f32 v185, v185, v21, v21
    v_mfma_f32_16x16x32_bf16 a[168:171], a[36:39], v[80:83], a[168:171]
    ds_read_b64_tr_b16 a[58:59], v10 offset:25600
    v_fma_f32 v186, v186, v21, v21
    v_fma_f32 v187, v187, v21, v21
    v_mfma_f32_16x16x32_bf16 a[172:175], a[36:39], v[84:87], a[172:175]
    s_waitcnt lgkmcnt(6)
    ds_read_b64_tr_b16 a[60:61], v11 offset:24576
    v_rcp_f32 v184, v184
    v_mfma_f32_16x16x32_bf16 a[176:179], a[40:43], v[80:83], a[176:179]
    ds_read_b64_tr_b16 a[62:63], v11 offset:25600
    v_rcp_f32 v185, v185
    v_rcp_f32 v186, v186
    v_mfma_f32_16x16x32_bf16 a[180:183], a[40:43], v[84:87], a[180:183]
    ds_read_b64_tr_b16 a[0:1], v12 offset:24576
    v_rcp_f32 v187, v187
    v_mfma_f32_16x16x32_bf16 a[184:187], a[44:47], v[80:83], a[184:187]
    ds_read_b64_tr_b16 a[2:3], v12 offset:25600
    v_mul_f32 v188, v184, v188
    v_mul_f32 v189, v185, v189
    v_mfma_f32_16x16x32_bf16 a[188:191], a[44:47], v[84:87], a[188:191]
    s_waitcnt lgkmcnt(6)
    ds_read_b64_tr_b16 a[4:5], v13 offset:24576
    v_mul_f32 v190, v186, v190
    v_mul_f32 v191, v187, v191
    v_mfma_f32_16x16x32_bf16 a[128:131], a[48:51], v[88:91], a[128:131]
    ds_read_b64_tr_b16 a[6:7], v13 offset:25600
    v_cvt_pk_bf16_f32 v184, v188, v189
    v_mfma_f32_16x16x32_bf16 a[132:135], a[48:51], v[92:95], a[132:135]
    ds_read_b64_tr_b16 a[8:9], v14 offset:24576
    v_cvt_pk_bf16_f32 v185, v190, v191
    v_mul_f32 v192, v18, v192
    v_mfma_f32_16x16x32_bf16 a[136:139], a[52:55], v[88:91], a[136:139]
    ds_read_b64_tr_b16 a[10:11], v14 offset:25600
    v_mul_f32 v193, v18, v193
    v_mul_f32 v194, v18, v194
    v_mfma_f32_16x16x32_bf16 a[140:143], a[52:55], v[92:95], a[140:143]
    s_waitcnt lgkmcnt(6)
    ds_read_b64_tr_b16 a[12:13], v15 offset:24576
    v_mul_f32 v195, v18, v195
    v_mfma_f32_16x16x32_bf16 a[144:147], a[56:59], v[88:91], a[144:147]
    ds_read_b64_tr_b16 a[14:15], v15 offset:25600
    v_exp_f32 v192, v192
    v_exp_f32 v193, v193
    v_mfma_f32_16x16x32_bf16 a[148:151], a[56:59], v[92:95], a[148:151]
    ds_read_b64_tr_b16 a[16:17], v8 offset:32768
    v_exp_f32 v194, v194
    v_exp_f32 v195, v195
    v_mfma_f32_16x16x32_bf16 a[152:155], a[60:63], v[88:91], a[152:155]
    ds_read_b64_tr_b16 a[18:19], v8 offset:33792
    v_fma_f32 v192, v192, v20, v20
    v_mfma_f32_16x16x32_bf16 a[156:159], a[60:63], v[92:95], a[156:159]
    s_waitcnt lgkmcnt(6)
    ds_read_b64_tr_b16 a[20:21], v9 offset:32768
    v_fma_f32 v193, v193, v20, v20
    v_fma_f32 v194, v194, v20, v20
    v_mfma_f32_16x16x32_bf16 a[160:163], a[0:3], v[88:91], a[160:163]
    ds_read_b64_tr_b16 a[22:23], v9 offset:33792
    v_fma_f32 v195, v195, v20, v20
    v_rcp_f32 v192, v192
    v_mfma_f32_16x16x32_bf16 a[164:167], a[0:3], v[92:95], a[164:167]
    ds_read_b64_tr_b16 a[24:25], v10 offset:32768
    v_rcp_f32 v193, v193
    v_mfma_f32_16x16x32_bf16 a[168:171], a[4:7], v[88:91], a[168:171]
    ds_read_b64_tr_b16 a[26:27], v10 offset:33792
    v_rcp_f32 v194, v194
    v_rcp_f32 v195, v195
    v_mfma_f32_16x16x32_bf16 a[172:175], a[4:7], v[92:95], a[172:175]
    s_waitcnt lgkmcnt(6)
    ds_read_b64_tr_b16 a[28:29], v11 offset:32768
    v_mul_f32 v196, v192, v196
    v_mul_f32 v197, v193, v197
    v_mfma_f32_16x16x32_bf16 a[176:179], a[8:11], v[88:91], a[176:179]
    ds_read_b64_tr_b16 a[30:31], v11 offset:33792
    v_mul_f32 v198, v194, v198
    v_mfma_f32_16x16x32_bf16 a[180:183], a[8:11], v[92:95], a[180:183]
    ds_read_b64_tr_b16 a[32:33], v12 offset:32768
    v_mul_f32 v199, v195, v199
    v_cvt_pk_bf16_f32 v178, v196, v197
    v_mfma_f32_16x16x32_bf16 a[184:187], a[12:15], v[88:91], a[184:187]
    ds_read_b64_tr_b16 a[34:35], v12 offset:33792
    v_cvt_pk_bf16_f32 v179, v198, v199
    v_mul_f32 v200, v19, v200
    v_mfma_f32_16x16x32_bf16 a[188:191], a[12:15], v[92:95], a[188:191]
    s_waitcnt lgkmcnt(6)
    ds_read_b64_tr_b16 a[36:37], v13 offset:32768
    v_mul_f32 v201, v19, v201
    v_mfma_f32_16x16x32_bf16 a[128:131], a[16:19], v[96:99], a[128:131]
    ds_read_b64_tr_b16 a[38:39], v13 offset:33792
    v_mul_f32 v202, v19, v202
    v_mul_f32 v203, v19, v203
    v_mfma_f32_16x16x32_bf16 a[132:135], a[16:19], v[100:103], a[132:135]
    s_waitcnt lgkmcnt(6)
    ds_read_b64_tr_b16 a[40:41], v14 offset:32768
    v_exp_f32 v200, v200
    v_exp_f32 v201, v201
    v_mfma_f32_16x16x32_bf16 a[136:139], a[20:23], v[96:99], a[136:139]
    s_waitcnt vmcnt(14)
    ds_read_b64_tr_b16 a[42:43], v14 offset:33792
    v_exp_f32 v202, v202
    v_mfma_f32_16x16x32_bf16 a[140:143], a[20:23], v[100:103], a[140:143]
    s_barrier
    ds_read_b64_tr_b16 a[44:45], v15 offset:32768
    v_exp_f32 v203, v203
    v_fma_f32 v200, v200, v21, v21
    v_mfma_f32_16x16x32_bf16 a[144:147], a[24:27], v[96:99], a[144:147]
    s_add_u32 m0, s69, 0
    ds_read_b64_tr_b16 a[46:47], v15 offset:33792
    v_fma_f32 v201, v201, v21, v21
    v_fma_f32 v202, v202, v21, v21
    v_mfma_f32_16x16x32_bf16 a[148:151], a[24:27], v[100:103], a[148:151]
    s_waitcnt lgkmcnt(6)
    s_mov_b32 s72, 1048832
    ds_read_b64_tr_b16 a[48:49], v8 offset:40960
    v_fma_f32 v203, v203, v21, v21
    v_mfma_f32_16x16x32_bf16 a[152:155], a[28:31], v[96:99], a[152:155]
    ds_read_b64_tr_b16 a[50:51], v8 offset:41984
    buffer_load_dwordx4 v1, s[40:43], s72 offen offset:0 lds
    v_mfma_f32_16x16x32_bf16 a[156:159], a[28:31], v[100:103], a[156:159]
    ds_read_b64_tr_b16 a[52:53], v9 offset:40960
    v_rcp_f32 v200, v200
    v_rcp_f32 v201, v201
    v_mfma_f32_16x16x32_bf16 a[160:163], a[32:35], v[96:99], a[160:163]
    s_waitcnt lgkmcnt(6)
    ds_read_b64_tr_b16 a[54:55], v9 offset:41984
    v_rcp_f32 v202, v202
    v_rcp_f32 v203, v203
    v_mfma_f32_16x16x32_bf16 a[164:167], a[32:35], v[100:103], a[164:167]
    s_mov_b32 s73, 1080576
    ds_read_b64_tr_b16 a[56:57], v10 offset:40960
    v_mul_f32 v204, v200, v204
    v_mfma_f32_16x16x32_bf16 a[168:171], a[36:39], v[96:99], a[168:171]
    ds_read_b64_tr_b16 a[58:59], v10 offset:41984
    buffer_load_dwordx4 v1, s[40:43], s73 offen offset:1024 lds
    v_mfma_f32_16x16x32_bf16 a[172:175], a[36:39], v[100:103], a[172:175]
    s_waitcnt lgkmcnt(6)
    ds_read_b64_tr_b16 a[60:61], v11 offset:40960
    v_mul_f32 v205, v201, v205
    v_mul_f32 v206, v202, v206
    v_mfma_f32_16x16x32_bf16 a[176:179], a[40:43], v[96:99], a[176:179]
    s_add_u32 m0, s69, 4096
    ds_read_b64_tr_b16 a[62:63], v11 offset:41984
    v_mul_f32 v207, v203, v207
    v_cvt_pk_bf16_f32 v186, v204, v205
    v_mfma_f32_16x16x32_bf16 a[180:183], a[40:43], v[100:103], a[180:183]
    s_mov_b32 s74, 1179904
    ds_read_b64_tr_b16 a[0:1], v12 offset:40960
    v_cvt_pk_bf16_f32 v187, v206, v207
    v_mfma_f32_16x16x32_bf16 a[184:187], a[44:47], v[96:99], a[184:187]
    ds_read_b64_tr_b16 a[2:3], v12 offset:41984
    buffer_load_dwordx4 v1, s[40:43], s74 offen offset:0 lds
    v_mfma_f32_16x16x32_bf16 a[188:191], a[44:47], v[100:103], a[188:191]
    s_waitcnt lgkmcnt(6)
    ds_read_b64_tr_b16 a[4:5], v13 offset:40960
    v_mul_f32 v208, v18, v208
    v_mul_f32 v209, v18, v209
    v_mfma_f32_16x16x32_bf16 a[128:131], a[48:51], v[104:107], a[128:131]
    ds_read_b64_tr_b16 a[6:7], v13 offset:41984
    v_mul_f32 v210, v18, v210
    v_mul_f32 v211, v18, v211
    v_mfma_f32_16x16x32_bf16 a[132:135], a[48:51], v[108:111], a[132:135]
    s_mov_b32 s75, 1211648
    ds_read_b64_tr_b16 a[8:9], v14 offset:40960
    v_exp_f32 v208, v208
    v_mfma_f32_16x16x32_bf16 a[136:139], a[52:55], v[104:107], a[136:139]
    ds_read_b64_tr_b16 a[10:11], v14 offset:41984
    buffer_load_dwordx4 v1, s[40:43], s75 offen offset:1024 lds
    v_mfma_f32_16x16x32_bf16 a[140:143], a[52:55], v[108:111], a[140:143]
    s_waitcnt lgkmcnt(6)
    ds_read_b64_tr_b16 a[12:13], v15 offset:40960
    v_exp_f32 v209, v209
    v_exp_f32 v210, v210
    v_mfma_f32_16x16x32_bf16 a[144:147], a[56:59], v[104:107], a[144:147]
    s_add_u32 m0, s67, 16384
    ds_read_b64_tr_b16 a[14:15], v15 offset:41984
    v_exp_f32 v211, v211
    v_fma_f32 v208, v208, v20, v20
    v_mfma_f32_16x16x32_bf16 a[148:151], a[56:59], v[108:111], a[148:151]
    s_mov_b32 s72, 128
    ds_read_b64_tr_b16 a[16:17], v8 offset:49152
    v_fma_f32 v209, v209, v20, v20
    v_mfma_f32_16x16x32_bf16 a[152:155], a[60:63], v[104:107], a[152:155]
    ds_read_b64_tr_b16 a[18:19], v8 offset:50176
    buffer_load_dwordx4 v2, s[44:47], s72 offen offset:0 lds
    v_mfma_f32_16x16x32_bf16 a[156:159], a[60:63], v[108:111], a[156:159]
    s_waitcnt lgkmcnt(6)
    ds_read_b64_tr_b16 a[20:21], v9 offset:49152
    v_fma_f32 v210, v210, v20, v20
    v_fma_f32 v211, v211, v20, v20
    v_mfma_f32_16x16x32_bf16 a[160:163], a[0:3], v[104:107], a[160:163]
    ds_read_b64_tr_b16 a[22:23], v9 offset:50176
    v_rcp_f32 v208, v208
    v_rcp_f32 v209, v209
    v_mfma_f32_16x16x32_bf16 a[164:167], a[0:3], v[108:111], a[164:167]
    s_mov_b32 s73, 6272
    ds_read_b64_tr_b16 a[24:25], v10 offset:49152
    v_rcp_f32 v210, v210
    v_mfma_f32_16x16x32_bf16 a[168:171], a[4:7], v[104:107], a[168:171]
    ds_read_b64_tr_b16 a[26:27], v10 offset:50176
    buffer_load_dwordx4 v2, s[44:47], s73 offen offset:1024 lds
    v_mfma_f32_16x16x32_bf16 a[172:175], a[4:7], v[108:111], a[172:175]
    s_waitcnt lgkmcnt(6)
    ds_read_b64_tr_b16 a[28:29], v11 offset:49152
    v_rcp_f32 v211, v211
    v_mul_f32 v212, v208, v212
    v_mfma_f32_16x16x32_bf16 a[176:179], a[8:11], v[104:107], a[176:179]
    ds_read_b64_tr_b16 a[30:31], v11 offset:50176
    v_mul_f32 v213, v209, v213
    v_mul_f32 v214, v210, v214
    v_mfma_f32_16x16x32_bf16 a[180:183], a[8:11], v[108:111], a[180:183]
    s_mov_b32 s74, 12416
    ds_read_b64_tr_b16 a[32:33], v12 offset:49152
    v_mul_f32 v215, v211, v215
    v_mfma_f32_16x16x32_bf16 a[184:187], a[12:15], v[104:107], a[184:187]
    ds_read_b64_tr_b16 a[34:35], v12 offset:50176
    buffer_load_dwordx4 v2, s[44:47], s74 offen offset:2048 lds
    v_mfma_f32_16x16x32_bf16 a[188:191], a[12:15], v[108:111], a[188:191]
    s_waitcnt lgkmcnt(6)
    ds_read_b64_tr_b16 a[36:37], v13 offset:49152
    v_cvt_pk_bf16_f32 v208, v212, v213
    v_cvt_pk_bf16_f32 v209, v214, v215
    v_mfma_f32_16x16x32_bf16 a[128:131], a[16:19], v[112:115], a[128:131]
    ds_read_b64_tr_b16 a[38:39], v13 offset:50176
    v_mul_f32 v216, v19, v216
    v_mul_f32 v217, v19, v217
    v_mfma_f32_16x16x32_bf16 a[132:135], a[16:19], v[116:119], a[132:135]
    s_mov_b32 s75, 18560
    ds_read_b64_tr_b16 a[40:41], v14 offset:49152
    v_mul_f32 v218, v19, v218
    v_mfma_f32_16x16x32_bf16 a[136:139], a[20:23], v[112:115], a[136:139]
    ds_read_b64_tr_b16 a[42:43], v14 offset:50176
    buffer_load_dwordx4 v2, s[44:47], s75 offen offset:3072 lds
    v_mfma_f32_16x16x32_bf16 a[140:143], a[20:23], v[116:119], a[140:143]
    s_waitcnt lgkmcnt(6)
    ds_read_b64_tr_b16 a[44:45], v15 offset:49152
    v_mul_f32 v219, v19, v219
    v_exp_f32 v216, v216
    v_mfma_f32_16x16x32_bf16 a[144:147], a[24:27], v[112:115], a[144:147]
    s_mov_b32 s96, 65536
    ds_read_b64_tr_b16 a[46:47], v15 offset:50176
    v_exp_f32 v217, v217
    v_exp_f32 v218, v218
    v_mfma_f32_16x16x32_bf16 a[148:151], a[24:27], v[116:119], a[148:151]
    ds_read_b64_tr_b16 a[48:49], v8 offset:57344
    buffer_load_dword v22, v23, s[52:55], s96 offen
    v_mfma_f32_16x16x32_bf16 a[152:155], a[28:31], v[112:115], a[152:155]
    ds_read_b64_tr_b16 a[50:51], v8 offset:58368
    v_exp_f32 v219, v219
    v_mfma_f32_16x16x32_bf16 a[156:159], a[28:31], v[116:119], a[156:159]
    s_waitcnt lgkmcnt(6)
    ds_read_b64_tr_b16 a[52:53], v9 offset:57344
    v_fma_f32 v216, v216, v21, v21
    v_fma_f32 v217, v217, v21, v21
    v_mfma_f32_16x16x32_bf16 a[160:163], a[32:35], v[112:115], a[160:163]
    ds_read_b64_tr_b16 a[54:55], v9 offset:58368
    v_fma_f32 v218, v218, v21, v21
    v_fma_f32 v219, v219, v21, v21
    v_mfma_f32_16x16x32_bf16 a[164:167], a[32:35], v[116:119], a[164:167]
    ds_read_b64_tr_b16 a[56:57], v10 offset:57344
    v_rcp_f32 v216, v216
    v_mfma_f32_16x16x32_bf16 a[168:171], a[36:39], v[112:115], a[168:171]
    ds_read_b64_tr_b16 a[58:59], v10 offset:58368
    v_rcp_f32 v217, v217
    v_rcp_f32 v218, v218
    v_mfma_f32_16x16x32_bf16 a[172:175], a[36:39], v[116:119], a[172:175]
    s_waitcnt lgkmcnt(6)
    ds_read_b64_tr_b16 a[60:61], v11 offset:57344
    v_rcp_f32 v219, v219
    v_mul_f32 v220, v216, v220
    v_mfma_f32_16x16x32_bf16 a[176:179], a[40:43], v[112:115], a[176:179]
    ds_read_b64_tr_b16 a[62:63], v11 offset:58368
    v_mul_f32 v221, v217, v221
    v_mfma_f32_16x16x32_bf16 a[180:183], a[40:43], v[116:119], a[180:183]
    ds_read_b64_tr_b16 a[0:1], v12 offset:57344
    v_mul_f32 v222, v218, v222
    v_mul_f32 v223, v219, v223
    v_mfma_f32_16x16x32_bf16 a[184:187], a[44:47], v[112:115], a[184:187]
    ds_read_b64_tr_b16 a[2:3], v12 offset:58368
    v_cvt_pk_bf16_f32 v216, v220, v221
    v_cvt_pk_bf16_f32 v217, v222, v223
    v_mfma_f32_16x16x32_bf16 a[188:191], a[44:47], v[116:119], a[188:191]
    s_waitcnt lgkmcnt(6)
    ds_read_b64_tr_b16 a[4:5], v13 offset:57344
    v_mul_f32 v224, v18, v224
    v_mfma_f32_16x16x32_bf16 a[128:131], a[48:51], v[120:123], a[128:131]
    ds_read_b64_tr_b16 a[6:7], v13 offset:58368
    v_mul_f32 v225, v18, v225
    v_mul_f32 v226, v18, v226
    v_mfma_f32_16x16x32_bf16 a[132:135], a[48:51], v[124:127], a[132:135]
    ds_read_b64_tr_b16 a[8:9], v14 offset:57344
    v_mul_f32 v227, v18, v227
    v_exp_f32 v224, v224
    v_mfma_f32_16x16x32_bf16 a[136:139], a[52:55], v[120:123], a[136:139]
    ds_read_b64_tr_b16 a[10:11], v14 offset:58368
    v_exp_f32 v225, v225
    v_mfma_f32_16x16x32_bf16 a[140:143], a[52:55], v[124:127], a[140:143]
    s_waitcnt lgkmcnt(6)
    ds_read_b64_tr_b16 a[12:13], v15 offset:57344
    v_exp_f32 v226, v226
    v_exp_f32 v227, v227
    v_mfma_f32_16x16x32_bf16 a[144:147], a[56:59], v[120:123], a[144:147]
    ds_read_b64_tr_b16 a[14:15], v15 offset:58368
    v_xor_b32 v8, 65536, v8
    v_fma_f32 v224, v224, v20, v20
    v_mfma_f32_16x16x32_bf16 a[148:151], a[56:59], v[124:127], a[148:151]
    ds_read_b64_tr_b16 a[16:17], v8 offset:0
    v_fma_f32 v225, v225, v20, v20
    v_mfma_f32_16x16x32_bf16 a[152:155], a[60:63], v[120:123], a[152:155]
    ds_read_b64_tr_b16 a[18:19], v8 offset:1024
    v_xor_b32 v9, 65536, v9
    v_fma_f32 v226, v226, v20, v20
    v_mfma_f32_16x16x32_bf16 a[156:159], a[60:63], v[124:127], a[156:159]
    s_waitcnt lgkmcnt(6)
    ds_read_b64_tr_b16 a[20:21], v9 offset:0
    v_fma_f32 v227, v227, v20, v20
    v_rcp_f32 v224, v224
    v_mfma_f32_16x16x32_bf16 a[160:163], a[0:3], v[120:123], a[160:163]
    ds_read_b64_tr_b16 a[22:23], v9 offset:1024
    v_xor_b32 v10, 65536, v10
    v_mfma_f32_16x16x32_bf16 a[164:167], a[0:3], v[124:127], a[164:167]
    ds_read_b64_tr_b16 a[24:25], v10 offset:0
    v_rcp_f32 v225, v225
    v_rcp_f32 v226, v226
    v_mfma_f32_16x16x32_bf16 a[168:171], a[4:7], v[120:123], a[168:171]
    ds_read_b64_tr_b16 a[26:27], v10 offset:1024
    v_xor_b32 v11, 65536, v11
    v_rcp_f32 v227, v227
    v_mfma_f32_16x16x32_bf16 a[172:175], a[4:7], v[124:127], a[172:175]
    s_waitcnt lgkmcnt(6)
    ds_read_b64_tr_b16 a[28:29], v11 offset:0
    v_mul_f32 v228, v224, v228
    v_mfma_f32_16x16x32_bf16 a[176:179], a[8:11], v[120:123], a[176:179]
    ds_read_b64_tr_b16 a[30:31], v11 offset:1024
    v_xor_b32 v12, 65536, v12
    v_mul_f32 v229, v225, v229
    v_mfma_f32_16x16x32_bf16 a[180:183], a[8:11], v[124:127], a[180:183]
    ds_read_b64_tr_b16 a[32:33], v12 offset:0
    v_mul_f32 v230, v226, v230
    v_mul_f32 v231, v227, v231
    v_mfma_f32_16x16x32_bf16 a[184:187], a[12:15], v[120:123], a[184:187]
    ds_read_b64_tr_b16 a[34:35], v12 offset:1024
    v_xor_b32 v13, 65536, v13
    v_mfma_f32_16x16x32_bf16 a[188:191], a[12:15], v[124:127], a[188:191]
    s_waitcnt lgkmcnt(6)
    ds_read_b64_tr_b16 a[36:37], v13 offset:0
    v_cvt_pk_bf16_f32 v210, v228, v229
    v_cvt_pk_bf16_f32 v211, v230, v231
    v_mfma_f32_16x16x32_bf16 a[128:131], a[16:19], v[128:131], a[128:131]
    ds_read_b64_tr_b16 a[38:39], v13 offset:1024
    v_xor_b32 v14, 65536, v14
    v_mul_f32 v232, v19, v232
    v_mfma_f32_16x16x32_bf16 a[132:135], a[16:19], v[132:135], a[132:135]
    s_waitcnt lgkmcnt(6)
    ds_read_b64_tr_b16 a[40:41], v14 offset:0
    v_mul_f32 v233, v19, v233
    v_mfma_f32_16x16x32_bf16 a[136:139], a[20:23], v[128:131], a[136:139]
    s_waitcnt vmcnt(14)
    ds_read_b64_tr_b16 a[42:43], v14 offset:1024
    v_xor_b32 v15, 65536, v15
    v_mul_f32 v234, v19, v234
    v_mfma_f32_16x16x32_bf16 a[140:143], a[20:23], v[132:135], a[140:143]
    s_barrier
    ds_read_b64_tr_b16 a[44:45], v15 offset:0
    v_mul_f32 v235, v19, v235
    v_exp_f32 v232, v232
    v_mfma_f32_16x16x32_bf16 a[144:147], a[24:27], v[128:131], a[144:147]
    s_add_u32 m0, s69, 32768
    ds_read_b64_tr_b16 a[46:47], v15 offset:1024
    v_exp_f32 v233, v233
    v_mfma_f32_16x16x32_bf16 a[148:151], a[24:27], v[132:135], a[148:151]
    s_waitcnt lgkmcnt(6)
    s_mov_b32 s72, 1573120
    ds_read_b64_tr_b16 a[48:49], v8 offset:8192
    v_exp_f32 v234, v234
    v_exp_f32 v235, v235
    v_mfma_f32_16x16x32_bf16 a[152:155], a[28:31], v[128:131], a[152:155]
    ds_read_b64_tr_b16 a[50:51], v8 offset:9216
    buffer_load_dwordx4 v1, s[40:43], s72 offen offset:0 lds
    v_mfma_f32_16x16x32_bf16 a[156:159], a[28:31], v[132:135], a[156:159]
    ds_read_b64_tr_b16 a[52:53], v9 offset:8192
    v_fma_f32 v232, v232, v21, v21
    v_fma_f32 v233, v233, v21, v21
    v_mfma_f32_16x16x32_bf16 a[160:163], a[32:35], v[128:131], a[160:163]
    s_waitcnt lgkmcnt(6)
    ds_read_b64_tr_b16 a[54:55], v9 offset:9216
    v_fma_f32 v234, v234, v21, v21
    v_mfma_f32_16x16x32_bf16 a[164:167], a[32:35], v[132:135], a[164:167]
    s_mov_b32 s73, 1604864
    ds_read_b64_tr_b16 a[56:57], v10 offset:8192
    v_fma_f32 v235, v235, v21, v21
    v_rcp_f32 v232, v232
    v_mfma_f32_16x16x32_bf16 a[168:171], a[36:39], v[128:131], a[168:171]
    ds_read_b64_tr_b16 a[58:59], v10 offset:9216
    buffer_load_dwordx4 v1, s[40:43], s73 offen offset:1024 lds
    v_mfma_f32_16x16x32_bf16 a[172:175], a[36:39], v[132:135], a[172:175]
    s_waitcnt lgkmcnt(6)
    ds_read_b64_tr_b16 a[60:61], v11 offset:8192
    v_rcp_f32 v233, v233
    v_rcp_f32 v234, v234
    v_mfma_f32_16x16x32_bf16 a[176:179], a[40:43], v[128:131], a[176:179]
    s_add_u32 m0, s69, 36864
    ds_read_b64_tr_b16 a[62:63], v11 offset:9216
    v_rcp_f32 v235, v235
    v_mfma_f32_16x16x32_bf16 a[180:183], a[40:43], v[132:135], a[180:183]
    s_mov_b32 s74, 1704192
    ds_read_b64_tr_b16 a[0:1], v12 offset:8192
    v_mul_f32 v236, v232, v236
    v_mul_f32 v237, v233, v237
    v_mfma_f32_16x16x32_bf16 a[184:187], a[44:47], v[128:131], a[184:187]
    ds_read_b64_tr_b16 a[2:3], v12 offset:9216
    buffer_load_dwordx4 v1, s[40:43], s74 offen offset:0 lds
    v_mfma_f32_16x16x32_bf16 a[188:191], a[44:47], v[132:135], a[188:191]
    s_waitcnt lgkmcnt(6)
    ds_read_b64_tr_b16 a[4:5], v13 offset:8192
    v_mul_f32 v238, v234, v238
    v_mul_f32 v239, v235, v239
    v_mfma_f32_16x16x32_bf16 a[128:131], a[48:51], v[136:139], a[128:131]
    ds_read_b64_tr_b16 a[6:7], v13 offset:9216
    v_cvt_pk_bf16_f32 v218, v236, v237
    v_mfma_f32_16x16x32_bf16 a[132:135], a[48:51], v[140:143], a[132:135]
    s_mov_b32 s75, 1735936
    ds_read_b64_tr_b16 a[8:9], v14 offset:8192
    v_cvt_pk_bf16_f32 v219, v238, v239
    v_mul_f32 v240, v18, v240
    v_mfma_f32_16x16x32_bf16 a[136:139], a[52:55], v[136:139], a[136:139]
    ds_read_b64_tr_b16 a[10:11], v14 offset:9216
    buffer_load_dwordx4 v1, s[40:43], s75 offen offset:1024 lds
    v_mfma_f32_16x16x32_bf16 a[140:143], a[52:55], v[140:143], a[140:143]
    s_waitcnt lgkmcnt(6)
    ds_read_b64_tr_b16 a[12:13], v15 offset:8192
    v_mul_f32 v241, v18, v241
    v_mul_f32 v242, v18, v242
    v_mfma_f32_16x16x32_bf16 a[144:147], a[56:59], v[136:139], a[144:147]
    s_add_u32 m0, s69, 49152
    ds_read_b64_tr_b16 a[14:15], v15 offset:9216
    v_mul_f32 v243, v18, v243
    v_mfma_f32_16x16x32_bf16 a[148:151], a[56:59], v[140:143], a[148:151]
    s_mov_b32 s72, 2097408
    ds_read_b64_tr_b16 a[16:17], v8 offset:16384
    v_exp_f32 v240, v240
    v_exp_f32 v241, v241
    v_mfma_f32_16x16x32_bf16 a[152:155], a[60:63], v[136:139], a[152:155]
    ds_read_b64_tr_b16 a[18:19], v8 offset:17408
    buffer_load_dwordx4 v1, s[40:43], s72 offen offset:0 lds
    v_mfma_f32_16x16x32_bf16 a[156:159], a[60:63], v[140:143], a[156:159]
    s_waitcnt lgkmcnt(6)
    ds_read_b64_tr_b16 a[20:21], v9 offset:16384
    v_exp_f32 v242, v242
    v_exp_f32 v243, v243
    v_mfma_f32_16x16x32_bf16 a[160:163], a[0:3], v[136:139], a[160:163]
    ds_read_b64_tr_b16 a[22:23], v9 offset:17408
    v_fma_f32 v240, v240, v20, v20
    v_mfma_f32_16x16x32_bf16 a[164:167], a[0:3], v[140:143], a[164:167]
    s_mov_b32 s73, 2129152
    ds_read_b64_tr_b16 a[24:25], v10 offset:16384
    v_fma_f32 v241, v241, v20, v20
    v_fma_f32 v242, v242, v20, v20
    v_mfma_f32_16x16x32_bf16 a[168:171], a[4:7], v[136:139], a[168:171]
    ds_read_b64_tr_b16 a[26:27], v10 offset:17408
    buffer_load_dwordx4 v1, s[40:43], s73 offen offset:1024 lds
    v_mfma_f32_16x16x32_bf16 a[172:175], a[4:7], v[140:143], a[172:175]
    s_waitcnt lgkmcnt(6)
    ds_read_b64_tr_b16 a[28:29], v11 offset:16384
    v_fma_f32 v243, v243, v20, v20
    v_rcp_f32 v240, v240
    v_mfma_f32_16x16x32_bf16 a[176:179], a[8:11], v[136:139], a[176:179]
    s_add_u32 m0, s69, 53248
    ds_read_b64_tr_b16 a[30:31], v11 offset:17408
    v_rcp_f32 v241, v241
    v_mfma_f32_16x16x32_bf16 a[180:183], a[8:11], v[140:143], a[180:183]
    s_mov_b32 s74, 2228480
    ds_read_b64_tr_b16 a[32:33], v12 offset:16384
    v_rcp_f32 v242, v242
    v_rcp_f32 v243, v243
    v_mfma_f32_16x16x32_bf16 a[184:187], a[12:15], v[136:139], a[184:187]
    ds_read_b64_tr_b16 a[34:35], v12 offset:17408
    buffer_load_dwordx4 v1, s[40:43], s74 offen offset:0 lds
    v_mfma_f32_16x16x32_bf16 a[188:191], a[12:15], v[140:143], a[188:191]
    s_waitcnt lgkmcnt(6)
    ds_read_b64_tr_b16 a[36:37], v13 offset:16384
    v_mul_f32 v244, v240, v244
    v_mul_f32 v245, v241, v245
    v_mfma_f32_16x16x32_bf16 a[192:195], a[16:19], v[32:35], 0
    ds_read_b64_tr_b16 a[38:39], v13 offset:17408
    v_mul_f32 v246, v242, v246
    v_mfma_f32_16x16x32_bf16 a[196:199], a[16:19], v[36:39], 0
    s_mov_b32 s75, 2260224
    ds_read_b64_tr_b16 a[40:41], v14 offset:16384
    v_mul_f32 v247, v243, v247
    v_cvt_pk_bf16_f32 v240, v244, v245
    v_mfma_f32_16x16x32_bf16 a[200:203], a[20:23], v[32:35], 0
    ds_read_b64_tr_b16 a[42:43], v14 offset:17408
    buffer_load_dwordx4 v1, s[40:43], s75 offen offset:1024 lds
    v_mfma_f32_16x16x32_bf16 a[204:207], a[20:23], v[36:39], 0
    s_waitcnt lgkmcnt(6)
    ds_read_b64_tr_b16 a[44:45], v15 offset:16384
    v_cvt_pk_bf16_f32 v241, v246, v247
    v_mul_f32 v248, v19, v248
    v_mfma_f32_16x16x32_bf16 a[208:211], a[24:27], v[32:35], 0
    ds_read_b64_tr_b16 a[46:47], v15 offset:17408
    v_mul_f32 v249, v19, v249
    v_mfma_f32_16x16x32_bf16 a[212:215], a[24:27], v[36:39], 0
    ds_read_b64_tr_b16 a[48:49], v8 offset:24576
    v_mul_f32 v250, v19, v250
    v_mul_f32 v251, v19, v251
    v_mfma_f32_16x16x32_bf16 a[216:219], a[28:31], v[32:35], 0
    ds_read_b64_tr_b16 a[50:51], v8 offset:25600
    v_exp_f32 v248, v248
    v_exp_f32 v249, v249
    v_mfma_f32_16x16x32_bf16 a[220:223], a[28:31], v[36:39], 0
    s_waitcnt lgkmcnt(6)
    ds_read_b64_tr_b16 a[52:53], v9 offset:24576
    v_exp_f32 v250, v250
    v_mfma_f32_16x16x32_bf16 a[224:227], a[32:35], v[32:35], 0
    ds_read_b64_tr_b16 a[54:55], v9 offset:25600
    v_exp_f32 v251, v251
    v_fma_f32 v248, v248, v21, v21
    v_mfma_f32_16x16x32_bf16 a[228:231], a[32:35], v[36:39], 0
    ds_read_b64_tr_b16 a[56:57], v10 offset:24576
    v_fma_f32 v249, v249, v21, v21
    v_fma_f32 v250, v250, v21, v21
    v_mfma_f32_16x16x32_bf16 a[232:235], a[36:39], v[32:35], 0
    ds_read_b64_tr_b16 a[58:59], v10 offset:25600
    v_fma_f32 v251, v251, v21, v21
    v_mfma_f32_16x16x32_bf16 a[236:239], a[36:39], v[36:39], 0
    s_waitcnt lgkmcnt(6)
    ds_read_b64_tr_b16 a[60:61], v11 offset:24576
    v_rcp_f32 v248, v248
    v_rcp_f32 v249, v249
    v_mfma_f32_16x16x32_bf16 a[240:243], a[40:43], v[32:35], 0
    ds_read_b64_tr_b16 a[62:63], v11 offset:25600
    v_rcp_f32 v250, v250
    v_rcp_f32 v251, v251
    v_mfma_f32_16x16x32_bf16 a[244:247], a[40:43], v[36:39], 0
    ds_read_b64_tr_b16 a[0:1], v12 offset:24576
    v_mul_f32 v252, v248, v252
    v_mfma_f32_16x16x32_bf16 a[248:251], a[44:47], v[32:35], 0
    ds_read_b64_tr_b16 a[2:3], v12 offset:25600
    v_mul_f32 v253, v249, v253
    v_mul_f32 v254, v250, v254
    v_mfma_f32_16x16x32_bf16 a[252:255], a[44:47], v[36:39], 0
    s_waitcnt lgkmcnt(6)
    ds_read_b64_tr_b16 a[4:5], v13 offset:24576
    v_mul_f32 v255, v251, v255
    v_cvt_pk_bf16_f32 v248, v252, v253
    v_mfma_f32_16x16x32_bf16 a[192:195], a[48:51], v[40:43], a[192:195]
    ds_read_b64_tr_b16 a[6:7], v13 offset:25600
    v_cvt_pk_bf16_f32 v249, v254, v255
    v_mfma_f32_16x16x32_bf16 a[196:199], a[48:51], v[44:47], a[196:199]
    ds_read_b64_tr_b16 a[8:9], v14 offset:24576
    v_xor_b32 v18, 32, v7
    v_xor_b32 v19, 64, v7
    v_mfma_f32_16x16x32_bf16 a[200:203], a[52:55], v[40:43], a[200:203]
    ds_read_b64_tr_b16 a[10:11], v14 offset:25600
    v_xor_b32 v20, 96, v7
    v_mfma_f32_16x16x32_bf16 a[204:207], a[52:55], v[44:47], a[204:207]
    s_waitcnt lgkmcnt(6)
    ds_read_b64_tr_b16 a[12:13], v15 offset:24576
    v_accvgpr_read_b32 v24, a128
    v_accvgpr_read_b32 v25, a129
    v_mfma_f32_16x16x32_bf16 a[208:211], a[56:59], v[40:43], a[208:211]
    ds_read_b64_tr_b16 a[14:15], v15 offset:25600
    v_xor_b32 v7, 65536, v7
    v_mfma_f32_16x16x32_bf16 a[212:215], a[56:59], v[44:47], a[212:215]
    ds_read_b64_tr_b16 a[16:17], v7 offset:32768
    v_accvgpr_read_b32 v26, a130
    v_mfma_f32_16x16x32_bf16 a[216:219], a[60:63], v[40:43], a[216:219]
    ds_read_b64_tr_b16 a[18:19], v7 offset:34816
    v_accvgpr_read_b32 v27, a131
    v_mfma_f32_16x16x32_bf16 a[220:223], a[60:63], v[44:47], a[220:223]
    s_waitcnt lgkmcnt(6)
    ds_read_b64_tr_b16 a[20:21], v7 offset:36864
    v_accvgpr_read_b32 v28, a136
    v_mfma_f32_16x16x32_bf16 a[224:227], a[0:3], v[40:43], a[224:227]
    ds_read_b64_tr_b16 a[22:23], v7 offset:38912
    v_accvgpr_read_b32 v29, a137
    v_mfma_f32_16x16x32_bf16 a[228:231], a[0:3], v[44:47], a[228:231]
    ds_read_b64_tr_b16 a[24:25], v7 offset:40960
    v_accvgpr_read_b32 v30, a138
    v_mfma_f32_16x16x32_bf16 a[232:235], a[4:7], v[40:43], a[232:235]
    ds_read_b64_tr_b16 a[26:27], v7 offset:43008
    v_accvgpr_read_b32 v31, a139
    v_mfma_f32_16x16x32_bf16 a[236:239], a[4:7], v[44:47], a[236:239]
    s_waitcnt lgkmcnt(6)
    ds_read_b64_tr_b16 a[28:29], v7 offset:45056
    v_mul_f32 v24, v16, v24
    v_mfma_f32_16x16x32_bf16 a[240:243], a[8:11], v[40:43], a[240:243]
    v_xor_b32 v18, 65536, v18
    v_mul_f32 v25, v16, v25
    v_mfma_f32_16x16x32_bf16 a[244:247], a[8:11], v[44:47], a[244:247]
    ds_read_b64_tr_b16 a[32:33], v18 offset:32768
    v_mul_f32 v26, v16, v26
    v_mfma_f32_16x16x32_bf16 a[248:251], a[12:15], v[40:43], a[248:251]
    ds_read_b64_tr_b16 a[34:35], v18 offset:34816
    v_mul_f32 v27, v16, v27
    v_mfma_f32_16x16x32_bf16 a[252:255], a[12:15], v[44:47], a[252:255]
    s_waitcnt lgkmcnt(5)
    ds_read_b64_tr_b16 a[36:37], v18 offset:36864
    v_mul_f32 v28, v16, v28
    v_mul_f32 v29, v16, v29
    v_mfma_f32_16x16x32_bf16 v[160:163], a[16:19], v[144:147], 0
    s_mul_i32 s96, s66, 20480
    ds_read_b64_tr_b16 a[38:39], v18 offset:38912
    v_mul_f32 v30, v16, v30
    v_mfma_f32_16x16x32_bf16 v[164:167], a[16:19], v[152:155], 0
    s_sub_u32 s96, 131072, s96
    ds_read_b64_tr_b16 a[40:41], v18 offset:40960
    v_mul_f32 v31, v16, v31
    v_mfma_f32_16x16x32_bf16 v[160:163], a[20:23], v[176:179], v[160:163]
    s_waitcnt vmcnt(13)
    ds_read_b64_tr_b16 a[42:43], v18 offset:43008
    v_add_u32 v44, s96, v3
    v_mfma_f32_16x16x32_bf16 v[164:167], a[20:23], v[184:187], v[164:167]
    s_waitcnt lgkmcnt(6)
    s_barrier
    ds_read_b64_tr_b16 a[44:45], v18 offset:45056
    v_xor_b32 v45, 8192, v44
    v_mfma_f32_16x16x32_bf16 v[160:163], a[24:27], v[208:211], v[160:163]
    s_add_u32 m0, s67, 65536
    v_xor_b32 v19, 65536, v19
    v_cvt_pk_bf16_f32 v212, v24, v25
    v_mfma_f32_16x16x32_bf16 v[164:167], a[24:27], v[216:219], v[164:167]
    s_mov_b32 s72, 256
    ds_read_b64_tr_b16 a[48:49], v19 offset:32768
    v_cvt_pk_bf16_f32 v213, v26, v27
    v_mfma_f32_16x16x16_bf16 v[160:163], a[28:29], v[240:241], v[160:163]
    ds_read_b64_tr_b16 a[50:51], v19 offset:34816
    buffer_load_dwordx4 v2, s[44:47], s72 offen offset:0 lds
    v_mfma_f32_16x16x16_bf16 v[164:167], a[28:29], v[248:249], v[164:167]
    s_waitcnt lgkmcnt(5)
    ds_read_b64_tr_b16 a[52:53], v19 offset:36864
    v_cvt_pk_bf16_f32 v214, v28, v29
    v_mfma_f32_16x16x32_bf16 v[168:171], a[32:35], v[144:147], 0
    ds_read_b64_tr_b16 a[54:55], v19 offset:38912
    v_cvt_pk_bf16_f32 v215, v30, v31
    v_mfma_f32_16x16x32_bf16 v[172:175], a[32:35], v[152:155], 0
    s_mov_b32 s73, 6400
    ds_read_b64_tr_b16 a[56:57], v19 offset:40960
    v_permlane16_swap_b32 v212, v214
    v_mfma_f32_16x16x32_bf16 v[168:171], a[36:39], v[176:179], v[168:171]
    ds_read_b64_tr_b16 a[58:59], v19 offset:43008
    buffer_load_dwordx4 v2, s[44:47], s73 offen offset:1024 lds
    v_mfma_f32_16x16x32_bf16 v[172:175], a[36:39], v[184:187], v[172:175]
    s_waitcnt lgkmcnt(6)
    ds_read_b64_tr_b16 a[60:61], v19 offset:45056
    v_permlane16_swap_b32 v213, v215
    v_mfma_f32_16x16x32_bf16 v[168:171], a[40:43], v[208:211], v[168:171]
    ds_write_b128 v44, v[212:215] offset:0
    v_xor_b32 v20, 65536, v20
    v_accvgpr_read_b32 v24, a132
    v_mfma_f32_16x16x32_bf16 v[172:175], a[40:43], v[216:219], v[172:175]
    s_mov_b32 s74, 12544
    ds_read_b64_tr_b16 a[0:1], v20 offset:32768
    v_accvgpr_read_b32 v25, a133
    v_accvgpr_read_b32 v26, a134
    v_mfma_f32_16x16x16_bf16 v[168:171], a[44:45], v[240:241], v[168:171]
    ds_read_b64_tr_b16 a[2:3], v20 offset:34816
    buffer_load_dwordx4 v2, s[44:47], s74 offen offset:2048 lds
    v_mfma_f32_16x16x16_bf16 v[172:175], a[44:45], v[248:249], v[172:175]
    s_waitcnt lgkmcnt(6)
    ds_read_b64_tr_b16 a[4:5], v20 offset:36864
    v_accvgpr_read_b32 v27, a135
    v_mfma_f32_16x16x32_bf16 v[192:195], a[48:51], v[144:147], 0
    ds_read_b64_tr_b16 a[6:7], v20 offset:38912
    v_accvgpr_read_b32 v28, a140
    v_mfma_f32_16x16x32_bf16 v[196:199], a[48:51], v[152:155], 0
    s_mov_b32 s75, 18688
    ds_read_b64_tr_b16 a[8:9], v20 offset:40960
    v_accvgpr_read_b32 v29, a141
    v_mfma_f32_16x16x32_bf16 v[192:195], a[52:55], v[176:179], v[192:195]
    ds_read_b64_tr_b16 a[10:11], v20 offset:43008
    buffer_load_dwordx4 v2, s[44:47], s75 offen offset:3072 lds
    v_mfma_f32_16x16x32_bf16 v[196:199], a[52:55], v[184:187], v[196:199]
    s_waitcnt lgkmcnt(6)
    ds_read_b64_tr_b16 a[12:13], v20 offset:45056
    v_cvt_pk_bf16_f32 v160, v160, v161
    v_mfma_f32_16x16x32_bf16 v[192:195], a[56:59], v[208:211], v[192:195]
    s_add_u32 m0, s69, 81920
    v_cvt_pk_bf16_f32 v161, v162, v163
    v_accvgpr_read_b32 v30, a142
    v_mfma_f32_16x16x32_bf16 v[196:199], a[56:59], v[216:219], v[196:199]
    s_mov_b32 s72, 2621696
    ds_read_b64_tr_b16 a[16:17], v8 offset:49152
    v_cvt_pk_bf16_f32 v162, v168, v169
    v_mfma_f32_16x16x16_bf16 v[192:195], a[60:61], v[240:241], v[192:195]
    ds_read_b64_tr_b16 a[18:19], v8 offset:50176
    buffer_load_dwordx4 v1, s[40:43], s72 offen offset:0 lds
    v_mfma_f32_16x16x16_bf16 v[196:199], a[60:61], v[248:249], v[196:199]
    s_waitcnt lgkmcnt(5)
    ds_read_b64_tr_b16 a[20:21], v9 offset:49152
    v_cvt_pk_bf16_f32 v163, v170, v171
    v_mfma_f32_16x16x32_bf16 v[200:203], a[0:3], v[144:147], 0
    s_add_u32 s89, s3, 0
    ds_read_b64_tr_b16 a[22:23], v9 offset:50176
    v_accvgpr_read_b32 v31, a143
    v_mfma_f32_16x16x32_bf16 v[204:207], a[0:3], v[152:155], 0
    s_mov_b32 s73, 2653440
    ds_read_b64_tr_b16 a[24:25], v10 offset:49152
    buffer_store_dwordx4 v[160:163], v3, s[8:11], s89 offen sc1
    v_mfma_f32_16x16x32_bf16 v[200:203], a[4:7], v[176:179], v[200:203]
    ds_read_b64_tr_b16 a[26:27], v10 offset:50176
    buffer_load_dwordx4 v1, s[40:43], s73 offen offset:1024 lds
    v_mfma_f32_16x16x32_bf16 v[204:207], a[4:7], v[184:187], v[204:207]
    s_waitcnt lgkmcnt(6)
    ds_read_b64_tr_b16 a[28:29], v11 offset:49152
    v_cvt_pk_bf16_f32 v164, v164, v165
    v_mfma_f32_16x16x32_bf16 v[200:203], a[8:11], v[208:211], v[200:203]
    s_add_u32 m0, s69, 86016
    ds_read_b64_tr_b16 a[30:31], v11 offset:50176
    v_cvt_pk_bf16_f32 v165, v166, v167
    v_mfma_f32_16x16x32_bf16 v[204:207], a[8:11], v[216:219], v[204:207]
    s_mov_b32 s74, 2752768
    ds_read_b64_tr_b16 a[32:33], v12 offset:49152
    v_cvt_pk_bf16_f32 v166, v172, v173
    v_mfma_f32_16x16x16_bf16 v[200:203], a[12:13], v[240:241], v[200:203]
    ds_read_b64_tr_b16 a[34:35], v12 offset:50176
    buffer_load_dwordx4 v1, s[40:43], s74 offen offset:0 lds
    v_mfma_f32_16x16x16_bf16 v[204:207], a[12:13], v[248:249], v[204:207]
    s_waitcnt lgkmcnt(6)
    ds_read_b64_tr_b16 a[36:37], v13 offset:49152
    v_cvt_pk_bf16_f32 v167, v174, v175
    v_mul_f32 v24, v17, v24
    v_mfma_f32_16x16x32_bf16 a[192:195], a[16:19], v[48:51], a[192:195]
    s_add_u32 s89, s3, 3678208
    ds_read_b64_tr_b16 a[38:39], v13 offset:50176
    v_mul_f32 v25, v17, v25
    v_mfma_f32_16x16x32_bf16 a[196:199], a[16:19], v[52:55], a[196:199]
    s_mov_b32 s75, 2784512
    ds_read_b64_tr_b16 a[40:41], v14 offset:49152
    buffer_store_dwordx4 v[164:167], v3, s[8:11], s89 offen sc1
    v_mfma_f32_16x16x32_bf16 a[200:203], a[20:23], v[48:51], a[200:203]
    ds_read_b64_tr_b16 a[42:43], v14 offset:50176
    buffer_load_dwordx4 v1, s[40:43], s75 offen offset:1024 lds
    v_mfma_f32_16x16x32_bf16 a[204:207], a[20:23], v[52:55], a[204:207]
    s_waitcnt lgkmcnt(6)
    ds_read_b64_tr_b16 a[44:45], v15 offset:49152
    v_cvt_pk_bf16_f32 v192, v192, v193
    v_mfma_f32_16x16x32_bf16 a[208:211], a[24:27], v[48:51], a[208:211]
    ds_read_b64_tr_b16 a[46:47], v15 offset:50176
    v_cvt_pk_bf16_f32 v193, v194, v195
    v_mfma_f32_16x16x32_bf16 a[212:215], a[24:27], v[52:55], a[212:215]
    ds_read_b64_tr_b16 a[48:49], v8 offset:57344
    v_cvt_pk_bf16_f32 v194, v200, v201
    v_mfma_f32_16x16x32_bf16 a[216:219], a[28:31], v[48:51], a[216:219]
    s_waitcnt lgkmcnt(6)
    ds_read_b64_tr_b16 a[50:51], v8 offset:58368
    v_cvt_pk_bf16_f32 v195, v202, v203
    v_mfma_f32_16x16x32_bf16 a[220:223], a[28:31], v[52:55], a[220:223]
    s_add_u32 s89, s3, 1839104
    ds_read_b64_tr_b16 a[52:53], v9 offset:57344
    v_mul_f32 v26, v17, v26
    v_mfma_f32_16x16x32_bf16 a[224:227], a[32:35], v[48:51], a[224:227]
    ds_read_b64_tr_b16 a[54:55], v9 offset:58368
    buffer_store_dwordx4 v[192:195], v3, s[8:11], s89 offen sc1
    v_mfma_f32_16x16x32_bf16 a[228:231], a[32:35], v[52:55], a[228:231]
    s_waitcnt lgkmcnt(6)
    ds_read_b64_tr_b16 a[56:57], v10 offset:57344
    v_cvt_pk_bf16_f32 v196, v196, v197
    v_mfma_f32_16x16x32_bf16 a[232:235], a[36:39], v[48:51], a[232:235]
    ds_read_b64_tr_b16 a[58:59], v10 offset:58368
    v_cvt_pk_bf16_f32 v197, v198, v199
    v_mfma_f32_16x16x32_bf16 a[236:239], a[36:39], v[52:55], a[236:239]
    ds_read_b64_tr_b16 a[60:61], v11 offset:57344
    v_cvt_pk_bf16_f32 v198, v204, v205
    v_mfma_f32_16x16x32_bf16 a[240:243], a[40:43], v[48:51], a[240:243]
    s_waitcnt lgkmcnt(6)
    ds_read_b64_tr_b16 a[62:63], v11 offset:58368
    v_cvt_pk_bf16_f32 v199, v206, v207
    v_mfma_f32_16x16x32_bf16 a[244:247], a[40:43], v[52:55], a[244:247]
    s_add_u32 s89, s3, 5517312
    ds_read_b64_tr_b16 a[0:1], v12 offset:57344
    v_mul_f32 v27, v17, v27
    v_mfma_f32_16x16x32_bf16 a[248:251], a[44:47], v[48:51], a[248:251]
    ds_read_b64_tr_b16 a[2:3], v12 offset:58368
    buffer_store_dwordx4 v[196:199], v3, s[8:11], s89 offen sc1
    v_mfma_f32_16x16x32_bf16 a[252:255], a[44:47], v[52:55], a[252:255]
    s_waitcnt lgkmcnt(6)
    ds_read_b64_tr_b16 a[4:5], v13 offset:57344
    v_mul_f32 v28, v17, v28
    v_mul_f32 v29, v17, v29
    v_mfma_f32_16x16x32_bf16 a[192:195], a[48:51], v[56:59], a[192:195]
    ds_read_b64_tr_b16 a[6:7], v13 offset:58368
    v_mul_f32 v30, v17, v30
    v_mfma_f32_16x16x32_bf16 a[196:199], a[48:51], v[60:63], a[196:199]
    ds_read_b64_tr_b16 a[8:9], v14 offset:57344
    v_mul_f32 v31, v17, v31
    v_mfma_f32_16x16x32_bf16 a[200:203], a[52:55], v[56:59], a[200:203]
    ds_read_b64_tr_b16 a[10:11], v14 offset:58368
    v_cvt_pk_bf16_f32 v220, v24, v25
    v_mfma_f32_16x16x32_bf16 a[204:207], a[52:55], v[60:63], a[204:207]
    s_waitcnt lgkmcnt(6)
    ds_read_b64_tr_b16 a[12:13], v15 offset:57344
    v_cvt_pk_bf16_f32 v221, v26, v27
    v_mfma_f32_16x16x32_bf16 a[208:211], a[56:59], v[56:59], a[208:211]
    ds_read_b64_tr_b16 a[14:15], v15 offset:58368
    v_xor_b32 v8, 65536, v8
    v_mfma_f32_16x16x32_bf16 a[212:215], a[56:59], v[60:63], a[212:215]
    ds_read_b64_tr_b16 a[16:17], v8 offset:0
    v_cvt_pk_bf16_f32 v222, v28, v29
    v_mfma_f32_16x16x32_bf16 a[216:219], a[60:63], v[56:59], a[216:219]
    ds_read_b64_tr_b16 a[18:19], v8 offset:1024
    v_xor_b32 v9, 65536, v9
    v_mfma_f32_16x16x32_bf16 a[220:223], a[60:63], v[60:63], a[220:223]
    s_waitcnt lgkmcnt(6)
    ds_read_b64_tr_b16 a[20:21], v9 offset:0
    v_cvt_pk_bf16_f32 v223, v30, v31
    v_mfma_f32_16x16x32_bf16 a[224:227], a[0:3], v[56:59], a[224:227]
    ds_read_b64_tr_b16 a[22:23], v9 offset:1024
    v_xor_b32 v10, 65536, v10
    v_mfma_f32_16x16x32_bf16 a[228:231], a[0:3], v[60:63], a[228:231]
    ds_read_b64_tr_b16 a[24:25], v10 offset:0
    v_permlane16_swap_b32 v220, v222
    v_mfma_f32_16x16x32_bf16 a[232:235], a[4:7], v[56:59], a[232:235]
    ds_read_b64_tr_b16 a[26:27], v10 offset:1024
    v_xor_b32 v11, 65536, v11
    v_mfma_f32_16x16x32_bf16 a[236:239], a[4:7], v[60:63], a[236:239]
    s_waitcnt lgkmcnt(6)
    ds_read_b64_tr_b16 a[28:29], v11 offset:0
    v_permlane16_swap_b32 v221, v223
    v_accvgpr_read_b32 v24, a144
    v_mfma_f32_16x16x32_bf16 a[240:243], a[8:11], v[56:59], a[240:243]
    ds_read_b64_tr_b16 a[30:31], v11 offset:1024
    ds_write_b128 v44, v[220:223] offset:1024
    v_xor_b32 v12, 65536, v12
    v_mfma_f32_16x16x32_bf16 a[244:247], a[8:11], v[60:63], a[244:247]
    ds_read_b64_tr_b16 a[32:33], v12 offset:0
    v_accvgpr_read_b32 v25, a145
    v_mfma_f32_16x16x32_bf16 a[248:251], a[12:15], v[56:59], a[248:251]
    ds_read_b64_tr_b16 a[34:35], v12 offset:1024
    v_xor_b32 v13, 65536, v13
    v_mfma_f32_16x16x32_bf16 a[252:255], a[12:15], v[60:63], a[252:255]
    s_waitcnt lgkmcnt(7)
    ds_read_b64_tr_b16 a[36:37], v13 offset:0
    v_accvgpr_read_b32 v26, a146
    v_mfma_f32_16x16x32_bf16 a[192:195], a[16:19], v[64:67], a[192:195]
    ds_read_b64_tr_b16 a[38:39], v13 offset:1024
    v_xor_b32 v14, 65536, v14
    v_mfma_f32_16x16x32_bf16 a[196:199], a[16:19], v[68:71], a[196:199]
    s_waitcnt lgkmcnt(7)
    ds_read_b64_tr_b16 a[40:41], v14 offset:0
    v_accvgpr_read_b32 v27, a147
    v_mfma_f32_16x16x32_bf16 a[200:203], a[20:23], v[64:67], a[200:203]
    s_waitcnt vmcnt(16)
    ds_read_b64_tr_b16 a[42:43], v14 offset:1024
    v_xor_b32 v15, 65536, v15
    v_mfma_f32_16x16x32_bf16 a[204:207], a[20:23], v[68:71], a[204:207]
    s_barrier
    ds_read_b64_tr_b16 a[44:45], v15 offset:0
    v_accvgpr_read_b32 v28, a152
    v_mfma_f32_16x16x32_bf16 a[208:211], a[24:27], v[64:67], a[208:211]
    s_add_u32 m0, s67, 98304
    ds_read_b64_tr_b16 a[46:47], v15 offset:1024
    v_accvgpr_read_b32 v29, a153
    v_mfma_f32_16x16x32_bf16 a[212:215], a[24:27], v[68:71], a[212:215]
    s_waitcnt lgkmcnt(6)
    s_mov_b32 s72, 384
    ds_read_b64_tr_b16 a[48:49], v8 offset:8192
    v_accvgpr_read_b32 v30, a154
    v_mfma_f32_16x16x32_bf16 a[216:219], a[28:31], v[64:67], a[216:219]
    ds_read_b64_tr_b16 a[50:51], v8 offset:9216
    buffer_load_dwordx4 v2, s[44:47], s72 offen offset:0 lds
    v_mfma_f32_16x16x32_bf16 a[220:223], a[28:31], v[68:71], a[220:223]
    ds_read_b64_tr_b16 a[52:53], v9 offset:8192
    v_accvgpr_read_b32 v31, a155
    v_mfma_f32_16x16x32_bf16 a[224:227], a[32:35], v[64:67], a[224:227]
    s_waitcnt lgkmcnt(6)
    ds_read_b64_tr_b16 a[54:55], v9 offset:9216
    v_mul_f32 v24, v16, v24
    v_mul_f32 v25, v16, v25
    v_mfma_f32_16x16x32_bf16 a[228:231], a[32:35], v[68:71], a[228:231]
    s_mov_b32 s73, 6528
    ds_read_b64_tr_b16 a[56:57], v10 offset:8192
    v_mul_f32 v26, v16, v26
    v_mfma_f32_16x16x32_bf16 a[232:235], a[36:39], v[64:67], a[232:235]
    ds_read_b64_tr_b16 a[58:59], v10 offset:9216
    buffer_load_dwordx4 v2, s[44:47], s73 offen offset:1024 lds
    v_mfma_f32_16x16x32_bf16 a[236:239], a[36:39], v[68:71], a[236:239]
    s_waitcnt lgkmcnt(6)
    ds_read_b64_tr_b16 a[60:61], v11 offset:8192
    v_mul_f32 v27, v16, v27
    v_mfma_f32_16x16x32_bf16 a[240:243], a[40:43], v[64:67], a[240:243]
    ds_read_b64_tr_b16 a[62:63], v11 offset:9216
    v_mul_f32 v28, v16, v28
    v_mfma_f32_16x16x32_bf16 a[244:247], a[40:43], v[68:71], a[244:247]
    s_mov_b32 s74, 12672
    ds_read_b64_tr_b16 a[0:1], v12 offset:8192
    v_mul_f32 v29, v16, v29
    v_mfma_f32_16x16x32_bf16 a[248:251], a[44:47], v[64:67], a[248:251]
    ds_read_b64_tr_b16 a[2:3], v12 offset:9216
    buffer_load_dwordx4 v2, s[44:47], s74 offen offset:2048 lds
    v_mfma_f32_16x16x32_bf16 a[252:255], a[44:47], v[68:71], a[252:255]
    s_waitcnt lgkmcnt(6)
    ds_read_b64_tr_b16 a[4:5], v13 offset:8192
    v_mul_f32 v30, v16, v30
    v_mfma_f32_16x16x32_bf16 a[192:195], a[48:51], v[72:75], a[192:195]
    ds_read_b64_tr_b16 a[6:7], v13 offset:9216
    v_mul_f32 v31, v16, v31
    v_mfma_f32_16x16x32_bf16 a[196:199], a[48:51], v[76:79], a[196:199]
    s_mov_b32 s75, 18816
    ds_read_b64_tr_b16 a[8:9], v14 offset:8192
    v_cvt_pk_bf16_f32 v244, v24, v25
    v_mfma_f32_16x16x32_bf16 a[200:203], a[52:55], v[72:75], a[200:203]
    ds_read_b64_tr_b16 a[10:11], v14 offset:9216
    buffer_load_dwordx4 v2, s[44:47], s75 offen offset:3072 lds
    v_mfma_f32_16x16x32_bf16 a[204:207], a[52:55], v[76:79], a[204:207]
    s_waitcnt lgkmcnt(6)
    ds_read_b64_tr_b16 a[12:13], v15 offset:8192
    v_cvt_pk_bf16_f32 v245, v26, v27
    v_mfma_f32_16x16x32_bf16 a[208:211], a[56:59], v[72:75], a[208:211]
    s_add_u32 m0, s69, 114688
    ds_read_b64_tr_b16 a[14:15], v15 offset:9216
    v_xor_b32 v7, 65536, v7
    v_mfma_f32_16x16x32_bf16 a[212:215], a[56:59], v[76:79], a[212:215]
    s_mov_b32 s72, 3145984
    ds_read_b64_tr_b16 a[16:17], v7 offset:16384
    v_cvt_pk_bf16_f32 v246, v28, v29
    v_mfma_f32_16x16x32_bf16 a[216:219], a[60:63], v[72:75], a[216:219]
    ds_read_b64_tr_b16 a[18:19], v7 offset:18432
    buffer_load_dwordx4 v1, s[40:43], s72 offen offset:0 lds
    v_mfma_f32_16x16x32_bf16 a[220:223], a[60:63], v[76:79], a[220:223]
    s_waitcnt lgkmcnt(6)
    ds_read_b64_tr_b16 a[20:21], v7 offset:20480
    v_cvt_pk_bf16_f32 v247, v30, v31
    v_mfma_f32_16x16x32_bf16 a[224:227], a[0:3], v[72:75], a[224:227]
    ds_read_b64_tr_b16 a[22:23], v7 offset:22528
    v_permlane16_swap_b32 v244, v246
    v_permlane16_swap_b32 v245, v247
    v_mfma_f32_16x16x32_bf16 a[228:231], a[0:3], v[76:79], a[228:231]
    s_mov_b32 s73, 3177728
    ds_read_b64_tr_b16 a[24:25], v7 offset:24576
    ds_write_b128 v44, v[244:247] offset:2048
    v_accvgpr_read_b32 v24, a148
    v_mfma_f32_16x16x32_bf16 a[232:235], a[4:7], v[72:75], a[232:235]
    ds_read_b64_tr_b16 a[26:27], v7 offset:26624
    buffer_load_dwordx4 v1, s[40:43], s73 offen offset:1024 lds
    v_mfma_f32_16x16x32_bf16 a[236:239], a[4:7], v[76:79], a[236:239]
    s_waitcnt lgkmcnt(7)
    ds_read_b64_tr_b16 a[28:29], v7 offset:28672
    v_accvgpr_read_b32 v25, a149
    v_mfma_f32_16x16x32_bf16 a[240:243], a[8:11], v[72:75], a[240:243]
    s_add_u32 m0, s69, 118784
    v_xor_b32 v18, 65536, v18
    v_accvgpr_read_b32 v26, a150
    v_mfma_f32_16x16x32_bf16 a[244:247], a[8:11], v[76:79], a[244:247]
    s_mov_b32 s74, 3277056
    ds_read_b64_tr_b16 a[32:33], v18 offset:16384
    v_accvgpr_read_b32 v27, a151
    v_mfma_f32_16x16x32_bf16 a[248:251], a[12:15], v[72:75], a[248:251]
    ds_read_b64_tr_b16 a[34:35], v18 offset:18432
    buffer_load_dwordx4 v1, s[40:43], s74 offen offset:0 lds
    v_mfma_f32_16x16x32_bf16 a[252:255], a[12:15], v[76:79], a[252:255]
    s_waitcnt lgkmcnt(6)
    ds_read_b64_tr_b16 a[36:37], v18 offset:20480
    v_accvgpr_read_b32 v28, a156
    v_mfma_f32_16x16x32_bf16 v[224:227], a[16:19], v[144:147], 0
    ds_read_b64_tr_b16 a[38:39], v18 offset:22528
    v_accvgpr_read_b32 v29, a157
    v_mfma_f32_16x16x32_bf16 v[228:231], a[16:19], v[152:155], 0
    s_mov_b32 s75, 3308800
    ds_read_b64_tr_b16 a[40:41], v18 offset:24576
    v_accvgpr_read_b32 v30, a158
    v_mfma_f32_16x16x32_bf16 v[224:227], a[20:23], v[176:179], v[224:227]
    ds_read_b64_tr_b16 a[42:43], v18 offset:26624
    buffer_load_dwordx4 v1, s[40:43], s75 offen offset:1024 lds
    v_mfma_f32_16x16x32_bf16 v[228:231], a[20:23], v[184:187], v[228:231]
    s_waitcnt lgkmcnt(6)
    ds_read_b64_tr_b16 a[44:45], v18 offset:28672
    v_accvgpr_read_b32 v31, a159
    v_mfma_f32_16x16x32_bf16 v[224:227], a[24:27], v[208:211], v[224:227]
    v_xor_b32 v19, 65536, v19
    v_mul_f32 v24, v17, v24
    v_mfma_f32_16x16x32_bf16 v[228:231], a[24:27], v[216:219], v[228:231]
    ds_read_b64_tr_b16 a[48:49], v19 offset:16384
    v_mul_f32 v25, v17, v25
    v_mfma_f32_16x16x16_bf16 v[224:227], a[28:29], v[240:241], v[224:227]
    ds_read_b64_tr_b16 a[50:51], v19 offset:18432
    v_mul_f32 v26, v17, v26
    v_mfma_f32_16x16x16_bf16 v[228:231], a[28:29], v[248:249], v[228:231]
    s_waitcnt lgkmcnt(5)
    ds_read_b64_tr_b16 a[52:53], v19 offset:20480
    v_mul_f32 v27, v17, v27
    v_mul_f32 v28, v17, v28
    v_mfma_f32_16x16x32_bf16 v[232:235], a[32:35], v[144:147], 0
    ds_read_b64_tr_b16 a[54:55], v19 offset:22528
    v_mul_f32 v29, v17, v29
    v_mfma_f32_16x16x32_bf16 v[236:239], a[32:35], v[152:155], 0
    ds_read_b64_tr_b16 a[56:57], v19 offset:24576
    v_mul_f32 v30, v17, v30
    v_mfma_f32_16x16x32_bf16 v[232:235], a[36:39], v[176:179], v[232:235]
    ds_read_b64_tr_b16 a[58:59], v19 offset:26624
    v_mul_f32 v31, v17, v31
    v_mfma_f32_16x16x32_bf16 v[236:239], a[36:39], v[184:187], v[236:239]
    s_waitcnt lgkmcnt(6)
    ds_read_b64_tr_b16 a[60:61], v19 offset:28672
    v_cvt_pk_bf16_f32 v252, v24, v25
    v_mfma_f32_16x16x32_bf16 v[232:235], a[40:43], v[208:211], v[232:235]
    v_xor_b32 v20, 65536, v20
    v_cvt_pk_bf16_f32 v253, v26, v27
    v_mfma_f32_16x16x32_bf16 v[236:239], a[40:43], v[216:219], v[236:239]
    ds_read_b64_tr_b16 a[0:1], v20 offset:16384
    v_cvt_pk_bf16_f32 v254, v28, v29
    v_mfma_f32_16x16x16_bf16 v[232:235], a[44:45], v[240:241], v[232:235]
    ds_read_b64_tr_b16 a[2:3], v20 offset:18432
    v_cvt_pk_bf16_f32 v255, v30, v31
    v_mfma_f32_16x16x16_bf16 v[236:239], a[44:45], v[248:249], v[236:239]
    s_waitcnt lgkmcnt(5)
    ds_read_b64_tr_b16 a[4:5], v20 offset:20480
    v_permlane16_swap_b32 v252, v254
    v_mfma_f32_16x16x32_bf16 v[148:151], a[48:51], v[144:147], 0
    ds_read_b64_tr_b16 a[6:7], v20 offset:22528
    v_permlane16_swap_b32 v253, v255
    v_mfma_f32_16x16x32_bf16 v[156:159], a[48:51], v[152:155], 0
    ds_read_b64_tr_b16 a[8:9], v20 offset:24576
    ds_write_b128 v44, v[252:255] offset:3072
    v_accvgpr_read_b32 v24, a160
    v_mfma_f32_16x16x32_bf16 v[148:151], a[52:55], v[176:179], v[148:151]
    ds_read_b64_tr_b16 a[10:11], v20 offset:26624
    v_accvgpr_read_b32 v25, a161
    v_mfma_f32_16x16x32_bf16 v[156:159], a[52:55], v[184:187], v[156:159]
    s_waitcnt lgkmcnt(7)
    ds_read_b64_tr_b16 a[12:13], v20 offset:28672
    v_cvt_pk_bf16_f32 v224, v224, v225
    v_accvgpr_read_b32 v26, a162
    v_mfma_f32_16x16x32_bf16 v[148:151], a[56:59], v[208:211], v[148:151]
    v_cvt_pk_bf16_f32 v225, v226, v227
    v_accvgpr_read_b32 v27, a163
    v_mfma_f32_16x16x32_bf16 v[156:159], a[56:59], v[216:219], v[156:159]
    ds_read_b64_tr_b16 a[16:17], v8 offset:32768
    v_cvt_pk_bf16_f32 v226, v232, v233
    v_mfma_f32_16x16x16_bf16 v[148:151], a[60:61], v[240:241], v[148:151]
    s_waitcnt lgkmcnt(6)
    ds_read_b64_tr_b16 a[18:19], v8 offset:33792
    v_cvt_pk_bf16_f32 v227, v234, v235
    v_mfma_f32_16x16x16_bf16 v[156:159], a[60:61], v[248:249], v[156:159]
    s_add_u32 s89, s3, 1024
    ds_read_b64_tr_b16 a[20:21], v9 offset:32768
    v_accvgpr_read_b32 v28, a168
    v_mfma_f32_16x16x32_bf16 v[180:183], a[0:3], v[144:147], 0
    ds_read_b64_tr_b16 a[22:23], v9 offset:33792
    buffer_store_dwordx4 v[224:227], v3, s[8:11], s89 offen sc1
    v_mfma_f32_16x16x32_bf16 v[188:191], a[0:3], v[152:155], 0
    s_waitcnt lgkmcnt(5)
    ds_read_b64_tr_b16 a[24:25], v10 offset:32768
    v_cvt_pk_bf16_f32 v228, v228, v229
    v_mfma_f32_16x16x32_bf16 v[180:183], a[4:7], v[176:179], v[180:183]
    ds_read_b64_tr_b16 a[26:27], v10 offset:33792
    v_cvt_pk_bf16_f32 v229, v230, v231
    v_mfma_f32_16x16x32_bf16 v[188:191], a[4:7], v[184:187], v[188:191]
    ds_read_b64_tr_b16 a[28:29], v11 offset:32768
    v_cvt_pk_bf16_f32 v230, v236, v237
    v_mfma_f32_16x16x32_bf16 v[180:183], a[8:11], v[208:211], v[180:183]
    s_waitcnt lgkmcnt(6)
    ds_read_b64_tr_b16 a[30:31], v11 offset:33792
    v_cvt_pk_bf16_f32 v231, v238, v239
    v_mfma_f32_16x16x32_bf16 v[188:191], a[8:11], v[216:219], v[188:191]
    s_add_u32 s89, s3, 3679232
    ds_read_b64_tr_b16 a[32:33], v12 offset:32768
    v_accvgpr_read_b32 v29, a169
    v_mfma_f32_16x16x16_bf16 v[180:183], a[12:13], v[240:241], v[180:183]
    ds_read_b64_tr_b16 a[34:35], v12 offset:33792
    buffer_store_dwordx4 v[228:231], v3, s[8:11], s89 offen sc1
    v_mfma_f32_16x16x16_bf16 v[188:191], a[12:13], v[248:249], v[188:191]
    s_waitcnt lgkmcnt(6)
    ds_read_b64_tr_b16 a[36:37], v13 offset:32768
    v_accvgpr_read_b32 v30, a170
    v_mfma_f32_16x16x32_bf16 a[192:195], a[16:19], v[80:83], a[192:195]
    ds_read_b64_tr_b16 a[38:39], v13 offset:33792
    v_accvgpr_read_b32 v31, a171
    v_mfma_f32_16x16x32_bf16 a[196:199], a[16:19], v[84:87], a[196:199]
    s_waitcnt lgkmcnt(6)
    ds_read_b64_tr_b16 a[40:41], v14 offset:32768
    v_mul_f32 v24, v16, v24
    v_mul_f32 v25, v16, v25
    v_mfma_f32_16x16x32_bf16 a[200:203], a[20:23], v[80:83], a[200:203]
    s_waitcnt vmcnt(18)
    ds_read_b64_tr_b16 a[42:43], v14 offset:33792
    v_mul_f32 v26, v16, v26
    v_mfma_f32_16x16x32_bf16 a[204:207], a[20:23], v[84:87], a[204:207]
    s_barrier
    ds_read_b64_tr_b16 a[44:45], v15 offset:32768
    v_cvt_pk_bf16_f32 v148, v148, v149
    v_mfma_f32_16x16x32_bf16 a[208:211], a[24:27], v[80:83], a[208:211]
    s_add_u32 m0, s67, 0
    ds_read_b64_tr_b16 a[46:47], v15 offset:33792
    v_cvt_pk_bf16_f32 v149, v150, v151
    v_mfma_f32_16x16x32_bf16 a[212:215], a[24:27], v[84:87], a[212:215]
    s_waitcnt lgkmcnt(6)
    s_mov_b32 s72, 512
    ds_read_b64_tr_b16 a[48:49], v8 offset:40960
    v_cvt_pk_bf16_f32 v150, v180, v181
    v_mfma_f32_16x16x32_bf16 a[216:219], a[28:31], v[80:83], a[216:219]
    ds_read_b64_tr_b16 a[50:51], v8 offset:41984
    v_cvt_pk_bf16_f32 v151, v182, v183
    v_mfma_f32_16x16x32_bf16 a[220:223], a[28:31], v[84:87], a[220:223]
    s_add_u32 s89, s3, 1840128
    ds_read_b64_tr_b16 a[52:53], v9 offset:40960
    buffer_load_dwordx4 v2, s[44:47], s72 offen offset:0 lds
    v_mfma_f32_16x16x32_bf16 a[224:227], a[32:35], v[80:83], a[224:227]
    s_waitcnt lgkmcnt(6)
    ds_read_b64_tr_b16 a[54:55], v9 offset:41984
    buffer_store_dwordx4 v[148:151], v3, s[8:11], s89 offen sc1
    v_mfma_f32_16x16x32_bf16 a[228:231], a[32:35], v[84:87], a[228:231]
    s_mov_b32 s73, 6656
    ds_read_b64_tr_b16 a[56:57], v10 offset:40960
    v_cvt_pk_bf16_f32 v156, v156, v157
    v_mfma_f32_16x16x32_bf16 a[232:235], a[36:39], v[80:83], a[232:235]
    ds_read_b64_tr_b16 a[58:59], v10 offset:41984
    buffer_load_dwordx4 v2, s[44:47], s73 offen offset:1024 lds
    v_cvt_pk_bf16_f32 v157, v158, v159
    v_mfma_f32_16x16x32_bf16 a[236:239], a[36:39], v[84:87], a[236:239]
    s_waitcnt lgkmcnt(6)
    ds_read_b64_tr_b16 a[60:61], v11 offset:40960
    v_cvt_pk_bf16_f32 v158, v188, v189
    v_mfma_f32_16x16x32_bf16 a[240:243], a[40:43], v[80:83], a[240:243]
    ds_read_b64_tr_b16 a[62:63], v11 offset:41984
    v_cvt_pk_bf16_f32 v159, v190, v191
    v_mfma_f32_16x16x32_bf16 a[244:247], a[40:43], v[84:87], a[244:247]
    s_add_u32 s89, s3, 5518336
    s_mov_b32 s74, 12800
    ds_read_b64_tr_b16 a[0:1], v12 offset:40960
    v_mul_f32 v27, v16, v27
    v_mfma_f32_16x16x32_bf16 a[248:251], a[44:47], v[80:83], a[248:251]
    ds_read_b64_tr_b16 a[2:3], v12 offset:41984
    buffer_store_dwordx4 v[156:159], v3, s[8:11], s89 offen sc1
    v_mfma_f32_16x16x32_bf16 a[252:255], a[44:47], v[84:87], a[252:255]
    s_waitcnt lgkmcnt(6)
    ds_read_b64_tr_b16 a[4:5], v13 offset:40960
    buffer_load_dwordx4 v2, s[44:47], s74 offen offset:2048 lds
    v_mfma_f32_16x16x32_bf16 a[192:195], a[48:51], v[88:91], a[192:195]
    ds_read_b64_tr_b16 a[6:7], v13 offset:41984
    v_mul_f32 v28, v16, v28
    v_mfma_f32_16x16x32_bf16 a[196:199], a[48:51], v[92:95], a[196:199]
    s_mov_b32 s75, 18944
    ds_read_b64_tr_b16 a[8:9], v14 offset:40960
    v_mul_f32 v29, v16, v29
    v_mfma_f32_16x16x32_bf16 a[200:203], a[52:55], v[88:91], a[200:203]
    ds_read_b64_tr_b16 a[10:11], v14 offset:41984
    buffer_load_dwordx4 v2, s[44:47], s75 offen offset:3072 lds
    v_mfma_f32_16x16x32_bf16 a[204:207], a[52:55], v[92:95], a[204:207]
    s_waitcnt lgkmcnt(6)
    ds_read_b64_tr_b16 a[12:13], v15 offset:40960
    v_mul_f32 v30, v16, v30
    v_mul_f32 v31, v16, v31
    v_mfma_f32_16x16x32_bf16 a[208:211], a[56:59], v[88:91], a[208:211]
    s_add_u32 m0, s67, 16384
    ds_read_b64_tr_b16 a[14:15], v15 offset:41984
    v_cvt_pk_bf16_f32 v32, v24, v25
    v_mfma_f32_16x16x32_bf16 a[212:215], a[56:59], v[92:95], a[212:215]
    s_mov_b32 s72, 640
    ds_read_b64_tr_b16 a[16:17], v8 offset:49152
    v_cvt_pk_bf16_f32 v33, v26, v27
    v_mfma_f32_16x16x32_bf16 a[216:219], a[60:63], v[88:91], a[216:219]
    ds_read_b64_tr_b16 a[18:19], v8 offset:50176
    buffer_load_dwordx4 v2, s[44:47], s72 offen offset:0 lds
    v_mfma_f32_16x16x32_bf16 a[220:223], a[60:63], v[92:95], a[220:223]
    s_waitcnt lgkmcnt(6)
    ds_read_b64_tr_b16 a[20:21], v9 offset:49152
    v_cvt_pk_bf16_f32 v34, v28, v29
    v_mfma_f32_16x16x32_bf16 a[224:227], a[0:3], v[88:91], a[224:227]
    ds_read_b64_tr_b16 a[22:23], v9 offset:50176
    v_cvt_pk_bf16_f32 v35, v30, v31
    v_mfma_f32_16x16x32_bf16 a[228:231], a[0:3], v[92:95], a[228:231]
    s_mov_b32 s73, 6784
    ds_read_b64_tr_b16 a[24:25], v10 offset:49152
    v_permlane16_swap_b32 v32, v34
    v_mfma_f32_16x16x32_bf16 a[232:235], a[4:7], v[88:91], a[232:235]
    ds_read_b64_tr_b16 a[26:27], v10 offset:50176
    buffer_load_dwordx4 v2, s[44:47], s73 offen offset:1024 lds
    v_mfma_f32_16x16x32_bf16 a[236:239], a[4:7], v[92:95], a[236:239]
    s_waitcnt lgkmcnt(6)
    ds_read_b64_tr_b16 a[28:29], v11 offset:49152
    v_permlane16_swap_b32 v33, v35
    v_mfma_f32_16x16x32_bf16 a[240:243], a[8:11], v[88:91], a[240:243]
    ds_read_b64_tr_b16 a[30:31], v11 offset:50176
    ds_write_b128 v44, v[32:35] offset:4096
    v_accvgpr_read_b32 v24, a164
    v_mfma_f32_16x16x32_bf16 a[244:247], a[8:11], v[92:95], a[244:247]
    s_mov_b32 s74, 12928
    ds_read_b64_tr_b16 a[32:33], v12 offset:49152
    v_accvgpr_read_b32 v25, a165
    v_mfma_f32_16x16x32_bf16 a[248:251], a[12:15], v[88:91], a[248:251]
    ds_read_b64_tr_b16 a[34:35], v12 offset:50176
    buffer_load_dwordx4 v2, s[44:47], s74 offen offset:2048 lds
    v_mfma_f32_16x16x32_bf16 a[252:255], a[12:15], v[92:95], a[252:255]
    s_waitcnt lgkmcnt(7)
    ds_read_b64_tr_b16 a[36:37], v13 offset:49152
    v_accvgpr_read_b32 v26, a166
    v_mfma_f32_16x16x32_bf16 a[192:195], a[16:19], v[96:99], a[192:195]
    ds_read_b64_tr_b16 a[38:39], v13 offset:50176
    v_accvgpr_read_b32 v27, a167
    v_mfma_f32_16x16x32_bf16 a[196:199], a[16:19], v[100:103], a[196:199]
    s_mov_b32 s75, 19072
    ds_read_b64_tr_b16 a[40:41], v14 offset:49152
    v_accvgpr_read_b32 v28, a172
    v_mfma_f32_16x16x32_bf16 a[200:203], a[20:23], v[96:99], a[200:203]
    ds_read_b64_tr_b16 a[42:43], v14 offset:50176
    buffer_load_dwordx4 v2, s[44:47], s75 offen offset:3072 lds
    v_mfma_f32_16x16x32_bf16 a[204:207], a[20:23], v[100:103], a[204:207]
    s_waitcnt lgkmcnt(6)
    ds_read_b64_tr_b16 a[44:45], v15 offset:49152
    v_accvgpr_read_b32 v29, a173
    v_accvgpr_read_b32 v30, a174
    v_mfma_f32_16x16x32_bf16 a[208:211], a[24:27], v[96:99], a[208:211]
    ds_read_b64_tr_b16 a[46:47], v15 offset:50176
    v_accvgpr_read_b32 v31, a175
    v_mfma_f32_16x16x32_bf16 a[212:215], a[24:27], v[100:103], a[212:215]
    ds_read_b64_tr_b16 a[48:49], v8 offset:57344
    v_mul_f32 v24, v17, v24
    v_mfma_f32_16x16x32_bf16 a[216:219], a[28:31], v[96:99], a[216:219]
    ds_read_b64_tr_b16 a[50:51], v8 offset:58368
    v_mul_f32 v25, v17, v25
    v_mfma_f32_16x16x32_bf16 a[220:223], a[28:31], v[100:103], a[220:223]
    s_waitcnt lgkmcnt(6)
    ds_read_b64_tr_b16 a[52:53], v9 offset:57344
    v_mul_f32 v26, v17, v26
    v_mfma_f32_16x16x32_bf16 a[224:227], a[32:35], v[96:99], a[224:227]
    ds_read_b64_tr_b16 a[54:55], v9 offset:58368
    v_mul_f32 v27, v17, v27
    v_mfma_f32_16x16x32_bf16 a[228:231], a[32:35], v[100:103], a[228:231]
    ds_read_b64_tr_b16 a[56:57], v10 offset:57344
    v_mul_f32 v28, v17, v28
    v_mfma_f32_16x16x32_bf16 a[232:235], a[36:39], v[96:99], a[232:235]
    ds_read_b64_tr_b16 a[58:59], v10 offset:58368
    v_mul_f32 v29, v17, v29
    v_mfma_f32_16x16x32_bf16 a[236:239], a[36:39], v[100:103], a[236:239]
    s_waitcnt lgkmcnt(6)
    ds_read_b64_tr_b16 a[60:61], v11 offset:57344
    v_mul_f32 v30, v17, v30
    v_mfma_f32_16x16x32_bf16 a[240:243], a[40:43], v[96:99], a[240:243]
    ds_read_b64_tr_b16 a[62:63], v11 offset:58368
    v_mul_f32 v31, v17, v31
    v_mfma_f32_16x16x32_bf16 a[244:247], a[40:43], v[100:103], a[244:247]
    ds_read_b64_tr_b16 a[0:1], v12 offset:57344
    v_cvt_pk_bf16_f32 v36, v24, v25
    v_mfma_f32_16x16x32_bf16 a[248:251], a[44:47], v[96:99], a[248:251]
    ds_read_b64_tr_b16 a[2:3], v12 offset:58368
    v_cvt_pk_bf16_f32 v37, v26, v27
    v_mfma_f32_16x16x32_bf16 a[252:255], a[44:47], v[100:103], a[252:255]
    s_waitcnt lgkmcnt(6)
    ds_read_b64_tr_b16 a[4:5], v13 offset:57344
    v_cvt_pk_bf16_f32 v38, v28, v29
    v_cvt_pk_bf16_f32 v39, v30, v31
    v_mfma_f32_16x16x32_bf16 a[192:195], a[48:51], v[104:107], a[192:195]
    ds_read_b64_tr_b16 a[6:7], v13 offset:58368
    v_permlane16_swap_b32 v36, v38
    v_mfma_f32_16x16x32_bf16 a[196:199], a[48:51], v[108:111], a[196:199]
    ds_read_b64_tr_b16 a[8:9], v14 offset:57344
    v_permlane16_swap_b32 v37, v39
    v_mfma_f32_16x16x32_bf16 a[200:203], a[52:55], v[104:107], a[200:203]
    ds_read_b64_tr_b16 a[10:11], v14 offset:58368
    ds_write_b128 v44, v[36:39] offset:5120
    v_accvgpr_read_b32 v24, a176
    v_mfma_f32_16x16x32_bf16 a[204:207], a[52:55], v[108:111], a[204:207]
    s_waitcnt lgkmcnt(7)
    ds_read_b64_tr_b16 a[12:13], v15 offset:57344
    v_accvgpr_read_b32 v25, a177
    v_mfma_f32_16x16x32_bf16 a[208:211], a[56:59], v[104:107], a[208:211]
    ds_read_b64_tr_b16 a[14:15], v15 offset:58368
    v_xor_b32 v7, 65536, v7
    v_mfma_f32_16x16x32_bf16 a[212:215], a[56:59], v[108:111], a[212:215]
    ds_read_b64_tr_b16 a[16:17], v7 offset:0
    v_accvgpr_read_b32 v26, a178
    v_mfma_f32_16x16x32_bf16 a[216:219], a[60:63], v[104:107], a[216:219]
    ds_read_b64_tr_b16 a[18:19], v7 offset:2048
    v_accvgpr_read_b32 v27, a179
    v_mfma_f32_16x16x32_bf16 a[220:223], a[60:63], v[108:111], a[220:223]
    s_waitcnt lgkmcnt(7)
    ds_read_b64_tr_b16 a[20:21], v7 offset:4096
    v_accvgpr_read_b32 v28, a184
    v_mfma_f32_16x16x32_bf16 a[224:227], a[0:3], v[104:107], a[224:227]
    ds_read_b64_tr_b16 a[22:23], v7 offset:6144
    v_accvgpr_read_b32 v29, a185
    v_mfma_f32_16x16x32_bf16 a[228:231], a[0:3], v[108:111], a[228:231]
    ds_read_b64_tr_b16 a[24:25], v7 offset:8192
    v_accvgpr_read_b32 v30, a186
    v_mfma_f32_16x16x32_bf16 a[232:235], a[4:7], v[104:107], a[232:235]
    ds_read_b64_tr_b16 a[26:27], v7 offset:10240
    v_accvgpr_read_b32 v31, a187
    v_mfma_f32_16x16x32_bf16 a[236:239], a[4:7], v[108:111], a[236:239]
    s_waitcnt lgkmcnt(6)
    ds_read_b64_tr_b16 a[28:29], v7 offset:12288
    v_mul_f32 v24, v16, v24
    v_mul_f32 v25, v16, v25
    v_mfma_f32_16x16x32_bf16 a[240:243], a[8:11], v[104:107], a[240:243]
    v_xor_b32 v18, 65536, v18
    v_mul_f32 v26, v16, v26
    v_mfma_f32_16x16x32_bf16 a[244:247], a[8:11], v[108:111], a[244:247]
    ds_read_b64_tr_b16 a[32:33], v18 offset:0
    v_mul_f32 v27, v16, v27
    v_mfma_f32_16x16x32_bf16 a[248:251], a[12:15], v[104:107], a[248:251]
    ds_read_b64_tr_b16 a[34:35], v18 offset:2048
    v_mul_f32 v28, v16, v28
    v_mfma_f32_16x16x32_bf16 a[252:255], a[12:15], v[108:111], a[252:255]
    s_waitcnt lgkmcnt(5)
    ds_read_b64_tr_b16 a[36:37], v18 offset:4096
    v_mul_f32 v29, v16, v29
    v_mfma_f32_16x16x32_bf16 v[160:163], a[16:19], v[144:147], 0
    ds_read_b64_tr_b16 a[38:39], v18 offset:6144
    v_mul_f32 v30, v16, v30
    v_mfma_f32_16x16x32_bf16 v[164:167], a[16:19], v[152:155], 0
    s_waitcnt lgkmcnt(5)
    ds_read_b64_tr_b16 a[40:41], v18 offset:8192
    v_mul_f32 v31, v16, v31
    v_mfma_f32_16x16x32_bf16 v[160:163], a[20:23], v[176:179], v[160:163]
    s_waitcnt vmcnt(16)
    ds_read_b64_tr_b16 a[42:43], v18 offset:10240
    v_cvt_pk_bf16_f32 v40, v24, v25
    v_mfma_f32_16x16x32_bf16 v[164:167], a[20:23], v[184:187], v[164:167]
    s_barrier
    ds_read_b64_tr_b16 a[44:45], v18 offset:12288
    v_cvt_pk_bf16_f32 v41, v26, v27
    v_mfma_f32_16x16x32_bf16 v[160:163], a[24:27], v[208:211], v[160:163]
    s_waitcnt lgkmcnt(6)
    s_add_u32 m0, s67, 32768
    v_xor_b32 v19, 65536, v19
    v_cvt_pk_bf16_f32 v42, v28, v29
    v_mfma_f32_16x16x32_bf16 v[164:167], a[24:27], v[216:219], v[164:167]
    s_mov_b32 s72, 768
    ds_read_b64_tr_b16 a[48:49], v19 offset:0
    v_cvt_pk_bf16_f32 v43, v30, v31
    v_mfma_f32_16x16x16_bf16 v[160:163], a[28:29], v[240:241], v[160:163]
    ds_read_b64_tr_b16 a[50:51], v19 offset:2048
    buffer_load_dwordx4 v2, s[44:47], s72 offen offset:0 lds
    v_mfma_f32_16x16x16_bf16 v[164:167], a[28:29], v[248:249], v[164:167]
    s_waitcnt lgkmcnt(5)
    ds_read_b64_tr_b16 a[52:53], v19 offset:4096
    v_permlane16_swap_b32 v40, v42
    v_mfma_f32_16x16x32_bf16 v[168:171], a[32:35], v[144:147], 0
    ds_read_b64_tr_b16 a[54:55], v19 offset:6144
    v_permlane16_swap_b32 v41, v43
    v_accvgpr_read_b32 v24, a180
    v_mfma_f32_16x16x32_bf16 v[172:175], a[32:35], v[152:155], 0
    s_mov_b32 s73, 6912
    ds_read_b64_tr_b16 a[56:57], v19 offset:8192
    ds_write_b128 v44, v[40:43] offset:6144
    v_accvgpr_read_b32 v25, a181
    v_mfma_f32_16x16x32_bf16 v[168:171], a[36:39], v[176:179], v[168:171]
    ds_read_b64_tr_b16 a[58:59], v19 offset:10240
    buffer_load_dwordx4 v2, s[44:47], s73 offen offset:1024 lds
    v_mfma_f32_16x16x32_bf16 v[172:175], a[36:39], v[184:187], v[172:175]
    s_waitcnt lgkmcnt(7)
    ds_read_b64_tr_b16 a[60:61], v19 offset:12288
    v_accvgpr_read_b32 v26, a182
    v_mfma_f32_16x16x32_bf16 v[168:171], a[40:43], v[208:211], v[168:171]
    v_xor_b32 v20, 65536, v20
    v_accvgpr_read_b32 v27, a183
    v_mfma_f32_16x16x32_bf16 v[172:175], a[40:43], v[216:219], v[172:175]
    s_mov_b32 s74, 13056
    ds_read_b64_tr_b16 a[0:1], v20 offset:0
    v_accvgpr_read_b32 v28, a188
    v_mfma_f32_16x16x16_bf16 v[168:171], a[44:45], v[240:241], v[168:171]
    ds_read_b64_tr_b16 a[2:3], v20 offset:2048
    buffer_load_dwordx4 v2, s[44:47], s74 offen offset:2048 lds
    v_mfma_f32_16x16x16_bf16 v[172:175], a[44:45], v[248:249], v[172:175]
    s_waitcnt lgkmcnt(6)
    ds_read_b64_tr_b16 a[4:5], v20 offset:4096
    v_accvgpr_read_b32 v29, a189
    v_mfma_f32_16x16x32_bf16 v[192:195], a[48:51], v[144:147], 0
    ds_read_b64_tr_b16 a[6:7], v20 offset:6144
    v_accvgpr_read_b32 v30, a190
    v_mfma_f32_16x16x32_bf16 v[196:199], a[48:51], v[152:155], 0
    s_mov_b32 s75, 19200
    ds_read_b64_tr_b16 a[8:9], v20 offset:8192
    v_accvgpr_read_b32 v31, a191
    v_mfma_f32_16x16x32_bf16 v[192:195], a[52:55], v[176:179], v[192:195]
    ds_read_b64_tr_b16 a[10:11], v20 offset:10240
    buffer_load_dwordx4 v2, s[44:47], s75 offen offset:3072 lds
    v_mfma_f32_16x16x32_bf16 v[196:199], a[52:55], v[184:187], v[196:199]
    s_waitcnt lgkmcnt(6)
    ds_read_b64_tr_b16 a[12:13], v20 offset:12288
    v_cvt_pk_bf16_f32 v160, v160, v161
    v_mfma_f32_16x16x32_bf16 v[192:195], a[56:59], v[208:211], v[192:195]
    v_cvt_pk_bf16_f32 v161, v162, v163
    v_xor_b32 v8, 65536, v8
    v_mfma_f32_16x16x32_bf16 v[196:199], a[56:59], v[216:219], v[196:199]
    ds_read_b64_tr_b16 a[16:17], v8 offset:16384
    v_cvt_pk_bf16_f32 v162, v168, v169
    v_mfma_f32_16x16x16_bf16 v[192:195], a[60:61], v[240:241], v[192:195]
    s_waitcnt lgkmcnt(5)
    ds_read_b64_tr_b16 a[18:19], v8 offset:17408
    v_cvt_pk_bf16_f32 v163, v170, v171
    v_xor_b32 v9, 65536, v9
    v_mfma_f32_16x16x16_bf16 v[196:199], a[60:61], v[248:249], v[196:199]
    s_add_u32 s89, s3, 2048
    ds_read_b64_tr_b16 a[20:21], v9 offset:16384
    v_mul_f32 v24, v17, v24
    v_mfma_f32_16x16x32_bf16 v[200:203], a[0:3], v[144:147], 0
    ds_read_b64_tr_b16 a[22:23], v9 offset:17408
    buffer_store_dwordx4 v[160:163], v3, s[8:11], s89 offen sc1
    v_xor_b32 v10, 65536, v10
    v_mfma_f32_16x16x32_bf16 v[204:207], a[0:3], v[152:155], 0
    s_waitcnt lgkmcnt(5)
    ds_read_b64_tr_b16 a[24:25], v10 offset:16384
    v_cvt_pk_bf16_f32 v164, v164, v165
    v_mul_f32 v25, v17, v25
    v_mfma_f32_16x16x32_bf16 v[200:203], a[4:7], v[176:179], v[200:203]
    ds_read_b64_tr_b16 a[26:27], v10 offset:17408
    v_cvt_pk_bf16_f32 v165, v166, v167
    v_xor_b32 v11, 65536, v11
    v_mfma_f32_16x16x32_bf16 v[204:207], a[4:7], v[184:187], v[204:207]
    ds_read_b64_tr_b16 a[28:29], v11 offset:16384
    v_cvt_pk_bf16_f32 v166, v172, v173
    v_mfma_f32_16x16x32_bf16 v[200:203], a[8:11], v[208:211], v[200:203]
    s_waitcnt lgkmcnt(6)
    ds_read_b64_tr_b16 a[30:31], v11 offset:17408
    v_cvt_pk_bf16_f32 v167, v174, v175
    v_xor_b32 v12, 65536, v12
    v_mfma_f32_16x16x32_bf16 v[204:207], a[8:11], v[216:219], v[204:207]
    s_add_u32 s89, s3, 3680256
    ds_read_b64_tr_b16 a[32:33], v12 offset:16384
    v_mul_f32 v26, v17, v26
    v_mfma_f32_16x16x16_bf16 v[200:203], a[12:13], v[240:241], v[200:203]
    ds_read_b64_tr_b16 a[34:35], v12 offset:17408
    buffer_store_dwordx4 v[164:167], v3, s[8:11], s89 offen sc1
    v_xor_b32 v13, 65536, v13
    v_mfma_f32_16x16x16_bf16 v[204:207], a[12:13], v[248:249], v[204:207]
    s_waitcnt lgkmcnt(6)
    ds_read_b64_tr_b16 a[36:37], v13 offset:16384
    v_mul_f32 v27, v17, v27
    v_mfma_f32_16x16x32_bf16 a[192:195], a[16:19], v[112:115], a[192:195]
    ds_read_b64_tr_b16 a[38:39], v13 offset:17408
    v_xor_b32 v14, 65536, v14
    v_mfma_f32_16x16x32_bf16 a[196:199], a[16:19], v[116:119], a[196:199]
    ds_read_b64_tr_b16 a[40:41], v14 offset:16384
    v_mul_f32 v28, v17, v28
    v_mfma_f32_16x16x32_bf16 a[200:203], a[20:23], v[112:115], a[200:203]
    ds_read_b64_tr_b16 a[42:43], v14 offset:17408
    v_xor_b32 v15, 65536, v15
    v_mfma_f32_16x16x32_bf16 a[204:207], a[20:23], v[116:119], a[204:207]
    s_waitcnt lgkmcnt(6)
    ds_read_b64_tr_b16 a[44:45], v15 offset:16384
    v_cvt_pk_bf16_f32 v192, v192, v193
    v_mfma_f32_16x16x32_bf16 a[208:211], a[24:27], v[112:115], a[208:211]
    ds_read_b64_tr_b16 a[46:47], v15 offset:17408
    v_cvt_pk_bf16_f32 v193, v194, v195
    v_mfma_f32_16x16x32_bf16 a[212:215], a[24:27], v[116:119], a[212:215]
    ds_read_b64_tr_b16 a[48:49], v8 offset:24576
    v_cvt_pk_bf16_f32 v194, v200, v201
    v_mfma_f32_16x16x32_bf16 a[216:219], a[28:31], v[112:115], a[216:219]
    s_waitcnt lgkmcnt(6)
    ds_read_b64_tr_b16 a[50:51], v8 offset:25600
    v_cvt_pk_bf16_f32 v195, v202, v203
    v_mfma_f32_16x16x32_bf16 a[220:223], a[28:31], v[116:119], a[220:223]
    s_add_u32 s89, s3, 1841152
    ds_read_b64_tr_b16 a[52:53], v9 offset:24576
    v_mul_f32 v29, v17, v29
    v_mfma_f32_16x16x32_bf16 a[224:227], a[32:35], v[112:115], a[224:227]
    ds_read_b64_tr_b16 a[54:55], v9 offset:25600
    buffer_store_dwordx4 v[192:195], v3, s[8:11], s89 offen sc1
    v_mfma_f32_16x16x32_bf16 a[228:231], a[32:35], v[116:119], a[228:231]
    s_waitcnt lgkmcnt(6)
    ds_read_b64_tr_b16 a[56:57], v10 offset:24576
    v_cvt_pk_bf16_f32 v196, v196, v197
    v_mul_f32 v30, v17, v30
    v_mfma_f32_16x16x32_bf16 a[232:235], a[36:39], v[112:115], a[232:235]
    ds_read_b64_tr_b16 a[58:59], v10 offset:25600
    v_cvt_pk_bf16_f32 v197, v198, v199
    v_mfma_f32_16x16x32_bf16 a[236:239], a[36:39], v[116:119], a[236:239]
    ds_read_b64_tr_b16 a[60:61], v11 offset:24576
    v_cvt_pk_bf16_f32 v198, v204, v205
    v_mfma_f32_16x16x32_bf16 a[240:243], a[40:43], v[112:115], a[240:243]
    s_waitcnt lgkmcnt(6)
    ds_read_b64_tr_b16 a[62:63], v11 offset:25600
    v_cvt_pk_bf16_f32 v199, v206, v207
    v_mfma_f32_16x16x32_bf16 a[244:247], a[40:43], v[116:119], a[244:247]
    s_add_u32 s89, s3, 5519360
    ds_read_b64_tr_b16 a[0:1], v12 offset:24576
    v_mul_f32 v31, v17, v31
    v_mfma_f32_16x16x32_bf16 a[248:251], a[44:47], v[112:115], a[248:251]
    ds_read_b64_tr_b16 a[2:3], v12 offset:25600
    buffer_store_dwordx4 v[196:199], v3, s[8:11], s89 offen sc1
    v_mfma_f32_16x16x32_bf16 a[252:255], a[44:47], v[116:119], a[252:255]
    s_waitcnt lgkmcnt(6)
    ds_read_b64_tr_b16 a[4:5], v13 offset:24576
    v_cvt_pk_bf16_f32 v48, v24, v25
    v_mfma_f32_16x16x32_bf16 a[192:195], a[48:51], v[120:123], a[192:195]
    ds_read_b64_tr_b16 a[6:7], v13 offset:25600
    v_cvt_pk_bf16_f32 v49, v26, v27
    v_mfma_f32_16x16x32_bf16 a[196:199], a[48:51], v[124:127], a[196:199]
    ds_read_b64_tr_b16 a[8:9], v14 offset:24576
    v_cvt_pk_bf16_f32 v50, v28, v29
    v_mfma_f32_16x16x32_bf16 a[200:203], a[52:55], v[120:123], a[200:203]
    ds_read_b64_tr_b16 a[10:11], v14 offset:25600
    v_cvt_pk_bf16_f32 v51, v30, v31
    v_mfma_f32_16x16x32_bf16 a[204:207], a[52:55], v[124:127], a[204:207]
    s_waitcnt lgkmcnt(6)
    ds_read_b64_tr_b16 a[12:13], v15 offset:24576
    v_permlane16_swap_b32 v48, v50
    v_mfma_f32_16x16x32_bf16 a[208:211], a[56:59], v[120:123], a[208:211]
    ds_read_b64_tr_b16 a[14:15], v15 offset:25600
    v_xor_b32 v0, 64, v6
    v_mfma_f32_16x16x32_bf16 a[212:215], a[56:59], v[124:127], a[212:215]
    ds_read_b64_tr_b16 a[16:17], v7 offset:32768
    v_permlane16_swap_b32 v49, v51
    v_mfma_f32_16x16x32_bf16 a[216:219], a[60:63], v[120:123], a[216:219]
    ds_read_b64_tr_b16 a[18:19], v7 offset:34816
    ds_write_b128 v44, v[48:51] offset:7168
    v_xor_b32 v1, 128, v6
    v_mfma_f32_16x16x32_bf16 a[220:223], a[60:63], v[124:127], a[220:223]
    s_waitcnt lgkmcnt(7)
    ds_read_b64_tr_b16 a[20:21], v7 offset:36864
    v_mfma_f32_16x16x32_bf16 a[224:227], a[0:3], v[120:123], a[224:227]
    ds_read_b64_tr_b16 a[22:23], v7 offset:38912
    v_mfma_f32_16x16x32_bf16 a[228:231], a[0:3], v[124:127], a[228:231]
    ds_read_b64_tr_b16 a[24:25], v7 offset:40960
    v_xor_b32 v21, 192, v6
    v_mfma_f32_16x16x32_bf16 a[232:235], a[4:7], v[120:123], a[232:235]
    ds_read_b64_tr_b16 a[26:27], v7 offset:43008
    v_mfma_f32_16x16x32_bf16 a[236:239], a[4:7], v[124:127], a[236:239]
    s_waitcnt lgkmcnt(7)
    ds_read_b64_tr_b16 a[28:29], v7 offset:45056
    v_mfma_f32_16x16x32_bf16 a[240:243], a[8:11], v[120:123], a[240:243]
    v_mfma_f32_16x16x32_bf16 a[244:247], a[8:11], v[124:127], a[244:247]
    ds_read_b64_tr_b16 a[32:33], v18 offset:32768
    v_mfma_f32_16x16x32_bf16 a[248:251], a[12:15], v[120:123], a[248:251]
    ds_read_b64_tr_b16 a[34:35], v18 offset:34816
    v_mfma_f32_16x16x32_bf16 a[252:255], a[12:15], v[124:127], a[252:255]
    s_waitcnt lgkmcnt(5)
    ds_read_b64_tr_b16 a[36:37], v18 offset:36864
    v_mfma_f32_16x16x32_bf16 v[224:227], a[16:19], v[144:147], 0
    ds_read_b64_tr_b16 a[38:39], v18 offset:38912
    v_mfma_f32_16x16x32_bf16 v[228:231], a[16:19], v[152:155], 0
    s_waitcnt lgkmcnt(5)
    ds_read_b64_tr_b16 a[40:41], v18 offset:40960
    v_mfma_f32_16x16x32_bf16 v[224:227], a[20:23], v[176:179], v[224:227]
    s_waitcnt vmcnt(12)
    ds_read_b64_tr_b16 a[42:43], v18 offset:43008
    v_mfma_f32_16x16x32_bf16 v[228:231], a[20:23], v[184:187], v[228:231]
    s_barrier
    ds_read_b64_tr_b16 a[44:45], v18 offset:45056
    v_mfma_f32_16x16x32_bf16 v[224:227], a[24:27], v[208:211], v[224:227]
    s_add_u32 m0, s67, 65536
    ds_read_b128 v[52:55], v45 offset:0
    v_mfma_f32_16x16x32_bf16 v[228:231], a[24:27], v[216:219], v[228:231]
    s_waitcnt lgkmcnt(6)
    s_add_u32 s70, s70, 16384
    ds_read_b64_tr_b16 a[48:49], v19 offset:32768
    v_mfma_f32_16x16x16_bf16 v[224:227], a[28:29], v[240:241], v[224:227]
    ds_read_b64_tr_b16 a[50:51], v19 offset:34816
    buffer_load_dwordx4 v6, s[48:51], s70 offen offset:0 lds
    v_mfma_f32_16x16x16_bf16 v[228:231], a[28:29], v[248:249], v[228:231]
    ds_read_b64_tr_b16 a[52:53], v19 offset:36864
    v_mfma_f32_16x16x32_bf16 v[232:235], a[32:35], v[144:147], 0
    ds_read_b64_tr_b16 a[54:55], v19 offset:38912
    ds_read_b128 v[56:59], v45 offset:1024
    v_mfma_f32_16x16x32_bf16 v[236:239], a[32:35], v[152:155], 0
    s_waitcnt lgkmcnt(7)
    ds_read_b64_tr_b16 a[56:57], v19 offset:40960
    v_mfma_f32_16x16x32_bf16 v[232:235], a[36:39], v[176:179], v[232:235]
    ds_read_b64_tr_b16 a[58:59], v19 offset:43008
    buffer_load_dwordx4 v0, s[48:51], s70 offen offset:1024 lds
    v_mfma_f32_16x16x32_bf16 v[236:239], a[36:39], v[184:187], v[236:239]
    ds_read_b64_tr_b16 a[60:61], v19 offset:45056
    v_mfma_f32_16x16x32_bf16 v[232:235], a[40:43], v[208:211], v[232:235]
    ds_read_b128 v[60:63], v45 offset:2048
    v_mfma_f32_16x16x32_bf16 v[236:239], a[40:43], v[216:219], v[236:239]
    s_waitcnt lgkmcnt(7)
    ds_read_b64_tr_b16 a[0:1], v20 offset:32768
    v_mfma_f32_16x16x16_bf16 v[232:235], a[44:45], v[240:241], v[232:235]
    ds_read_b64_tr_b16 a[2:3], v20 offset:34816
    buffer_load_dwordx4 v1, s[48:51], s70 offen offset:2048 lds
    v_mfma_f32_16x16x16_bf16 v[236:239], a[44:45], v[248:249], v[236:239]
    ds_read_b64_tr_b16 a[4:5], v20 offset:36864
    v_mfma_f32_16x16x32_bf16 v[148:151], a[48:51], v[144:147], 0
    ds_read_b64_tr_b16 a[6:7], v20 offset:38912
    ds_read_b128 v[64:67], v45 offset:3072
    v_mfma_f32_16x16x32_bf16 v[156:159], a[48:51], v[152:155], 0
    s_waitcnt lgkmcnt(7)
    ds_read_b64_tr_b16 a[8:9], v20 offset:40960
    v_mfma_f32_16x16x32_bf16 v[148:151], a[52:55], v[176:179], v[148:151]
    ds_read_b64_tr_b16 a[10:11], v20 offset:43008
    buffer_load_dwordx4 v21, s[48:51], s70 offen offset:3072 lds
    v_mfma_f32_16x16x32_bf16 v[156:159], a[52:55], v[184:187], v[156:159]
    s_waitcnt lgkmcnt(7)
    ds_read_b64_tr_b16 a[12:13], v20 offset:45056
    v_cvt_pk_bf16_f32 v224, v224, v225
    v_mfma_f32_16x16x32_bf16 v[148:151], a[56:59], v[208:211], v[148:151]
    s_add_u32 m0, s67, 81920
    ds_read_b128 v[68:71], v45 offset:4096
    v_cvt_pk_bf16_f32 v225, v226, v227
    v_mfma_f32_16x16x32_bf16 v[156:159], a[56:59], v[216:219], v[156:159]
    s_add_u32 s70, s70, 16384
    ds_read_b64_tr_b16 a[16:17], v8 offset:49152
    v_cvt_pk_bf16_f32 v226, v232, v233
    v_mfma_f32_16x16x16_bf16 v[148:151], a[60:61], v[240:241], v[148:151]
    ds_read_b64_tr_b16 a[18:19], v8 offset:50176
    buffer_load_dwordx4 v6, s[48:51], s70 offen offset:0 lds
    v_mfma_f32_16x16x16_bf16 v[156:159], a[60:61], v[248:249], v[156:159]
    s_waitcnt lgkmcnt(6)
    ds_read_b64_tr_b16 a[20:21], v9 offset:49152
    v_cvt_pk_bf16_f32 v227, v234, v235
    v_mfma_f32_16x16x32_bf16 v[180:183], a[0:3], v[144:147], 0
    s_add_u32 s89, s3, 3072
    ds_read_b64_tr_b16 a[22:23], v9 offset:50176
    ds_read_b128 v[72:75], v45 offset:5120
    v_mfma_f32_16x16x32_bf16 v[188:191], a[0:3], v[152:155], 0
    ds_read_b64_tr_b16 a[24:25], v10 offset:49152
    buffer_store_dwordx4 v[224:227], v3, s[8:11], s89 offen sc1
    v_mfma_f32_16x16x32_bf16 v[180:183], a[4:7], v[176:179], v[180:183]
    ds_read_b64_tr_b16 a[26:27], v10 offset:50176
    buffer_load_dwordx4 v0, s[48:51], s70 offen offset:1024 lds
    v_mfma_f32_16x16x32_bf16 v[188:191], a[4:7], v[184:187], v[188:191]
    s_waitcnt lgkmcnt(7)
    ds_read_b64_tr_b16 a[28:29], v11 offset:49152
    v_cvt_pk_bf16_f32 v228, v228, v229
    v_mfma_f32_16x16x32_bf16 v[180:183], a[8:11], v[208:211], v[180:183]
    ds_read_b64_tr_b16 a[30:31], v11 offset:50176
    ds_read_b128 v[76:79], v45 offset:6144
    v_cvt_pk_bf16_f32 v229, v230, v231
    v_mfma_f32_16x16x32_bf16 v[188:191], a[8:11], v[216:219], v[188:191]
    ds_read_b64_tr_b16 a[32:33], v12 offset:49152
    v_cvt_pk_bf16_f32 v230, v236, v237
    v_mfma_f32_16x16x16_bf16 v[180:183], a[12:13], v[240:241], v[180:183]
    ds_read_b64_tr_b16 a[34:35], v12 offset:50176
    buffer_load_dwordx4 v1, s[48:51], s70 offen offset:2048 lds
    v_mfma_f32_16x16x16_bf16 v[188:191], a[12:13], v[248:249], v[188:191]
    s_waitcnt lgkmcnt(7)
    ds_read_b64_tr_b16 a[36:37], v13 offset:49152
    v_cvt_pk_bf16_f32 v231, v238, v239
    v_mfma_f32_16x16x32_bf16 a[192:195], a[16:19], v[128:131], a[192:195]
    s_add_u32 s89, s3, 3681280
    ds_read_b64_tr_b16 a[38:39], v13 offset:50176
    ds_read_b128 v[80:83], v45 offset:7168
    v_mfma_f32_16x16x32_bf16 a[196:199], a[16:19], v[132:135], a[196:199]
    ds_read_b64_tr_b16 a[40:41], v14 offset:49152
    buffer_store_dwordx4 v[228:231], v3, s[8:11], s89 offen sc1
    v_mfma_f32_16x16x32_bf16 a[200:203], a[20:23], v[128:131], a[200:203]
    ds_read_b64_tr_b16 a[42:43], v14 offset:50176
    buffer_load_dwordx4 v21, s[48:51], s70 offen offset:3072 lds
    v_mfma_f32_16x16x32_bf16 a[204:207], a[20:23], v[132:135], a[204:207]
    s_waitcnt lgkmcnt(7)
    ds_read_b64_tr_b16 a[44:45], v15 offset:49152
    v_cvt_pk_bf16_f32 v148, v148, v149
    v_mfma_f32_16x16x32_bf16 a[208:211], a[24:27], v[128:131], a[208:211]
    ds_read_b64_tr_b16 a[46:47], v15 offset:50176
    v_cvt_pk_bf16_f32 v149, v150, v151
    v_mfma_f32_16x16x32_bf16 a[212:215], a[24:27], v[132:135], a[212:215]
    ds_read_b64_tr_b16 a[48:49], v8 offset:57344
    v_cvt_pk_bf16_f32 v150, v180, v181
    v_mfma_f32_16x16x32_bf16 a[216:219], a[28:31], v[128:131], a[216:219]
    s_waitcnt lgkmcnt(7)
    ds_read_b64_tr_b16 a[50:51], v8 offset:58368
    v_cvt_pk_bf16_f32 v151, v182, v183
    v_mfma_f32_16x16x32_bf16 a[220:223], a[28:31], v[132:135], a[220:223]
    s_add_u32 s89, s3, 1842176
    ds_read_b64_tr_b16 a[52:53], v9 offset:57344
    v_mfma_f32_16x16x32_bf16 a[224:227], a[32:35], v[128:131], a[224:227]
    ds_read_b64_tr_b16 a[54:55], v9 offset:58368
    buffer_store_dwordx4 v[148:151], v3, s[8:11], s89 offen sc1
    v_mfma_f32_16x16x32_bf16 a[228:231], a[32:35], v[132:135], a[228:231]
    s_waitcnt lgkmcnt(6)
    ds_read_b64_tr_b16 a[56:57], v10 offset:57344
    v_cvt_pk_bf16_f32 v156, v156, v157
    v_mfma_f32_16x16x32_bf16 a[232:235], a[36:39], v[128:131], a[232:235]
    ds_read_b64_tr_b16 a[58:59], v10 offset:58368
    v_cvt_pk_bf16_f32 v157, v158, v159
    v_mfma_f32_16x16x32_bf16 a[236:239], a[36:39], v[132:135], a[236:239]
    ds_read_b64_tr_b16 a[60:61], v11 offset:57344
    v_cvt_pk_bf16_f32 v158, v188, v189
    v_mfma_f32_16x16x32_bf16 a[240:243], a[40:43], v[128:131], a[240:243]
    s_waitcnt lgkmcnt(6)
    ds_read_b64_tr_b16 a[62:63], v11 offset:58368
    v_cvt_pk_bf16_f32 v159, v190, v191
    v_mfma_f32_16x16x32_bf16 a[244:247], a[40:43], v[132:135], a[244:247]
    s_add_u32 s89, s3, 5520384
    ds_read_b64_tr_b16 a[0:1], v12 offset:57344
    v_mfma_f32_16x16x32_bf16 a[248:251], a[44:47], v[128:131], a[248:251]
    ds_read_b64_tr_b16 a[2:3], v12 offset:58368
    buffer_store_dwordx4 v[156:159], v3, s[8:11], s89 offen sc1
    v_mfma_f32_16x16x32_bf16 a[252:255], a[44:47], v[132:135], a[252:255]
    s_waitcnt lgkmcnt(6)
    ds_read_b64_tr_b16 a[4:5], v13 offset:57344
    v_mfma_f32_16x16x32_bf16 a[192:195], a[48:51], v[136:139], a[192:195]
    ds_read_b64_tr_b16 a[6:7], v13 offset:58368
    v_mfma_f32_16x16x32_bf16 a[196:199], a[48:51], v[140:143], a[196:199]
    ds_read_b64_tr_b16 a[8:9], v14 offset:57344
    v_mfma_f32_16x16x32_bf16 a[200:203], a[52:55], v[136:139], a[200:203]
    ds_read_b64_tr_b16 a[10:11], v14 offset:58368
    v_mfma_f32_16x16x32_bf16 a[204:207], a[52:55], v[140:143], a[204:207]
    s_waitcnt lgkmcnt(6)
    ds_read_b64_tr_b16 a[12:13], v15 offset:57344
    v_mfma_f32_16x16x32_bf16 a[208:211], a[56:59], v[136:139], a[208:211]
    ds_read_b64_tr_b16 a[14:15], v15 offset:58368
    v_xor_b32 v7, 65536, v7
    v_mfma_f32_16x16x32_bf16 a[212:215], a[56:59], v[140:143], a[212:215]
    ds_read_b64_tr_b16 a[16:17], v7 offset:0
    v_mfma_f32_16x16x32_bf16 a[216:219], a[60:63], v[136:139], a[216:219]
    ds_read_b64_tr_b16 a[18:19], v7 offset:2048
    v_mfma_f32_16x16x32_bf16 a[220:223], a[60:63], v[140:143], a[220:223]
    s_waitcnt lgkmcnt(6)
    ds_read_b64_tr_b16 a[20:21], v7 offset:4096
    v_mfma_f32_16x16x32_bf16 a[224:227], a[0:3], v[136:139], a[224:227]
    ds_read_b64_tr_b16 a[22:23], v7 offset:6144
    v_mfma_f32_16x16x32_bf16 a[228:231], a[0:3], v[140:143], a[228:231]
    ds_read_b64_tr_b16 a[24:25], v7 offset:8192
    v_mfma_f32_16x16x32_bf16 a[232:235], a[4:7], v[136:139], a[232:235]
    ds_read_b64_tr_b16 a[26:27], v7 offset:10240
    v_mfma_f32_16x16x32_bf16 a[236:239], a[4:7], v[140:143], a[236:239]
    s_waitcnt lgkmcnt(6)
    ds_read_b64_tr_b16 a[28:29], v7 offset:12288
    v_mfma_f32_16x16x32_bf16 a[240:243], a[8:11], v[136:139], a[240:243]
    v_xor_b32 v18, 65536, v18
    v_mfma_f32_16x16x32_bf16 a[244:247], a[8:11], v[140:143], a[244:247]
    ds_read_b64_tr_b16 a[32:33], v18 offset:0
    v_xor_b32 v11, 65536, v4
    v_xor_b32 v8, 64, v4
    v_xor_b32 v12, 65600, v4
    v_mfma_f32_16x16x32_bf16 a[248:251], a[12:15], v[136:139], a[248:251]
    ds_read_b64_tr_b16 a[34:35], v18 offset:2048
    v_xor_b32 v9, 128, v4
    v_xor_b32 v13, 65664, v4
    v_xor_b32 v10, 192, v4
    v_mfma_f32_16x16x32_bf16 a[252:255], a[12:15], v[140:143], a[252:255]
    s_waitcnt lgkmcnt(5)
    ds_read_b64_tr_b16 a[36:37], v18 offset:4096
    v_xor_b32 v14, 65728, v4
    v_accvgpr_read_b32 v24, a192
    v_accvgpr_read_b32 v25, a193
    v_mfma_f32_16x16x32_bf16 v[160:163], a[16:19], v[144:147], 0
    ds_read_b64_tr_b16 a[38:39], v18 offset:6144
    v_accvgpr_read_b32 v26, a194
    v_accvgpr_read_b32 v27, a195
    v_accvgpr_read_b32 v28, a200
    v_mfma_f32_16x16x32_bf16 v[164:167], a[16:19], v[152:155], 0
    s_waitcnt lgkmcnt(5)
    ds_read_b64_tr_b16 a[40:41], v18 offset:8192
    v_accvgpr_read_b32 v29, a201
    v_accvgpr_read_b32 v30, a202
    v_accvgpr_read_b32 v31, a203
    v_mfma_f32_16x16x32_bf16 v[160:163], a[20:23], v[176:179], v[160:163]
    s_waitcnt vmcnt(16)
    ds_read_b64_tr_b16 a[42:43], v18 offset:10240
    v_mul_f32 v24, v16, v24
    v_mul_f32 v25, v16, v25
    v_mfma_f32_16x16x32_bf16 v[164:167], a[20:23], v[184:187], v[164:167]
    s_barrier
    ds_read_b64_tr_b16 a[44:45], v18 offset:12288
    v_mul_f32 v26, v16, v26
    v_mul_f32 v27, v16, v27
    v_mul_f32 v28, v16, v28
    v_mfma_f32_16x16x32_bf16 v[160:163], a[24:27], v[208:211], v[160:163]
    s_waitcnt lgkmcnt(6)
    s_add_u32 m0, s67, 98304
    v_xor_b32 v19, 65536, v19
    v_mul_f32 v29, v16, v29
    v_mul_f32 v30, v16, v30
    v_mul_f32 v31, v16, v31
    v_mfma_f32_16x16x32_bf16 v[164:167], a[24:27], v[216:219], v[164:167]
    s_add_u32 s70, s70, 16384
    ds_read_b64_tr_b16 a[48:49], v19 offset:0
    v_cvt_pk_bf16_f32 v84, v24, v25
    v_cvt_pk_bf16_f32 v85, v26, v27
    v_cvt_pk_bf16_f32 v86, v28, v29
    v_mfma_f32_16x16x16_bf16 v[160:163], a[28:29], v[240:241], v[160:163]
    ds_read_b64_tr_b16 a[50:51], v19 offset:2048
    buffer_load_dwordx4 v6, s[48:51], s70 offen offset:0 lds
    v_cvt_pk_bf16_f32 v87, v30, v31
    v_mfma_f32_16x16x16_bf16 v[164:167], a[28:29], v[248:249], v[164:167]
    s_waitcnt lgkmcnt(5)
    ds_read_b64_tr_b16 a[52:53], v19 offset:4096
    v_permlane16_swap_b32 v84, v86
    v_permlane16_swap_b32 v85, v87
    v_mfma_f32_16x16x32_bf16 v[168:171], a[32:35], v[144:147], 0
    ds_read_b64_tr_b16 a[54:55], v19 offset:6144
    ds_write_b128 v44, v[84:87] offset:0
    v_accvgpr_read_b32 v24, a196
    v_accvgpr_read_b32 v25, a197
    v_accvgpr_read_b32 v26, a198
    v_mfma_f32_16x16x32_bf16 v[172:175], a[32:35], v[152:155], 0
    ds_read_b64_tr_b16 a[56:57], v19 offset:8192
    v_accvgpr_read_b32 v27, a199
    v_accvgpr_read_b32 v28, a204
    v_accvgpr_read_b32 v29, a205
    v_mfma_f32_16x16x32_bf16 v[168:171], a[36:39], v[176:179], v[168:171]
    ds_read_b64_tr_b16 a[58:59], v19 offset:10240
    buffer_load_dwordx4 v0, s[48:51], s70 offen offset:1024 lds
    v_accvgpr_read_b32 v30, a206
    v_mfma_f32_16x16x32_bf16 v[172:175], a[36:39], v[184:187], v[172:175]
    s_waitcnt lgkmcnt(7)
    ds_read_b64_tr_b16 a[60:61], v19 offset:12288
    v_accvgpr_read_b32 v31, a207
    v_mul_f32 v24, v17, v24
    v_mul_f32 v25, v17, v25
    v_mfma_f32_16x16x32_bf16 v[168:171], a[40:43], v[208:211], v[168:171]
    v_xor_b32 v20, 65536, v20
    v_mul_f32 v26, v17, v26
    v_mul_f32 v27, v17, v27
    v_mul_f32 v28, v17, v28
    v_mfma_f32_16x16x32_bf16 v[172:175], a[40:43], v[216:219], v[172:175]
    ds_read_b64_tr_b16 a[0:1], v20 offset:0
    v_mul_f32 v29, v17, v29
    v_mul_f32 v30, v17, v30
    v_mfma_f32_16x16x16_bf16 v[168:171], a[44:45], v[240:241], v[168:171]
    ds_read_b64_tr_b16 a[2:3], v20 offset:2048
    buffer_load_dwordx4 v1, s[48:51], s70 offen offset:2048 lds
    v_mul_f32 v31, v17, v31
    v_mfma_f32_16x16x16_bf16 v[172:175], a[44:45], v[248:249], v[172:175]
    s_waitcnt lgkmcnt(5)
    ds_read_b64_tr_b16 a[4:5], v20 offset:4096
    v_cvt_pk_bf16_f32 v88, v24, v25
    v_cvt_pk_bf16_f32 v89, v26, v27
    v_cvt_pk_bf16_f32 v90, v28, v29
    v_mfma_f32_16x16x32_bf16 v[192:195], a[48:51], v[144:147], 0
    ds_read_b64_tr_b16 a[6:7], v20 offset:6144
    v_cvt_pk_bf16_f32 v91, v30, v31
    v_permlane16_swap_b32 v88, v90
    s_nop 0
    v_permlane16_swap_b32 v89, v91
    v_mfma_f32_16x16x32_bf16 v[196:199], a[48:51], v[152:155], 0
    ds_read_b64_tr_b16 a[8:9], v20 offset:8192
    ds_write_b128 v44, v[88:91] offset:1024
    v_accvgpr_read_b32 v24, a208
    v_accvgpr_read_b32 v25, a209
    v_accvgpr_read_b32 v26, a210
    v_mfma_f32_16x16x32_bf16 v[192:195], a[52:55], v[176:179], v[192:195]
    ds_read_b64_tr_b16 a[10:11], v20 offset:10240
    buffer_load_dwordx4 v21, s[48:51], s70 offen offset:3072 lds
    v_mfma_f32_16x16x32_bf16 v[196:199], a[52:55], v[184:187], v[196:199]
    s_waitcnt lgkmcnt(7)
    ds_read_b64_tr_b16 a[12:13], v20 offset:12288
    v_cvt_pk_bf16_f32 v160, v160, v161
    v_accvgpr_read_b32 v27, a211
    v_accvgpr_read_b32 v28, a216
    v_mfma_f32_16x16x32_bf16 v[192:195], a[56:59], v[208:211], v[192:195]
    s_add_u32 m0, s67, 114688
    v_cvt_pk_bf16_f32 v161, v162, v163
    v_accvgpr_read_b32 v29, a217
    v_accvgpr_read_b32 v30, a218
    v_accvgpr_read_b32 v31, a219
    v_mfma_f32_16x16x32_bf16 v[196:199], a[56:59], v[216:219], v[196:199]
    s_add_u32 s70, s70, 16384
    ds_read_b64_tr_b16 a[16:17], v7 offset:16384
    v_cvt_pk_bf16_f32 v162, v168, v169
    v_mul_f32 v24, v16, v24
    v_mul_f32 v25, v16, v25
    v_mfma_f32_16x16x16_bf16 v[192:195], a[60:61], v[240:241], v[192:195]
    ds_read_b64_tr_b16 a[18:19], v7 offset:18432
    buffer_load_dwordx4 v6, s[48:51], s70 offen offset:0 lds
    v_mul_f32 v26, v16, v26
    v_mfma_f32_16x16x16_bf16 v[196:199], a[60:61], v[248:249], v[196:199]
    s_waitcnt lgkmcnt(6)
    ds_read_b64_tr_b16 a[20:21], v7 offset:20480
    v_cvt_pk_bf16_f32 v163, v170, v171
    v_mul_f32 v27, v16, v27
    v_mul_f32 v28, v16, v28
    v_mfma_f32_16x16x32_bf16 v[200:203], a[0:3], v[144:147], 0
    s_add_u32 s89, s3, 4096
    ds_read_b64_tr_b16 a[22:23], v7 offset:22528
    v_mul_f32 v29, v16, v29
    v_mul_f32 v30, v16, v30
    v_mfma_f32_16x16x32_bf16 v[204:207], a[0:3], v[152:155], 0
    ds_read_b64_tr_b16 a[24:25], v7 offset:24576
    buffer_store_dwordx4 v[160:163], v3, s[8:11], s89 offen sc1
    v_mul_f32 v31, v16, v31
    v_mfma_f32_16x16x32_bf16 v[200:203], a[4:7], v[176:179], v[200:203]
    ds_read_b64_tr_b16 a[26:27], v7 offset:26624
    buffer_load_dwordx4 v0, s[48:51], s70 offen offset:1024 lds
    v_cvt_pk_bf16_f32 v92, v24, v25
    v_mfma_f32_16x16x32_bf16 v[204:207], a[4:7], v[184:187], v[204:207]
    s_waitcnt lgkmcnt(6)
    ds_read_b64_tr_b16 a[28:29], v7 offset:28672
    v_cvt_pk_bf16_f32 v164, v164, v165
    v_cvt_pk_bf16_f32 v93, v26, v27
    v_cvt_pk_bf16_f32 v94, v28, v29
    v_mfma_f32_16x16x32_bf16 v[200:203], a[8:11], v[208:211], v[200:203]
    v_cvt_pk_bf16_f32 v165, v166, v167
    v_cvt_pk_bf16_f32 v95, v30, v31
    v_permlane16_swap_b32 v92, v94
    s_nop 0
    v_permlane16_swap_b32 v93, v95
    v_mfma_f32_16x16x32_bf16 v[204:207], a[8:11], v[216:219], v[204:207]
    ds_read_b64_tr_b16 a[32:33], v18 offset:16384
    ds_write_b128 v44, v[92:95] offset:2048
    v_cvt_pk_bf16_f32 v166, v172, v173
    v_accvgpr_read_b32 v24, a212
    v_mfma_f32_16x16x16_bf16 v[200:203], a[12:13], v[240:241], v[200:203]
    ds_read_b64_tr_b16 a[34:35], v18 offset:18432
    buffer_load_dwordx4 v1, s[48:51], s70 offen offset:2048 lds
    v_accvgpr_read_b32 v25, a213
    v_mfma_f32_16x16x16_bf16 v[204:207], a[12:13], v[248:249], v[204:207]
    s_waitcnt lgkmcnt(6)
    ds_read_b64_tr_b16 a[36:37], v18 offset:20480
    v_cvt_pk_bf16_f32 v167, v174, v175
    v_accvgpr_read_b32 v26, a214
    v_accvgpr_read_b32 v27, a215
    v_mfma_f32_16x16x32_bf16 v[224:227], a[16:19], v[144:147], 0
    s_add_u32 s89, s3, 3682304
    ds_read_b64_tr_b16 a[38:39], v18 offset:22528
    v_accvgpr_read_b32 v28, a220
    v_accvgpr_read_b32 v29, a221
    v_accvgpr_read_b32 v30, a222
    v_mfma_f32_16x16x32_bf16 v[228:231], a[16:19], v[152:155], 0
    ds_read_b64_tr_b16 a[40:41], v18 offset:24576
    buffer_store_dwordx4 v[164:167], v3, s[8:11], s89 offen sc1
    v_accvgpr_read_b32 v31, a223
    v_mfma_f32_16x16x32_bf16 v[224:227], a[20:23], v[176:179], v[224:227]
    ds_read_b64_tr_b16 a[42:43], v18 offset:26624
    buffer_load_dwordx4 v21, s[48:51], s70 offen offset:3072 lds
    v_mul_f32 v24, v17, v24
    v_mfma_f32_16x16x32_bf16 v[228:231], a[20:23], v[184:187], v[228:231]
    s_waitcnt lgkmcnt(7)
    ds_read_b64_tr_b16 a[44:45], v18 offset:28672
    v_cvt_pk_bf16_f32 v192, v192, v193
    v_mul_f32 v25, v17, v25
    v_mfma_f32_16x16x32_bf16 v[224:227], a[24:27], v[208:211], v[224:227]
    v_cvt_pk_bf16_f32 v193, v194, v195
    v_mul_f32 v26, v17, v26
    v_mul_f32 v27, v17, v27
    v_mul_f32 v28, v17, v28
    v_mfma_f32_16x16x32_bf16 v[228:231], a[24:27], v[216:219], v[228:231]
    ds_read_b64_tr_b16 a[48:49], v19 offset:16384
    v_cvt_pk_bf16_f32 v194, v200, v201
    v_mul_f32 v29, v17, v29
    v_mul_f32 v30, v17, v30
    v_mfma_f32_16x16x16_bf16 v[224:227], a[28:29], v[240:241], v[224:227]
    s_waitcnt lgkmcnt(5)
    ds_read_b64_tr_b16 a[50:51], v19 offset:18432
    v_cvt_pk_bf16_f32 v195, v202, v203
    v_mul_f32 v31, v17, v31
    v_cvt_pk_bf16_f32 v96, v24, v25
    v_mfma_f32_16x16x16_bf16 v[228:231], a[28:29], v[248:249], v[228:231]
    s_add_u32 s89, s3, 1843200
    ds_read_b64_tr_b16 a[52:53], v19 offset:20480
    v_cvt_pk_bf16_f32 v97, v26, v27
    v_cvt_pk_bf16_f32 v98, v28, v29
    v_cvt_pk_bf16_f32 v99, v30, v31
    v_mfma_f32_16x16x32_bf16 v[232:235], a[32:35], v[144:147], 0
    ds_read_b64_tr_b16 a[54:55], v19 offset:22528
    buffer_store_dwordx4 v[192:195], v3, s[8:11], s89 offen sc1
    v_mfma_f32_16x16x32_bf16 v[236:239], a[32:35], v[152:155], 0
    s_waitcnt lgkmcnt(5)
    ds_read_b64_tr_b16 a[56:57], v19 offset:24576
    v_cvt_pk_bf16_f32 v196, v196, v197
    v_permlane16_swap_b32 v96, v98
    v_permlane16_swap_b32 v97, v99
    v_mfma_f32_16x16x32_bf16 v[232:235], a[36:39], v[176:179], v[232:235]
    ds_read_b64_tr_b16 a[58:59], v19 offset:26624
    ds_write_b128 v44, v[96:99] offset:3072
    v_cvt_pk_bf16_f32 v197, v198, v199
    v_accvgpr_read_b32 v24, a224
    v_accvgpr_read_b32 v25, a225
    v_mfma_f32_16x16x32_bf16 v[236:239], a[36:39], v[184:187], v[236:239]
    ds_read_b64_tr_b16 a[60:61], v19 offset:28672
    v_cvt_pk_bf16_f32 v198, v204, v205
    v_accvgpr_read_b32 v26, a226
    v_accvgpr_read_b32 v27, a227
    v_mfma_f32_16x16x32_bf16 v[232:235], a[40:43], v[208:211], v[232:235]
    s_waitcnt lgkmcnt(7)
    v_cvt_pk_bf16_f32 v199, v206, v207
    v_accvgpr_read_b32 v28, a232
    v_accvgpr_read_b32 v29, a233
    v_accvgpr_read_b32 v30, a234
    v_mfma_f32_16x16x32_bf16 v[236:239], a[40:43], v[216:219], v[236:239]
    s_add_u32 s89, s3, 5521408
    ds_read_b64_tr_b16 a[0:1], v20 offset:16384
    v_accvgpr_read_b32 v31, a235
    v_mul_f32 v24, v16, v24
    v_mfma_f32_16x16x16_bf16 v[232:235], a[44:45], v[240:241], v[232:235]
    ds_read_b64_tr_b16 a[2:3], v20 offset:18432
    buffer_store_dwordx4 v[196:199], v3, s[8:11], s89 offen sc1
    v_mul_f32 v25, v16, v25
    v_mfma_f32_16x16x16_bf16 v[236:239], a[44:45], v[248:249], v[236:239]
    s_waitcnt lgkmcnt(6)
    ds_read_b64_tr_b16 a[4:5], v20 offset:20480
    v_mul_f32 v26, v16, v26
    v_mul_f32 v27, v16, v27
    v_mul_f32 v28, v16, v28
    v_mfma_f32_16x16x32_bf16 v[148:151], a[48:51], v[144:147], 0
    ds_read_b64_tr_b16 a[6:7], v20 offset:22528
    v_mul_f32 v29, v16, v29
    v_mul_f32 v30, v16, v30
    v_mul_f32 v31, v16, v31
    v_mfma_f32_16x16x32_bf16 v[156:159], a[48:51], v[152:155], 0
    ds_read_b64_tr_b16 a[8:9], v20 offset:24576
    v_cvt_pk_bf16_f32 v100, v24, v25
    v_cvt_pk_bf16_f32 v101, v26, v27
    v_cvt_pk_bf16_f32 v102, v28, v29
    v_mfma_f32_16x16x32_bf16 v[148:151], a[52:55], v[176:179], v[148:151]
    ds_read_b64_tr_b16 a[10:11], v20 offset:26624
    v_cvt_pk_bf16_f32 v103, v30, v31
    v_permlane16_swap_b32 v100, v102
    s_nop 0
    v_permlane16_swap_b32 v101, v103
    v_mfma_f32_16x16x32_bf16 v[156:159], a[52:55], v[184:187], v[156:159]
    s_waitcnt lgkmcnt(6)
    ds_read_b64_tr_b16 a[12:13], v20 offset:28672
    ds_write_b128 v44, v[100:103] offset:4096
    v_cvt_pk_bf16_f32 v224, v224, v225
    v_accvgpr_read_b32 v24, a228
    v_mfma_f32_16x16x32_bf16 v[148:151], a[56:59], v[208:211], v[148:151]
    v_cvt_pk_bf16_f32 v225, v226, v227
    v_accvgpr_read_b32 v25, a229
    v_accvgpr_read_b32 v26, a230
    v_accvgpr_read_b32 v27, a231
    v_mfma_f32_16x16x32_bf16 v[156:159], a[56:59], v[216:219], v[156:159]
    ds_read_b64_tr_b16 a[16:17], v7 offset:32768
    v_cvt_pk_bf16_f32 v226, v232, v233
    v_accvgpr_read_b32 v28, a236
    v_accvgpr_read_b32 v29, a237
    v_mfma_f32_16x16x16_bf16 v[148:151], a[60:61], v[240:241], v[148:151]
    s_waitcnt lgkmcnt(6)
    ds_read_b64_tr_b16 a[18:19], v7 offset:34816
    v_cvt_pk_bf16_f32 v227, v234, v235
    v_accvgpr_read_b32 v30, a238
    v_accvgpr_read_b32 v31, a239
    v_mfma_f32_16x16x16_bf16 v[156:159], a[60:61], v[248:249], v[156:159]
    s_add_u32 s89, s3, 5120
    ds_read_b64_tr_b16 a[20:21], v7 offset:36864
    v_mul_f32 v24, v17, v24
    v_mul_f32 v25, v17, v25
    v_mul_f32 v26, v17, v26
    v_mfma_f32_16x16x32_bf16 v[180:183], a[0:3], v[144:147], 0
    ds_read_b64_tr_b16 a[22:23], v7 offset:38912
    buffer_store_dwordx4 v[224:227], v3, s[8:11], s89 offen sc1
    v_mfma_f32_16x16x32_bf16 v[188:191], a[0:3], v[152:155], 0
    s_waitcnt lgkmcnt(6)
    ds_read_b64_tr_b16 a[24:25], v7 offset:40960
    v_cvt_pk_bf16_f32 v228, v228, v229
    v_mul_f32 v27, v17, v27
    v_mul_f32 v28, v17, v28
    v_mfma_f32_16x16x32_bf16 v[180:183], a[4:7], v[176:179], v[180:183]
    ds_read_b64_tr_b16 a[26:27], v7 offset:43008
    v_cvt_pk_bf16_f32 v229, v230, v231
    v_mul_f32 v29, v17, v29
    v_mul_f32 v30, v17, v30
    v_mfma_f32_16x16x32_bf16 v[188:191], a[4:7], v[184:187], v[188:191]
    ds_read_b64_tr_b16 a[28:29], v7 offset:45056
    v_cvt_pk_bf16_f32 v230, v236, v237
    v_mul_f32 v31, v17, v31
    v_cvt_pk_bf16_f32 v104, v24, v25
    v_mfma_f32_16x16x32_bf16 v[180:183], a[8:11], v[208:211], v[180:183]
    s_waitcnt lgkmcnt(6)
    v_cvt_pk_bf16_f32 v231, v238, v239
    v_cvt_pk_bf16_f32 v105, v26, v27
    v_cvt_pk_bf16_f32 v106, v28, v29
    v_cvt_pk_bf16_f32 v107, v30, v31
    v_mfma_f32_16x16x32_bf16 v[188:191], a[8:11], v[216:219], v[188:191]
    s_add_u32 s89, s3, 3683328
    ds_read_b64_tr_b16 a[32:33], v18 offset:32768
    v_permlane16_swap_b32 v104, v106
    v_permlane16_swap_b32 v105, v107
    v_accvgpr_read_b32 v24, a240
    v_mfma_f32_16x16x16_bf16 v[180:183], a[12:13], v[240:241], v[180:183]
    ds_read_b64_tr_b16 a[34:35], v18 offset:34816
    ds_write_b128 v44, v[104:107] offset:5120
    buffer_store_dwordx4 v[228:231], v3, s[8:11], s89 offen sc1
    v_mfma_f32_16x16x16_bf16 v[188:191], a[12:13], v[248:249], v[188:191]
    s_waitcnt lgkmcnt(6)
    ds_read_b64_tr_b16 a[36:37], v18 offset:36864
    v_accvgpr_read_b32 v25, a241
    v_accvgpr_read_b32 v26, a242
    v_accvgpr_read_b32 v27, a243
    v_mfma_f32_16x16x32_bf16 v[160:163], a[16:19], v[144:147], 0
    ds_read_b64_tr_b16 a[38:39], v18 offset:38912
    v_accvgpr_read_b32 v28, a248
    v_accvgpr_read_b32 v29, a249
    v_accvgpr_read_b32 v30, a250
    v_mfma_f32_16x16x32_bf16 v[164:167], a[16:19], v[152:155], 0
    s_waitcnt lgkmcnt(6)
    ds_read_b64_tr_b16 a[40:41], v18 offset:40960
    v_accvgpr_read_b32 v31, a251
    v_mul_f32 v24, v16, v24
    v_mul_f32 v25, v16, v25
    v_mfma_f32_16x16x32_bf16 v[160:163], a[20:23], v[176:179], v[160:163]
    s_waitcnt vmcnt(16)
    ds_read_b64_tr_b16 a[42:43], v18 offset:43008
    v_mul_f32 v26, v16, v26
    v_mul_f32 v27, v16, v27
    v_mul_f32 v28, v16, v28
    v_mfma_f32_16x16x32_bf16 v[164:167], a[20:23], v[184:187], v[164:167]
    s_barrier
    ds_read_b64_tr_b16 a[44:45], v18 offset:45056
    v_cvt_pk_bf16_f32 v148, v148, v149
    v_mul_f32 v29, v16, v29
    v_mfma_f32_16x16x32_bf16 v[160:163], a[24:27], v[208:211], v[160:163]
    s_waitcnt lgkmcnt(7)
    s_add_u32 m0, s67, 0
    v_cvt_pk_bf16_f32 v149, v150, v151
    v_mul_f32 v30, v16, v30
    v_mul_f32 v31, v16, v31
    v_cvt_pk_bf16_f32 v108, v24, v25
    v_mfma_f32_16x16x32_bf16 v[164:167], a[24:27], v[216:219], v[164:167]
    s_add_u32 s71, s71, 16384
    ds_read_b64_tr_b16 a[48:49], v19 offset:32768
    v_cvt_pk_bf16_f32 v150, v180, v181
    v_cvt_pk_bf16_f32 v109, v26, v27
    v_cvt_pk_bf16_f32 v110, v28, v29
    v_mfma_f32_16x16x16_bf16 v[160:163], a[28:29], v[240:241], v[160:163]
    s_waitcnt lgkmcnt(5)
    ds_read_b64_tr_b16 a[50:51], v19 offset:34816
    buffer_load_dwordx4 v6, s[52:55], s71 offen offset:0 lds
    v_cvt_pk_bf16_f32 v151, v182, v183
    v_mfma_f32_16x16x16_bf16 v[164:167], a[28:29], v[248:249], v[164:167]
    s_add_u32 s89, s3, 1844224
    ds_read_b64_tr_b16 a[52:53], v19 offset:36864
    v_cvt_pk_bf16_f32 v111, v30, v31
    v_permlane16_swap_b32 v108, v110
    s_nop 0
    v_permlane16_swap_b32 v109, v111
    v_mfma_f32_16x16x32_bf16 v[168:171], a[32:35], v[144:147], 0
    ds_read_b64_tr_b16 a[54:55], v19 offset:38912
    ds_write_b128 v44, v[108:111] offset:6144
    buffer_store_dwordx4 v[148:151], v3, s[8:11], s89 offen sc1
    v_accvgpr_read_b32 v24, a244
    v_mfma_f32_16x16x32_bf16 v[172:175], a[32:35], v[152:155], 0
    s_waitcnt lgkmcnt(6)
    ds_read_b64_tr_b16 a[56:57], v19 offset:40960
    buffer_load_dwordx4 v0, s[52:55], s71 offen offset:1024 lds
    v_cvt_pk_bf16_f32 v156, v156, v157
    v_mfma_f32_16x16x32_bf16 v[168:171], a[36:39], v[176:179], v[168:171]
    ds_read_b64_tr_b16 a[58:59], v19 offset:43008
    v_cvt_pk_bf16_f32 v157, v158, v159
    v_accvgpr_read_b32 v25, a245
    v_accvgpr_read_b32 v26, a246
    v_mfma_f32_16x16x32_bf16 v[172:175], a[36:39], v[184:187], v[172:175]
    ds_read_b64_tr_b16 a[60:61], v19 offset:45056
    v_cvt_pk_bf16_f32 v158, v188, v189
    v_accvgpr_read_b32 v27, a247
    v_mfma_f32_16x16x32_bf16 v[168:171], a[40:43], v[208:211], v[168:171]
    s_waitcnt lgkmcnt(7)
    buffer_load_dwordx4 v1, s[52:55], s71 offen offset:2048 lds
    v_cvt_pk_bf16_f32 v159, v190, v191
    v_accvgpr_read_b32 v28, a252
    v_mfma_f32_16x16x32_bf16 v[172:175], a[40:43], v[216:219], v[172:175]
    s_add_u32 s89, s3, 5522432
    ds_read_b64_tr_b16 a[0:1], v20 offset:32768
    v_accvgpr_read_b32 v29, a253
    v_accvgpr_read_b32 v30, a254
    v_accvgpr_read_b32 v31, a255
    v_mfma_f32_16x16x16_bf16 v[168:171], a[44:45], v[240:241], v[168:171]
    ds_read_b64_tr_b16 a[2:3], v20 offset:34816
    buffer_store_dwordx4 v[156:159], v3, s[8:11], s89 offen sc1
    v_mul_f32 v24, v17, v24
    v_mfma_f32_16x16x16_bf16 v[172:175], a[44:45], v[248:249], v[172:175]
    s_waitcnt lgkmcnt(5)
    ds_read_b64_tr_b16 a[4:5], v20 offset:36864
    buffer_load_dwordx4 v21, s[52:55], s71 offen offset:3072 lds
    v_mul_f32 v25, v17, v25
    v_mfma_f32_16x16x32_bf16 v[192:195], a[48:51], v[144:147], 0
    s_add_u32 m0, s67, 16384
    ds_read_b64_tr_b16 a[6:7], v20 offset:38912
    v_mul_f32 v26, v17, v26
    v_mul_f32 v27, v17, v27
    v_mfma_f32_16x16x32_bf16 v[196:199], a[48:51], v[152:155], 0
    s_add_u32 s71, s71, 16384
    ds_read_b64_tr_b16 a[8:9], v20 offset:40960
    v_mul_f32 v28, v17, v28
    v_mul_f32 v29, v17, v29
    v_mul_f32 v30, v17, v30
    v_mfma_f32_16x16x32_bf16 v[192:195], a[52:55], v[176:179], v[192:195]
    ds_read_b64_tr_b16 a[10:11], v20 offset:43008
    buffer_load_dwordx4 v6, s[52:55], s71 offen offset:0 lds
    v_mul_f32 v31, v17, v31
    v_mfma_f32_16x16x32_bf16 v[196:199], a[52:55], v[184:187], v[196:199]
    s_waitcnt lgkmcnt(6)
    ds_read_b64_tr_b16 a[12:13], v20 offset:45056
    v_cvt_pk_bf16_f32 v160, v160, v161
    v_cvt_pk_bf16_f32 v112, v24, v25
    v_cvt_pk_bf16_f32 v113, v26, v27
    v_mfma_f32_16x16x32_bf16 v[192:195], a[56:59], v[208:211], v[192:195]
    ds_read_b128 v[224:227], v11 offset:0
    v_cvt_pk_bf16_f32 v161, v162, v163
    v_cvt_pk_bf16_f32 v114, v28, v29
    v_cvt_pk_bf16_f32 v115, v30, v31
    s_nop 0
    v_permlane16_swap_b32 v112, v114
    v_mfma_f32_16x16x32_bf16 v[196:199], a[56:59], v[216:219], v[196:199]
    buffer_load_dwordx4 v0, s[52:55], s71 offen offset:1024 lds
    v_permlane16_swap_b32 v113, v115
    v_mfma_f32_16x16x16_bf16 v[192:195], a[60:61], v[240:241], v[192:195]
    ds_write_b128 v44, v[112:115] offset:7168
    v_cvt_pk_bf16_f32 v162, v168, v169
    v_mfma_f32_16x16x16_bf16 v[196:199], a[60:61], v[248:249], v[196:199]
    s_waitcnt lgkmcnt(5)
    v_cvt_pk_bf16_f32 v163, v170, v171
    v_mfma_f32_16x16x32_bf16 v[200:203], a[0:3], v[144:147], 0
    s_add_u32 s89, s3, 6144
    ds_read_b128 v[228:231], v12 offset:0
    buffer_load_dwordx4 v1, s[52:55], s71 offen offset:2048 lds
    v_mfma_f32_16x16x32_bf16 v[204:207], a[0:3], v[152:155], 0
    buffer_store_dwordx4 v[160:163], v3, s[8:11], s89 offen sc1
    v_mfma_f32_16x16x32_bf16 v[200:203], a[4:7], v[176:179], v[200:203]
    v_cvt_pk_bf16_f32 v164, v164, v165
    v_mfma_f32_16x16x32_bf16 v[204:207], a[4:7], v[184:187], v[204:207]
    s_waitcnt lgkmcnt(2)
    buffer_load_dwordx4 v21, s[52:55], s71 offen offset:3072 lds
    v_mfma_f32_16x16x32_bf16 v[200:203], a[8:11], v[208:211], v[200:203]
    ds_read_b128 v[232:235], v13 offset:0
    v_cvt_pk_bf16_f32 v165, v166, v167
    v_mfma_f32_16x16x32_bf16 v[204:207], a[8:11], v[216:219], v[204:207]
    v_cvt_pk_bf16_f32 v166, v172, v173
    v_mfma_f32_16x16x16_bf16 v[200:203], a[12:13], v[240:241], v[200:203]
    v_cvt_pk_bf16_f32 v167, v174, v175
    v_mfma_f32_16x16x16_bf16 v[204:207], a[12:13], v[248:249], v[204:207]
    s_add_u32 s89, s3, 3684352
    v_mfma_f32_16x16x32_bf16 v[148:151], v[224:227], v[212:215], 0
    ds_read_b128 v[236:239], v14 offset:0
    buffer_store_dwordx4 v[164:167], v3, s[8:11], s89 offen sc1
    v_mfma_f32_16x16x32_bf16 v[156:159], v[224:227], v[220:223], 0
    v_mfma_f32_16x16x32_bf16 v[180:183], v[224:227], v[52:55], 0
    s_waitcnt vmcnt(16)
    v_mfma_f32_16x16x32_bf16 v[188:191], v[224:227], v[56:59], 0
    s_waitcnt lgkmcnt(1)
    s_barrier
    v_cvt_pk_bf16_f32 v192, v192, v193
    v_mfma_f32_16x16x32_bf16 v[148:151], v[228:231], v[244:247], v[148:151]
    s_add_u32 m0, s67, 32768
    ds_read_b128 v[224:227], v11 offset:256
    v_cvt_pk_bf16_f32 v193, v194, v195
    v_mfma_f32_16x16x32_bf16 v[156:159], v[228:231], v[252:255], v[156:159]
    s_add_u32 s70, s70, 16384
    ds_read_b128 v[116:119], v45 offset:0
    v_cvt_pk_bf16_f32 v194, v200, v201
    v_mfma_f32_16x16x32_bf16 v[180:183], v[228:231], v[60:63], v[180:183]
    ds_read_b128 v[120:123], v45 offset:1024
    buffer_load_dwordx4 v6, s[48:51], s70 offen offset:0 lds
    v_cvt_pk_bf16_f32 v195, v202, v203
    v_mfma_f32_16x16x32_bf16 v[188:191], v[228:231], v[64:67], v[188:191]
    s_add_u32 s89, s3, 1845248
    ds_read_b128 v[124:127], v45 offset:2048
    v_mfma_f32_16x16x32_bf16 v[148:151], v[232:235], v[32:35], v[148:151]
    ds_read_b128 v[228:231], v12 offset:256
    ds_read_b128 v[128:131], v45 offset:3072
    buffer_store_dwordx4 v[192:195], v3, s[8:11], s89 offen sc1
    v_mfma_f32_16x16x32_bf16 v[156:159], v[232:235], v[36:39], v[156:159]
    ds_read_b128 v[132:135], v45 offset:4096
    v_cvt_pk_bf16_f32 v196, v196, v197
    v_mfma_f32_16x16x32_bf16 v[180:183], v[232:235], v[68:71], v[180:183]
    ds_read_b128 v[136:139], v45 offset:5120
    buffer_load_dwordx4 v0, s[48:51], s70 offen offset:1024 lds
    v_cvt_pk_bf16_f32 v197, v198, v199
    v_mfma_f32_16x16x32_bf16 v[188:191], v[232:235], v[72:75], v[188:191]
    s_waitcnt lgkmcnt(7)
    ds_read_b128 v[140:143], v45 offset:6144
    v_cvt_pk_bf16_f32 v198, v204, v205
    v_mfma_f32_16x16x32_bf16 v[148:151], v[236:239], v[40:43], v[148:151]
    ds_read_b128 v[232:235], v13 offset:256
    ds_read_b128 v[44:47], v45 offset:7168
    v_cvt_pk_bf16_f32 v199, v206, v207
    v_mfma_f32_16x16x32_bf16 v[156:159], v[236:239], v[48:51], v[156:159]
    s_add_u32 s89, s3, 5523456
    v_mfma_f32_16x16x32_bf16 v[180:183], v[236:239], v[76:79], v[180:183]
    buffer_store_dwordx4 v[196:199], v3, s[8:11], s89 offen sc1
    buffer_load_dwordx4 v1, s[48:51], s70 offen offset:2048 lds
    v_mfma_f32_16x16x32_bf16 v[188:191], v[236:239], v[80:83], v[188:191]
    v_mov_b32 v24, 0
    v_mfma_f32_16x16x32_bf16 v[148:151], v[224:227], v[84:87], v[148:151]
    ds_read_b128 v[236:239], v14 offset:256
    v_mfma_f32_16x16x32_bf16 v[156:159], v[224:227], v[88:91], v[156:159]
    s_waitcnt lgkmcnt(4)
    v_mfma_f32_16x16x32_bf16 v[180:183], v[224:227], v[116:119], v[180:183]
    buffer_load_dwordx4 v21, s[48:51], s70 offen offset:3072 lds
    v_mfma_f32_16x16x32_bf16 v[188:191], v[224:227], v[120:123], v[188:191]
    v_mov_b32 v25, 0
    v_mfma_f32_16x16x32_bf16 v[148:151], v[228:231], v[92:95], v[148:151]
    s_add_u32 m0, s67, 49152
    ds_read_b128 v[224:227], v11 offset:8192
    v_mfma_f32_16x16x32_bf16 v[156:159], v[228:231], v[96:99], v[156:159]
    s_add_u32 s70, s70, 16384
    v_mfma_f32_16x16x32_bf16 v[180:183], v[228:231], v[124:127], v[180:183]
    buffer_load_dwordx4 v6, s[48:51], s70 offen offset:0 lds
    v_mfma_f32_16x16x32_bf16 v[188:191], v[228:231], v[128:131], v[188:191]
    s_waitcnt lgkmcnt(1)
    v_mov_b32 v26, 0
    v_mfma_f32_16x16x32_bf16 v[148:151], v[232:235], v[100:103], v[148:151]
    ds_read_b128 v[228:231], v12 offset:8192
    v_mfma_f32_16x16x32_bf16 v[156:159], v[232:235], v[104:107], v[156:159]
    v_mfma_f32_16x16x32_bf16 v[180:183], v[232:235], v[132:135], v[180:183]
    buffer_load_dwordx4 v0, s[48:51], s70 offen offset:1024 lds
    v_mfma_f32_16x16x32_bf16 v[188:191], v[232:235], v[136:139], v[188:191]
    v_mov_b32 v27, 0
    v_mfma_f32_16x16x32_bf16 v[148:151], v[236:239], v[108:111], v[148:151]
    ds_read_b128 v[232:235], v13 offset:8192
    v_mfma_f32_16x16x32_bf16 v[156:159], v[236:239], v[112:115], v[156:159]
    v_mfma_f32_16x16x32_bf16 v[180:183], v[236:239], v[140:143], v[180:183]
    buffer_load_dwordx4 v1, s[48:51], s70 offen offset:2048 lds
    v_mfma_f32_16x16x32_bf16 v[188:191], v[236:239], v[44:47], v[188:191]
    s_waitcnt lgkmcnt(1)
    v_mfma_f32_16x16x32_bf16 v[144:147], v[224:227], v[212:215], 0
    s_mov_b32 s96, 131072
    ds_read_b128 v[236:239], v14 offset:8192
    v_mfma_f32_16x16x32_bf16 v[152:155], v[224:227], v[220:223], 0
    buffer_load_dword v22, v23, s[48:51], s96 offen
    v_mfma_f32_16x16x32_bf16 v[176:179], v[224:227], v[52:55], 0
    buffer_load_dwordx4 v21, s[48:51], s70 offen offset:3072 lds
    v_max3_f32 v160, v148, v149, v150
    v_mfma_f32_16x16x32_bf16 v[184:187], v[224:227], v[56:59], 0
    v_max_f32 v160, v160, v151
    v_max3_f32 v164, v156, v157, v158
    v_max_f32 v164, v164, v159
    v_mfma_f32_16x16x32_bf16 v[144:147], v[228:231], v[244:247], v[144:147]
    ds_read_b128 v[224:227], v11 offset:8448
    v_max3_f32 v168, v180, v181, v182
    v_max_f32 v168, v168, v183
    v_mfma_f32_16x16x32_bf16 v[152:155], v[228:231], v[252:255], v[152:155]
    v_max3_f32 v172, v188, v189, v190
    v_max_f32 v172, v172, v191
    v_mfma_f32_16x16x32_bf16 v[176:179], v[228:231], v[60:63], v[176:179]
    v_mov_b32 v161, v160
    v_mov_b32 v165, v164
    v_mov_b32 v169, v168
    v_mfma_f32_16x16x32_bf16 v[184:187], v[228:231], v[64:67], v[184:187]
    s_waitcnt lgkmcnt(1)
    v_mov_b32 v173, v172
    v_permlane32_swap_b32 v160, v161
    v_permlane32_swap_b32 v164, v165
    v_mfma_f32_16x16x32_bf16 v[144:147], v[232:235], v[32:35], v[144:147]
    ds_read_b128 v[228:231], v12 offset:8448
    v_permlane32_swap_b32 v168, v169
    v_mfma_f32_16x16x32_bf16 v[152:155], v[232:235], v[36:39], v[152:155]
    v_permlane32_swap_b32 v172, v173
    v_max_f32 v160, v160, v161
    v_max_f32 v164, v164, v165
    v_mfma_f32_16x16x32_bf16 v[176:179], v[232:235], v[68:71], v[176:179]
    v_max_f32 v168, v168, v169
    v_max_f32 v172, v172, v173
    v_mov_b32 v161, v160
    v_mfma_f32_16x16x32_bf16 v[184:187], v[232:235], v[72:75], v[184:187]
    v_mov_b32 v165, v164
    v_mov_b32 v169, v168
    v_mfma_f32_16x16x32_bf16 v[144:147], v[236:239], v[40:43], v[144:147]
    ds_read_b128 v[232:235], v13 offset:8448
    v_mov_b32 v173, v172
    v_permlane16_swap_b32 v160, v161
    v_mfma_f32_16x16x32_bf16 v[152:155], v[236:239], v[48:51], v[152:155]
    v_permlane16_swap_b32 v164, v165
    v_permlane16_swap_b32 v168, v169
    v_permlane16_swap_b32 v172, v173
    v_mfma_f32_16x16x32_bf16 v[176:179], v[236:239], v[76:79], v[176:179]
    v_max_f32 v160, v160, v161
    v_max_f32 v164, v164, v165
    v_mfma_f32_16x16x32_bf16 v[184:187], v[236:239], v[80:83], v[184:187]
    s_waitcnt lgkmcnt(1)
    v_max_f32 v168, v168, v169
    v_max_f32 v172, v172, v173
    v_sub_f32 v208, 0, v160
    v_mfma_f32_16x16x32_bf16 v[144:147], v[224:227], v[84:87], v[144:147]
    ds_read_b128 v[236:239], v14 offset:8448
    v_sub_f32 v209, 0, v160
    v_sub_f32 v210, 0, v160
    v_mfma_f32_16x16x32_bf16 v[152:155], v[224:227], v[88:91], v[152:155]
    v_sub_f32 v211, 0, v160
    v_add_f32 v148, v148, v208
    v_add_f32 v149, v149, v208
    v_mfma_f32_16x16x32_bf16 v[176:179], v[224:227], v[116:119], v[176:179]
    v_add_f32 v150, v150, v208
    v_add_f32 v151, v151, v208
    v_mfma_f32_16x16x32_bf16 v[184:187], v[224:227], v[120:123], v[184:187]
    v_sub_f32 v216, 0, v164
    v_sub_f32 v217, 0, v164
    v_sub_f32 v218, 0, v164
    v_mfma_f32_16x16x32_bf16 v[144:147], v[228:231], v[92:95], v[144:147]
    ds_read_b128 v[224:227], v11 offset:32768
    v_sub_f32 v219, 0, v164
    v_add_f32 v156, v156, v216
    v_add_f32 v157, v157, v216
    v_mfma_f32_16x16x32_bf16 v[152:155], v[228:231], v[96:99], v[152:155]
    v_add_f32 v158, v158, v216
    v_add_f32 v159, v159, v216
    v_mfma_f32_16x16x32_bf16 v[176:179], v[228:231], v[124:127], v[176:179]
    v_sub_f32 v240, 0, v168
    v_sub_f32 v241, 0, v168
    v_sub_f32 v242, 0, v168
    v_mfma_f32_16x16x32_bf16 v[184:187], v[228:231], v[128:131], v[184:187]
    s_waitcnt lgkmcnt(1)
    v_sub_f32 v243, 0, v168
    v_add_f32 v180, v180, v240
    v_add_f32 v181, v181, v240
    v_mfma_f32_16x16x32_bf16 v[144:147], v[232:235], v[100:103], v[144:147]
    ds_read_b128 v[228:231], v12 offset:32768
    v_add_f32 v182, v182, v240
    v_add_f32 v183, v183, v240
    v_mfma_f32_16x16x32_bf16 v[152:155], v[232:235], v[104:107], v[152:155]
    v_sub_f32 v248, 0, v172
    v_sub_f32 v249, 0, v172
    v_sub_f32 v250, 0, v172
    v_mfma_f32_16x16x32_bf16 v[176:179], v[232:235], v[132:135], v[176:179]
    v_sub_f32 v251, 0, v172
    v_add_f32 v188, v188, v248
    v_add_f32 v189, v189, v248
    v_mfma_f32_16x16x32_bf16 v[184:187], v[232:235], v[136:139], v[184:187]
    v_add_f32 v190, v190, v248
    v_add_f32 v191, v191, v248
    v_mfma_f32_16x16x32_bf16 v[144:147], v[236:239], v[108:111], v[144:147]
    ds_read_b128 v[232:235], v13 offset:32768
    v_exp_f32 v148, v148
    v_exp_f32 v149, v149
    v_exp_f32 v150, v150
    v_mfma_f32_16x16x32_bf16 v[152:155], v[236:239], v[112:115], v[152:155]
    v_exp_f32 v151, v151
    v_add_f32 v28, v148, v149
    v_add_f32 v28, v28, v150
    v_mfma_f32_16x16x32_bf16 v[176:179], v[236:239], v[140:143], v[176:179]
    v_add_f32 v28, v28, v151
    v_exp_f32 v156, v156
    v_mfma_f32_16x16x32_bf16 v[184:187], v[236:239], v[44:47], v[184:187]
    v_exp_f32 v157, v157
    v_exp_f32 v158, v158
    v_exp_f32 v159, v159
    v_add_f32 v29, v156, v157
    v_add_f32 v29, v29, v158
    v_add_f32 v29, v29, v159
    v_exp_f32 v180, v180
    v_exp_f32 v181, v181
    v_exp_f32 v182, v182
    v_exp_f32 v183, v183
    v_add_f32 v30, v180, v181
    v_add_f32 v30, v30, v182
    v_add_f32 v30, v30, v183
    v_exp_f32 v188, v188
    v_exp_f32 v189, v189
    v_exp_f32 v190, v190
    v_exp_f32 v191, v191
    v_add_f32 v31, v188, v189
    v_add_f32 v31, v31, v190
    v_add_f32 v31, v31, v191
    v_cvt_pk_bf16_f32 v160, v148, v149
    v_cvt_pk_bf16_f32 v161, v150, v151
    v_cvt_pk_bf16_f32 v164, v156, v157
    v_cvt_pk_bf16_f32 v165, v158, v159
    v_cvt_pk_bf16_f32 v168, v180, v181
    v_cvt_pk_bf16_f32 v169, v182, v183
    v_cvt_pk_bf16_f32 v172, v188, v189
    v_cvt_pk_bf16_f32 v173, v190, v191
    v_add_f32 v144, v144, v208
    v_add_f32 v145, v145, v208
    v_add_f32 v146, v146, v208
    v_add_f32 v147, v147, v208
    v_add_f32 v152, v152, v216
    v_add_f32 v153, v153, v216
    v_add_f32 v154, v154, v216
    v_add_f32 v155, v155, v216
    v_add_f32 v176, v176, v240
    v_add_f32 v177, v177, v240
    v_add_f32 v178, v178, v240
    v_add_f32 v179, v179, v240
    v_add_f32 v184, v184, v248
    v_add_f32 v185, v185, v248
    v_add_f32 v186, v186, v248
    v_add_f32 v187, v187, v248
    v_exp_f32 v144, v144
    v_exp_f32 v145, v145
    v_exp_f32 v146, v146
    v_exp_f32 v147, v147
    v_add_f32 v28, v28, v144
    v_add_f32 v28, v28, v145
    v_add_f32 v28, v28, v146
    v_add_f32 v28, v28, v147
    v_exp_f32 v152, v152
    v_exp_f32 v153, v153
    v_exp_f32 v154, v154
    v_exp_f32 v155, v155
    v_add_f32 v29, v29, v152
    v_add_f32 v29, v29, v153
    v_add_f32 v29, v29, v154
    v_add_f32 v29, v29, v155
    v_exp_f32 v176, v176
    v_exp_f32 v177, v177
    v_exp_f32 v178, v178
    v_exp_f32 v179, v179
    v_add_f32 v30, v30, v176
    v_add_f32 v30, v30, v177
    v_add_f32 v30, v30, v178
    v_add_f32 v30, v30, v179
    v_exp_f32 v184, v184
    v_exp_f32 v185, v185
    v_exp_f32 v186, v186
    v_exp_f32 v187, v187
    v_add_f32 v31, v31, v184
    v_add_f32 v31, v31, v185
    v_add_f32 v31, v31, v186
    v_add_f32 v31, v31, v187
    v_max3_f32 v16, v28, v29, v30
    v_max_f32 v16, v16, v31
    v_cmp_nge_f32 vcc, s77, v16
    s_cbranch_vccnz L_slow_p0
L_back_p0:
    s_waitcnt lgkmcnt(1)
    v_mfma_f32_16x16x32_bf16 v[148:151], v[224:227], v[212:215], v[208:211]
    ds_read_b128 v[236:239], v14 offset:32768
    v_mfma_f32_16x16x32_bf16 v[156:159], v[224:227], v[220:223], v[216:219]
    v_add_f32 v24, v24, v28
    v_add_f32 v25, v25, v29
    v_mfma_f32_16x16x32_bf16 v[180:183], v[224:227], v[52:55], v[240:243]
    s_waitcnt vmcnt(12)
    v_mfma_f32_16x16x32_bf16 v[188:191], v[224:227], v[56:59], v[248:251]
    s_barrier
    v_cvt_pk_bf16_f32 v162, v144, v145
    v_cvt_pk_bf16_f32 v163, v146, v147
    v_mfma_f32_16x16x32_bf16 v[148:151], v[228:231], v[244:247], v[148:151]
    s_add_u32 m0, s67, 65536
    ds_read_b128 v[224:227], v11 offset:33024
    v_mfma_f32_16x16x32_bf16 v[156:159], v[228:231], v[252:255], v[156:159]
    s_add_u32 s71, s71, 16384
    v_add_f32 v26, v26, v30
    v_add_f32 v27, v27, v31
    v_mfma_f32_16x16x32_bf16 v[180:183], v[228:231], v[60:63], v[180:183]
    buffer_load_dwordx4 v6, s[52:55], s71 offen offset:0 lds
    v_mfma_f32_16x16x32_bf16 v[188:191], v[228:231], v[64:67], v[188:191]
    s_waitcnt lgkmcnt(1)
    v_cvt_pk_bf16_f32 v166, v152, v153
    v_cvt_pk_bf16_f32 v167, v154, v155
    v_mfma_f32_16x16x32_bf16 v[148:151], v[232:235], v[32:35], v[148:151]
    ds_read_b128 v[228:231], v12 offset:33024
    v_mfma_f32_16x16x32_bf16 v[156:159], v[232:235], v[36:39], v[156:159]
    v_mfma_f32_16x16x32_bf16 v[180:183], v[232:235], v[68:71], v[180:183]
    buffer_load_dwordx4 v0, s[52:55], s71 offen offset:1024 lds
    v_mfma_f32_16x16x32_bf16 v[188:191], v[232:235], v[72:75], v[188:191]
    v_cvt_pk_bf16_f32 v170, v176, v177
    v_cvt_pk_bf16_f32 v171, v178, v179
    v_mfma_f32_16x16x32_bf16 v[148:151], v[236:239], v[40:43], v[148:151]
    ds_read_b128 v[232:235], v13 offset:33024
    v_mfma_f32_16x16x32_bf16 v[156:159], v[236:239], v[48:51], v[156:159]
    v_mfma_f32_16x16x32_bf16 v[180:183], v[236:239], v[76:79], v[180:183]
    buffer_load_dwordx4 v1, s[52:55], s71 offen offset:2048 lds
    v_mfma_f32_16x16x32_bf16 v[188:191], v[236:239], v[80:83], v[188:191]
    s_waitcnt lgkmcnt(1)
    v_cvt_pk_bf16_f32 v174, v184, v185
    v_cvt_pk_bf16_f32 v175, v186, v187
    v_mfma_f32_16x16x32_bf16 v[148:151], v[224:227], v[84:87], v[148:151]
    ds_read_b128 v[236:239], v14 offset:33024
    v_mfma_f32_16x16x32_bf16 v[156:159], v[224:227], v[88:91], v[156:159]
    v_mfma_f32_16x16x32_bf16 v[180:183], v[224:227], v[116:119], v[180:183]
    buffer_load_dwordx4 v21, s[52:55], s71 offen offset:3072 lds
    v_xor_b32 v195, 65536, v5
    v_mfma_f32_16x16x32_bf16 v[188:191], v[224:227], v[120:123], v[188:191]
    v_xor_b32 v15, 32, v5
    v_mfma_f32_16x16x32_bf16 v[148:151], v[228:231], v[92:95], v[148:151]
    s_add_u32 m0, s67, 81920
    ds_read_b128 v[224:227], v11 offset:40960
    v_xor_b32 v196, 65568, v5
    v_mfma_f32_16x16x32_bf16 v[156:159], v[228:231], v[96:99], v[156:159]
    s_add_u32 s71, s71, 16384
    v_xor_b32 v18, 64, v5
    v_mfma_f32_16x16x32_bf16 v[180:183], v[228:231], v[124:127], v[180:183]
    buffer_load_dwordx4 v6, s[52:55], s71 offen offset:0 lds
    v_xor_b32 v197, 65600, v5
    v_mfma_f32_16x16x32_bf16 v[188:191], v[228:231], v[128:131], v[188:191]
    s_waitcnt lgkmcnt(1)
    v_xor_b32 v19, 96, v5
    v_mfma_f32_16x16x32_bf16 v[148:151], v[232:235], v[100:103], v[148:151]
    ds_read_b128 v[228:231], v12 offset:40960
    v_xor_b32 v198, 65632, v5
    v_mfma_f32_16x16x32_bf16 v[156:159], v[232:235], v[104:107], v[156:159]
    s_and_b32 s96, s76, 3
    v_xor_b32 v20, 128, v5
    v_mfma_f32_16x16x32_bf16 v[180:183], v[232:235], v[132:135], v[180:183]
    s_lshl_b32 s96, s96, 16
    buffer_load_dwordx4 v0, s[52:55], s71 offen offset:1024 lds
    v_xor_b32 v199, 65664, v5
    v_mfma_f32_16x16x32_bf16 v[188:191], v[232:235], v[136:139], v[188:191]
    buffer_load_dword v22, v23, s[56:59], s96 offen
    v_xor_b32 v192, 160, v5
    v_mfma_f32_16x16x32_bf16 v[148:151], v[236:239], v[108:111], v[148:151]
    ds_read_b128 v[232:235], v13 offset:40960
    v_xor_b32 v200, 65696, v5
    v_mfma_f32_16x16x32_bf16 v[156:159], v[236:239], v[112:115], v[156:159]
    v_xor_b32 v193, 192, v5
    v_mfma_f32_16x16x32_bf16 v[180:183], v[236:239], v[140:143], v[180:183]
    buffer_load_dwordx4 v1, s[52:55], s71 offen offset:2048 lds
    v_xor_b32 v201, 65728, v5
    v_mfma_f32_16x16x32_bf16 v[188:191], v[236:239], v[44:47], v[188:191]
    s_waitcnt lgkmcnt(1)
    v_xor_b32 v194, 224, v5
    v_mfma_f32_16x16x32_bf16 v[144:147], v[224:227], v[212:215], v[208:211]
    ds_read_b128 v[236:239], v14 offset:40960
    v_xor_b32 v202, 65760, v5
    v_mfma_f32_16x16x32_bf16 v[152:155], v[224:227], v[220:223], v[216:219]
    v_mfma_f32_16x16x32_bf16 v[176:179], v[224:227], v[52:55], v[240:243]
    buffer_load_dwordx4 v21, s[52:55], s71 offen offset:3072 lds
    v_mfma_f32_16x16x32_bf16 v[184:187], v[224:227], v[56:59], v[248:251]
    v_exp_f32 v148, v148
    v_mfma_f32_16x16x32_bf16 v[144:147], v[228:231], v[244:247], v[144:147]
    s_mov_b32 s3, 2147483648
    ds_read_b128 v[224:227], v11 offset:41216
    v_mfma_f32_16x16x32_bf16 v[152:155], v[228:231], v[252:255], v[152:155]
    s_mov_b32 s96, 131072
    v_exp_f32 v149, v149
    v_mfma_f32_16x16x32_bf16 v[176:179], v[228:231], v[60:63], v[176:179]
    buffer_load_dword v22, v23, s[52:55], s96 offen
    v_add_f32 v28, v148, v149
    v_mfma_f32_16x16x32_bf16 v[184:187], v[228:231], v[64:67], v[184:187]
    s_waitcnt lgkmcnt(1)
    v_exp_f32 v150, v150
    v_mfma_f32_16x16x32_bf16 v[144:147], v[232:235], v[32:35], v[144:147]
    ds_read_b128 v[228:231], v12 offset:41216
    v_add_f32 v28, v28, v150
    v_mfma_f32_16x16x32_bf16 v[152:155], v[232:235], v[36:39], v[152:155]
    v_exp_f32 v151, v151
    v_mfma_f32_16x16x32_bf16 v[176:179], v[232:235], v[68:71], v[176:179]
    v_add_f32 v28, v28, v151
    v_mfma_f32_16x16x32_bf16 v[184:187], v[232:235], v[72:75], v[184:187]
    v_exp_f32 v156, v156
    v_mfma_f32_16x16x32_bf16 v[144:147], v[236:239], v[40:43], v[144:147]
    ds_read_b128 v[232:235], v13 offset:41216
    v_mfma_f32_16x16x32_bf16 v[152:155], v[236:239], v[48:51], v[152:155]
    v_exp_f32 v157, v157
    v_mfma_f32_16x16x32_bf16 v[176:179], v[236:239], v[76:79], v[176:179]
    v_add_f32 v29, v156, v157
    v_mfma_f32_16x16x32_bf16 v[184:187], v[236:239], v[80:83], v[184:187]
    s_waitcnt lgkmcnt(1)
    v_exp_f32 v158, v158
    v_mfma_f32_16x16x32_bf16 v[144:147], v[224:227], v[84:87], v[144:147]
    ds_read_b128 v[236:239], v14 offset:41216
    v_add_f32 v29, v29, v158
    v_mfma_f32_16x16x32_bf16 v[152:155], v[224:227], v[88:91], v[152:155]
    v_exp_f32 v159, v159
    v_mfma_f32_16x16x32_bf16 v[176:179], v[224:227], v[116:119], v[176:179]
    v_add_f32 v29, v29, v159
    v_mfma_f32_16x16x32_bf16 v[184:187], v[224:227], v[120:123], v[184:187]
    v_exp_f32 v180, v180
    v_mfma_f32_16x16x32_bf16 v[144:147], v[228:231], v[92:95], v[144:147]
    ds_read_b64_tr_b16 v[224:225], v5 offset:0
    v_mfma_f32_16x16x32_bf16 v[152:155], v[228:231], v[96:99], v[152:155]
    ds_read_b64_tr_b16 v[226:227], v5 offset:8192
    v_mfma_f32_16x16x32_bf16 v[176:179], v[228:231], v[124:127], v[176:179]
    v_exp_f32 v181, v181
    v_mfma_f32_16x16x32_bf16 v[184:187], v[228:231], v[128:131], v[184:187]
    s_waitcnt lgkmcnt(2)
    v_exp_f32 v182, v182
    v_mfma_f32_16x16x32_bf16 v[144:147], v[232:235], v[100:103], v[144:147]
    ds_read_b64_tr_b16 v[228:229], v15 offset:0
    v_add_f32 v30, v180, v181
    v_mfma_f32_16x16x32_bf16 v[152:155], v[232:235], v[104:107], v[152:155]
    ds_read_b64_tr_b16 v[230:231], v15 offset:8192
    v_add_f32 v30, v30, v182
    v_mfma_f32_16x16x32_bf16 v[176:179], v[232:235], v[132:135], v[176:179]
    v_exp_f32 v183, v183
    v_mfma_f32_16x16x32_bf16 v[184:187], v[232:235], v[136:139], v[184:187]
    v_lshrrev_b32 v17, 1, v23
    v_exp_f32 v188, v188
    v_mfma_f32_16x16x32_bf16 v[144:147], v[236:239], v[108:111], v[144:147]
    ds_read_b64_tr_b16 v[232:233], v18 offset:0
    v_add_f32 v30, v30, v183
    v_mfma_f32_16x16x32_bf16 v[152:155], v[236:239], v[112:115], v[152:155]
    ds_read_b64_tr_b16 v[234:235], v18 offset:8192
    v_mfma_f32_16x16x32_bf16 v[176:179], v[236:239], v[140:143], v[176:179]
    v_exp_f32 v189, v189
    v_mfma_f32_16x16x32_bf16 v[184:187], v[236:239], v[44:47], v[184:187]
    s_waitcnt lgkmcnt(3)
    v_exp_f32 v190, v190
    v_mfma_f32_16x16x32_bf16 a[0:3], v[224:227], v[160:163], 0
    ds_read_b64_tr_b16 v[236:237], v19 offset:0
    v_add_f32 v31, v188, v189
    v_mfma_f32_16x16x32_bf16 a[64:67], v[224:227], v[164:167], 0
    ds_read_b64_tr_b16 v[238:239], v19 offset:8192
    v_add_f32 v31, v31, v190
    v_mfma_f32_16x16x32_bf16 a[128:131], v[224:227], v[168:171], 0
    s_waitcnt vmcnt(10)
    v_add_u32 v17, L_tail-L_pc0, v17
    v_exp_f32 v191, v191
    v_mfma_f32_16x16x32_bf16 a[192:195], v[224:227], v[172:175], 0
    s_waitcnt lgkmcnt(3)
    s_barrier
    v_mfma_f32_16x16x32_bf16 a[4:7], v[228:231], v[160:163], 0
    ds_read_b64_tr_b16 v[224:225], v20 offset:0
    v_add_f32 v31, v31, v191
    v_mfma_f32_16x16x32_bf16 a[68:71], v[228:231], v[164:167], 0
    s_add_u32 m0, s67, 98304
    ds_read_b64_tr_b16 v[226:227], v20 offset:8192
    v_mfma_f32_16x16x32_bf16 a[132:135], v[228:231], v[168:171], 0
    s_add_u32 s70, s70, 16384
    v_exp_f32 v144, v144
    v_mfma_f32_16x16x32_bf16 a[196:199], v[228:231], v[172:175], 0
    s_waitcnt lgkmcnt(3)
    buffer_load_dwordx4 v6, s[48:51], s70 offen offset:0 lds
    v_mfma_f32_16x16x32_bf16 a[8:11], v[232:235], v[160:163], 0
    ds_read_b64_tr_b16 v[228:229], v192 offset:0
    v_add_f32 v28, v28, v144
    v_mfma_f32_16x16x32_bf16 a[72:75], v[232:235], v[164:167], 0
    ds_read_b64_tr_b16 v[230:231], v192 offset:8192
    v_min_u32 v17, L_k1_last-L_pc0, v17
    v_mfma_f32_16x16x32_bf16 a[136:139], v[232:235], v[168:171], 0
    v_exp_f32 v145, v145
    v_mfma_f32_16x16x32_bf16 a[200:203], v[232:235], v[172:175], 0
    s_waitcnt lgkmcnt(3)
    buffer_load_dwordx4 v0, s[48:51], s70 offen offset:1024 lds
    v_mfma_f32_16x16x32_bf16 a[12:15], v[236:239], v[160:163], 0
    ds_read_b64_tr_b16 v[232:233], v193 offset:0
    v_add_f32 v28, v28, v145
    v_mfma_f32_16x16x32_bf16 a[76:79], v[236:239], v[164:167], 0
    ds_read_b64_tr_b16 v[234:235], v193 offset:8192
    v_mfma_f32_16x16x32_bf16 a[140:143], v[236:239], v[168:171], 0
    v_exp_f32 v146, v146
    v_mfma_f32_16x16x32_bf16 a[204:207], v[236:239], v[172:175], 0
    s_waitcnt lgkmcnt(3)
    buffer_load_dwordx4 v1, s[48:51], s70 offen offset:2048 lds
    v_mfma_f32_16x16x32_bf16 a[16:19], v[224:227], v[160:163], 0
    ds_read_b64_tr_b16 v[236:237], v194 offset:0
    v_lshlrev_b32 v204, 4, v3
    v_add_f32 v28, v28, v146
    v_mfma_f32_16x16x32_bf16 a[80:83], v[224:227], v[164:167], 0
    ds_read_b64_tr_b16 v[238:239], v194 offset:8192
    v_mfma_f32_16x16x32_bf16 a[144:147], v[224:227], v[168:171], 0
    v_exp_f32 v147, v147
    v_mfma_f32_16x16x32_bf16 a[208:211], v[224:227], v[172:175], 0
    s_waitcnt lgkmcnt(3)
    buffer_load_dwordx4 v21, s[48:51], s70 offen offset:3072 lds
    v_mfma_f32_16x16x32_bf16 a[20:23], v[228:231], v[160:163], 0
    ds_read_b64_tr_b16 v[224:225], v5 offset:256
    v_add_f32 v28, v28, v147
    v_mfma_f32_16x16x32_bf16 a[84:87], v[228:231], v[164:167], 0
    s_add_u32 m0, s67, 114688
    ds_read_b64_tr_b16 v[226:227], v5 offset:8448
    v_mfma_f32_16x16x32_bf16 a[148:151], v[228:231], v[168:171], 0
    s_add_u32 s70, s70, 16384
    v_exp_f32 v152, v152
    v_mfma_f32_16x16x32_bf16 a[212:215], v[228:231], v[172:175], 0
    s_waitcnt lgkmcnt(3)
    buffer_load_dwordx4 v6, s[48:51], s70 offen offset:0 lds
    v_mov_b32 v203, s94
    v_mfma_f32_16x16x32_bf16 a[24:27], v[232:235], v[160:163], 0
    ds_read_b64_tr_b16 v[228:229], v15 offset:256
    v_add_f32 v29, v29, v152
    v_mfma_f32_16x16x32_bf16 a[88:91], v[232:235], v[164:167], 0
    ds_read_b64_tr_b16 v[230:231], v15 offset:8448
    v_mfma_f32_16x16x32_bf16 a[152:155], v[232:235], v[168:171], 0
    v_exp_f32 v153, v153
    v_mfma_f32_16x16x32_bf16 a[216:219], v[232:235], v[172:175], 0
    s_waitcnt lgkmcnt(3)
    buffer_load_dwordx4 v0, s[48:51], s70 offen offset:1024 lds
    v_mfma_f32_16x16x32_bf16 a[28:31], v[236:239], v[160:163], 0
    ds_read_b64_tr_b16 v[232:233], v18 offset:256
    v_add_f32 v29, v29, v153
    v_mfma_f32_16x16x32_bf16 a[92:95], v[236:239], v[164:167], 0
    ds_read_b64_tr_b16 v[234:235], v18 offset:8448
    v_mfma_f32_16x16x32_bf16 a[156:159], v[236:239], v[168:171], 0
    v_subrev_u32 v206, s88, v3
    v_exp_f32 v154, v154
    v_mfma_f32_16x16x32_bf16 a[220:223], v[236:239], v[172:175], 0
    s_waitcnt lgkmcnt(3)
    buffer_load_dwordx4 v1, s[48:51], s70 offen offset:2048 lds
    v_mfma_f32_16x16x32_bf16 a[32:35], v[224:227], v[160:163], 0
    ds_read_b64_tr_b16 v[236:237], v19 offset:256
    v_add_f32 v29, v29, v154
    v_mfma_f32_16x16x32_bf16 a[96:99], v[224:227], v[164:167], 0
    ds_read_b64_tr_b16 v[238:239], v19 offset:8448
    v_mfma_f32_16x16x32_bf16 a[160:163], v[224:227], v[168:171], 0
    v_exp_f32 v155, v155
    v_mfma_f32_16x16x32_bf16 a[224:227], v[224:227], v[172:175], 0
    s_waitcnt lgkmcnt(3)
    buffer_load_dwordx4 v21, s[48:51], s70 offen offset:3072 lds
    v_mfma_f32_16x16x32_bf16 a[36:39], v[228:231], v[160:163], 0
    ds_read_b64_tr_b16 v[224:225], v20 offset:256
    v_add_f32 v29, v29, v155
    v_mfma_f32_16x16x32_bf16 a[100:103], v[228:231], v[164:167], 0
    ds_read_b64_tr_b16 v[226:227], v20 offset:8448
    v_lshl_add_u32 v206, v206, 2, s88
    v_mfma_f32_16x16x32_bf16 a[164:167], v[228:231], v[168:171], 0
    v_exp_f32 v176, v176
    v_mfma_f32_16x16x32_bf16 a[228:231], v[228:231], v[172:175], 0
    s_waitcnt lgkmcnt(3)
    v_exp_f32 v177, v177
    v_mfma_f32_16x16x32_bf16 a[40:43], v[232:235], v[160:163], 0
    ds_read_b64_tr_b16 v[228:229], v192 offset:256
    v_add_f32 v30, v30, v176
    v_mfma_f32_16x16x32_bf16 a[104:107], v[232:235], v[164:167], 0
    ds_read_b64_tr_b16 v[230:231], v192 offset:8448
    v_add_f32 v30, v30, v177
    v_mfma_f32_16x16x32_bf16 a[168:171], v[232:235], v[168:171], 0
    v_exp_f32 v178, v178
    v_mfma_f32_16x16x32_bf16 a[232:235], v[232:235], v[172:175], 0
    s_waitcnt lgkmcnt(3)
    v_exp_f32 v179, v179
    v_mfma_f32_16x16x32_bf16 a[44:47], v[236:239], v[160:163], 0
    ds_read_b64_tr_b16 v[232:233], v193 offset:256
    v_add_f32 v30, v30, v178
    v_mfma_f32_16x16x32_bf16 a[108:111], v[236:239], v[164:167], 0
    ds_read_b64_tr_b16 v[234:235], v193 offset:8448
    v_add_f32 v30, v30, v179
    v_mfma_f32_16x16x32_bf16 a[172:175], v[236:239], v[168:171], 0
    v_exp_f32 v184, v184
    v_mfma_f32_16x16x32_bf16 a[236:239], v[236:239], v[172:175], 0
    s_waitcnt lgkmcnt(3)
    v_exp_f32 v185, v185
    v_mfma_f32_16x16x32_bf16 a[48:51], v[224:227], v[160:163], 0
    ds_read_b64_tr_b16 v[236:237], v194 offset:256
    v_add_f32 v31, v31, v184
    v_mfma_f32_16x16x32_bf16 a[112:115], v[224:227], v[164:167], 0
    ds_read_b64_tr_b16 v[238:239], v194 offset:8448
    v_add_f32 v31, v31, v185
    v_mfma_f32_16x16x32_bf16 a[176:179], v[224:227], v[168:171], 0
    v_exp_f32 v186, v186
    v_mfma_f32_16x16x32_bf16 a[240:243], v[224:227], v[172:175], 0
    s_waitcnt lgkmcnt(3)
    v_exp_f32 v187, v187
    v_mfma_f32_16x16x32_bf16 a[52:55], v[228:231], v[160:163], 0
    ds_read_b128 v[224:227], v4 offset:32768
    v_add_f32 v31, v31, v186
    v_mfma_f32_16x16x32_bf16 a[116:119], v[228:231], v[164:167], 0
    v_add_f32 v31, v31, v187
    v_mfma_f32_16x16x32_bf16 a[180:183], v[228:231], v[168:171], 0
    v_max3_f32 v16, v28, v29, v30
    v_max_f32 v16, v16, v31
    v_mfma_f32_16x16x32_bf16 a[244:247], v[228:231], v[172:175], 0
    s_waitcnt lgkmcnt(2)
    v_cmp_nge_f32 vcc, s77, v16
    v_mfma_f32_16x16x32_bf16 a[56:59], v[232:235], v[160:163], 0
    s_add_u32 s96, s70, 81920
    ds_read_b128 v[228:231], v8 offset:32768
    v_mfma_f32_16x16x32_bf16 a[120:123], v[232:235], v[164:167], 0
    buffer_load_dword v22, v23, s[48:51], s96 offen
    v_mfma_f32_16x16x32_bf16 a[184:187], v[232:235], v[168:171], 0
    global_load_dword v22, v17, s[90:91]
    v_mfma_f32_16x16x32_bf16 a[248:251], v[232:235], v[172:175], 0
    s_waitcnt lgkmcnt(1)
    v_mfma_f32_16x16x32_bf16 a[60:63], v[236:239], v[160:163], 0
    ds_read_b128 v[232:235], v9 offset:32768
    v_cvt_pk_bf16_f32 v160, v148, v149
    v_cvt_pk_bf16_f32 v161, v150, v151
    v_mfma_f32_16x16x32_bf16 a[124:127], v[236:239], v[164:167], 0
    v_cvt_pk_bf16_f32 v164, v156, v157
    v_cvt_pk_bf16_f32 v165, v158, v159
    v_mfma_f32_16x16x32_bf16 a[188:191], v[236:239], v[168:171], 0
    v_cvt_pk_bf16_f32 v168, v180, v181
    v_cvt_pk_bf16_f32 v169, v182, v183
    v_mfma_f32_16x16x32_bf16 a[252:255], v[236:239], v[172:175], 0
    v_cvt_pk_bf16_f32 v172, v188, v189
    v_cvt_pk_bf16_f32 v173, v190, v191
    s_cbranch_vccnz L_slow_p1
L_back_p1:
    v_mfma_f32_16x16x32_bf16 v[148:151], v[224:227], v[212:215], v[208:211]
    ds_read_b128 v[236:239], v10 offset:32768
    v_mfma_f32_16x16x32_bf16 v[156:159], v[224:227], v[220:223], v[216:219]
    v_add_f32 v24, v24, v28
    v_add_f32 v25, v25, v29
L_loop:
    v_mfma_f32_16x16x32_bf16 v[180:183], v[224:227], v[52:55], v[240:243]
    s_waitcnt vmcnt(11)
    v_mfma_f32_16x16x32_bf16 v[188:191], v[224:227], v[56:59], v[248:251]
    s_waitcnt lgkmcnt(1)
    s_barrier
    v_cvt_pk_bf16_f32 v162, v144, v145
    v_cvt_pk_bf16_f32 v163, v146, v147
    v_mfma_f32_16x16x32_bf16 v[148:151], v[228:231], v[244:247], v[148:151]
    s_add_u32 m0, s67, 0
    ds_read_b128 v[224:227], v4 offset:33024
    v_mfma_f32_16x16x32_bf16 v[156:159], v[228:231], v[252:255], v[156:159]
    s_add_u32 s71, s71, 16384
    v_add_f32 v26, v26, v30
    v_add_f32 v27, v27, v31
    v_mfma_f32_16x16x32_bf16 v[180:183], v[228:231], v[60:63], v[180:183]
    buffer_load_dwordx4 v6, s[52:55], s71 offen offset:0 lds
    v_mfma_f32_16x16x32_bf16 v[188:191], v[228:231], v[64:67], v[188:191]
    v_cvt_pk_bf16_f32 v166, v152, v153
    v_cvt_pk_bf16_f32 v167, v154, v155
    v_mfma_f32_16x16x32_bf16 v[148:151], v[232:235], v[32:35], v[148:151]
    ds_read_b128 v[228:231], v8 offset:33024
    v_mfma_f32_16x16x32_bf16 v[156:159], v[232:235], v[36:39], v[156:159]
    v_mfma_f32_16x16x32_bf16 v[180:183], v[232:235], v[68:71], v[180:183]
    buffer_load_dwordx4 v0, s[52:55], s71 offen offset:1024 lds
    v_mfma_f32_16x16x32_bf16 v[188:191], v[232:235], v[72:75], v[188:191]
    s_waitcnt lgkmcnt(1)
    v_cvt_pk_bf16_f32 v170, v176, v177
    v_cvt_pk_bf16_f32 v171, v178, v179
    v_mfma_f32_16x16x32_bf16 v[148:151], v[236:239], v[40:43], v[148:151]
    ds_read_b128 v[232:235], v9 offset:33024
    v_mfma_f32_16x16x32_bf16 v[156:159], v[236:239], v[48:51], v[156:159]
    v_mfma_f32_16x16x32_bf16 v[180:183], v[236:239], v[76:79], v[180:183]
    buffer_load_dwordx4 v1, s[52:55], s71 offen offset:2048 lds
    v_mfma_f32_16x16x32_bf16 v[188:191], v[236:239], v[80:83], v[188:191]
    s_cmp_lt_u32 s76, s26
    v_cvt_pk_bf16_f32 v174, v184, v185
    v_cvt_pk_bf16_f32 v175, v186, v187
    v_mfma_f32_16x16x32_bf16 v[148:151], v[224:227], v[84:87], v[148:151]
    s_cselect_b32 s74, s95, 2147483648
    ds_read_b128 v[236:239], v10 offset:33024
    v_mfma_f32_16x16x32_bf16 v[156:159], v[224:227], v[88:91], v[156:159]
    buffer_load_dword v205, off, s[4:7], s74 sc1
    v_mfma_f32_16x16x32_bf16 v[180:183], v[224:227], v[116:119], v[180:183]
    buffer_load_dwordx4 v21, s[52:55], s71 offen offset:3072 lds
    v_mfma_f32_16x16x32_bf16 v[188:191], v[224:227], v[120:123], v[188:191]
    s_waitcnt lgkmcnt(1)
    v_mfma_f32_16x16x32_bf16 v[148:151], v[228:231], v[92:95], v[148:151]
    s_add_u32 m0, s67, 16384
    ds_read_b128 v[224:227], v4 offset:40960
    v_mfma_f32_16x16x32_bf16 v[156:159], v[228:231], v[96:99], v[156:159]
    s_add_u32 s71, s71, 16384
    v_mfma_f32_16x16x32_bf16 v[180:183], v[228:231], v[124:127], v[180:183]
    buffer_load_dwordx4 v6, s[52:55], s71 offen offset:0 lds
    v_mfma_f32_16x16x32_bf16 v[188:191], v[228:231], v[128:131], v[188:191]
    s_cmp_eq_u32 s76, 2
    v_mfma_f32_16x16x32_bf16 v[148:151], v[232:235], v[100:103], v[148:151]
    s_cselect_b32 s96, s27, 0
    ds_read_b128 v[228:231], v8 offset:40960
    v_mfma_f32_16x16x32_bf16 v[156:159], v[232:235], v[104:107], v[156:159]
    s_cmp_lg_u32 s96, 0
    v_mfma_f32_16x16x32_bf16 v[180:183], v[232:235], v[132:135], v[180:183]
    s_cselect_b32 s3, 0, s3
    buffer_load_dwordx4 v0, s[52:55], s71 offen offset:1024 lds
    v_mfma_f32_16x16x32_bf16 v[188:191], v[232:235], v[136:139], v[188:191]
    s_waitcnt lgkmcnt(1)
    v_mfma_f32_16x16x32_bf16 v[148:151], v[236:239], v[108:111], v[148:151]
    ds_read_b128 v[232:235], v9 offset:40960
    v_mfma_f32_16x16x32_bf16 v[156:159], v[236:239], v[112:115], v[156:159]
    v_mfma_f32_16x16x32_bf16 v[180:183], v[236:239], v[140:143], v[180:183]
    buffer_load_dwordx4 v1, s[52:55], s71 offen offset:2048 lds
    v_mfma_f32_16x16x32_bf16 v[188:191], v[236:239], v[44:47], v[188:191]
    v_mfma_f32_16x16x32_bf16 v[144:147], v[224:227], v[212:215], v[208:211]
    ds_read_b128 v[236:239], v10 offset:40960
    v_mfma_f32_16x16x32_bf16 v[152:155], v[224:227], v[220:223], v[216:219]
    v_mfma_f32_16x16x32_bf16 v[176:179], v[224:227], v[52:55], v[240:243]
    buffer_load_dwordx4 v21, s[52:55], s71 offen offset:3072 lds
    v_mfma_f32_16x16x32_bf16 v[184:187], v[224:227], v[56:59], v[248:251]
    s_waitcnt lgkmcnt(1)
    v_exp_f32 v148, v148
    v_mfma_f32_16x16x32_bf16 v[144:147], v[228:231], v[244:247], v[144:147]
    ds_read_b128 v[224:227], v4 offset:41216
    v_mfma_f32_16x16x32_bf16 v[152:155], v[228:231], v[252:255], v[152:155]
    v_exp_f32 v149, v149
    v_mfma_f32_16x16x32_bf16 v[176:179], v[228:231], v[60:63], v[176:179]
    v_add_f32 v28, v148, v149
    v_mfma_f32_16x16x32_bf16 v[184:187], v[228:231], v[64:67], v[184:187]
    v_exp_f32 v150, v150
    v_mfma_f32_16x16x32_bf16 v[144:147], v[232:235], v[32:35], v[144:147]
    ds_read_b128 v[228:231], v8 offset:41216
    v_add_f32 v28, v28, v150
    v_mfma_f32_16x16x32_bf16 v[152:155], v[232:235], v[36:39], v[152:155]
    v_exp_f32 v151, v151
    v_mfma_f32_16x16x32_bf16 v[176:179], v[232:235], v[68:71], v[176:179]
    v_add_f32 v28, v28, v151
    v_mfma_f32_16x16x32_bf16 v[184:187], v[232:235], v[72:75], v[184:187]
    s_waitcnt lgkmcnt(1)
    v_exp_f32 v156, v156
    v_mfma_f32_16x16x32_bf16 v[144:147], v[236:239], v[40:43], v[144:147]
    ds_read_b128 v[232:235], v9 offset:41216
    v_mfma_f32_16x16x32_bf16 v[152:155], v[236:239], v[48:51], v[152:155]
    v_exp_f32 v157, v157
    v_mfma_f32_16x16x32_bf16 v[176:179], v[236:239], v[76:79], v[176:179]
    v_add_f32 v29, v156, v157
    v_mfma_f32_16x16x32_bf16 v[184:187], v[236:239], v[80:83], v[184:187]
    v_exp_f32 v158, v158
    v_mfma_f32_16x16x32_bf16 v[144:147], v[224:227], v[84:87], v[144:147]
    ds_read_b128 v[236:239], v10 offset:41216
    v_add_f32 v29, v29, v158
    v_mfma_f32_16x16x32_bf16 v[152:155], v[224:227], v[88:91], v[152:155]
    v_exp_f32 v159, v159
    v_mfma_f32_16x16x32_bf16 v[176:179], v[224:227], v[116:119], v[176:179]
    v_add_f32 v29, v29, v159
    v_mfma_f32_16x16x32_bf16 v[184:187], v[224:227], v[120:123], v[184:187]
    s_waitcnt lgkmcnt(1)
    v_exp_f32 v180, v180
    v_mfma_f32_16x16x32_bf16 v[144:147], v[228:231], v[92:95], v[144:147]
    ds_read_b64_tr_b16 v[224:225], v195 offset:0
    v_mfma_f32_16x16x32_bf16 v[152:155], v[228:231], v[96:99], v[152:155]
    ds_read_b64_tr_b16 v[226:227], v195 offset:8192
    v_mfma_f32_16x16x32_bf16 v[176:179], v[228:231], v[124:127], v[176:179]
    v_exp_f32 v181, v181
    v_mfma_f32_16x16x32_bf16 v[184:187], v[228:231], v[128:131], v[184:187]
    v_exp_f32 v182, v182
    v_mfma_f32_16x16x32_bf16 v[144:147], v[232:235], v[100:103], v[144:147]
    ds_read_b64_tr_b16 v[228:229], v196 offset:0
    v_add_f32 v30, v180, v181
    v_mfma_f32_16x16x32_bf16 v[152:155], v[232:235], v[104:107], v[152:155]
    ds_read_b64_tr_b16 v[230:231], v196 offset:8192
    v_add_f32 v30, v30, v182
    v_mfma_f32_16x16x32_bf16 v[176:179], v[232:235], v[132:135], v[176:179]
    v_exp_f32 v183, v183
    v_mfma_f32_16x16x32_bf16 v[184:187], v[232:235], v[136:139], v[184:187]
    s_waitcnt lgkmcnt(3)
    v_exp_f32 v188, v188
    v_mfma_f32_16x16x32_bf16 v[144:147], v[236:239], v[108:111], v[144:147]
    ds_read_b64_tr_b16 v[232:233], v197 offset:0
    v_add_f32 v30, v30, v183
    v_mfma_f32_16x16x32_bf16 v[152:155], v[236:239], v[112:115], v[152:155]
    ds_read_b64_tr_b16 v[234:235], v197 offset:8192
    v_mfma_f32_16x16x32_bf16 v[176:179], v[236:239], v[140:143], v[176:179]
    v_exp_f32 v189, v189
    v_mfma_f32_16x16x32_bf16 v[184:187], v[236:239], v[44:47], v[184:187]
    s_waitcnt lgkmcnt(3)
    v_exp_f32 v190, v190
    v_mfma_f32_16x16x32_bf16 a[0:3], v[224:227], v[160:163], a[0:3]
    ds_read_b64_tr_b16 v[236:237], v198 offset:0
    v_add_f32 v31, v188, v189
    v_mfma_f32_16x16x32_bf16 a[64:67], v[224:227], v[164:167], a[64:67]
    ds_read_b64_tr_b16 v[238:239], v198 offset:8192
    v_add_f32 v31, v31, v190
    v_mfma_f32_16x16x32_bf16 a[128:131], v[224:227], v[168:171], a[128:131]
    s_waitcnt vmcnt(11)
    v_exp_f32 v191, v191
    v_mfma_f32_16x16x32_bf16 a[192:195], v[224:227], v[172:175], a[192:195]
    s_waitcnt lgkmcnt(3)
    s_barrier
    v_mfma_f32_16x16x32_bf16 a[4:7], v[228:231], v[160:163], a[4:7]
    ds_read_b64_tr_b16 v[224:225], v199 offset:0
    v_add_f32 v31, v31, v191
    v_mfma_f32_16x16x32_bf16 a[68:71], v[228:231], v[164:167], a[68:71]
    s_add_u32 m0, s67, 32768
    ds_read_b64_tr_b16 v[226:227], v199 offset:8192
    v_mfma_f32_16x16x32_bf16 a[132:135], v[228:231], v[168:171], a[132:135]
    s_add_u32 s70, s70, 16384
    v_exp_f32 v144, v144
    v_mfma_f32_16x16x32_bf16 a[196:199], v[228:231], v[172:175], a[196:199]
    s_waitcnt lgkmcnt(3)
    buffer_load_dwordx4 v6, s[48:51], s70 offen offset:0 lds
    v_mfma_f32_16x16x32_bf16 a[8:11], v[232:235], v[160:163], a[8:11]
    ds_read_b64_tr_b16 v[228:229], v200 offset:0
    v_add_f32 v28, v28, v144
    v_mfma_f32_16x16x32_bf16 a[72:75], v[232:235], v[164:167], a[72:75]
    ds_read_b64_tr_b16 v[230:231], v200 offset:8192
    v_mfma_f32_16x16x32_bf16 a[136:139], v[232:235], v[168:171], a[136:139]
    v_exp_f32 v145, v145
    v_mfma_f32_16x16x32_bf16 a[200:203], v[232:235], v[172:175], a[200:203]
    s_waitcnt lgkmcnt(3)
    buffer_load_dwordx4 v0, s[48:51], s70 offen offset:1024 lds
    v_mfma_f32_16x16x32_bf16 a[12:15], v[236:239], v[160:163], a[12:15]
    ds_read_b64_tr_b16 v[232:233], v201 offset:0
    v_add_f32 v28, v28, v145
    v_mfma_f32_16x16x32_bf16 a[76:79], v[236:239], v[164:167], a[76:79]
    ds_read_b64_tr_b16 v[234:235], v201 offset:8192
    v_mfma_f32_16x16x32_bf16 a[140:143], v[236:239], v[168:171], a[140:143]
    v_exp_f32 v146, v146
    v_mfma_f32_16x16x32_bf16 a[204:207], v[236:239], v[172:175], a[204:207]
    s_waitcnt lgkmcnt(3)
    buffer_load_dwordx4 v1, s[48:51], s70 offen offset:2048 lds
    v_mfma_f32_16x16x32_bf16 a[16:19], v[224:227], v[160:163], a[16:19]
    ds_read_b64_tr_b16 v[236:237], v202 offset:0
    v_add_f32 v28, v28, v146
    v_mfma_f32_16x16x32_bf16 a[80:83], v[224:227], v[164:167], a[80:83]
    ds_read_b64_tr_b16 v[238:239], v202 offset:8192
    v_mfma_f32_16x16x32_bf16 a[144:147], v[224:227], v[168:171], a[144:147]
    v_exp_f32 v147, v147
    v_mfma_f32_16x16x32_bf16 a[208:211], v[224:227], v[172:175], a[208:211]
    s_waitcnt lgkmcnt(3)
    buffer_load_dwordx4 v21, s[48:51], s70 offen offset:3072 lds
    v_mfma_f32_16x16x32_bf16 a[20:23], v[228:231], v[160:163], a[20:23]
    ds_read_b64_tr_b16 v[224:225], v195 offset:256
    v_add_f32 v28, v28, v147
    v_mfma_f32_16x16x32_bf16 a[84:87], v[228:231], v[164:167], a[84:87]
    s_add_u32 m0, s67, 49152
    ds_read_b64_tr_b16 v[226:227], v195 offset:8448
    v_mfma_f32_16x16x32_bf16 a[148:151], v[228:231], v[168:171], a[148:151]
    s_add_u32 s70, s70, 16384
    v_exp_f32 v152, v152
    v_mfma_f32_16x16x32_bf16 a[212:215], v[228:231], v[172:175], a[212:215]
    s_waitcnt lgkmcnt(3)
    buffer_load_dwordx4 v6, s[48:51], s70 offen offset:0 lds
    v_mfma_f32_16x16x32_bf16 a[24:27], v[232:235], v[160:163], a[24:27]
    ds_read_b64_tr_b16 v[228:229], v196 offset:256
    v_add_f32 v29, v29, v152
    v_mfma_f32_16x16x32_bf16 a[88:91], v[232:235], v[164:167], a[88:91]
    ds_read_b64_tr_b16 v[230:231], v196 offset:8448
    v_mfma_f32_16x16x32_bf16 a[152:155], v[232:235], v[168:171], a[152:155]
    v_exp_f32 v153, v153
    v_mfma_f32_16x16x32_bf16 a[216:219], v[232:235], v[172:175], a[216:219]
    s_waitcnt lgkmcnt(3)
    buffer_load_dwordx4 v0, s[48:51], s70 offen offset:1024 lds
    v_mfma_f32_16x16x32_bf16 a[28:31], v[236:239], v[160:163], a[28:31]
    ds_read_b64_tr_b16 v[232:233], v197 offset:256
    v_add_f32 v29, v29, v153
    v_mfma_f32_16x16x32_bf16 a[92:95], v[236:239], v[164:167], a[92:95]
    ds_read_b64_tr_b16 v[234:235], v197 offset:8448
    v_mfma_f32_16x16x32_bf16 a[156:159], v[236:239], v[168:171], a[156:159]
    v_exp_f32 v154, v154
    v_mfma_f32_16x16x32_bf16 a[220:223], v[236:239], v[172:175], a[220:223]
    s_waitcnt lgkmcnt(3)
    buffer_load_dwordx4 v1, s[48:51], s70 offen offset:2048 lds
    v_mfma_f32_16x16x32_bf16 a[32:35], v[224:227], v[160:163], a[32:35]
    ds_read_b64_tr_b16 v[236:237], v198 offset:256
    v_add_f32 v29, v29, v154
    v_mfma_f32_16x16x32_bf16 a[96:99], v[224:227], v[164:167], a[96:99]
    ds_read_b64_tr_b16 v[238:239], v198 offset:8448
    v_mfma_f32_16x16x32_bf16 a[160:163], v[224:227], v[168:171], a[160:163]
    v_exp_f32 v155, v155
    v_mfma_f32_16x16x32_bf16 a[224:227], v[224:227], v[172:175], a[224:227]
    s_waitcnt lgkmcnt(3)
    buffer_load_dwordx4 v21, s[48:51], s70 offen offset:3072 lds
    v_mfma_f32_16x16x32_bf16 a[36:39], v[228:231], v[160:163], a[36:39]
    ds_read_b64_tr_b16 v[224:225], v199 offset:256
    v_add_f32 v29, v29, v155
    v_mfma_f32_16x16x32_bf16 a[100:103], v[228:231], v[164:167], a[100:103]
    ds_read_b64_tr_b16 v[226:227], v199 offset:8448
    buffer_load_dword v22, v206, s[60:63], s3 offen sc1
    v_mfma_f32_16x16x32_bf16 a[164:167], v[228:231], v[168:171], a[164:167]
    s_add_u32 s3, s3, 4096
    v_exp_f32 v176, v176
    v_mfma_f32_16x16x32_bf16 a[228:231], v[228:231], v[172:175], a[228:231]
    s_waitcnt lgkmcnt(3)
    v_exp_f32 v177, v177
    v_mfma_f32_16x16x32_bf16 a[40:43], v[232:235], v[160:163], a[40:43]
    ds_read_b64_tr_b16 v[228:229], v200 offset:256
    v_add_f32 v30, v30, v176
    v_mfma_f32_16x16x32_bf16 a[104:107], v[232:235], v[164:167], a[104:107]
    ds_read_b64_tr_b16 v[230:231], v200 offset:8448
    v_add_f32 v30, v30, v177
    v_mfma_f32_16x16x32_bf16 a[168:171], v[232:235], v[168:171], a[168:171]
    v_exp_f32 v178, v178
    v_mfma_f32_16x16x32_bf16 a[232:235], v[232:235], v[172:175], a[232:235]
    s_waitcnt lgkmcnt(3)
    v_exp_f32 v179, v179
    v_mfma_f32_16x16x32_bf16 a[44:47], v[236:239], v[160:163], a[44:47]
    ds_read_b64_tr_b16 v[232:233], v201 offset:256
    v_add_f32 v30, v30, v178
    v_mfma_f32_16x16x32_bf16 a[108:111], v[236:239], v[164:167], a[108:111]
    ds_read_b64_tr_b16 v[234:235], v201 offset:8448
    v_add_f32 v30, v30, v179
    v_mfma_f32_16x16x32_bf16 a[172:175], v[236:239], v[168:171], a[172:175]
    v_exp_f32 v184, v184
    v_mfma_f32_16x16x32_bf16 a[236:239], v[236:239], v[172:175], a[236:239]
    s_waitcnt lgkmcnt(3)
    v_exp_f32 v185, v185
    v_mfma_f32_16x16x32_bf16 a[48:51], v[224:227], v[160:163], a[48:51]
    ds_read_b64_tr_b16 v[236:237], v202 offset:256
    v_add_f32 v31, v31, v184
    v_mfma_f32_16x16x32_bf16 a[112:115], v[224:227], v[164:167], a[112:115]
    ds_read_b64_tr_b16 v[238:239], v202 offset:8448
    v_add_f32 v31, v31, v185
    v_mfma_f32_16x16x32_bf16 a[176:179], v[224:227], v[168:171], a[176:179]
    v_exp_f32 v186, v186
    v_mfma_f32_16x16x32_bf16 a[240:243], v[224:227], v[172:175], a[240:243]
    s_waitcnt lgkmcnt(3)
    v_exp_f32 v187, v187
    v_mfma_f32_16x16x32_bf16 a[52:55], v[228:231], v[160:163], a[52:55]
    ds_read_b128 v[224:227], v11 offset:32768
    v_add_f32 v31, v31, v186
    v_mfma_f32_16x16x32_bf16 a[116:119], v[228:231], v[164:167], a[116:119]
    v_add_f32 v31, v31, v187
    v_mfma_f32_16x16x32_bf16 a[180:183], v[228:231], v[168:171], a[180:183]
    v_max3_f32 v16, v28, v29, v30
    v_max_f32 v16, v16, v31
    v_mfma_f32_16x16x32_bf16 a[244:247], v[228:231], v[172:175], a[244:247]
    s_waitcnt lgkmcnt(2)
    v_cmp_nge_f32 vcc, s77, v16
    v_mfma_f32_16x16x32_bf16 a[56:59], v[232:235], v[160:163], a[56:59]
    s_add_u32 s96, s70, 49152
    ds_read_b128 v[228:231], v12 offset:32768
    v_mfma_f32_16x16x32_bf16 a[120:123], v[232:235], v[164:167], a[120:123]
    buffer_load_dword v22, v23, s[52:55], s96 offen
    v_mfma_f32_16x16x32_bf16 a[184:187], v[232:235], v[168:171], a[184:187]
    buffer_atomic_or v203, v204, s[4:7], s1 offen
    v_mfma_f32_16x16x32_bf16 a[248:251], v[232:235], v[172:175], a[248:251]
    s_waitcnt lgkmcnt(1)
    s_mov_b32 s1, 2147483648
    v_mfma_f32_16x16x32_bf16 a[60:63], v[236:239], v[160:163], a[60:63]
    ds_read_b128 v[232:235], v13 offset:32768
    v_cvt_pk_bf16_f32 v160, v148, v149
    v_cvt_pk_bf16_f32 v161, v150, v151
    v_mfma_f32_16x16x32_bf16 a[124:127], v[236:239], v[164:167], a[124:127]
    v_cvt_pk_bf16_f32 v164, v156, v157
    v_cvt_pk_bf16_f32 v165, v158, v159
    v_mfma_f32_16x16x32_bf16 a[188:191], v[236:239], v[168:171], a[188:191]
    v_cvt_pk_bf16_f32 v168, v180, v181
    v_cvt_pk_bf16_f32 v169, v182, v183
    v_mfma_f32_16x16x32_bf16 a[252:255], v[236:239], v[172:175], a[252:255]
    v_cvt_pk_bf16_f32 v172, v188, v189
    v_cvt_pk_bf16_f32 v173, v190, v191
    s_cbranch_vccnz L_slow_w0
L_back_w0:
    v_mfma_f32_16x16x32_bf16 v[148:151], v[224:227], v[212:215], v[208:211]
    ds_read_b128 v[236:239], v14 offset:32768
    v_mfma_f32_16x16x32_bf16 v[156:159], v[224:227], v[220:223], v[216:219]
    v_add_f32 v24, v24, v28
    v_add_f32 v25, v25, v29
    v_mfma_f32_16x16x32_bf16 v[180:183], v[224:227], v[52:55], v[240:243]
    s_waitcnt vmcnt(11)
    v_mfma_f32_16x16x32_bf16 v[188:191], v[224:227], v[56:59], v[248:251]
    s_waitcnt lgkmcnt(1)
    s_barrier
    v_cvt_pk_bf16_f32 v162, v144, v145
    v_cvt_pk_bf16_f32 v163, v146, v147
    v_mfma_f32_16x16x32_bf16 v[148:151], v[228:231], v[244:247], v[148:151]
    s_add_u32 m0, s67, 65536
    ds_read_b128 v[224:227], v11 offset:33024
    v_mfma_f32_16x16x32_bf16 v[156:159], v[228:231], v[252:255], v[156:159]
    s_add_u32 s71, s71, 16384
    v_add_f32 v26, v26, v30
    v_add_f32 v27, v27, v31
    v_mfma_f32_16x16x32_bf16 v[180:183], v[228:231], v[60:63], v[180:183]
    buffer_load_dwordx4 v6, s[52:55], s71 offen offset:0 lds
    v_mfma_f32_16x16x32_bf16 v[188:191], v[228:231], v[64:67], v[188:191]
    v_cvt_pk_bf16_f32 v166, v152, v153
    v_cvt_pk_bf16_f32 v167, v154, v155
    v_mfma_f32_16x16x32_bf16 v[148:151], v[232:235], v[32:35], v[148:151]
    ds_read_b128 v[228:231], v12 offset:33024
    v_mfma_f32_16x16x32_bf16 v[156:159], v[232:235], v[36:39], v[156:159]
    v_mfma_f32_16x16x32_bf16 v[180:183], v[232:235], v[68:71], v[180:183]
    buffer_load_dwordx4 v0, s[52:55], s71 offen offset:1024 lds
    v_mfma_f32_16x16x32_bf16 v[188:191], v[232:235], v[72:75], v[188:191]
    s_waitcnt lgkmcnt(1)
    v_cvt_pk_bf16_f32 v170, v176, v177
    v_cvt_pk_bf16_f32 v171, v178, v179
    v_mfma_f32_16x16x32_bf16 v[148:151], v[236:239], v[40:43], v[148:151]
    ds_read_b128 v[232:235], v13 offset:33024
    v_mfma_f32_16x16x32_bf16 v[156:159], v[236:239], v[48:51], v[156:159]
    v_mfma_f32_16x16x32_bf16 v[180:183], v[236:239], v[76:79], v[180:183]
    buffer_load_dwordx4 v1, s[52:55], s71 offen offset:2048 lds
    v_mfma_f32_16x16x32_bf16 v[188:191], v[236:239], v[80:83], v[188:191]
    v_cvt_pk_bf16_f32 v174, v184, v185
    v_cvt_pk_bf16_f32 v175, v186, v187
    v_mfma_f32_16x16x32_bf16 v[148:151], v[224:227], v[84:87], v[148:151]
    ds_read_b128 v[236:239], v14 offset:33024
    v_mfma_f32_16x16x32_bf16 v[156:159], v[224:227], v[88:91], v[156:159]
    v_mfma_f32_16x16x32_bf16 v[180:183], v[224:227], v[116:119], v[180:183]
    buffer_load_dwordx4 v21, s[52:55], s71 offen offset:3072 lds
    v_mfma_f32_16x16x32_bf16 v[188:191], v[224:227], v[120:123], v[188:191]
    s_waitcnt lgkmcnt(1)
    v_mfma_f32_16x16x32_bf16 v[148:151], v[228:231], v[92:95], v[148:151]
    s_add_u32 m0, s67, 81920
    ds_read_b128 v[224:227], v11 offset:40960
    v_mfma_f32_16x16x32_bf16 v[156:159], v[228:231], v[96:99], v[156:159]
    s_add_u32 s71, s71, 16384
    v_mfma_f32_16x16x32_bf16 v[180:183], v[228:231], v[124:127], v[180:183]
    buffer_load_dwordx4 v6, s[52:55], s71 offen offset:0 lds
    v_mfma_f32_16x16x32_bf16 v[188:191], v[228:231], v[128:131], v[188:191]
    v_mfma_f32_16x16x32_bf16 v[148:151], v[232:235], v[100:103], v[148:151]
    ds_read_b128 v[228:231], v12 offset:40960
    v_mfma_f32_16x16x32_bf16 v[156:159], v[232:235], v[104:107], v[156:159]
    s_and_b32 s96, s76, 3
    v_mfma_f32_16x16x32_bf16 v[180:183], v[232:235], v[132:135], v[180:183]
    s_lshl_b32 s96, s96, 16
    buffer_load_dwordx4 v0, s[52:55], s71 offen offset:1024 lds
    v_mfma_f32_16x16x32_bf16 v[188:191], v[232:235], v[136:139], v[188:191]
    s_waitcnt lgkmcnt(1)
    buffer_load_dword v22, v23, s[56:59], s96 offen
    v_mfma_f32_16x16x32_bf16 v[148:151], v[236:239], v[108:111], v[148:151]
    ds_read_b128 v[232:235], v13 offset:40960
    v_mfma_f32_16x16x32_bf16 v[156:159], v[236:239], v[112:115], v[156:159]
    v_readfirstlane_b32 s96, v205
    v_mfma_f32_16x16x32_bf16 v[180:183], v[236:239], v[140:143], v[180:183]
    buffer_load_dwordx4 v1, s[52:55], s71 offen offset:2048 lds
    v_mfma_f32_16x16x32_bf16 v[188:191], v[236:239], v[44:47], v[188:191]
    s_cmp_eq_u32 s96, 65535
    v_mfma_f32_16x16x32_bf16 v[144:147], v[224:227], v[212:215], v[208:211]
    s_cselect_b32 s27, 1, s27
    ds_read_b128 v[236:239], v14 offset:40960
    v_mfma_f32_16x16x32_bf16 v[152:155], v[224:227], v[220:223], v[216:219]
    s_cselect_b32 s26, 0, s26
    v_mfma_f32_16x16x32_bf16 v[176:179], v[224:227], v[52:55], v[240:243]
    buffer_load_dwordx4 v21, s[52:55], s71 offen offset:3072 lds
    v_mfma_f32_16x16x32_bf16 v[184:187], v[224:227], v[56:59], v[248:251]
    s_waitcnt lgkmcnt(1)
    v_exp_f32 v148, v148
    v_mfma_f32_16x16x32_bf16 v[144:147], v[228:231], v[244:247], v[144:147]
    ds_read_b128 v[224:227], v11 offset:41216
    v_mfma_f32_16x16x32_bf16 v[152:155], v[228:231], v[252:255], v[152:155]
    v_exp_f32 v149, v149
    v_mfma_f32_16x16x32_bf16 v[176:179], v[228:231], v[60:63], v[176:179]
    v_add_f32 v28, v148, v149
    v_mfma_f32_16x16x32_bf16 v[184:187], v[228:231], v[64:67], v[184:187]
    v_exp_f32 v150, v150
    v_mfma_f32_16x16x32_bf16 v[144:147], v[232:235], v[32:35], v[144:147]
    ds_read_b128 v[228:231], v12 offset:41216
    v_add_f32 v28, v28, v150
    v_mfma_f32_16x16x32_bf16 v[152:155], v[232:235], v[36:39], v[152:155]
    v_exp_f32 v151, v151
    v_mfma_f32_16x16x32_bf16 v[176:179], v[232:235], v[68:71], v[176:179]
    v_add_f32 v28, v28, v151
    v_mfma_f32_16x16x32_bf16 v[184:187], v[232:235], v[72:75], v[184:187]
    s_waitcnt lgkmcnt(1)
    v_exp_f32 v156, v156
    v_mfma_f32_16x16x32_bf16 v[144:147], v[236:239], v[40:43], v[144:147]
    ds_read_b128 v[232:235], v13 offset:41216
    v_mfma_f32_16x16x32_bf16 v[152:155], v[236:239], v[48:51], v[152:155]
    v_exp_f32 v157, v157
    v_mfma_f32_16x16x32_bf16 v[176:179], v[236:239], v[76:79], v[176:179]
    v_add_f32 v29, v156, v157
    v_mfma_f32_16x16x32_bf16 v[184:187], v[236:239], v[80:83], v[184:187]
    v_exp_f32 v158, v158
    v_mfma_f32_16x16x32_bf16 v[144:147], v[224:227], v[84:87], v[144:147]
    ds_read_b128 v[236:239], v14 offset:41216
    v_add_f32 v29, v29, v158
    v_mfma_f32_16x16x32_bf16 v[152:155], v[224:227], v[88:91], v[152:155]
    v_exp_f32 v159, v159
    v_mfma_f32_16x16x32_bf16 v[176:179], v[224:227], v[116:119], v[176:179]
    v_add_f32 v29, v29, v159
    v_mfma_f32_16x16x32_bf16 v[184:187], v[224:227], v[120:123], v[184:187]
    s_waitcnt lgkmcnt(1)
    v_exp_f32 v180, v180
    v_mfma_f32_16x16x32_bf16 v[144:147], v[228:231], v[92:95], v[144:147]
    ds_read_b64_tr_b16 v[224:225], v5 offset:0
    v_mfma_f32_16x16x32_bf16 v[152:155], v[228:231], v[96:99], v[152:155]
    ds_read_b64_tr_b16 v[226:227], v5 offset:8192
    v_mfma_f32_16x16x32_bf16 v[176:179], v[228:231], v[124:127], v[176:179]
    v_exp_f32 v181, v181
    v_mfma_f32_16x16x32_bf16 v[184:187], v[228:231], v[128:131], v[184:187]
    v_exp_f32 v182, v182
    v_mfma_f32_16x16x32_bf16 v[144:147], v[232:235], v[100:103], v[144:147]
    ds_read_b64_tr_b16 v[228:229], v15 offset:0
    v_add_f32 v30, v180, v181
    v_mfma_f32_16x16x32_bf16 v[152:155], v[232:235], v[104:107], v[152:155]
    ds_read_b64_tr_b16 v[230:231], v15 offset:8192
    v_add_f32 v30, v30, v182
    v_mfma_f32_16x16x32_bf16 v[176:179], v[232:235], v[132:135], v[176:179]
    v_exp_f32 v183, v183
    v_mfma_f32_16x16x32_bf16 v[184:187], v[232:235], v[136:139], v[184:187]
    s_waitcnt lgkmcnt(3)
    v_exp_f32 v188, v188
    v_mfma_f32_16x16x32_bf16 v[144:147], v[236:239], v[108:111], v[144:147]
    ds_read_b64_tr_b16 v[232:233], v18 offset:0
    v_add_f32 v30, v30, v183
    v_mfma_f32_16x16x32_bf16 v[152:155], v[236:239], v[112:115], v[152:155]
    ds_read_b64_tr_b16 v[234:235], v18 offset:8192
    v_mfma_f32_16x16x32_bf16 v[176:179], v[236:239], v[140:143], v[176:179]
    v_exp_f32 v189, v189
    v_mfma_f32_16x16x32_bf16 v[184:187], v[236:239], v[44:47], v[184:187]
    s_waitcnt lgkmcnt(3)
    v_exp_f32 v190, v190
    v_mfma_f32_16x16x32_bf16 a[0:3], v[224:227], v[160:163], a[0:3]
    ds_read_b64_tr_b16 v[236:237], v19 offset:0
    v_add_f32 v31, v188, v189
    v_mfma_f32_16x16x32_bf16 a[64:67], v[224:227], v[164:167], a[64:67]
    ds_read_b64_tr_b16 v[238:239], v19 offset:8192
    v_add_f32 v31, v31, v190
    v_mfma_f32_16x16x32_bf16 a[128:131], v[224:227], v[168:171], a[128:131]
    s_waitcnt vmcnt(12)
    v_exp_f32 v191, v191
    v_mfma_f32_16x16x32_bf16 a[192:195], v[224:227], v[172:175], a[192:195]
    s_waitcnt lgkmcnt(3)
    s_barrier
    v_mfma_f32_16x16x32_bf16 a[4:7], v[228:231], v[160:163], a[4:7]
    ds_read_b64_tr_b16 v[224:225], v20 offset:0
    v_add_f32 v31, v31, v191
    v_mfma_f32_16x16x32_bf16 a[68:71], v[228:231], v[164:167], a[68:71]
    s_add_u32 m0, s67, 98304
    ds_read_b64_tr_b16 v[226:227], v20 offset:8192
    v_mfma_f32_16x16x32_bf16 a[132:135], v[228:231], v[168:171], a[132:135]
    s_add_u32 s70, s70, 16384
    v_exp_f32 v144, v144
    v_mfma_f32_16x16x32_bf16 a[196:199], v[228:231], v[172:175], a[196:199]
    s_waitcnt lgkmcnt(3)
    buffer_load_dwordx4 v6, s[48:51], s70 offen offset:0 lds
    v_mfma_f32_16x16x32_bf16 a[8:11], v[232:235], v[160:163], a[8:11]
    ds_read_b64_tr_b16 v[228:229], v192 offset:0
    v_add_f32 v28, v28, v144
    v_mfma_f32_16x16x32_bf16 a[72:75], v[232:235], v[164:167], a[72:75]
    ds_read_b64_tr_b16 v[230:231], v192 offset:8192
    v_mfma_f32_16x16x32_bf16 a[136:139], v[232:235], v[168:171], a[136:139]
    v_exp_f32 v145, v145
    v_mfma_f32_16x16x32_bf16 a[200:203], v[232:235], v[172:175], a[200:203]
    s_waitcnt lgkmcnt(3)
    buffer_load_dwordx4 v0, s[48:51], s70 offen offset:1024 lds
    v_mfma_f32_16x16x32_bf16 a[12:15], v[236:239], v[160:163], a[12:15]
    ds_read_b64_tr_b16 v[232:233], v193 offset:0
    v_add_f32 v28, v28, v145
    v_mfma_f32_16x16x32_bf16 a[76:79], v[236:239], v[164:167], a[76:79]
    ds_read_b64_tr_b16 v[234:235], v193 offset:8192
    v_mfma_f32_16x16x32_bf16 a[140:143], v[236:239], v[168:171], a[140:143]
    v_exp_f32 v146, v146
    v_mfma_f32_16x16x32_bf16 a[204:207], v[236:239], v[172:175], a[204:207]
    s_waitcnt lgkmcnt(3)
    buffer_load_dwordx4 v1, s[48:51], s70 offen offset:2048 lds
    v_mfma_f32_16x16x32_bf16 a[16:19], v[224:227], v[160:163], a[16:19]
    ds_read_b64_tr_b16 v[236:237], v194 offset:0
    v_add_f32 v28, v28, v146
    v_mfma_f32_16x16x32_bf16 a[80:83], v[224:227], v[164:167], a[80:83]
    ds_read_b64_tr_b16 v[238:239], v194 offset:8192
    v_mfma_f32_16x16x32_bf16 a[144:147], v[224:227], v[168:171], a[144:147]
    v_exp_f32 v147, v147
    v_mfma_f32_16x16x32_bf16 a[208:211], v[224:227], v[172:175], a[208:211]
    s_waitcnt lgkmcnt(3)
    buffer_load_dwordx4 v21, s[48:51], s70 offen offset:3072 lds
    v_mfma_f32_16x16x32_bf16 a[20:23], v[228:231], v[160:163], a[20:23]
    ds_read_b64_tr_b16 v[224:225], v5 offset:256
    v_add_f32 v28, v28, v147
    v_mfma_f32_16x16x32_bf16 a[84:87], v[228:231], v[164:167], a[84:87]
    s_add_u32 m0, s67, 114688
    ds_read_b64_tr_b16 v[226:227], v5 offset:8448
    v_mfma_f32_16x16x32_bf16 a[148:151], v[228:231], v[168:171], a[148:151]
    s_add_u32 s70, s70, 16384
    v_exp_f32 v152, v152
    v_mfma_f32_16x16x32_bf16 a[212:215], v[228:231], v[172:175], a[212:215]
    s_waitcnt lgkmcnt(3)
    buffer_load_dwordx4 v6, s[48:51], s70 offen offset:0 lds
    v_mfma_f32_16x16x32_bf16 a[24:27], v[232:235], v[160:163], a[24:27]
    ds_read_b64_tr_b16 v[228:229], v15 offset:256
    v_add_f32 v29, v29, v152
    v_mfma_f32_16x16x32_bf16 a[88:91], v[232:235], v[164:167], a[88:91]
    ds_read_b64_tr_b16 v[230:231], v15 offset:8448
    v_mfma_f32_16x16x32_bf16 a[152:155], v[232:235], v[168:171], a[152:155]
    v_exp_f32 v153, v153
    v_mfma_f32_16x16x32_bf16 a[216:219], v[232:235], v[172:175], a[216:219]
    s_waitcnt lgkmcnt(3)
    buffer_load_dwordx4 v0, s[48:51], s70 offen offset:1024 lds
    v_mfma_f32_16x16x32_bf16 a[28:31], v[236:239], v[160:163], a[28:31]
    ds_read_b64_tr_b16 v[232:233], v18 offset:256
    v_add_f32 v29, v29, v153
    v_mfma_f32_16x16x32_bf16 a[92:95], v[236:239], v[164:167], a[92:95]
    ds_read_b64_tr_b16 v[234:235], v18 offset:8448
    v_mfma_f32_16x16x32_bf16 a[156:159], v[236:239], v[168:171], a[156:159]
    v_exp_f32 v154, v154
    v_mfma_f32_16x16x32_bf16 a[220:223], v[236:239], v[172:175], a[220:223]
    s_waitcnt lgkmcnt(3)
    buffer_load_dwordx4 v1, s[48:51], s70 offen offset:2048 lds
    v_mfma_f32_16x16x32_bf16 a[32:35], v[224:227], v[160:163], a[32:35]
    ds_read_b64_tr_b16 v[236:237], v19 offset:256
    v_add_f32 v29, v29, v154
    v_mfma_f32_16x16x32_bf16 a[96:99], v[224:227], v[164:167], a[96:99]
    ds_read_b64_tr_b16 v[238:239], v19 offset:8448
    v_mfma_f32_16x16x32_bf16 a[160:163], v[224:227], v[168:171], a[160:163]
    v_exp_f32 v155, v155
    v_mfma_f32_16x16x32_bf16 a[224:227], v[224:227], v[172:175], a[224:227]
    s_waitcnt lgkmcnt(3)
    buffer_load_dwordx4 v21, s[48:51], s70 offen offset:3072 lds
    v_mfma_f32_16x16x32_bf16 a[36:39], v[228:231], v[160:163], a[36:39]
    ds_read_b64_tr_b16 v[224:225], v20 offset:256
    v_add_f32 v29, v29, v155
    v_mfma_f32_16x16x32_bf16 a[100:103], v[228:231], v[164:167], a[100:103]
    ds_read_b64_tr_b16 v[226:227], v20 offset:8448
    buffer_load_dword v22, v206, s[60:63], s3 offen sc1
    v_mfma_f32_16x16x32_bf16 a[164:167], v[228:231], v[168:171], a[164:167]
    s_add_u32 s3, s3, 4096
    v_exp_f32 v176, v176
    v_mfma_f32_16x16x32_bf16 a[228:231], v[228:231], v[172:175], a[228:231]
    s_waitcnt lgkmcnt(3)
    v_exp_f32 v177, v177
    v_mfma_f32_16x16x32_bf16 a[40:43], v[232:235], v[160:163], a[40:43]
    ds_read_b64_tr_b16 v[228:229], v192 offset:256
    v_add_f32 v30, v30, v176
    v_mfma_f32_16x16x32_bf16 a[104:107], v[232:235], v[164:167], a[104:107]
    ds_read_b64_tr_b16 v[230:231], v192 offset:8448
    v_add_f32 v30, v30, v177
    v_mfma_f32_16x16x32_bf16 a[168:171], v[232:235], v[168:171], a[168:171]
    v_exp_f32 v178, v178
    v_mfma_f32_16x16x32_bf16 a[232:235], v[232:235], v[172:175], a[232:235]
    s_waitcnt lgkmcnt(3)
    v_exp_f32 v179, v179
    v_mfma_f32_16x16x32_bf16 a[44:47], v[236:239], v[160:163], a[44:47]
    ds_read_b64_tr_b16 v[232:233], v193 offset:256
    v_add_f32 v30, v30, v178
    v_mfma_f32_16x16x32_bf16 a[108:111], v[236:239], v[164:167], a[108:111]
    ds_read_b64_tr_b16 v[234:235], v193 offset:8448
    v_add_f32 v30, v30, v179
    v_mfma_f32_16x16x32_bf16 a[172:175], v[236:239], v[168:171], a[172:175]
    v_exp_f32 v184, v184
    v_mfma_f32_16x16x32_bf16 a[236:239], v[236:239], v[172:175], a[236:239]
    s_waitcnt lgkmcnt(3)
    v_exp_f32 v185, v185
    v_mfma_f32_16x16x32_bf16 a[48:51], v[224:227], v[160:163], a[48:51]
    ds_read_b64_tr_b16 v[236:237], v194 offset:256
    v_add_f32 v31, v31, v184
    v_mfma_f32_16x16x32_bf16 a[112:115], v[224:227], v[164:167], a[112:115]
    ds_read_b64_tr_b16 v[238:239], v194 offset:8448
    v_add_f32 v31, v31, v185
    v_mfma_f32_16x16x32_bf16 a[176:179], v[224:227], v[168:171], a[176:179]
    v_exp_f32 v186, v186
    v_mfma_f32_16x16x32_bf16 a[240:243], v[224:227], v[172:175], a[240:243]
    s_waitcnt lgkmcnt(3)
    v_exp_f32 v187, v187
    v_mfma_f32_16x16x32_bf16 a[52:55], v[228:231], v[160:163], a[52:55]
    ds_read_b128 v[224:227], v4 offset:32768
    v_add_f32 v31, v31, v186
    v_mfma_f32_16x16x32_bf16 a[116:119], v[228:231], v[164:167], a[116:119]
    v_add_f32 v31, v31, v187
    v_mfma_f32_16x16x32_bf16 a[180:183], v[228:231], v[168:171], a[180:183]
    v_max3_f32 v16, v28, v29, v30
    v_max_f32 v16, v16, v31
    v_mfma_f32_16x16x32_bf16 a[244:247], v[228:231], v[172:175], a[244:247]
    s_waitcnt lgkmcnt(2)
    v_cmp_nge_f32 vcc, s77, v16
    v_mfma_f32_16x16x32_bf16 a[56:59], v[232:235], v[160:163], a[56:59]
    s_add_u32 s96, s70, 81920
    ds_read_b128 v[228:231], v8 offset:32768
    v_mfma_f32_16x16x32_bf16 a[120:123], v[232:235], v[164:167], a[120:123]
    buffer_load_dword v22, v23, s[48:51], s96 offen
    v_mfma_f32_16x16x32_bf16 a[184:187], v[232:235], v[168:171], a[184:187]
    global_load_dword v22, v17, s[90:91]
    v_mfma_f32_16x16x32_bf16 a[248:251], v[232:235], v[172:175], a[248:251]
    s_waitcnt lgkmcnt(1)
    v_mfma_f32_16x16x32_bf16 a[60:63], v[236:239], v[160:163], a[60:63]
    ds_read_b128 v[232:235], v9 offset:32768
    v_cvt_pk_bf16_f32 v160, v148, v149
    v_cvt_pk_bf16_f32 v161, v150, v151
    v_mfma_f32_16x16x32_bf16 a[124:127], v[236:239], v[164:167], a[124:127]
    v_cvt_pk_bf16_f32 v164, v156, v157
    v_cvt_pk_bf16_f32 v165, v158, v159
    v_mfma_f32_16x16x32_bf16 a[188:191], v[236:239], v[168:171], a[188:191]
    v_cvt_pk_bf16_f32 v168, v180, v181
    v_cvt_pk_bf16_f32 v169, v182, v183
    v_mfma_f32_16x16x32_bf16 a[252:255], v[236:239], v[172:175], a[252:255]
    v_cvt_pk_bf16_f32 v172, v188, v189
    v_cvt_pk_bf16_f32 v173, v190, v191
    s_cbranch_vccnz L_slow_w1
L_back_w1:
    v_mfma_f32_16x16x32_bf16 v[148:151], v[224:227], v[212:215], v[208:211]
    s_sub_u32 s76, s76, 1
    ds_read_b128 v[236:239], v10 offset:32768
    v_mfma_f32_16x16x32_bf16 v[156:159], v[224:227], v[220:223], v[216:219]
    v_add_f32 v24, v24, v28
    v_add_f32 v25, v25, v29
    s_cbranch_scc0 L_loop
L_tail:
    v_mfma_f32_16x16x32_bf16 v[180:183], v[224:227], v[52:55], v[240:243]
    s_waitcnt vmcnt(11)
    v_mfma_f32_16x16x32_bf16 v[188:191], v[224:227], v[56:59], v[248:251]
    s_waitcnt lgkmcnt(1)
    s_barrier
    v_cvt_pk_bf16_f32 v162, v144, v145
    v_cvt_pk_bf16_f32 v163, v146, v147
    v_mfma_f32_16x16x32_bf16 v[148:151], v[228:231], v[244:247], v[148:151]
    s_add_u32 m0, s67, 0
    ds_read_b128 v[224:227], v4 offset:33024
    v_mfma_f32_16x16x32_bf16 v[156:159], v[228:231], v[252:255], v[156:159]
    s_add_u32 s71, s71, 16384
    v_add_f32 v26, v26, v30
    v_add_f32 v27, v27, v31
    v_mfma_f32_16x16x32_bf16 v[180:183], v[228:231], v[60:63], v[180:183]
    buffer_load_dwordx4 v6, s[52:55], s71 offen offset:0 lds
    v_mfma_f32_16x16x32_bf16 v[188:191], v[228:231], v[64:67], v[188:191]
    v_cvt_pk_bf16_f32 v166, v152, v153
    v_cvt_pk_bf16_f32 v167, v154, v155
    v_mfma_f32_16x16x32_bf16 v[148:151], v[232:235], v[32:35], v[148:151]
    ds_read_b128 v[228:231], v8 offset:33024
    v_mfma_f32_16x16x32_bf16 v[156:159], v[232:235], v[36:39], v[156:159]
    v_mfma_f32_16x16x32_bf16 v[180:183], v[232:235], v[68:71], v[180:183]
    buffer_load_dwordx4 v0, s[52:55], s71 offen offset:1024 lds
    v_mfma_f32_16x16x32_bf16 v[188:191], v[232:235], v[72:75], v[188:191]
    s_waitcnt lgkmcnt(1)
    v_cvt_pk_bf16_f32 v170, v176, v177
    v_cvt_pk_bf16_f32 v171, v178, v179
    v_mfma_f32_16x16x32_bf16 v[148:151], v[236:239], v[40:43], v[148:151]
    ds_read_b128 v[232:235], v9 offset:33024
    v_mfma_f32_16x16x32_bf16 v[156:159], v[236:239], v[48:51], v[156:159]
    v_mfma_f32_16x16x32_bf16 v[180:183], v[236:239], v[76:79], v[180:183]
    buffer_load_dwordx4 v1, s[52:55], s71 offen offset:2048 lds
    v_mfma_f32_16x16x32_bf16 v[188:191], v[236:239], v[80:83], v[188:191]
    v_cvt_pk_bf16_f32 v174, v184, v185
    v_cvt_pk_bf16_f32 v175, v186, v187
    v_mfma_f32_16x16x32_bf16 v[148:151], v[224:227], v[84:87], v[148:151]
    ds_read_b128 v[236:239], v10 offset:33024
    v_mfma_f32_16x16x32_bf16 v[156:159], v[224:227], v[88:91], v[156:159]
    v_mfma_f32_16x16x32_bf16 v[180:183], v[224:227], v[116:119], v[180:183]
    buffer_load_dwordx4 v21, s[52:55], s71 offen offset:3072 lds
    v_mfma_f32_16x16x32_bf16 v[188:191], v[224:227], v[120:123], v[188:191]
    s_waitcnt lgkmcnt(1)
    v_mfma_f32_16x16x32_bf16 v[148:151], v[228:231], v[92:95], v[148:151]
    s_add_u32 m0, s67, 16384
    ds_read_b128 v[224:227], v4 offset:40960
    v_mfma_f32_16x16x32_bf16 v[156:159], v[228:231], v[96:99], v[156:159]
    s_add_u32 s71, s71, 16384
    v_mfma_f32_16x16x32_bf16 v[180:183], v[228:231], v[124:127], v[180:183]
    buffer_load_dwordx4 v6, s[52:55], s71 offen offset:0 lds
    v_mfma_f32_16x16x32_bf16 v[188:191], v[228:231], v[128:131], v[188:191]
    v_mfma_f32_16x16x32_bf16 v[148:151], v[232:235], v[100:103], v[148:151]
    ds_read_b128 v[228:231], v8 offset:40960
    v_mfma_f32_16x16x32_bf16 v[156:159], v[232:235], v[104:107], v[156:159]
    v_mfma_f32_16x16x32_bf16 v[180:183], v[232:235], v[132:135], v[180:183]
    buffer_load_dwordx4 v0, s[52:55], s71 offen offset:1024 lds
    v_mfma_f32_16x16x32_bf16 v[188:191], v[232:235], v[136:139], v[188:191]
    s_waitcnt lgkmcnt(1)
    v_mfma_f32_16x16x32_bf16 v[148:151], v[236:239], v[108:111], v[148:151]
    ds_read_b128 v[232:235], v9 offset:40960
    v_mfma_f32_16x16x32_bf16 v[156:159], v[236:239], v[112:115], v[156:159]
    v_mfma_f32_16x16x32_bf16 v[180:183], v[236:239], v[140:143], v[180:183]
    buffer_load_dwordx4 v1, s[52:55], s71 offen offset:2048 lds
    v_mfma_f32_16x16x32_bf16 v[188:191], v[236:239], v[44:47], v[188:191]
    v_mfma_f32_16x16x32_bf16 v[144:147], v[224:227], v[212:215], v[208:211]
    ds_read_b128 v[236:239], v10 offset:40960
    v_mfma_f32_16x16x32_bf16 v[152:155], v[224:227], v[220:223], v[216:219]
    v_mfma_f32_16x16x32_bf16 v[176:179], v[224:227], v[52:55], v[240:243]
    buffer_load_dwordx4 v21, s[52:55], s71 offen offset:3072 lds
    v_mfma_f32_16x16x32_bf16 v[184:187], v[224:227], v[56:59], v[248:251]
    s_waitcnt lgkmcnt(1)
    v_exp_f32 v148, v148
    v_mfma_f32_16x16x32_bf16 v[144:147], v[228:231], v[244:247], v[144:147]
    ds_read_b128 v[224:227], v4 offset:41216
    v_mfma_f32_16x16x32_bf16 v[152:155], v[228:231], v[252:255], v[152:155]
    v_exp_f32 v149, v149
    v_mfma_f32_16x16x32_bf16 v[176:179], v[228:231], v[60:63], v[176:179]
    v_add_f32 v28, v148, v149
    v_mfma_f32_16x16x32_bf16 v[184:187], v[228:231], v[64:67], v[184:187]
    v_exp_f32 v150, v150
    v_mfma_f32_16x16x32_bf16 v[144:147], v[232:235], v[32:35], v[144:147]
    s_cmp_eq_u32 s27, 0
    ds_read_b128 v[228:231], v8 offset:41216
    v_add_f32 v28, v28, v150
    v_mfma_f32_16x16x32_bf16 v[152:155], v[232:235], v[36:39], v[152:155]
    s_cbranch_scc1 L_dlate
L_dback:
    v_exp_f32 v151, v151
    v_mfma_f32_16x16x32_bf16 v[176:179], v[232:235], v[68:71], v[176:179]
    v_add_f32 v28, v28, v151
    v_mfma_f32_16x16x32_bf16 v[184:187], v[232:235], v[72:75], v[184:187]
    s_waitcnt lgkmcnt(1)
    v_exp_f32 v156, v156
    v_mfma_f32_16x16x32_bf16 v[144:147], v[236:239], v[40:43], v[144:147]
    ds_read_b128 v[232:235], v9 offset:41216
    v_mfma_f32_16x16x32_bf16 v[152:155], v[236:239], v[48:51], v[152:155]
    v_exp_f32 v157, v157
    v_mfma_f32_16x16x32_bf16 v[176:179], v[236:239], v[76:79], v[176:179]
    v_add_f32 v29, v156, v157
    v_mfma_f32_16x16x32_bf16 v[184:187], v[236:239], v[80:83], v[184:187]
    v_exp_f32 v158, v158
    v_mfma_f32_16x16x32_bf16 v[144:147], v[224:227], v[84:87], v[144:147]
    ds_read_b128 v[236:239], v10 offset:41216
    v_add_f32 v29, v29, v158
    v_mfma_f32_16x16x32_bf16 v[152:155], v[224:227], v[88:91], v[152:155]
    v_exp_f32 v159, v159
    v_mfma_f32_16x16x32_bf16 v[176:179], v[224:227], v[116:119], v[176:179]
    v_add_f32 v29, v29, v159
    v_mfma_f32_16x16x32_bf16 v[184:187], v[224:227], v[120:123], v[184:187]
    s_waitcnt lgkmcnt(1)
    v_exp_f32 v180, v180
    v_mfma_f32_16x16x32_bf16 v[144:147], v[228:231], v[92:95], v[144:147]
    ds_read_b64_tr_b16 v[224:225], v195 offset:0
    v_mfma_f32_16x16x32_bf16 v[152:155], v[228:231], v[96:99], v[152:155]
    ds_read_b64_tr_b16 v[226:227], v195 offset:8192
    v_mfma_f32_16x16x32_bf16 v[176:179], v[228:231], v[124:127], v[176:179]
    v_exp_f32 v181, v181
    v_mfma_f32_16x16x32_bf16 v[184:187], v[228:231], v[128:131], v[184:187]
    v_exp_f32 v182, v182
    v_mfma_f32_16x16x32_bf16 v[144:147], v[232:235], v[100:103], v[144:147]
    ds_read_b64_tr_b16 v[228:229], v196 offset:0
    v_add_f32 v30, v180, v181
    v_mfma_f32_16x16x32_bf16 v[152:155], v[232:235], v[104:107], v[152:155]
    ds_read_b64_tr_b16 v[230:231], v196 offset:8192
    v_add_f32 v30, v30, v182
    v_mfma_f32_16x16x32_bf16 v[176:179], v[232:235], v[132:135], v[176:179]
    v_exp_f32 v183, v183
    v_mfma_f32_16x16x32_bf16 v[184:187], v[232:235], v[136:139], v[184:187]
    s_waitcnt lgkmcnt(3)
    v_exp_f32 v188, v188
    v_mfma_f32_16x16x32_bf16 v[144:147], v[236:239], v[108:111], v[144:147]
    ds_read_b64_tr_b16 v[232:233], v197 offset:0
    v_add_f32 v30, v30, v183
    v_mfma_f32_16x16x32_bf16 v[152:155], v[236:239], v[112:115], v[152:155]
    ds_read_b64_tr_b16 v[234:235], v197 offset:8192
    v_mfma_f32_16x16x32_bf16 v[176:179], v[236:239], v[140:143], v[176:179]
    v_exp_f32 v189, v189
    v_mfma_f32_16x16x32_bf16 v[184:187], v[236:239], v[44:47], v[184:187]
    s_waitcnt lgkmcnt(3)
    v_exp_f32 v190, v190
    v_mfma_f32_16x16x32_bf16 a[0:3], v[224:227], v[160:163], a[0:3]
    ds_read_b64_tr_b16 v[236:237], v198 offset:0
    v_add_f32 v31, v188, v189
    v_mfma_f32_16x16x32_bf16 a[64:67], v[224:227], v[164:167], a[64:67]
    ds_read_b64_tr_b16 v[238:239], v198 offset:8192
    v_add_f32 v31, v31, v190
    v_mfma_f32_16x16x32_bf16 a[128:131], v[224:227], v[168:171], a[128:131]
    s_waitcnt vmcnt(11)
    v_exp_f32 v191, v191
    v_mfma_f32_16x16x32_bf16 a[192:195], v[224:227], v[172:175], a[192:195]
    s_waitcnt lgkmcnt(3)
    s_barrier
    v_mfma_f32_16x16x32_bf16 a[4:7], v[228:231], v[160:163], a[4:7]
    ds_read_b64_tr_b16 v[224:225], v199 offset:0
    v_add_f32 v31, v31, v191
    v_mfma_f32_16x16x32_bf16 a[68:71], v[228:231], v[164:167], a[68:71]
    s_add_u32 m0, s67, 32768
    ds_read_b64_tr_b16 v[226:227], v199 offset:8192
    v_mfma_f32_16x16x32_bf16 a[132:135], v[228:231], v[168:171], a[132:135]
    s_add_u32 s71, s71, 16384
    v_exp_f32 v144, v144
    v_mfma_f32_16x16x32_bf16 a[196:199], v[228:231], v[172:175], a[196:199]
    s_waitcnt lgkmcnt(3)
    buffer_load_dwordx4 v6, s[52:55], s71 offen offset:0 lds
    v_mfma_f32_16x16x32_bf16 a[8:11], v[232:235], v[160:163], a[8:11]
    ds_read_b64_tr_b16 v[228:229], v200 offset:0
    v_add_f32 v28, v28, v144
    v_mfma_f32_16x16x32_bf16 a[72:75], v[232:235], v[164:167], a[72:75]
    ds_read_b64_tr_b16 v[230:231], v200 offset:8192
    v_mfma_f32_16x16x32_bf16 a[136:139], v[232:235], v[168:171], a[136:139]
    v_exp_f32 v145, v145
    v_mfma_f32_16x16x32_bf16 a[200:203], v[232:235], v[172:175], a[200:203]
    s_waitcnt lgkmcnt(3)
    buffer_load_dwordx4 v0, s[52:55], s71 offen offset:1024 lds
    v_mfma_f32_16x16x32_bf16 a[12:15], v[236:239], v[160:163], a[12:15]
    ds_read_b64_tr_b16 v[232:233], v201 offset:0
    v_add_f32 v28, v28, v145
    v_mfma_f32_16x16x32_bf16 a[76:79], v[236:239], v[164:167], a[76:79]
    ds_read_b64_tr_b16 v[234:235], v201 offset:8192
    v_mfma_f32_16x16x32_bf16 a[140:143], v[236:239], v[168:171], a[140:143]
    v_exp_f32 v146, v146
    v_mfma_f32_16x16x32_bf16 a[204:207], v[236:239], v[172:175], a[204:207]
    s_waitcnt lgkmcnt(3)
    buffer_load_dwordx4 v1, s[52:55], s71 offen offset:2048 lds
    v_mfma_f32_16x16x32_bf16 a[16:19], v[224:227], v[160:163], a[16:19]
    ds_read_b64_tr_b16 v[236:237], v202 offset:0
    v_add_f32 v28, v28, v146
    v_mfma_f32_16x16x32_bf16 a[80:83], v[224:227], v[164:167], a[80:83]
    ds_read_b64_tr_b16 v[238:239], v202 offset:8192
    v_mfma_f32_16x16x32_bf16 a[144:147], v[224:227], v[168:171], a[144:147]
    v_exp_f32 v147, v147
    v_mfma_f32_16x16x32_bf16 a[208:211], v[224:227], v[172:175], a[208:211]
    s_waitcnt lgkmcnt(3)
    buffer_load_dwordx4 v21, s[52:55], s71 offen offset:3072 lds
    v_mfma_f32_16x16x32_bf16 a[20:23], v[228:231], v[160:163], a[20:23]
    ds_read_b64_tr_b16 v[224:225], v195 offset:256
    v_add_f32 v28, v28, v147
    v_mfma_f32_16x16x32_bf16 a[84:87], v[228:231], v[164:167], a[84:87]
    s_add_u32 m0, s67, 49152
    ds_read_b64_tr_b16 v[226:227], v195 offset:8448
    v_mfma_f32_16x16x32_bf16 a[148:151], v[228:231], v[168:171], a[148:151]
    s_add_u32 s71, s71, 16384
    v_exp_f32 v152, v152
    v_mfma_f32_16x16x32_bf16 a[212:215], v[228:231], v[172:175], a[212:215]
    s_waitcnt lgkmcnt(3)
    buffer_load_dwordx4 v6, s[52:55], s71 offen offset:0 lds
    v_mfma_f32_16x16x32_bf16 a[24:27], v[232:235], v[160:163], a[24:27]
    ds_read_b64_tr_b16 v[228:229], v196 offset:256
    v_add_f32 v29, v29, v152
    v_mfma_f32_16x16x32_bf16 a[88:91], v[232:235], v[164:167], a[88:91]
    ds_read_b64_tr_b16 v[230:231], v196 offset:8448
    v_mfma_f32_16x16x32_bf16 a[152:155], v[232:235], v[168:171], a[152:155]
    v_exp_f32 v153, v153
    v_mfma_f32_16x16x32_bf16 a[216:219], v[232:235], v[172:175], a[216:219]
    s_waitcnt lgkmcnt(3)
    buffer_load_dwordx4 v0, s[52:55], s71 offen offset:1024 lds
    v_mfma_f32_16x16x32_bf16 a[28:31], v[236:239], v[160:163], a[28:31]
    ds_read_b64_tr_b16 v[232:233], v197 offset:256
    v_add_f32 v29, v29, v153
    v_mfma_f32_16x16x32_bf16 a[92:95], v[236:239], v[164:167], a[92:95]
    ds_read_b64_tr_b16 v[234:235], v197 offset:8448
    v_mfma_f32_16x16x32_bf16 a[156:159], v[236:239], v[168:171], a[156:159]
    v_exp_f32 v154, v154
    v_mfma_f32_16x16x32_bf16 a[220:223], v[236:239], v[172:175], a[220:223]
    s_waitcnt lgkmcnt(3)
    buffer_load_dwordx4 v1, s[52:55], s71 offen offset:2048 lds
    v_mfma_f32_16x16x32_bf16 a[32:35], v[224:227], v[160:163], a[32:35]
    ds_read_b64_tr_b16 v[236:237], v198 offset:256
    v_add_f32 v29, v29, v154
    v_mfma_f32_16x16x32_bf16 a[96:99], v[224:227], v[164:167], a[96:99]
    ds_read_b64_tr_b16 v[238:239], v198 offset:8448
    v_mfma_f32_16x16x32_bf16 a[160:163], v[224:227], v[168:171], a[160:163]
    v_exp_f32 v155, v155
    v_mfma_f32_16x16x32_bf16 a[224:227], v[224:227], v[172:175], a[224:227]
    s_waitcnt lgkmcnt(3)
    buffer_load_dwordx4 v21, s[52:55], s71 offen offset:3072 lds
    v_mfma_f32_16x16x32_bf16 a[36:39], v[228:231], v[160:163], a[36:39]
    ds_read_b64_tr_b16 v[224:225], v199 offset:256
    v_add_f32 v29, v29, v155
    v_mfma_f32_16x16x32_bf16 a[100:103], v[228:231], v[164:167], a[100:103]
    ds_read_b64_tr_b16 v[226:227], v199 offset:8448
    buffer_load_dword v22, v206, s[60:63], s3 offen sc1
    v_mfma_f32_16x16x32_bf16 a[164:167], v[228:231], v[168:171], a[164:167]
    s_add_u32 s3, s3, 4096
    v_exp_f32 v176, v176
    v_mfma_f32_16x16x32_bf16 a[228:231], v[228:231], v[172:175], a[228:231]
    s_waitcnt lgkmcnt(3)
    v_exp_f32 v177, v177
    v_mfma_f32_16x16x32_bf16 a[40:43], v[232:235], v[160:163], a[40:43]
    ds_read_b64_tr_b16 v[228:229], v200 offset:256
    v_add_f32 v30, v30, v176
    v_mfma_f32_16x16x32_bf16 a[104:107], v[232:235], v[164:167], a[104:107]
    ds_read_b64_tr_b16 v[230:231], v200 offset:8448
    v_add_f32 v30, v30, v177
    v_mfma_f32_16x16x32_bf16 a[168:171], v[232:235], v[168:171], a[168:171]
    v_exp_f32 v178, v178
    v_mfma_f32_16x16x32_bf16 a[232:235], v[232:235], v[172:175], a[232:235]
    s_waitcnt lgkmcnt(3)
    v_exp_f32 v179, v179
    v_mfma_f32_16x16x32_bf16 a[44:47], v[236:239], v[160:163], a[44:47]
    ds_read_b64_tr_b16 v[232:233], v201 offset:256
    v_add_f32 v30, v30, v178
    v_mfma_f32_16x16x32_bf16 a[108:111], v[236:239], v[164:167], a[108:111]
    ds_read_b64_tr_b16 v[234:235], v201 offset:8448
    v_add_f32 v30, v30, v179
    v_mfma_f32_16x16x32_bf16 a[172:175], v[236:239], v[168:171], a[172:175]
    v_exp_f32 v184, v184
    v_mfma_f32_16x16x32_bf16 a[236:239], v[236:239], v[172:175], a[236:239]
    s_waitcnt lgkmcnt(3)
    v_exp_f32 v185, v185
    v_mfma_f32_16x16x32_bf16 a[48:51], v[224:227], v[160:163], a[48:51]
    ds_read_b64_tr_b16 v[236:237], v202 offset:256
    v_add_f32 v31, v31, v184
    v_mfma_f32_16x16x32_bf16 a[112:115], v[224:227], v[164:167], a[112:115]
    ds_read_b64_tr_b16 v[238:239], v202 offset:8448
    v_add_f32 v31, v31, v185
    v_mfma_f32_16x16x32_bf16 a[176:179], v[224:227], v[168:171], a[176:179]
    v_exp_f32 v186, v186
    v_mfma_f32_16x16x32_bf16 a[240:243], v[224:227], v[172:175], a[240:243]
    s_waitcnt lgkmcnt(3)
    v_exp_f32 v187, v187
    v_mfma_f32_16x16x32_bf16 a[52:55], v[228:231], v[160:163], a[52:55]
    ds_read_b128 v[224:227], v11 offset:32768
    v_add_f32 v31, v31, v186
    v_mfma_f32_16x16x32_bf16 a[116:119], v[228:231], v[164:167], a[116:119]
    v_add_f32 v31, v31, v187
    v_mfma_f32_16x16x32_bf16 a[180:183], v[228:231], v[168:171], a[180:183]
    v_max3_f32 v16, v28, v29, v30
    v_max_f32 v16, v16, v31
    v_mfma_f32_16x16x32_bf16 a[244:247], v[228:231], v[172:175], a[244:247]
    s_waitcnt lgkmcnt(2)
    v_cmp_nge_f32 vcc, s77, v16
    v_mfma_f32_16x16x32_bf16 a[56:59], v[232:235], v[160:163], a[56:59]
    ds_read_b128 v[228:231], v12 offset:32768
    v_mfma_f32_16x16x32_bf16 a[120:123], v[232:235], v[164:167], a[120:123]
    v_mfma_f32_16x16x32_bf16 a[184:187], v[232:235], v[168:171], a[184:187]
    v_mfma_f32_16x16x32_bf16 a[248:251], v[232:235], v[172:175], a[248:251]
    s_waitcnt lgkmcnt(1)
    v_mfma_f32_16x16x32_bf16 a[60:63], v[236:239], v[160:163], a[60:63]
    ds_read_b128 v[232:235], v13 offset:32768
    v_cvt_pk_bf16_f32 v160, v148, v149
    v_cvt_pk_bf16_f32 v161, v150, v151
    v_mfma_f32_16x16x32_bf16 a[124:127], v[236:239], v[164:167], a[124:127]
    v_cvt_pk_bf16_f32 v164, v156, v157
    v_cvt_pk_bf16_f32 v165, v158, v159
    v_mfma_f32_16x16x32_bf16 a[188:191], v[236:239], v[168:171], a[188:191]
    v_cvt_pk_bf16_f32 v168, v180, v181
    v_cvt_pk_bf16_f32 v169, v182, v183
    v_mfma_f32_16x16x32_bf16 a[252:255], v[236:239], v[172:175], a[252:255]
    v_cvt_pk_bf16_f32 v172, v188, v189
    v_cvt_pk_bf16_f32 v173, v190, v191
    s_cbranch_vccnz L_slow_p30
L_back_p30:
    v_mfma_f32_16x16x32_bf16 v[148:151], v[224:227], v[212:215], v[208:211]
    ds_read_b128 v[236:239], v14 offset:32768
    v_mfma_f32_16x16x32_bf16 v[156:159], v[224:227], v[220:223], v[216:219]
    v_add_f32 v24, v24, v28
    v_add_f32 v25, v25, v29
    v_mfma_f32_16x16x32_bf16 v[180:183], v[224:227], v[52:55], v[240:243]
    s_waitcnt vmcnt(9)
    v_mfma_f32_16x16x32_bf16 v[188:191], v[224:227], v[56:59], v[248:251]
    s_waitcnt lgkmcnt(1)
    s_barrier
    v_cvt_pk_bf16_f32 v162, v144, v145
    v_cvt_pk_bf16_f32 v163, v146, v147
    v_mfma_f32_16x16x32_bf16 v[148:151], v[228:231], v[244:247], v[148:151]
    ds_read_b128 v[224:227], v11 offset:33024
    v_mfma_f32_16x16x32_bf16 v[156:159], v[228:231], v[252:255], v[156:159]
    v_add_f32 v26, v26, v30
    v_add_f32 v27, v27, v31
    v_mfma_f32_16x16x32_bf16 v[180:183], v[228:231], v[60:63], v[180:183]
    v_mfma_f32_16x16x32_bf16 v[188:191], v[228:231], v[64:67], v[188:191]
    v_cvt_pk_bf16_f32 v166, v152, v153
    v_cvt_pk_bf16_f32 v167, v154, v155
    v_mfma_f32_16x16x32_bf16 v[148:151], v[232:235], v[32:35], v[148:151]
    ds_read_b128 v[228:231], v12 offset:33024
    v_mfma_f32_16x16x32_bf16 v[156:159], v[232:235], v[36:39], v[156:159]
    v_mfma_f32_16x16x32_bf16 v[180:183], v[232:235], v[68:71], v[180:183]
    v_mfma_f32_16x16x32_bf16 v[188:191], v[232:235], v[72:75], v[188:191]
    s_waitcnt lgkmcnt(1)
    v_cvt_pk_bf16_f32 v170, v176, v177
    v_cvt_pk_bf16_f32 v171, v178, v179
    v_mfma_f32_16x16x32_bf16 v[148:151], v[236:239], v[40:43], v[148:151]
    ds_read_b128 v[232:235], v13 offset:33024
    v_mfma_f32_16x16x32_bf16 v[156:159], v[236:239], v[48:51], v[156:159]
    v_mfma_f32_16x16x32_bf16 v[180:183], v[236:239], v[76:79], v[180:183]
    v_mfma_f32_16x16x32_bf16 v[188:191], v[236:239], v[80:83], v[188:191]
    v_cvt_pk_bf16_f32 v174, v184, v185
    v_cvt_pk_bf16_f32 v175, v186, v187
    v_mfma_f32_16x16x32_bf16 v[148:151], v[224:227], v[84:87], v[148:151]
    ds_read_b128 v[236:239], v14 offset:33024
    v_mfma_f32_16x16x32_bf16 v[156:159], v[224:227], v[88:91], v[156:159]
    v_mfma_f32_16x16x32_bf16 v[180:183], v[224:227], v[116:119], v[180:183]
    v_mfma_f32_16x16x32_bf16 v[188:191], v[224:227], v[120:123], v[188:191]
    s_waitcnt lgkmcnt(1)
    v_mfma_f32_16x16x32_bf16 v[148:151], v[228:231], v[92:95], v[148:151]
    ds_read_b128 v[224:227], v11 offset:40960
    v_mfma_f32_16x16x32_bf16 v[156:159], v[228:231], v[96:99], v[156:159]
    v_mfma_f32_16x16x32_bf16 v[180:183], v[228:231], v[124:127], v[180:183]
    v_mfma_f32_16x16x32_bf16 v[188:191], v[228:231], v[128:131], v[188:191]
    v_mfma_f32_16x16x32_bf16 v[148:151], v[232:235], v[100:103], v[148:151]
    ds_read_b128 v[228:231], v12 offset:40960
    v_mfma_f32_16x16x32_bf16 v[156:159], v[232:235], v[104:107], v[156:159]
    v_mfma_f32_16x16x32_bf16 v[180:183], v[232:235], v[132:135], v[180:183]
    v_mfma_f32_16x16x32_bf16 v[188:191], v[232:235], v[136:139], v[188:191]
    s_waitcnt lgkmcnt(1)
    v_mfma_f32_16x16x32_bf16 v[148:151], v[236:239], v[108:111], v[148:151]
    ds_read_b128 v[232:235], v13 offset:40960
    v_mfma_f32_16x16x32_bf16 v[156:159], v[236:239], v[112:115], v[156:159]
    v_mfma_f32_16x16x32_bf16 v[180:183], v[236:239], v[140:143], v[180:183]
    v_mfma_f32_16x16x32_bf16 v[188:191], v[236:239], v[44:47], v[188:191]
    v_mfma_f32_16x16x32_bf16 v[144:147], v[224:227], v[212:215], v[208:211]
    ds_read_b128 v[236:239], v14 offset:40960
    v_mfma_f32_16x16x32_bf16 v[152:155], v[224:227], v[220:223], v[216:219]
    v_mfma_f32_16x16x32_bf16 v[176:179], v[224:227], v[52:55], v[240:243]
    v_mfma_f32_16x16x32_bf16 v[184:187], v[224:227], v[56:59], v[248:251]
    s_waitcnt lgkmcnt(1)
    v_exp_f32 v212, v148
    v_mfma_f32_16x16x32_bf16 v[144:147], v[228:231], v[244:247], v[144:147]
    ds_read_b128 v[224:227], v11 offset:41216
    v_mfma_f32_16x16x32_bf16 v[152:155], v[228:231], v[252:255], v[152:155]
    v_exp_f32 v213, v149
    v_mfma_f32_16x16x32_bf16 v[176:179], v[228:231], v[60:63], v[176:179]
    v_add_f32 v28, v212, v213
    v_mfma_f32_16x16x32_bf16 v[184:187], v[228:231], v[64:67], v[184:187]
    v_exp_f32 v214, v150
    v_mfma_f32_16x16x32_bf16 v[144:147], v[232:235], v[32:35], v[144:147]
    ds_read_b128 v[228:231], v12 offset:41216
    v_add_f32 v28, v28, v214
    v_mfma_f32_16x16x32_bf16 v[152:155], v[232:235], v[36:39], v[152:155]
    v_exp_f32 v215, v151
    v_mfma_f32_16x16x32_bf16 v[176:179], v[232:235], v[68:71], v[176:179]
    v_add_f32 v28, v28, v215
    v_mfma_f32_16x16x32_bf16 v[184:187], v[232:235], v[72:75], v[184:187]
    s_waitcnt lgkmcnt(1)
    v_exp_f32 v220, v156
    v_mfma_f32_16x16x32_bf16 v[144:147], v[236:239], v[40:43], v[144:147]
    ds_read_b128 v[232:235], v13 offset:41216
    v_mfma_f32_16x16x32_bf16 v[152:155], v[236:239], v[48:51], v[152:155]
    v_exp_f32 v221, v157
    v_mfma_f32_16x16x32_bf16 v[176:179], v[236:239], v[76:79], v[176:179]
    v_add_f32 v29, v220, v221
    v_mfma_f32_16x16x32_bf16 v[184:187], v[236:239], v[80:83], v[184:187]
    v_exp_f32 v222, v158
    v_mfma_f32_16x16x32_bf16 v[144:147], v[224:227], v[84:87], v[144:147]
    ds_read_b128 v[236:239], v14 offset:41216
    v_add_f32 v29, v29, v222
    v_mfma_f32_16x16x32_bf16 v[152:155], v[224:227], v[88:91], v[152:155]
    v_exp_f32 v223, v159
    v_mfma_f32_16x16x32_bf16 v[176:179], v[224:227], v[116:119], v[176:179]
    v_add_f32 v29, v29, v223
    v_mfma_f32_16x16x32_bf16 v[184:187], v[224:227], v[120:123], v[184:187]
    s_waitcnt lgkmcnt(1)
    v_exp_f32 v52, v180
    v_mfma_f32_16x16x32_bf16 v[144:147], v[228:231], v[92:95], v[144:147]
    ds_read_b64_tr_b16 v[224:225], v5 offset:0
    v_mfma_f32_16x16x32_bf16 v[152:155], v[228:231], v[96:99], v[152:155]
    ds_read_b64_tr_b16 v[226:227], v5 offset:8192
    v_mfma_f32_16x16x32_bf16 v[176:179], v[228:231], v[124:127], v[176:179]
    v_exp_f32 v53, v181
    v_mfma_f32_16x16x32_bf16 v[184:187], v[228:231], v[128:131], v[184:187]
    v_exp_f32 v54, v182
    v_mfma_f32_16x16x32_bf16 v[144:147], v[232:235], v[100:103], v[144:147]
    ds_read_b64_tr_b16 v[228:229], v15 offset:0
    v_add_f32 v30, v52, v53
    v_mfma_f32_16x16x32_bf16 v[152:155], v[232:235], v[104:107], v[152:155]
    ds_read_b64_tr_b16 v[230:231], v15 offset:8192
    v_add_f32 v30, v30, v54
    v_mfma_f32_16x16x32_bf16 v[176:179], v[232:235], v[132:135], v[176:179]
    v_exp_f32 v55, v183
    v_mfma_f32_16x16x32_bf16 v[184:187], v[232:235], v[136:139], v[184:187]
    s_waitcnt lgkmcnt(3)
    v_exp_f32 v56, v188
    v_mfma_f32_16x16x32_bf16 v[144:147], v[236:239], v[108:111], v[144:147]
    ds_read_b64_tr_b16 v[232:233], v18 offset:0
    v_add_f32 v30, v30, v55
    v_mfma_f32_16x16x32_bf16 v[152:155], v[236:239], v[112:115], v[152:155]
    ds_read_b64_tr_b16 v[234:235], v18 offset:8192
    v_mfma_f32_16x16x32_bf16 v[176:179], v[236:239], v[140:143], v[176:179]
    v_exp_f32 v57, v189
    v_mfma_f32_16x16x32_bf16 v[184:187], v[236:239], v[44:47], v[184:187]
    s_waitcnt lgkmcnt(3)
    v_exp_f32 v58, v190
    v_mfma_f32_16x16x32_bf16 a[0:3], v[224:227], v[160:163], a[0:3]
    ds_read_b64_tr_b16 v[236:237], v19 offset:0
    v_add_f32 v31, v56, v57
    v_mfma_f32_16x16x32_bf16 a[64:67], v[224:227], v[164:167], a[64:67]
    s_mul_i32 s0, s66, 27648
    ds_read_b64_tr_b16 v[238:239], v19 offset:8192
    v_add_f32 v31, v31, v58
    v_mfma_f32_16x16x32_bf16 a[128:131], v[224:227], v[168:171], a[128:131]
    s_waitcnt vmcnt(1)
    v_exp_f32 v59, v191
    v_mfma_f32_16x16x32_bf16 a[192:195], v[224:227], v[172:175], a[192:195]
    s_waitcnt lgkmcnt(3)
    s_barrier
    v_subrev_u32 v11, s0, v3
    v_add_u32 v12, 4096, v11
    v_add_u32 v12, s97, v12
    v_mfma_f32_16x16x32_bf16 a[4:7], v[228:231], v[160:163], a[4:7]
    ds_read_b64_tr_b16 v[224:225], v20 offset:0
    v_add_f32 v31, v31, v59
    v_mfma_f32_16x16x32_bf16 a[68:71], v[228:231], v[164:167], a[68:71]
    ds_read_b64_tr_b16 v[226:227], v20 offset:8192
    v_mfma_f32_16x16x32_bf16 a[132:135], v[228:231], v[168:171], a[132:135]
    s_mov_b32 s3, 0
    v_exp_f32 v244, v144
    v_mfma_f32_16x16x32_bf16 a[196:199], v[228:231], v[172:175], a[196:199]
    s_waitcnt lgkmcnt(3)
    buffer_load_dwordx4 v[32:35], v11, s[60:63], s3 offen sc1
    v_mfma_f32_16x16x32_bf16 a[8:11], v[232:235], v[160:163], a[8:11]
    s_mov_b32 s72, 65536
    ds_read_b64_tr_b16 v[228:229], v192 offset:0
    v_add_f32 v28, v28, v244
    v_mfma_f32_16x16x32_bf16 a[72:75], v[232:235], v[164:167], a[72:75]
    s_mov_b32 s73, 98304
    ds_read_b64_tr_b16 v[230:231], v192 offset:8192
    v_mfma_f32_16x16x32_bf16 a[136:139], v[232:235], v[168:171], a[136:139]
    s_cmp_ge_u32 s66, 2
    v_exp_f32 v245, v145
    v_mfma_f32_16x16x32_bf16 a[200:203], v[232:235], v[172:175], a[200:203]
    s_waitcnt lgkmcnt(3)
    s_cselect_b32 s72, 0, s72
    buffer_load_dwordx4 v[36:39], v12, s[60:63], s3 offen sc1
    v_mfma_f32_16x16x32_bf16 a[12:15], v[236:239], v[160:163], a[12:15]
    s_cselect_b32 s73, 131072, s73
    ds_read_b64_tr_b16 v[232:233], v193 offset:0
    v_add_f32 v28, v28, v245
    v_mfma_f32_16x16x32_bf16 a[76:79], v[236:239], v[164:167], a[76:79]
    s_bitcmp1_b32 s66, 0
    ds_read_b64_tr_b16 v[234:235], v193 offset:8192
    v_mfma_f32_16x16x32_bf16 a[140:143], v[236:239], v[168:171], a[140:143]
    s_cselect_b32 s74, s73, s72
    s_mov_b32 s0, 7168
    v_exp_f32 v246, v146
    v_mfma_f32_16x16x32_bf16 a[204:207], v[236:239], v[172:175], a[204:207]
    s_waitcnt lgkmcnt(3)
    s_cselect_b32 s75, s72, s73
    buffer_load_dwordx4 v[40:43], v11, s[60:63], s0 offen sc1
    v_mfma_f32_16x16x32_bf16 a[16:19], v[224:227], v[160:163], a[16:19]
    s_sub_u32 s74, s74, s88
    ds_read_b64_tr_b16 v[236:237], v194 offset:0
    v_add_f32 v28, v28, v246
    v_mfma_f32_16x16x32_bf16 a[80:83], v[224:227], v[164:167], a[80:83]
    s_sub_u32 s75, s75, s88
    ds_read_b64_tr_b16 v[238:239], v194 offset:8192
    v_mfma_f32_16x16x32_bf16 a[144:147], v[224:227], v[168:171], a[144:147]
    s_mul_i32 s96, s66, 27648
    v_exp_f32 v247, v147
    v_mfma_f32_16x16x32_bf16 a[208:211], v[224:227], v[172:175], a[208:211]
    s_waitcnt lgkmcnt(3)
    s_sub_u32 s96, 159744, s96
    buffer_load_dwordx4 v[48:51], v12, s[60:63], s0 offen sc1
    v_mfma_f32_16x16x32_bf16 a[20:23], v[228:231], v[160:163], a[20:23]
    ds_read_b64_tr_b16 v[224:225], v5 offset:256
    v_add_f32 v28, v28, v247
    v_mfma_f32_16x16x32_bf16 a[84:87], v[228:231], v[164:167], a[84:87]
    ds_read_b64_tr_b16 v[226:227], v5 offset:8448
    v_mfma_f32_16x16x32_bf16 a[148:151], v[228:231], v[168:171], a[148:151]
    s_mov_b32 s3, 14336
    v_exp_f32 v252, v152
    v_mfma_f32_16x16x32_bf16 a[212:215], v[228:231], v[172:175], a[212:215]
    s_waitcnt lgkmcnt(3)
    buffer_load_dwordx4 v[68:71], v11, s[60:63], s3 offen sc1
    v_add_u32 v4, s74, v3
    v_mfma_f32_16x16x32_bf16 a[24:27], v[232:235], v[160:163], a[24:27]
    ds_read_b64_tr_b16 v[228:229], v15 offset:256
    v_add_f32 v29, v29, v252
    v_mfma_f32_16x16x32_bf16 a[88:91], v[232:235], v[164:167], a[88:91]
    ds_read_b64_tr_b16 v[230:231], v15 offset:8448
    buffer_load_dwordx4 v[72:75], v12, s[60:63], s3 offen sc1
    v_mfma_f32_16x16x32_bf16 a[152:155], v[232:235], v[168:171], a[152:155]
    s_mov_b32 s0, 21504
    v_exp_f32 v253, v153
    v_mfma_f32_16x16x32_bf16 a[216:219], v[232:235], v[172:175], a[216:219]
    s_waitcnt lgkmcnt(3)
    buffer_load_dwordx4 v[76:79], v11, s[60:63], s0 offen sc1
    v_add_u32 v8, s75, v3
    v_mfma_f32_16x16x32_bf16 a[28:31], v[236:239], v[160:163], a[28:31]
    ds_read_b64_tr_b16 v[232:233], v18 offset:256
    v_add_f32 v29, v29, v253
    v_mfma_f32_16x16x32_bf16 a[92:95], v[236:239], v[164:167], a[92:95]
    ds_read_b64_tr_b16 v[234:235], v18 offset:8448
    buffer_load_dwordx4 v[80:83], v12, s[60:63], s0 offen sc1
    v_mfma_f32_16x16x32_bf16 a[156:159], v[236:239], v[168:171], a[156:159]
    s_mov_b32 s3, 28672
    v_exp_f32 v254, v154
    v_mfma_f32_16x16x32_bf16 a[220:223], v[236:239], v[172:175], a[220:223]
    s_waitcnt lgkmcnt(3)
    buffer_load_dwordx4 v[84:87], v11, s[60:63], s3 offen sc1
    v_add_u32 v9, s96, v3
    v_mfma_f32_16x16x32_bf16 a[32:35], v[224:227], v[160:163], a[32:35]
    ds_read_b64_tr_b16 v[236:237], v19 offset:256
    v_add_f32 v29, v29, v254
    v_mfma_f32_16x16x32_bf16 a[96:99], v[224:227], v[164:167], a[96:99]
    ds_read_b64_tr_b16 v[238:239], v19 offset:8448
    buffer_load_dwordx4 v[88:91], v12, s[60:63], s3 offen sc1
    v_mfma_f32_16x16x32_bf16 a[160:163], v[224:227], v[168:171], a[160:163]
    s_mov_b32 s0, 35840
    v_exp_f32 v255, v155
    v_mfma_f32_16x16x32_bf16 a[224:227], v[224:227], v[172:175], a[224:227]
    s_waitcnt lgkmcnt(3)
    buffer_load_dwordx4 v[92:95], v11, s[60:63], s0 offen sc1
    v_xor_b32 v10, 1024, v9
    v_mfma_f32_16x16x32_bf16 a[36:39], v[228:231], v[160:163], a[36:39]
    ds_read_b64_tr_b16 v[224:225], v20 offset:256
    v_add_f32 v29, v29, v255
    v_mfma_f32_16x16x32_bf16 a[100:103], v[228:231], v[164:167], a[100:103]
    ds_read_b64_tr_b16 v[226:227], v20 offset:8448
    buffer_load_dwordx4 v[96:99], v12, s[60:63], s0 offen sc1
    v_mfma_f32_16x16x32_bf16 a[164:167], v[228:231], v[168:171], a[164:167]
    v_exp_f32 v60, v176
    v_mfma_f32_16x16x32_bf16 a[228:231], v[228:231], v[172:175], a[228:231]
    s_waitcnt lgkmcnt(3)
    v_exp_f32 v61, v177
    v_mfma_f32_16x16x32_bf16 a[40:43], v[232:235], v[160:163], a[40:43]
    s_mov_b32 s3, 43008
    ds_read_b64_tr_b16 v[228:229], v192 offset:256
    v_add_f32 v30, v30, v60
    v_mfma_f32_16x16x32_bf16 a[104:107], v[232:235], v[164:167], a[104:107]
    ds_read_b64_tr_b16 v[230:231], v192 offset:8448
    buffer_load_dwordx4 v[100:103], v11, s[60:63], s3 offen sc1
    v_add_f32 v30, v30, v61
    v_mfma_f32_16x16x32_bf16 a[168:171], v[232:235], v[168:171], a[168:171]
    v_exp_f32 v62, v178
    v_mfma_f32_16x16x32_bf16 a[232:235], v[232:235], v[172:175], a[232:235]
    s_waitcnt lgkmcnt(3)
    v_exp_f32 v63, v179
    v_mfma_f32_16x16x32_bf16 a[44:47], v[236:239], v[160:163], a[44:47]
    ds_read_b64_tr_b16 v[232:233], v193 offset:256
    v_add_f32 v30, v30, v62
    v_mfma_f32_16x16x32_bf16 a[108:111], v[236:239], v[164:167], a[108:111]
    ds_read_b64_tr_b16 v[234:235], v193 offset:8448
    buffer_load_dwordx4 v[104:107], v12, s[60:63], s3 offen sc1
    v_add_f32 v30, v30, v63
    v_mfma_f32_16x16x32_bf16 a[172:175], v[236:239], v[168:171], a[172:175]
    v_exp_f32 v64, v184
    v_mfma_f32_16x16x32_bf16 a[236:239], v[236:239], v[172:175], a[236:239]
    s_waitcnt lgkmcnt(3)
    v_exp_f32 v65, v185
    v_mfma_f32_16x16x32_bf16 a[48:51], v[224:227], v[160:163], a[48:51]
    s_mov_b32 s0, 50176
    ds_read_b64_tr_b16 v[236:237], v194 offset:256
    v_add_f32 v31, v31, v64
    v_mfma_f32_16x16x32_bf16 a[112:115], v[224:227], v[164:167], a[112:115]
    ds_read_b64_tr_b16 v[238:239], v194 offset:8448
    buffer_load_dwordx4 v[108:111], v11, s[60:63], s0 offen sc1
    v_add_f32 v31, v31, v65
    v_mfma_f32_16x16x32_bf16 a[176:179], v[224:227], v[168:171], a[176:179]
    v_exp_f32 v66, v186
    v_mfma_f32_16x16x32_bf16 a[240:243], v[224:227], v[172:175], a[240:243]
    s_waitcnt lgkmcnt(3)
    v_exp_f32 v67, v187
    v_mfma_f32_16x16x32_bf16 a[52:55], v[228:231], v[160:163], a[52:55]
    ds_read_b64_tr_b16 v[224:225], v5 offset:32768
    v_add_f32 v31, v31, v66
    v_mfma_f32_16x16x32_bf16 a[116:119], v[228:231], v[164:167], a[116:119]
    ds_read_b64_tr_b16 v[226:227], v5 offset:40960
    buffer_load_dwordx4 v[112:115], v12, s[60:63], s0 offen sc1
    v_add_f32 v31, v31, v67
    v_mfma_f32_16x16x32_bf16 a[180:183], v[228:231], v[168:171], a[180:183]
    v_max3_f32 v16, v28, v29, v30
    v_max_f32 v16, v16, v31
    v_mfma_f32_16x16x32_bf16 a[244:247], v[228:231], v[172:175], a[244:247]
    s_waitcnt lgkmcnt(3)
    v_cmp_nge_f32 vcc, s77, v16
    v_mfma_f32_16x16x32_bf16 a[56:59], v[232:235], v[160:163], a[56:59]
    s_mov_b32 s3, 57344
    ds_read_b64_tr_b16 v[228:229], v15 offset:32768
    v_mfma_f32_16x16x32_bf16 a[120:123], v[232:235], v[164:167], a[120:123]
    ds_read_b64_tr_b16 v[230:231], v15 offset:40960
    buffer_load_dwordx4 v[116:119], v11, s[60:63], s3 offen sc1
    v_mfma_f32_16x16x32_bf16 a[184:187], v[232:235], v[168:171], a[184:187]
    s_mov_b32 s0, 64512
    buffer_load_dwordx4 v[120:123], v12, s[60:63], s3 offen sc1
    v_mfma_f32_16x16x32_bf16 a[248:251], v[232:235], v[172:175], a[248:251]
    s_waitcnt lgkmcnt(3)
    buffer_load_dwordx4 v[124:127], v11, s[60:63], s0 offen sc1
    v_mfma_f32_16x16x32_bf16 a[60:63], v[236:239], v[160:163], a[60:63]
    ds_read_b64_tr_b16 v[232:233], v18 offset:32768
    v_cvt_pk_bf16_f32 v160, v212, v213
    v_cvt_pk_bf16_f32 v161, v214, v215
    v_mfma_f32_16x16x32_bf16 a[124:127], v[236:239], v[164:167], a[124:127]
    ds_read_b64_tr_b16 v[234:235], v18 offset:40960
    v_cvt_pk_bf16_f32 v164, v220, v221
    v_cvt_pk_bf16_f32 v165, v222, v223
    v_mfma_f32_16x16x32_bf16 a[188:191], v[236:239], v[168:171], a[188:191]
    v_cvt_pk_bf16_f32 v168, v52, v53
    v_cvt_pk_bf16_f32 v169, v54, v55
    v_mfma_f32_16x16x32_bf16 a[252:255], v[236:239], v[172:175], a[252:255]
    v_cvt_pk_bf16_f32 v172, v56, v57
    v_cvt_pk_bf16_f32 v173, v58, v59
    s_cbranch_vccnz L_slow_p31
L_back_p31:
    v_cvt_pk_bf16_f32 v162, v244, v245
    v_cvt_pk_bf16_f32 v163, v246, v247
    v_cvt_pk_bf16_f32 v166, v252, v253
    v_cvt_pk_bf16_f32 v167, v254, v255
    v_cvt_pk_bf16_f32 v170, v60, v61
    v_cvt_pk_bf16_f32 v171, v62, v63
    v_cvt_pk_bf16_f32 v174, v64, v65
    v_cvt_pk_bf16_f32 v175, v66, v67
    s_waitcnt lgkmcnt(3)
    v_mfma_f32_16x16x32_bf16 a[0:3], v[224:227], v[160:163], a[0:3]
    ds_read_b64_tr_b16 v[236:237], v19 offset:32768
    v_add_f32 v150, v26, v30
    v_add_f32 v151, v27, v31
    v_mfma_f32_16x16x32_bf16 a[64:67], v[224:227], v[164:167], a[64:67]
    ds_read_b64_tr_b16 v[238:239], v19 offset:40960
    v_mov_b32 v148, v240
    v_mov_b32 v149, v248
    v_mfma_f32_16x16x32_bf16 a[128:131], v[224:227], v[168:171], a[128:131]
    ds_write_b128 v9, v[148:151]
    v_mfma_f32_16x16x32_bf16 a[192:195], v[224:227], v[172:175], a[192:195]
    s_waitcnt lgkmcnt(4)
    buffer_load_dwordx4 v[128:131], v12, s[60:63], s0 offen sc1
    v_mfma_f32_16x16x32_bf16 a[4:7], v[228:231], v[160:163], a[4:7]
    ds_read_b64_tr_b16 v[224:225], v20 offset:32768
    v_mfma_f32_16x16x32_bf16 a[68:71], v[228:231], v[164:167], a[68:71]
    ds_read_b64_tr_b16 v[226:227], v20 offset:40960
    v_mfma_f32_16x16x32_bf16 a[132:135], v[228:231], v[168:171], a[132:135]
    s_waitcnt lgkmcnt(2)
    s_waitcnt vmcnt(21)
    v_mfma_f32_16x16x32_bf16 a[196:199], v[228:231], v[172:175], a[196:199]
    s_mov_b32 s3, 71680
    s_barrier
    v_mfma_f32_16x16x32_bf16 a[8:11], v[232:235], v[160:163], a[8:11]
    ds_read_b64_tr_b16 v[228:229], v192 offset:32768
    buffer_load_dwordx4 v[132:135], v11, s[60:63], s3 offen sc1
    v_mfma_f32_16x16x32_bf16 a[72:75], v[232:235], v[164:167], a[72:75]
    ds_read_b64_tr_b16 v[230:231], v192 offset:40960
    buffer_load_dwordx4 v[136:139], v12, s[60:63], s3 offen sc1
    v_mfma_f32_16x16x32_bf16 a[136:139], v[232:235], v[168:171], a[136:139]
    ds_read_b128 v[156:159], v10
    ds_write_b128 v4, a[128:131] offset:0
    v_mfma_f32_16x16x32_bf16 a[200:203], v[232:235], v[172:175], a[200:203]
    s_mov_b32 s0, 78848
    ds_write_b128 v4, a[192:195] offset:1024
    v_mfma_f32_16x16x32_bf16 a[12:15], v[236:239], v[160:163], a[12:15]
    ds_read_b64_tr_b16 v[232:233], v193 offset:32768
    buffer_load_dwordx4 v[140:143], v11, s[60:63], s0 offen sc1
    v_mfma_f32_16x16x32_bf16 a[76:79], v[236:239], v[164:167], a[76:79]
    ds_read_b64_tr_b16 v[234:235], v193 offset:40960
    v_mfma_f32_16x16x32_bf16 a[140:143], v[236:239], v[168:171], a[140:143]
    s_waitcnt lgkmcnt(7)
    ds_write_b128 v4, a[132:135] offset:2048
    buffer_load_dwordx4 v[44:47], v12, s[60:63], s0 offen sc1
    v_mfma_f32_16x16x32_bf16 a[204:207], v[236:239], v[172:175], a[204:207]
    s_mov_b32 s3, 86016
    ds_write_b128 v4, a[196:199] offset:3072
    v_mfma_f32_16x16x32_bf16 a[16:19], v[224:227], v[160:163], a[16:19]
    ds_read_b64_tr_b16 v[236:237], v194 offset:32768
    buffer_load_dwordx4 v[212:215], v11, s[60:63], s3 offen sc1
    v_mfma_f32_16x16x32_bf16 a[80:83], v[224:227], v[164:167], a[80:83]
    ds_read_b64_tr_b16 v[238:239], v194 offset:40960
    v_mfma_f32_16x16x32_bf16 a[144:147], v[224:227], v[168:171], a[144:147]
    s_waitcnt lgkmcnt(6)
    ds_write_b128 v4, a[136:139] offset:4096
    buffer_load_dwordx4 v[220:223], v12, s[60:63], s3 offen sc1
    v_mfma_f32_16x16x32_bf16 a[208:211], v[224:227], v[172:175], a[208:211]
    s_mov_b32 s0, 93184
    ds_write_b128 v4, a[200:203] offset:5120
    v_mfma_f32_16x16x32_bf16 a[20:23], v[228:231], v[160:163], a[20:23]
    ds_read_b64_tr_b16 v[224:225], v5 offset:33024
    buffer_load_dwordx4 v[52:55], v11, s[60:63], s0 offen sc1
    v_add_f32 v24, v24, v28
    v_mfma_f32_16x16x32_bf16 a[84:87], v[228:231], v[164:167], a[84:87]
    ds_read_b64_tr_b16 v[226:227], v5 offset:41216
    v_add_f32 v25, v25, v29
    v_mfma_f32_16x16x32_bf16 a[148:151], v[228:231], v[168:171], a[148:151]
    s_waitcnt lgkmcnt(6)
    ds_write_b128 v4, a[140:143] offset:6144
    buffer_load_dwordx4 v[56:59], v12, s[60:63], s0 offen sc1
    v_mfma_f32_16x16x32_bf16 a[212:215], v[228:231], v[172:175], a[212:215]
    s_mov_b32 s3, 100352
    ds_write_b128 v4, a[204:207] offset:7168
    v_mfma_f32_16x16x32_bf16 a[24:27], v[232:235], v[160:163], a[24:27]
    ds_read_b64_tr_b16 v[228:229], v15 offset:33024
    buffer_load_dwordx4 v[244:247], v11, s[60:63], s3 offen sc1
    v_sub_f32 v182, v208, v156
    v_mfma_f32_16x16x32_bf16 a[88:91], v[232:235], v[164:167], a[88:91]
    ds_read_b64_tr_b16 v[230:231], v15 offset:41216
    v_sub_f32 v183, v216, v157
    v_mfma_f32_16x16x32_bf16 a[152:155], v[232:235], v[168:171], a[152:155]
    s_waitcnt lgkmcnt(6)
    ds_write_b128 v4, a[144:147] offset:8192
    buffer_load_dwordx4 v[252:255], v12, s[60:63], s3 offen sc1
    v_mfma_f32_16x16x32_bf16 a[216:219], v[232:235], v[172:175], a[216:219]
    s_mov_b32 s0, 107520
    ds_write_b128 v4, a[208:211] offset:9216
    v_mfma_f32_16x16x32_bf16 a[28:31], v[236:239], v[160:163], a[28:31]
    ds_read_b64_tr_b16 v[232:233], v18 offset:33024
    buffer_load_dwordx4 v[60:63], v11, s[60:63], s0 offen sc1
    v_exp_f32 v180, v182
    v_mfma_f32_16x16x32_bf16 a[92:95], v[236:239], v[164:167], a[92:95]
    ds_read_b64_tr_b16 v[234:235], v18 offset:41216
    v_exp_f32 v181, v183
    v_mfma_f32_16x16x32_bf16 a[156:159], v[236:239], v[168:171], a[156:159]
    ds_write_b128 v4, a[148:151] offset:10240
    buffer_load_dwordx4 v[64:67], v12, s[60:63], s0 offen sc1
    v_mfma_f32_16x16x32_bf16 a[220:223], v[236:239], v[172:175], a[220:223]
    s_waitcnt lgkmcnt(6)
    ds_write_b128 v4, a[212:215] offset:11264
    v_mfma_f32_16x16x32_bf16 a[32:35], v[224:227], v[160:163], a[32:35]
    ds_read_b64_tr_b16 v[236:237], v19 offset:33024
    v_max_f32 v16, v182, v183
    v_mfma_f32_16x16x32_bf16 a[96:99], v[224:227], v[164:167], a[96:99]
    ds_read_b64_tr_b16 v[238:239], v19 offset:41216
    v_cmp_lt_f32 vcc, 1109393408, v16
    v_mfma_f32_16x16x32_bf16 a[160:163], v[224:227], v[168:171], a[160:163]
    ds_write_b128 v4, a[152:155] offset:12288
    v_subrev_u32 v13, s88, v3
    v_mfma_f32_16x16x32_bf16 a[224:227], v[224:227], v[172:175], a[224:227]
    s_waitcnt lgkmcnt(6)
    ds_write_b128 v4, a[216:219] offset:13312
    v_lshrrev_b32 v13, 2, v13
    v_mfma_f32_16x16x32_bf16 a[36:39], v[228:231], v[160:163], a[36:39]
    ds_read_b64_tr_b16 v[224:225], v20 offset:33024
    v_bfe_u32 v144, v13, 5, 1
    v_mfma_f32_16x16x32_bf16 a[100:103], v[228:231], v[164:167], a[100:103]
    ds_read_b64_tr_b16 v[226:227], v20 offset:41216
    v_bfe_u32 v145, v13, 3, 1
    v_mfma_f32_16x16x32_bf16 a[164:167], v[228:231], v[168:171], a[164:167]
    s_waitcnt lgkmcnt(6)
    ds_write_b128 v4, a[156:159] offset:14336
    v_lshl_add_u32 v144, v144, 1, v145
    v_mfma_f32_16x16x32_bf16 a[228:231], v[228:231], v[172:175], a[228:231]
    s_barrier
    ds_write_b128 v4, a[220:223] offset:15360
    v_bfe_u32 v145, v13, 4, 1
    v_mfma_f32_16x16x32_bf16 a[40:43], v[232:235], v[160:163], a[40:43]
    ds_read_b64_tr_b16 v[228:229], v192 offset:33024
    v_mfma_f32_16x16x32_bf16 a[104:107], v[232:235], v[164:167], a[104:107]
    ds_read_b64_tr_b16 v[230:231], v192 offset:41216
    v_lshlrev_b32 v145, 1, v145
    v_mfma_f32_16x16x32_bf16 a[168:171], v[232:235], v[168:171], a[168:171]
    ds_write_b128 v4, a[160:163] offset:16384
    v_lshrrev_b32 v146, 6, v13
    v_mfma_f32_16x16x32_bf16 a[232:235], v[232:235], v[172:175], a[232:235]
    s_waitcnt lgkmcnt(6)
    ds_write_b128 v4, a[224:227] offset:17408
    v_xor_b32 v145, v145, v146
    v_mfma_f32_16x16x32_bf16 a[44:47], v[236:239], v[160:163], a[44:47]
    ds_read_b64_tr_b16 v[232:233], v193 offset:33024
    v_lshl_add_u32 v144, v145, 2, v144
    v_mfma_f32_16x16x32_bf16 a[108:111], v[236:239], v[164:167], a[108:111]
    ds_read_b64_tr_b16 v[234:235], v193 offset:41216
    v_and_b32 v145, 4, v13
    v_mfma_f32_16x16x32_bf16 a[172:175], v[236:239], v[168:171], a[172:175]
    ds_write_b128 v4, a[164:167] offset:18432
    v_lshlrev_b32 v145, 2, v145
    v_mfma_f32_16x16x32_bf16 a[236:239], v[236:239], v[172:175], a[236:239]
    s_waitcnt lgkmcnt(6)
    ds_write_b128 v4, a[228:231] offset:19456
    v_mfma_f32_16x16x32_bf16 a[48:51], v[224:227], v[160:163], a[48:51]
    ds_read_b64_tr_b16 v[236:237], v194 offset:33024
    v_mov_b32 v146, 16256
    v_mfma_f32_16x16x32_bf16 a[112:115], v[224:227], v[164:167], a[112:115]
    ds_read_b64_tr_b16 v[238:239], v194 offset:41216
    v_lshlrev_b32 v145, v145, v146
    v_mfma_f32_16x16x32_bf16 a[176:179], v[224:227], v[168:171], a[176:179]
    ds_write_b128 v4, a[168:171] offset:20480
    v_cmp_eq_u32 s[26:27], 0, v144
    v_mfma_f32_16x16x32_bf16 a[240:243], v[224:227], v[172:175], a[240:243]
    s_waitcnt lgkmcnt(6)
    ds_write_b128 v4, a[232:235] offset:21504
    v_cmp_eq_u32 s[74:75], 1, v144
    v_mfma_f32_16x16x32_bf16 a[52:55], v[228:231], v[160:163], a[52:55]
    v_cndmask_b32 v188, 0, v145, s[26:27]
    v_cndmask_b32 v189, 0, v145, s[74:75]
    v_mfma_f32_16x16x32_bf16 a[116:119], v[228:231], v[164:167], a[116:119]
    v_cmp_eq_u32 s[26:27], 2, v144
    v_cmp_eq_u32 s[74:75], 3, v144
    v_mfma_f32_16x16x32_bf16 a[180:183], v[228:231], v[168:171], a[180:183]
    ds_write_b128 v4, a[172:175] offset:22528
    v_mfma_f32_16x16x32_bf16 a[244:247], v[228:231], v[172:175], a[244:247]
    s_waitcnt lgkmcnt(4)
    ds_write_b128 v4, a[236:239] offset:23552
    v_cndmask_b32 v190, 0, v145, s[26:27]
    v_mfma_f32_16x16x32_bf16 a[56:59], v[232:235], v[160:163], a[56:59]
    v_cndmask_b32 v191, 0, v145, s[74:75]
    v_cmp_eq_u32 s[26:27], 4, v144
    v_mfma_f32_16x16x32_bf16 a[120:123], v[232:235], v[164:167], a[120:123]
    v_cmp_eq_u32 s[74:75], 5, v144
    v_cndmask_b32 v148, 0, v145, s[26:27]
    v_mfma_f32_16x16x32_bf16 a[184:187], v[232:235], v[168:171], a[184:187]
    ds_write_b128 v4, a[176:179] offset:24576
    v_cndmask_b32 v149, 0, v145, s[74:75]
    v_mfma_f32_16x16x32_bf16 a[248:251], v[232:235], v[172:175], a[248:251]
    s_waitcnt lgkmcnt(3)
    ds_write_b128 v4, a[240:243] offset:25600
    v_cmp_eq_u32 s[26:27], 6, v144
    v_mfma_f32_16x16x32_bf16 a[60:63], v[236:239], v[160:163], a[60:63]
    v_cmp_eq_u32 s[74:75], 7, v144
    v_cndmask_b32 v150, 0, v145, s[26:27]
    v_mfma_f32_16x16x32_bf16 a[124:127], v[236:239], v[164:167], a[124:127]
    v_cndmask_b32 v151, 0, v145, s[74:75]
    v_mfma_f32_16x16x32_bf16 a[188:191], v[236:239], v[168:171], a[188:191]
    ds_write_b128 v4, a[180:183] offset:26624
    v_mfma_f32_16x16x32_bf16 a[252:255], v[236:239], v[172:175], a[252:255]
    s_waitcnt vmcnt(30)
    ds_write_b128 v4, a[244:247] offset:27648
    v_mfma_f32_16x16x32_bf16 a[192:195], v[188:191], v[32:35], 0
    v_mfma_f32_16x16x32_bf16 a[196:199], v[148:151], v[32:35], 0
    v_xor_b32 v18, 32, v7
    v_mfma_f32_16x16x32_bf16 a[200:203], v[188:191], v[36:39], 0
    ds_write_b128 v4, a[184:187] offset:28672
    v_xor_b32 v19, 64, v7
    v_mfma_f32_16x16x32_bf16 a[204:207], v[148:151], v[36:39], 0
    s_waitcnt vmcnt(28)
    ds_write_b128 v4, a[248:251] offset:29696
    v_xor_b32 v20, 96, v7
    v_mfma_f32_16x16x32_bf16 a[192:195], v[188:191], v[40:43], a[192:195]
    v_mfma_f32_16x16x32_bf16 a[196:199], v[148:151], v[40:43], a[196:199]
    v_mfma_f32_16x16x32_bf16 a[200:203], v[188:191], v[48:51], a[200:203]
    ds_write_b128 v4, a[188:191] offset:30720
    v_mfma_f32_16x16x32_bf16 a[204:207], v[148:151], v[48:51], a[204:207]
    s_waitcnt vmcnt(26)
    ds_write_b128 v4, a[252:255] offset:31744
    v_mfma_f32_16x16x32_bf16 a[192:195], v[188:191], v[68:71], a[192:195]
    v_mfma_f32_16x16x32_bf16 a[196:199], v[148:151], v[68:71], a[196:199]
    s_cbranch_vccnz L_mfix
L_mback:
    v_mfma_f32_16x16x32_bf16 a[200:203], v[188:191], v[72:75], a[200:203]
    v_mfma_f32_16x16x32_bf16 a[204:207], v[148:151], v[72:75], a[204:207]
    s_waitcnt vmcnt(24)
    v_mfma_f32_16x16x32_bf16 a[192:195], v[188:191], v[76:79], a[192:195]
    v_mfma_f32_16x16x32_bf16 a[196:199], v[148:151], v[76:79], a[196:199]
    s_waitcnt lgkmcnt(0)
    v_mfma_f32_16x16x32_bf16 a[200:203], v[188:191], v[80:83], a[200:203]
    s_barrier
    v_mfma_f32_16x16x32_bf16 a[204:207], v[148:151], v[80:83], a[204:207]
    s_waitcnt vmcnt(22)
    s_add_u32 m0, s67, 32768
    ds_read_b128 v[32:35], v8 offset:0
    v_mfma_f32_16x16x32_bf16 a[192:195], v[188:191], v[84:87], a[192:195]
    s_mov_b32 s72, 0
    ds_read_b128 v[36:39], v8 offset:2048
    v_mfma_f32_16x16x32_bf16 a[196:199], v[148:151], v[84:87], a[196:199]
    ds_read_b128 v[40:43], v8 offset:1024
    buffer_load_dwordx4 v2, s[56:59], s72 offen offset:0 lds
    v_mfma_f32_16x16x32_bf16 a[200:203], v[188:191], v[88:91], a[200:203]
    ds_read_b128 v[48:51], v8 offset:3072
    v_accvgpr_read_b32 v144, a0
    v_accvgpr_read_b32 v145, a1
    v_mfma_f32_16x16x32_bf16 a[204:207], v[148:151], v[88:91], a[204:207]
    s_waitcnt vmcnt(21)
    s_mov_b32 s73, 6144
    ds_read_b128 v[68:71], v8 offset:4096
    v_accvgpr_read_b32 v146, a2
    v_accvgpr_read_b32 v147, a3
    v_mfma_f32_16x16x32_bf16 a[192:195], v[188:191], v[92:95], a[192:195]
    ds_read_b128 v[72:75], v8 offset:6144
    buffer_load_dwordx4 v2, s[56:59], s73 offen offset:1024 lds
    v_mfma_f32_16x16x32_bf16 a[196:199], v[148:151], v[92:95], a[196:199]
    ds_read_b128 v[76:79], v8 offset:5120
    v_accvgpr_read_b32 v152, a4
    v_mfma_f32_16x16x32_bf16 a[200:203], v[188:191], v[96:99], a[200:203]
    s_mov_b32 s74, 12288
    ds_read_b128 v[80:83], v8 offset:7168
    v_accvgpr_read_b32 v153, a5
    v_accvgpr_read_b32 v154, a6
    v_mfma_f32_16x16x32_bf16 a[204:207], v[148:151], v[96:99], a[204:207]
    s_waitcnt vmcnt(20)
    ds_read_b128 v[84:87], v8 offset:8192
    buffer_load_dwordx4 v2, s[56:59], s74 offen offset:2048 lds
    v_mfma_f32_16x16x32_bf16 a[192:195], v[188:191], v[100:103], a[192:195]
    ds_read_b128 v[88:91], v8 offset:10240
    v_accvgpr_read_b32 v155, a7
    s_waitcnt lgkmcnt(8)
    v_fmac_f32 v144, v180, v32
    v_mfma_f32_16x16x32_bf16 a[196:199], v[148:151], v[100:103], a[196:199]
    s_mov_b32 s75, 18432
    ds_read_b128 v[92:95], v8 offset:9216
    v_fmac_f32 v145, v180, v33
    v_mfma_f32_16x16x32_bf16 a[200:203], v[188:191], v[104:107], a[200:203]
    ds_read_b128 v[96:99], v8 offset:11264
    buffer_load_dwordx4 v2, s[56:59], s75 offen offset:3072 lds
    v_mfma_f32_16x16x32_bf16 a[204:207], v[148:151], v[104:107], a[204:207]
    s_waitcnt vmcnt(20)
    s_add_u32 m0, s67, 49152
    v_fmac_f32 v146, v180, v34
    v_fmac_f32 v147, v180, v35
    v_fmac_f32 v152, v180, v36
    v_mfma_f32_16x16x32_bf16 a[192:195], v[188:191], v[108:111], a[192:195]
    s_mov_b32 s72, 114688
    ds_read_b128 v[100:103], v8 offset:12288
    v_fmac_f32 v153, v180, v37
    v_fmac_f32 v154, v180, v38
    v_mfma_f32_16x16x32_bf16 a[196:199], v[148:151], v[108:111], a[196:199]
    ds_read_b128 v[104:107], v8 offset:14336
    buffer_load_dwordx4 v2, s[56:59], s72 offen offset:0 lds
    v_mfma_f32_16x16x32_bf16 a[200:203], v[188:191], v[112:115], a[200:203]
    v_fmac_f32 v155, v180, v39
    v_cvt_pk_bf16_f32 v32, v144, v145
    v_mfma_f32_16x16x32_bf16 a[204:207], v[148:151], v[112:115], a[204:207]
    s_waitcnt vmcnt(19)
    s_mov_b32 s73, 120832
    v_cvt_pk_bf16_f32 v33, v146, v147
    v_cvt_pk_bf16_f32 v34, v152, v153
    v_cvt_pk_bf16_f32 v35, v154, v155
    v_mfma_f32_16x16x32_bf16 a[192:195], v[188:191], v[116:119], a[192:195]
    ds_read_b128 v[108:111], v8 offset:13312
    buffer_load_dwordx4 v2, s[56:59], s73 offen offset:1024 lds
    v_mfma_f32_16x16x32_bf16 a[196:199], v[148:151], v[116:119], a[196:199]
    ds_read_b128 v[112:115], v8 offset:15360
    v_accvgpr_read_b32 v176, a64
    v_accvgpr_read_b32 v177, a65
    v_mfma_f32_16x16x32_bf16 a[200:203], v[188:191], v[120:123], a[200:203]
    s_mov_b32 s74, 126976
    v_accvgpr_read_b32 v178, a66
    v_accvgpr_read_b32 v179, a67
    v_mfma_f32_16x16x32_bf16 a[204:207], v[148:151], v[120:123], a[204:207]
    s_waitcnt vmcnt(18)
    buffer_load_dwordx4 v2, s[56:59], s74 offen offset:2048 lds
    v_accvgpr_read_b32 v184, a68
    v_mfma_f32_16x16x32_bf16 a[192:195], v[188:191], v[124:127], a[192:195]
    ds_read_b128 v[116:119], v8 offset:16384
    v_accvgpr_read_b32 v185, a69
    v_accvgpr_read_b32 v186, a70
    v_mfma_f32_16x16x32_bf16 a[196:199], v[148:151], v[124:127], a[196:199]
    s_mov_b32 s75, 133120
    ds_read_b128 v[120:123], v8 offset:18432
    v_accvgpr_read_b32 v187, a71
    v_mfma_f32_16x16x32_bf16 a[200:203], v[188:191], v[128:131], a[200:203]
    buffer_load_dwordx4 v2, s[56:59], s75 offen offset:3072 lds
    s_waitcnt lgkmcnt(4)
    v_fmac_f32 v176, v181, v40
    v_mfma_f32_16x16x32_bf16 a[204:207], v[148:151], v[128:131], a[204:207]
    s_waitcnt vmcnt(18)
    v_fmac_f32 v177, v181, v41
    v_fmac_f32 v178, v181, v42
    v_fmac_f32 v179, v181, v43
    v_mfma_f32_16x16x32_bf16 a[192:195], v[188:191], v[132:135], a[192:195]
    ds_read_b128 v[124:127], v8 offset:17408
    v_fmac_f32 v184, v181, v48
    v_mfma_f32_16x16x32_bf16 a[196:199], v[148:151], v[132:135], a[196:199]
    ds_read_b128 v[128:131], v8 offset:19456
    v_fmac_f32 v185, v181, v49
    v_fmac_f32 v186, v181, v50
    v_mfma_f32_16x16x32_bf16 a[200:203], v[188:191], v[136:139], a[200:203]
    v_fmac_f32 v187, v181, v51
    v_cvt_pk_bf16_f32 v40, v176, v177
    v_mfma_f32_16x16x32_bf16 a[204:207], v[148:151], v[136:139], a[204:207]
    s_waitcnt vmcnt(16)
    v_cvt_pk_bf16_f32 v41, v178, v179
    v_cvt_pk_bf16_f32 v42, v184, v185
    v_cvt_pk_bf16_f32 v43, v186, v187
    v_mfma_f32_16x16x32_bf16 a[192:195], v[188:191], v[140:143], a[192:195]
    ds_read_b128 v[132:135], v8 offset:20480
    v_accvgpr_read_b32 v144, a8
    v_accvgpr_read_b32 v145, a9
    v_mfma_f32_16x16x32_bf16 a[196:199], v[148:151], v[140:143], a[196:199]
    ds_read_b128 v[136:139], v8 offset:22528
    v_accvgpr_read_b32 v146, a10
    v_mfma_f32_16x16x32_bf16 a[200:203], v[188:191], v[44:47], a[200:203]
    v_accvgpr_read_b32 v147, a11
    v_accvgpr_read_b32 v152, a12
    v_accvgpr_read_b32 v153, a13
    v_mfma_f32_16x16x32_bf16 a[204:207], v[148:151], v[44:47], a[204:207]
    s_waitcnt vmcnt(14)
    v_accvgpr_read_b32 v154, a14
    v_accvgpr_read_b32 v155, a15
    v_fmac_f32 v144, v180, v68
    v_mfma_f32_16x16x32_bf16 a[192:195], v[188:191], v[212:215], a[192:195]
    ds_read_b128 v[140:143], v8 offset:21504
    v_fmac_f32 v145, v180, v69
    v_mfma_f32_16x16x32_bf16 a[196:199], v[148:151], v[212:215], a[196:199]
    ds_read_b128 v[44:47], v8 offset:23552
    v_fmac_f32 v146, v180, v70
    v_fmac_f32 v147, v180, v71
    v_mfma_f32_16x16x32_bf16 a[200:203], v[188:191], v[220:223], a[200:203]
    v_fmac_f32 v152, v180, v72
    v_fmac_f32 v153, v180, v73
    v_fmac_f32 v154, v180, v74
    v_mfma_f32_16x16x32_bf16 a[204:207], v[148:151], v[220:223], a[204:207]
    s_waitcnt vmcnt(12)
    v_fmac_f32 v155, v180, v75
    v_cvt_pk_bf16_f32 v68, v144, v145
    v_mfma_f32_16x16x32_bf16 a[192:195], v[188:191], v[52:55], a[192:195]
    ds_read_b128 v[212:215], v8 offset:24576
    v_cvt_pk_bf16_f32 v69, v146, v147
    v_cvt_pk_bf16_f32 v70, v152, v153
    v_mfma_f32_16x16x32_bf16 a[196:199], v[148:151], v[52:55], a[196:199]
    ds_read_b128 v[220:223], v8 offset:26624
    v_cvt_pk_bf16_f32 v71, v154, v155
    v_accvgpr_read_b32 v176, a72
    v_mfma_f32_16x16x32_bf16 a[200:203], v[188:191], v[56:59], a[200:203]
    v_accvgpr_read_b32 v177, a73
    v_accvgpr_read_b32 v178, a74
    v_mfma_f32_16x16x32_bf16 a[204:207], v[148:151], v[56:59], a[204:207]
    s_waitcnt vmcnt(10)
    v_accvgpr_read_b32 v179, a75
    v_accvgpr_read_b32 v184, a76
    v_accvgpr_read_b32 v185, a77
    v_mfma_f32_16x16x32_bf16 a[192:195], v[188:191], v[244:247], a[192:195]
    ds_read_b128 v[52:55], v8 offset:25600
    v_accvgpr_read_b32 v186, a78
    v_accvgpr_read_b32 v187, a79
    v_mfma_f32_16x16x32_bf16 a[196:199], v[148:151], v[244:247], a[196:199]
    ds_read_b128 v[56:59], v8 offset:27648
    v_fmac_f32 v176, v181, v76
    v_mfma_f32_16x16x32_bf16 a[200:203], v[188:191], v[252:255], a[200:203]
    v_fmac_f32 v177, v181, v77
    v_fmac_f32 v178, v181, v78
    v_fmac_f32 v179, v181, v79
    v_mfma_f32_16x16x32_bf16 a[204:207], v[148:151], v[252:255], a[204:207]
    s_waitcnt vmcnt(8)
    v_fmac_f32 v184, v181, v80
    v_fmac_f32 v185, v181, v81
    v_fmac_f32 v186, v181, v82
    v_mfma_f32_16x16x32_bf16 a[192:195], v[188:191], v[60:63], a[192:195]
    ds_read_b128 v[244:247], v8 offset:28672
    v_fmac_f32 v187, v181, v83
    v_mfma_f32_16x16x32_bf16 a[196:199], v[148:151], v[60:63], a[196:199]
    ds_read_b128 v[252:255], v8 offset:30720
    v_cvt_pk_bf16_f32 v76, v176, v177
    v_cvt_pk_bf16_f32 v77, v178, v179
    v_mfma_f32_16x16x32_bf16 a[200:203], v[188:191], v[64:67], a[200:203]
    v_cvt_pk_bf16_f32 v78, v184, v185
    v_cvt_pk_bf16_f32 v79, v186, v187
    v_mfma_f32_16x16x32_bf16 a[204:207], v[148:151], v[64:67], a[204:207]
    ds_read_b128 v[60:63], v8 offset:29696
    ds_read_b128 v[64:67], v8 offset:31744
    v_accvgpr_read_b32 v144, a16
    v_accvgpr_read_b32 v145, a17
    v_accvgpr_read_b32 v146, a18
    v_accvgpr_read_b32 v147, a19
    v_accvgpr_read_b32 v152, a20
    v_accvgpr_read_b32 v153, a21
    v_accvgpr_read_b32 v154, a22
    v_accvgpr_read_b32 v155, a23
    v_fmac_f32 v144, v180, v84
    v_fmac_f32 v145, v180, v85
    v_fmac_f32 v146, v180, v86
    v_fmac_f32 v147, v180, v87
    v_fmac_f32 v152, v180, v88
    v_fmac_f32 v153, v180, v89
    v_fmac_f32 v154, v180, v90
    v_fmac_f32 v155, v180, v91
    v_cvt_pk_bf16_f32 v84, v144, v145
    v_cvt_pk_bf16_f32 v85, v146, v147
    v_cvt_pk_bf16_f32 v86, v152, v153
    v_cvt_pk_bf16_f32 v87, v154, v155
    v_accvgpr_read_b32 v176, a80
    v_accvgpr_read_b32 v177, a81
    v_accvgpr_read_b32 v178, a82
    v_accvgpr_read_b32 v179, a83
    v_accvgpr_read_b32 v184, a84
    v_accvgpr_read_b32 v185, a85
    v_accvgpr_read_b32 v186, a86
    v_accvgpr_read_b32 v187, a87
    v_fmac_f32 v176, v181, v92
    v_fmac_f32 v177, v181, v93
    v_fmac_f32 v178, v181, v94
    v_fmac_f32 v179, v181, v95
    v_fmac_f32 v184, v181, v96
    v_fmac_f32 v185, v181, v97
    v_fmac_f32 v186, v181, v98
    v_fmac_f32 v187, v181, v99
    v_cvt_pk_bf16_f32 v92, v176, v177
    v_cvt_pk_bf16_f32 v93, v178, v179
    v_cvt_pk_bf16_f32 v94, v184, v185
    v_cvt_pk_bf16_f32 v95, v186, v187
    s_waitcnt lgkmcnt(0)
    s_waitcnt vmcnt(0)
    s_barrier
    ds_read_b64_tr_b16 a[144:145], v7 offset:32768
    ds_read_b64_tr_b16 a[146:147], v7 offset:34816
    ds_read_b64_tr_b16 a[148:149], v7 offset:36864
    ds_read_b64_tr_b16 a[150:151], v7 offset:38912
    ds_read_b64_tr_b16 a[152:153], v7 offset:40960
    ds_read_b64_tr_b16 a[154:155], v7 offset:43008
    ds_read_b64_tr_b16 a[156:157], v7 offset:45056
    ds_read_b64_tr_b16 a[158:159], v7 offset:47104
    ds_read_b64_tr_b16 a[160:161], v18 offset:32768
    ds_read_b64_tr_b16 a[162:163], v18 offset:34816
    ds_read_b64_tr_b16 a[164:165], v18 offset:36864
    v_accvgpr_read_b32 v144, a24
    v_accvgpr_read_b32 v145, a25
    v_accvgpr_read_b32 v146, a26
    v_accvgpr_read_b32 v147, a27
    v_accvgpr_read_b32 v152, a28
    s_add_u32 m0, s67, 65536
    s_mov_b32 s72, 128
    buffer_load_dwordx4 v2, s[56:59], s72 offen offset:0 lds
    v_accvgpr_read_b32 v153, a29
    v_accvgpr_read_b32 v154, a30
    v_accvgpr_read_b32 v155, a31
    v_fmac_f32 v144, v180, v100
    v_fmac_f32 v145, v180, v101
    s_mov_b32 s73, 6272
    buffer_load_dwordx4 v2, s[56:59], s73 offen offset:1024 lds
    v_fmac_f32 v146, v180, v102
    v_fmac_f32 v147, v180, v103
    v_fmac_f32 v152, v180, v104
    v_fmac_f32 v153, v180, v105
    v_fmac_f32 v154, v180, v106
    s_mov_b32 s74, 12416
    buffer_load_dwordx4 v2, s[56:59], s74 offen offset:2048 lds
    v_fmac_f32 v155, v180, v107
    v_cvt_pk_bf16_f32 v100, v144, v145
    v_cvt_pk_bf16_f32 v101, v146, v147
    v_cvt_pk_bf16_f32 v102, v152, v153
    v_cvt_pk_bf16_f32 v103, v154, v155
    s_mov_b32 s75, 18560
    buffer_load_dwordx4 v2, s[56:59], s75 offen offset:3072 lds
    v_accvgpr_read_b32 v176, a88
    v_accvgpr_read_b32 v177, a89
    v_accvgpr_read_b32 v178, a90
    v_accvgpr_read_b32 v179, a91
    v_accvgpr_read_b32 v184, a92
    s_add_u32 m0, s67, 81920
    s_mov_b32 s72, 114816
    buffer_load_dwordx4 v2, s[56:59], s72 offen offset:0 lds
    v_accvgpr_read_b32 v185, a93
    v_accvgpr_read_b32 v186, a94
    v_accvgpr_read_b32 v187, a95
    v_fmac_f32 v176, v181, v108
    v_fmac_f32 v177, v181, v109
    s_mov_b32 s73, 120960
    buffer_load_dwordx4 v2, s[56:59], s73 offen offset:1024 lds
    v_fmac_f32 v178, v181, v110
    v_fmac_f32 v179, v181, v111
    v_fmac_f32 v184, v181, v112
    v_fmac_f32 v185, v181, v113
    v_fmac_f32 v186, v181, v114
    s_mov_b32 s74, 127104
    buffer_load_dwordx4 v2, s[56:59], s74 offen offset:2048 lds
    v_fmac_f32 v187, v181, v115
    v_cvt_pk_bf16_f32 v108, v176, v177
    v_cvt_pk_bf16_f32 v109, v178, v179
    v_cvt_pk_bf16_f32 v110, v184, v185
    v_cvt_pk_bf16_f32 v111, v186, v187
    s_mov_b32 s75, 133248
    buffer_load_dwordx4 v2, s[56:59], s75 offen offset:3072 lds
    s_waitcnt lgkmcnt(9)
    v_mfma_f32_16x16x32_bf16 v[160:163], a[144:147], v[32:35], 0
    ds_read_b64_tr_b16 a[166:167], v18 offset:38912
    v_accvgpr_read_b32 v144, a32
    v_accvgpr_read_b32 v145, a33
    v_accvgpr_read_b32 v146, a34
    v_accvgpr_read_b32 v147, a35
    v_accvgpr_read_b32 v152, a36
    v_accvgpr_read_b32 v153, a37
    v_mfma_f32_16x16x32_bf16 v[164:167], a[144:147], v[40:43], 0
    s_waitcnt lgkmcnt(8)
    s_add_u32 m0, s67, 98304
    ds_read_b64_tr_b16 a[168:169], v18 offset:40960
    v_accvgpr_read_b32 v154, a38
    v_accvgpr_read_b32 v155, a39
    v_fmac_f32 v144, v180, v116
    v_fmac_f32 v145, v180, v117
    v_fmac_f32 v146, v180, v118
    v_fmac_f32 v147, v180, v119
    v_mfma_f32_16x16x32_bf16 v[160:163], a[148:151], v[68:71], v[160:163]
    s_mov_b32 s72, 256
    ds_read_b64_tr_b16 a[170:171], v18 offset:43008
    v_fmac_f32 v152, v180, v120
    v_fmac_f32 v153, v180, v121
    v_fmac_f32 v154, v180, v122
    v_fmac_f32 v155, v180, v123
    v_cvt_pk_bf16_f32 v116, v144, v145
    v_cvt_pk_bf16_f32 v117, v146, v147
    v_mfma_f32_16x16x32_bf16 v[164:167], a[148:151], v[76:79], v[164:167]
    s_waitcnt lgkmcnt(8)
    ds_read_b64_tr_b16 a[172:173], v18 offset:45056
    buffer_load_dwordx4 v2, s[56:59], s72 offen offset:0 lds
    v_cvt_pk_bf16_f32 v118, v152, v153
    v_cvt_pk_bf16_f32 v119, v154, v155
    v_accvgpr_read_b32 v176, a96
    v_accvgpr_read_b32 v177, a97
    v_mfma_f32_16x16x32_bf16 v[160:163], a[152:155], v[84:87], v[160:163]
    s_mov_b32 s73, 6400
    ds_read_b64_tr_b16 a[174:175], v18 offset:47104
    v_accvgpr_read_b32 v178, a98
    v_accvgpr_read_b32 v179, a99
    v_accvgpr_read_b32 v184, a100
    v_accvgpr_read_b32 v185, a101
    v_accvgpr_read_b32 v186, a102
    v_accvgpr_read_b32 v187, a103
    v_mfma_f32_16x16x32_bf16 v[164:167], a[152:155], v[92:95], v[164:167]
    s_waitcnt lgkmcnt(8)
    ds_read_b64_tr_b16 a[176:177], v19 offset:32768
    buffer_load_dwordx4 v2, s[56:59], s73 offen offset:1024 lds
    v_fmac_f32 v176, v181, v124
    v_fmac_f32 v177, v181, v125
    v_fmac_f32 v178, v181, v126
    v_fmac_f32 v179, v181, v127
    v_mfma_f32_16x16x32_bf16 v[160:163], a[156:159], v[100:103], v[160:163]
    s_mov_b32 s74, 12544
    ds_read_b64_tr_b16 a[178:179], v19 offset:34816
    v_fmac_f32 v184, v181, v128
    v_fmac_f32 v185, v181, v129
    v_fmac_f32 v186, v181, v130
    v_fmac_f32 v187, v181, v131
    v_cvt_pk_bf16_f32 v124, v176, v177
    v_cvt_pk_bf16_f32 v125, v178, v179
    v_mfma_f32_16x16x32_bf16 v[164:167], a[156:159], v[108:111], v[164:167]
    s_waitcnt lgkmcnt(6)
    ds_read_b64_tr_b16 a[180:181], v19 offset:36864
    buffer_load_dwordx4 v2, s[56:59], s74 offen offset:2048 lds
    v_cvt_pk_bf16_f32 v126, v184, v185
    v_cvt_pk_bf16_f32 v127, v186, v187
    v_accvgpr_read_b32 v144, a40
    v_accvgpr_read_b32 v145, a41
    v_mfma_f32_16x16x32_bf16 v[168:171], a[160:163], v[32:35], 0
    s_mov_b32 s75, 18688
    ds_read_b64_tr_b16 a[182:183], v19 offset:38912
    v_accvgpr_read_b32 v146, a42
    v_accvgpr_read_b32 v147, a43
    v_accvgpr_read_b32 v152, a44
    v_accvgpr_read_b32 v153, a45
    v_accvgpr_read_b32 v154, a46
    v_accvgpr_read_b32 v155, a47
    v_mfma_f32_16x16x32_bf16 v[172:175], a[160:163], v[40:43], 0
    ds_read_b64_tr_b16 a[184:185], v19 offset:40960
    buffer_load_dwordx4 v2, s[56:59], s75 offen offset:3072 lds
    v_fmac_f32 v144, v180, v132
    v_fmac_f32 v145, v180, v133
    v_fmac_f32 v146, v180, v134
    v_fmac_f32 v147, v180, v135
    v_mfma_f32_16x16x32_bf16 v[168:171], a[164:167], v[68:71], v[168:171]
    s_waitcnt lgkmcnt(6)
    ds_read_b64_tr_b16 a[186:187], v19 offset:43008
    v_fmac_f32 v152, v180, v136
    v_fmac_f32 v153, v180, v137
    v_fmac_f32 v154, v180, v138
    v_fmac_f32 v155, v180, v139
    v_cvt_pk_bf16_f32 v132, v144, v145
    v_cvt_pk_bf16_f32 v133, v146, v147
    v_mfma_f32_16x16x32_bf16 v[172:175], a[164:167], v[76:79], v[172:175]
    s_add_u32 m0, s67, 114688
    ds_read_b64_tr_b16 a[188:189], v19 offset:45056
    v_cvt_pk_bf16_f32 v134, v152, v153
    v_cvt_pk_bf16_f32 v135, v154, v155
    v_accvgpr_read_b32 v176, a104
    v_accvgpr_read_b32 v177, a105
    v_accvgpr_read_b32 v178, a106
    v_accvgpr_read_b32 v179, a107
    v_mfma_f32_16x16x32_bf16 v[168:171], a[168:171], v[84:87], v[168:171]
    s_mov_b32 s72, 114944
    ds_read_b64_tr_b16 a[190:191], v19 offset:47104
    v_accvgpr_read_b32 v184, a108
    v_accvgpr_read_b32 v185, a109
    v_accvgpr_read_b32 v186, a110
    v_accvgpr_read_b32 v187, a111
    v_fmac_f32 v176, v181, v140
    v_fmac_f32 v177, v181, v141
    v_mfma_f32_16x16x32_bf16 v[172:175], a[168:171], v[92:95], v[172:175]
    s_waitcnt lgkmcnt(6)
    ds_read_b64_tr_b16 a[128:129], v20 offset:32768
    buffer_load_dwordx4 v2, s[56:59], s72 offen offset:0 lds
    v_fmac_f32 v178, v181, v142
    v_fmac_f32 v179, v181, v143
    v_fmac_f32 v184, v181, v44
    v_fmac_f32 v185, v181, v45
    v_mfma_f32_16x16x32_bf16 v[168:171], a[172:175], v[100:103], v[168:171]
    s_mov_b32 s73, 121088
    ds_read_b64_tr_b16 a[130:131], v20 offset:34816
    v_fmac_f32 v186, v181, v46
    v_fmac_f32 v187, v181, v47
    v_cvt_pk_bf16_f32 v140, v176, v177
    v_cvt_pk_bf16_f32 v141, v178, v179
    v_cvt_pk_bf16_f32 v142, v184, v185
    v_cvt_pk_bf16_f32 v143, v186, v187
    v_mfma_f32_16x16x32_bf16 v[172:175], a[172:175], v[108:111], v[172:175]
    ds_read_b64_tr_b16 a[132:133], v20 offset:36864
    buffer_load_dwordx4 v2, s[56:59], s73 offen offset:1024 lds
    v_accvgpr_read_b32 v144, a48
    v_accvgpr_read_b32 v145, a49
    v_accvgpr_read_b32 v146, a50
    v_mfma_f32_16x16x32_bf16 v[224:227], a[176:179], v[32:35], 0
    s_mov_b32 s74, 127232
    ds_read_b64_tr_b16 a[134:135], v20 offset:38912
    v_accvgpr_read_b32 v147, a51
    v_accvgpr_read_b32 v152, a52
    v_accvgpr_read_b32 v153, a53
    v_accvgpr_read_b32 v154, a54
    v_accvgpr_read_b32 v155, a55
    v_fmac_f32 v144, v180, v212
    v_mfma_f32_16x16x32_bf16 v[228:231], a[176:179], v[40:43], 0
    s_waitcnt lgkmcnt(6)
    ds_read_b64_tr_b16 a[136:137], v20 offset:40960
    buffer_load_dwordx4 v2, s[56:59], s74 offen offset:2048 lds
    v_fmac_f32 v145, v180, v213
    v_fmac_f32 v146, v180, v214
    v_fmac_f32 v147, v180, v215
    v_fmac_f32 v152, v180, v220
    v_mfma_f32_16x16x32_bf16 v[224:227], a[180:183], v[68:71], v[224:227]
    s_mov_b32 s75, 133376
    ds_read_b64_tr_b16 a[138:139], v20 offset:43008
    v_fmac_f32 v153, v180, v221
    v_fmac_f32 v154, v180, v222
    v_fmac_f32 v155, v180, v223
    v_cvt_pk_bf16_f32 v212, v144, v145
    v_cvt_pk_bf16_f32 v213, v146, v147
    v_cvt_pk_bf16_f32 v214, v152, v153
    v_mfma_f32_16x16x32_bf16 v[228:231], a[180:183], v[76:79], v[228:231]
    ds_read_b64_tr_b16 a[140:141], v20 offset:45056
    buffer_load_dwordx4 v2, s[56:59], s75 offen offset:3072 lds
    v_cvt_pk_bf16_f32 v215, v154, v155
    v_accvgpr_read_b32 v176, a112
    v_accvgpr_read_b32 v177, a113
    v_accvgpr_read_b32 v178, a114
    v_mfma_f32_16x16x32_bf16 v[224:227], a[184:187], v[84:87], v[224:227]
    s_waitcnt lgkmcnt(6)
    ds_read_b64_tr_b16 a[142:143], v20 offset:47104
    v_accvgpr_read_b32 v179, a115
    v_accvgpr_read_b32 v184, a116
    v_accvgpr_read_b32 v185, a117
    v_accvgpr_read_b32 v186, a118
    v_accvgpr_read_b32 v187, a119
    v_fmac_f32 v176, v181, v52
    v_mfma_f32_16x16x32_bf16 v[228:231], a[184:187], v[92:95], v[228:231]
    s_add_u32 m0, s67, 0
    ds_read_b64_tr_b16 a[144:145], v7 offset:49152
    v_fmac_f32 v177, v181, v53
    v_fmac_f32 v178, v181, v54
    v_fmac_f32 v179, v181, v55
    v_fmac_f32 v184, v181, v56
    v_fmac_f32 v185, v181, v57
    v_fmac_f32 v186, v181, v58
    v_mfma_f32_16x16x32_bf16 v[224:227], a[188:191], v[100:103], v[224:227]
    s_mov_b32 s72, 384
    ds_read_b64_tr_b16 a[146:147], v7 offset:51200
    v_fmac_f32 v187, v181, v59
    v_cvt_pk_bf16_f32 v52, v176, v177
    v_cvt_pk_bf16_f32 v53, v178, v179
    v_cvt_pk_bf16_f32 v54, v184, v185
    v_cvt_pk_bf16_f32 v55, v186, v187
    v_accvgpr_read_b32 v144, a56
    v_mfma_f32_16x16x32_bf16 v[228:231], a[188:191], v[108:111], v[228:231]
    s_waitcnt lgkmcnt(6)
    ds_read_b64_tr_b16 a[148:149], v7 offset:53248
    buffer_load_dwordx4 v2, s[56:59], s72 offen offset:0 lds
    v_accvgpr_read_b32 v145, a57
    v_accvgpr_read_b32 v146, a58
    v_accvgpr_read_b32 v147, a59
    v_accvgpr_read_b32 v152, a60
    v_mfma_f32_16x16x32_bf16 v[232:235], a[128:131], v[32:35], 0
    s_mov_b32 s73, 6528
    ds_read_b64_tr_b16 a[150:151], v7 offset:55296
    v_accvgpr_read_b32 v153, a61
    v_accvgpr_read_b32 v154, a62
    v_accvgpr_read_b32 v155, a63
    v_fmac_f32 v144, v180, v244
    v_fmac_f32 v145, v180, v245
    v_fmac_f32 v146, v180, v246
    v_mfma_f32_16x16x32_bf16 v[236:239], a[128:131], v[40:43], 0
    ds_read_b64_tr_b16 a[152:153], v7 offset:57344
    buffer_load_dwordx4 v2, s[56:59], s73 offen offset:1024 lds
    v_fmac_f32 v147, v180, v247
    v_fmac_f32 v152, v180, v252
    v_fmac_f32 v153, v180, v253
    v_fmac_f32 v154, v180, v254
    v_mfma_f32_16x16x32_bf16 v[232:235], a[132:135], v[68:71], v[232:235]
    s_mov_b32 s74, 12672
    ds_read_b64_tr_b16 a[154:155], v7 offset:59392
    v_fmac_f32 v155, v180, v255
    v_cvt_pk_bf16_f32 v244, v144, v145
    v_cvt_pk_bf16_f32 v245, v146, v147
    v_cvt_pk_bf16_f32 v246, v152, v153
    v_cvt_pk_bf16_f32 v247, v154, v155
    v_accvgpr_read_b32 v176, a120
    v_mfma_f32_16x16x32_bf16 v[236:239], a[132:135], v[76:79], v[236:239]
    s_waitcnt lgkmcnt(6)
    ds_read_b64_tr_b16 a[156:157], v7 offset:61440
    buffer_load_dwordx4 v2, s[56:59], s74 offen offset:2048 lds
    v_accvgpr_read_b32 v177, a121
    v_accvgpr_read_b32 v178, a122
    v_accvgpr_read_b32 v179, a123
    v_accvgpr_read_b32 v184, a124
    v_mfma_f32_16x16x32_bf16 v[232:235], a[136:139], v[84:87], v[232:235]
    s_mov_b32 s75, 18816
    ds_read_b64_tr_b16 a[158:159], v7 offset:63488
    v_accvgpr_read_b32 v185, a125
    v_accvgpr_read_b32 v186, a126
    v_accvgpr_read_b32 v187, a127
    v_fmac_f32 v176, v181, v60
    v_fmac_f32 v177, v181, v61
    v_fmac_f32 v178, v181, v62
    v_mfma_f32_16x16x32_bf16 v[236:239], a[136:139], v[92:95], v[236:239]
    ds_read_b64_tr_b16 a[160:161], v18 offset:49152
    buffer_load_dwordx4 v2, s[56:59], s75 offen offset:3072 lds
    v_fmac_f32 v179, v181, v63
    v_fmac_f32 v184, v181, v64
    v_fmac_f32 v185, v181, v65
    v_fmac_f32 v186, v181, v66
    v_mfma_f32_16x16x32_bf16 v[232:235], a[140:143], v[100:103], v[232:235]
    s_waitcnt lgkmcnt(6)
    ds_read_b64_tr_b16 a[162:163], v18 offset:51200
    v_fmac_f32 v187, v181, v67
    v_cvt_pk_bf16_f32 v60, v176, v177
    v_cvt_pk_bf16_f32 v61, v178, v179
    v_cvt_pk_bf16_f32 v62, v184, v185
    v_cvt_pk_bf16_f32 v63, v186, v187
    v_mfma_f32_16x16x32_bf16 v[236:239], a[140:143], v[108:111], v[236:239]
    s_add_u32 m0, s67, 16384
    ds_read_b64_tr_b16 a[164:165], v18 offset:53248
    v_mfma_f32_16x16x32_bf16 v[160:163], a[144:147], v[116:119], v[160:163]
    s_mov_b32 s72, 115072
    ds_read_b64_tr_b16 a[166:167], v18 offset:55296
    v_fma_f32 v26, v180, v158, v24
    v_mov_b32 v27, v26
    v_mfma_f32_16x16x32_bf16 v[164:167], a[144:147], v[124:127], v[164:167]
    s_waitcnt lgkmcnt(6)
    ds_read_b64_tr_b16 a[168:169], v18 offset:57344
    buffer_load_dwordx4 v2, s[56:59], s72 offen offset:0 lds
    v_mfma_f32_16x16x32_bf16 v[160:163], a[148:151], v[132:135], v[160:163]
    s_mov_b32 s73, 121216
    ds_read_b64_tr_b16 a[170:171], v18 offset:59392
    v_permlane32_swap_b32 v26, v27
    v_add_f32 v26, v26, v27
    v_mfma_f32_16x16x32_bf16 v[164:167], a[148:151], v[140:143], v[164:167]
    ds_read_b64_tr_b16 a[172:173], v18 offset:61440
    buffer_load_dwordx4 v2, s[56:59], s73 offen offset:1024 lds
    v_mfma_f32_16x16x32_bf16 v[160:163], a[152:155], v[212:215], v[160:163]
    s_mov_b32 s74, 127360
    ds_read_b64_tr_b16 a[174:175], v18 offset:63488
    v_mov_b32 v27, v26
    s_nop 1
    v_permlane16_swap_b32 v26, v27
    v_mfma_f32_16x16x32_bf16 v[164:167], a[152:155], v[52:55], v[164:167]
    s_waitcnt lgkmcnt(6)
    ds_read_b64_tr_b16 a[176:177], v19 offset:49152
    buffer_load_dwordx4 v2, s[56:59], s74 offen offset:2048 lds
    v_mfma_f32_16x16x32_bf16 v[160:163], a[156:159], v[244:247], v[160:163]
    s_mov_b32 s75, 133504
    ds_read_b64_tr_b16 a[178:179], v19 offset:51200
    v_add_f32 v26, v26, v27
    v_rcp_f32 v16, v26
    v_mfma_f32_16x16x32_bf16 v[164:167], a[156:159], v[60:63], v[164:167]
    ds_read_b64_tr_b16 a[180:181], v19 offset:53248
    buffer_load_dwordx4 v2, s[56:59], s75 offen offset:3072 lds
    v_mfma_f32_16x16x32_bf16 v[168:171], a[160:163], v[116:119], v[168:171]
    s_waitcnt lgkmcnt(6)
    ds_read_b64_tr_b16 a[182:183], v19 offset:55296
    v_fma_f32 v28, v181, v159, v25
    v_mfma_f32_16x16x32_bf16 v[172:175], a[160:163], v[124:127], v[172:175]
    s_add_u32 m0, s67, 131072
    ds_read_b64_tr_b16 a[184:185], v19 offset:57344
    v_mov_b32 v29, v28
    s_nop 1
    v_permlane32_swap_b32 v28, v29
    v_mfma_f32_16x16x32_bf16 v[168:171], a[164:167], v[132:135], v[168:171]
    s_mov_b32 s72, 512
    ds_read_b64_tr_b16 a[186:187], v19 offset:59392
    v_add_f32 v28, v28, v29
    v_mov_b32 v29, v28
    v_mfma_f32_16x16x32_bf16 v[172:175], a[164:167], v[140:143], v[172:175]
    s_waitcnt lgkmcnt(6)
    s_waitcnt vmcnt(20)
    ds_read_b64_tr_b16 a[188:189], v19 offset:61440
    buffer_load_dwordx4 v2, s[56:59], s72 offen offset:0 lds
    v_mfma_f32_16x16x32_bf16 v[168:171], a[168:171], v[212:215], v[168:171]
    s_mov_b32 s73, 6656
    s_barrier
    ds_read_b64_tr_b16 a[190:191], v19 offset:63488
    v_permlane16_swap_b32 v28, v29
    v_add_f32 v28, v28, v29
    v_mfma_f32_16x16x32_bf16 v[172:175], a[168:171], v[52:55], v[172:175]
    ds_read_b64_tr_b16 a[128:129], v20 offset:49152
    buffer_load_dwordx4 v2, s[56:59], s73 offen offset:1024 lds
    v_mfma_f32_16x16x32_bf16 v[168:171], a[172:175], v[244:247], v[168:171]
    s_mov_b32 s74, 12800
    ds_read_b64_tr_b16 a[130:131], v20 offset:51200
    v_rcp_f32 v17, v28
    v_mfma_f32_16x16x32_bf16 v[172:175], a[172:175], v[60:63], v[172:175]
    s_waitcnt lgkmcnt(6)
    ds_read_b64_tr_b16 a[132:133], v20 offset:53248
    buffer_load_dwordx4 v2, s[56:59], s74 offen offset:2048 lds
    v_mfma_f32_16x16x32_bf16 v[224:227], a[176:179], v[116:119], v[224:227]
    s_mov_b32 s75, 18944
    ds_read_b64_tr_b16 a[134:135], v20 offset:55296
    v_mfma_f32_16x16x32_bf16 v[228:231], a[176:179], v[124:127], v[228:231]
    ds_read_b64_tr_b16 a[136:137], v20 offset:57344
    buffer_load_dwordx4 v2, s[56:59], s75 offen offset:3072 lds
    v_mfma_f32_16x16x32_bf16 v[224:227], a[180:183], v[132:135], v[224:227]
    s_waitcnt lgkmcnt(6)
    ds_read_b64_tr_b16 a[138:139], v20 offset:59392
    v_mfma_f32_16x16x32_bf16 v[228:231], a[180:183], v[140:143], v[228:231]
    s_add_u32 m0, s67, 147456
    ds_read_b64_tr_b16 a[140:141], v20 offset:61440
    v_mul_f32 v160, v16, v160
    v_mfma_f32_16x16x32_bf16 v[224:227], a[184:187], v[212:215], v[224:227]
    s_mov_b32 s72, 115200
    ds_read_b64_tr_b16 a[142:143], v20 offset:63488
    v_mul_f32 v161, v16, v161
    v_xor_b32 v7, 65536, v7
    v_mfma_f32_16x16x32_bf16 v[228:231], a[184:187], v[52:55], v[228:231]
    s_waitcnt lgkmcnt(6)
    ds_read_b64_tr_b16 a[144:145], v7 offset:0
    buffer_load_dwordx4 v2, s[56:59], s72 offen offset:0 lds
    v_mfma_f32_16x16x32_bf16 v[224:227], a[188:191], v[244:247], v[224:227]
    s_mov_b32 s73, 121344
    ds_read_b64_tr_b16 a[146:147], v7 offset:2048
    v_mul_f32 v162, v16, v162
    v_mfma_f32_16x16x32_bf16 v[228:231], a[188:191], v[60:63], v[228:231]
    ds_read_b64_tr_b16 a[148:149], v7 offset:4096
    buffer_load_dwordx4 v2, s[56:59], s73 offen offset:1024 lds
    v_mfma_f32_16x16x32_bf16 v[232:235], a[128:131], v[116:119], v[232:235]
    s_mov_b32 s74, 127488
    ds_read_b64_tr_b16 a[150:151], v7 offset:6144
    v_mul_f32 v163, v16, v163
    v_mfma_f32_16x16x32_bf16 v[236:239], a[128:131], v[124:127], v[236:239]
    s_waitcnt lgkmcnt(6)
    ds_read_b64_tr_b16 a[152:153], v7 offset:8192
    buffer_load_dwordx4 v2, s[56:59], s74 offen offset:2048 lds
    v_mfma_f32_16x16x32_bf16 v[232:235], a[132:135], v[132:135], v[232:235]
    s_mov_b32 s75, 133632
    ds_read_b64_tr_b16 a[154:155], v7 offset:10240
    v_mul_f32 v168, v16, v168
    v_mfma_f32_16x16x32_bf16 v[236:239], a[132:135], v[140:143], v[236:239]
    ds_read_b64_tr_b16 a[156:157], v7 offset:12288
    buffer_load_dwordx4 v2, s[56:59], s75 offen offset:3072 lds
    v_mfma_f32_16x16x32_bf16 v[232:235], a[136:139], v[212:215], v[232:235]
    ds_read_b64_tr_b16 a[158:159], v7 offset:14336
    v_mul_f32 v169, v16, v169
    v_xor_b32 v18, 65536, v18
    v_mfma_f32_16x16x32_bf16 v[236:239], a[136:139], v[52:55], v[236:239]
    s_waitcnt lgkmcnt(6)
    ds_read_b64_tr_b16 a[160:161], v18 offset:0
    v_mul_f32 v170, v16, v170
    v_mfma_f32_16x16x32_bf16 v[232:235], a[140:143], v[244:247], v[232:235]
    ds_read_b64_tr_b16 a[162:163], v18 offset:2048
    v_mul_f32 v171, v16, v171
    v_mfma_f32_16x16x32_bf16 v[236:239], a[140:143], v[60:63], v[236:239]
    ds_read_b64_tr_b16 a[164:165], v18 offset:4096
    v_cvt_pk_bf16_f32 v160, v160, v161
    v_mfma_f32_16x16x32_bf16 v[208:211], a[144:147], v[32:35], 0
    ds_read_b64_tr_b16 a[166:167], v18 offset:6144
    v_cvt_pk_bf16_f32 v161, v162, v163
    v_add_u32 v11, s92, v3
    v_mfma_f32_16x16x32_bf16 v[216:219], a[144:147], v[40:43], 0
    s_waitcnt lgkmcnt(6)
    ds_read_b64_tr_b16 a[168:169], v18 offset:8192
    v_cvt_pk_bf16_f32 v162, v168, v169
    v_mfma_f32_16x16x32_bf16 v[208:211], a[148:151], v[68:71], v[208:211]
    s_waitcnt vmcnt(20)
    ds_read_b64_tr_b16 a[170:171], v18 offset:10240
    v_cvt_pk_bf16_f32 v163, v170, v171
    v_mfma_f32_16x16x32_bf16 v[216:219], a[148:151], v[76:79], v[216:219]
    s_mov_b32 s89, 0
    s_barrier
    ds_read_b64_tr_b16 a[172:173], v18 offset:12288
    v_add_u32 v12, 16384, v11
    v_mfma_f32_16x16x32_bf16 v[208:211], a[152:155], v[84:87], v[208:211]
    s_add_u32 m0, s67, 32768
    ds_read_b64_tr_b16 a[174:175], v18 offset:14336
    buffer_store_dwordx4 v[160:163], v3, s[60:63], s89 offen offset:0 sc1
    v_xor_b32 v19, 65536, v19
    v_mfma_f32_16x16x32_bf16 v[216:219], a[152:155], v[92:95], v[216:219]
    s_waitcnt lgkmcnt(6)
    s_mov_b32 s72, 640
    ds_read_b64_tr_b16 a[176:177], v19 offset:0
    v_mul_f32 v164, v17, v164
    v_mfma_f32_16x16x32_bf16 v[208:211], a[156:159], v[100:103], v[208:211]
    ds_read_b64_tr_b16 a[178:179], v19 offset:2048
    buffer_load_dwordx4 v2, s[56:59], s72 offen offset:0 lds
    v_mul_f32 v165, v17, v165
    v_mfma_f32_16x16x32_bf16 v[216:219], a[156:159], v[108:111], v[216:219]
    ds_read_b64_tr_b16 a[180:181], v19 offset:4096
    v_mul_f32 v166, v17, v166
    v_mfma_f32_16x16x32_bf16 v[240:243], a[160:163], v[32:35], 0
    ds_read_b64_tr_b16 a[182:183], v19 offset:6144
    v_mul_f32 v167, v17, v167
    v_mfma_f32_16x16x32_bf16 v[248:251], a[160:163], v[40:43], 0
    s_waitcnt lgkmcnt(6)
    ds_read_b64_tr_b16 a[184:185], v19 offset:8192
    v_mul_f32 v172, v17, v172
    v_mfma_f32_16x16x32_bf16 v[240:243], a[164:167], v[68:71], v[240:243]
    ds_read_b64_tr_b16 a[186:187], v19 offset:10240
    v_mul_f32 v173, v17, v173
    v_mfma_f32_16x16x32_bf16 v[248:251], a[164:167], v[76:79], v[248:251]
    s_mov_b32 s73, 6784
    ds_read_b64_tr_b16 a[188:189], v19 offset:12288
    v_mul_f32 v174, v17, v174
    v_mfma_f32_16x16x32_bf16 v[240:243], a[168:171], v[84:87], v[240:243]
    ds_read_b64_tr_b16 a[190:191], v19 offset:14336
    buffer_load_dwordx4 v2, s[56:59], s73 offen offset:1024 lds
    v_mul_f32 v175, v17, v175
    v_xor_b32 v20, 65536, v20
    v_mfma_f32_16x16x32_bf16 v[248:251], a[168:171], v[92:95], v[248:251]
    s_waitcnt lgkmcnt(6)
    ds_read_b64_tr_b16 a[128:129], v20 offset:0
    v_cvt_pk_bf16_f32 v164, v164, v165
    v_mfma_f32_16x16x32_bf16 v[240:243], a[172:175], v[100:103], v[240:243]
    ds_read_b64_tr_b16 a[130:131], v20 offset:2048
    v_cvt_pk_bf16_f32 v165, v166, v167
    v_mfma_f32_16x16x32_bf16 v[248:251], a[172:175], v[108:111], v[248:251]
    ds_read_b64_tr_b16 a[132:133], v20 offset:4096
    v_cvt_pk_bf16_f32 v166, v172, v173
    v_mfma_f32_16x16x32_bf16 v[144:147], a[176:179], v[32:35], 0
    s_waitcnt lgkmcnt(6)
    ds_read_b64_tr_b16 a[134:135], v20 offset:6144
    v_cvt_pk_bf16_f32 v167, v174, v175
    v_mfma_f32_16x16x32_bf16 v[152:155], a[176:179], v[40:43], 0
    s_mov_b32 s74, 12928
    ds_read_b64_tr_b16 a[136:137], v20 offset:8192
    v_add_u32 v12, s97, v12
    v_mfma_f32_16x16x32_bf16 v[144:147], a[180:183], v[68:71], v[144:147]
    ds_read_b64_tr_b16 a[138:139], v20 offset:10240
    buffer_store_dwordx4 v[164:167], v3, s[60:63], s89 offen offset:2048 sc1
    buffer_load_dwordx4 v2, s[56:59], s74 offen offset:2048 lds
    v_mfma_f32_16x16x32_bf16 v[152:155], a[180:183], v[76:79], v[152:155]
    s_waitcnt lgkmcnt(6)
    ds_read_b64_tr_b16 a[140:141], v20 offset:12288
    v_mul_f32 v224, v16, v224
    v_mfma_f32_16x16x32_bf16 v[144:147], a[184:187], v[84:87], v[144:147]
    ds_read_b64_tr_b16 a[142:143], v20 offset:14336
    v_mul_f32 v225, v16, v225
    v_mfma_f32_16x16x32_bf16 v[152:155], a[184:187], v[92:95], v[152:155]
    ds_read_b64_tr_b16 a[144:145], v7 offset:16384
    v_mul_f32 v226, v16, v226
    v_min_u32 v14, 60, v13
    v_mfma_f32_16x16x32_bf16 v[144:147], a[188:191], v[100:103], v[144:147]
    s_waitcnt lgkmcnt(6)
    ds_read_b64_tr_b16 a[146:147], v7 offset:18432
    v_mul_f32 v227, v16, v227
    v_mfma_f32_16x16x32_bf16 v[152:155], a[188:191], v[108:111], v[152:155]
    s_mov_b32 s75, 19072
    ds_read_b64_tr_b16 a[148:149], v7 offset:20480
    v_mul_f32 v232, v16, v232
    v_mfma_f32_16x16x32_bf16 v[176:179], a[128:131], v[32:35], 0
    ds_read_b64_tr_b16 a[150:151], v7 offset:22528
    buffer_load_dwordx4 v2, s[56:59], s75 offen offset:3072 lds
    v_mul_f32 v233, v16, v233
    v_mfma_f32_16x16x32_bf16 v[184:187], a[128:131], v[40:43], 0
    s_waitcnt lgkmcnt(6)
    ds_read_b64_tr_b16 a[152:153], v7 offset:24576
    v_mul_f32 v234, v16, v234
    v_mfma_f32_16x16x32_bf16 v[176:179], a[132:135], v[68:71], v[176:179]
    ds_read_b64_tr_b16 a[154:155], v7 offset:26624
    v_mul_f32 v235, v16, v235
    v_mfma_f32_16x16x32_bf16 v[184:187], a[132:135], v[76:79], v[184:187]
    s_waitcnt lgkmcnt(6)
    ds_read_b64_tr_b16 a[156:157], v7 offset:28672
    v_cvt_pk_bf16_f32 v224, v224, v225
    v_mfma_f32_16x16x32_bf16 v[176:179], a[136:139], v[84:87], v[176:179]
    s_add_u32 m0, s67, 49152
    ds_read_b64_tr_b16 a[158:159], v7 offset:30720
    v_cvt_pk_bf16_f32 v225, v226, v227
    v_mfma_f32_16x16x32_bf16 v[184:187], a[136:139], v[92:95], v[184:187]
    s_mov_b32 s72, 115328
    ds_read_b64_tr_b16 a[160:161], v18 offset:16384
    v_cvt_pk_bf16_f32 v226, v232, v233
    v_mfma_f32_16x16x32_bf16 v[176:179], a[140:143], v[100:103], v[176:179]
    s_waitcnt lgkmcnt(6)
    ds_read_b64_tr_b16 a[162:163], v18 offset:18432
    v_cvt_pk_bf16_f32 v227, v234, v235
    v_mfma_f32_16x16x32_bf16 v[184:187], a[140:143], v[108:111], v[184:187]
    s_mov_b32 s89, 0
    ds_read_b64_tr_b16 a[164:165], v18 offset:20480
    buffer_load_dwordx4 v2, s[56:59], s72 offen offset:0 lds
    v_mfma_f32_16x16x32_bf16 v[208:211], a[144:147], v[116:119], v[208:211]
    ds_read_b64_tr_b16 a[166:167], v18 offset:22528
    buffer_store_dwordx4 v[224:227], v3, s[60:63], s89 offen offset:1024 sc1
    v_mfma_f32_16x16x32_bf16 v[216:219], a[144:147], v[124:127], v[216:219]
    s_waitcnt lgkmcnt(6)
    ds_read_b64_tr_b16 a[168:169], v18 offset:24576
    v_mul_f32 v228, v17, v228
    v_mfma_f32_16x16x32_bf16 v[208:211], a[148:151], v[132:135], v[208:211]
    ds_read_b64_tr_b16 a[170:171], v18 offset:26624
    v_mul_f32 v229, v17, v229
    v_mfma_f32_16x16x32_bf16 v[216:219], a[148:151], v[140:143], v[216:219]
    s_mov_b32 s73, 121472
    ds_read_b64_tr_b16 a[172:173], v18 offset:28672
    v_mul_f32 v230, v17, v230
    v_mfma_f32_16x16x32_bf16 v[208:211], a[152:155], v[212:215], v[208:211]
    ds_read_b64_tr_b16 a[174:175], v18 offset:30720
    buffer_load_dwordx4 v2, s[56:59], s73 offen offset:1024 lds
    v_mul_f32 v231, v17, v231
    v_mfma_f32_16x16x32_bf16 v[216:219], a[152:155], v[52:55], v[216:219]
    s_waitcnt lgkmcnt(6)
    ds_read_b64_tr_b16 a[176:177], v19 offset:16384
    v_mul_f32 v236, v17, v236
    v_mfma_f32_16x16x32_bf16 v[208:211], a[156:159], v[244:247], v[208:211]
    ds_read_b64_tr_b16 a[178:179], v19 offset:18432
    v_mul_f32 v237, v17, v237
    v_mfma_f32_16x16x32_bf16 v[216:219], a[156:159], v[60:63], v[216:219]
    ds_read_b64_tr_b16 a[180:181], v19 offset:20480
    v_mul_f32 v238, v17, v238
    v_mfma_f32_16x16x32_bf16 v[240:243], a[160:163], v[116:119], v[240:243]
    s_waitcnt lgkmcnt(6)
    ds_read_b64_tr_b16 a[182:183], v19 offset:22528
    v_mul_f32 v239, v17, v239
    v_mfma_f32_16x16x32_bf16 v[248:251], a[160:163], v[124:127], v[248:251]
    s_mov_b32 s74, 127616
    ds_read_b64_tr_b16 a[184:185], v19 offset:24576
    v_cvt_pk_bf16_f32 v228, v228, v229
    v_mfma_f32_16x16x32_bf16 v[240:243], a[164:167], v[132:135], v[240:243]
    ds_read_b64_tr_b16 a[186:187], v19 offset:26624
    buffer_load_dwordx4 v2, s[56:59], s74 offen offset:2048 lds
    v_cvt_pk_bf16_f32 v229, v230, v231
    v_mfma_f32_16x16x32_bf16 v[248:251], a[164:167], v[140:143], v[248:251]
    s_waitcnt lgkmcnt(6)
    ds_read_b64_tr_b16 a[188:189], v19 offset:28672
    v_cvt_pk_bf16_f32 v230, v236, v237
    v_mfma_f32_16x16x32_bf16 v[240:243], a[168:171], v[212:215], v[240:243]
    ds_read_b64_tr_b16 a[190:191], v19 offset:30720
    v_cvt_pk_bf16_f32 v231, v238, v239
    v_bfe_u32 v8, v13, 2, 4
    v_mfma_f32_16x16x32_bf16 v[248:251], a[168:171], v[52:55], v[248:251]
    ds_read_b64_tr_b16 a[128:129], v20 offset:16384
    v_mul_u32_u24 v8, 896, v8
    v_mfma_f32_16x16x32_bf16 v[240:243], a[172:175], v[244:247], v[240:243]
    s_waitcnt lgkmcnt(6)
    ds_read_b64_tr_b16 a[130:131], v20 offset:18432
    buffer_store_dwordx4 v[228:231], v3, s[60:63], s89 offen offset:3072 sc1
    v_mfma_f32_16x16x32_bf16 v[248:251], a[172:175], v[60:63], v[248:251]
    s_mov_b32 s75, 133760
    ds_read_b64_tr_b16 a[132:133], v20 offset:20480
    v_lshrrev_b32 v9, 6, v13
    v_mfma_f32_16x16x32_bf16 v[144:147], a[176:179], v[116:119], v[144:147]
    ds_read_b64_tr_b16 a[134:135], v20 offset:22528
    buffer_load_dwordx4 v2, s[56:59], s75 offen offset:3072 lds
    v_mfma_f32_16x16x32_bf16 v[152:155], a[176:179], v[124:127], v[152:155]
    s_waitcnt lgkmcnt(6)
    ds_read_b64_tr_b16 a[136:137], v20 offset:24576
    v_lshl_add_u32 v8, v9, 4, v8
    v_mfma_f32_16x16x32_bf16 v[144:147], a[180:183], v[132:135], v[144:147]
    ds_read_b64_tr_b16 a[138:139], v20 offset:26624
    v_add_u32 v4, s93, v8
    v_mfma_f32_16x16x32_bf16 v[152:155], a[180:183], v[140:143], v[152:155]
    ds_read_b64_tr_b16 a[140:141], v20 offset:28672
    v_mul_f32 v208, v16, v208
    v_mfma_f32_16x16x32_bf16 v[144:147], a[184:187], v[212:215], v[144:147]
    ds_read_b64_tr_b16 a[142:143], v20 offset:30720
    v_mul_f32 v209, v16, v209
    v_mfma_f32_16x16x32_bf16 v[152:155], a[184:187], v[52:55], v[152:155]
    s_waitcnt lgkmcnt(6)
    ds_read_b64_tr_b16 a[144:145], v7 offset:32768
    v_mul_f32 v210, v16, v210
    v_mfma_f32_16x16x32_bf16 v[144:147], a[188:191], v[244:247], v[144:147]
    ds_read_b64_tr_b16 a[146:147], v7 offset:34816
    v_mul_f32 v211, v16, v211
    v_mfma_f32_16x16x32_bf16 v[152:155], a[188:191], v[60:63], v[152:155]
    ds_read_b64_tr_b16 a[148:149], v7 offset:36864
    v_mul_f32 v240, v16, v240
    v_mfma_f32_16x16x32_bf16 v[176:179], a[128:131], v[116:119], v[176:179]
    ds_read_b64_tr_b16 a[150:151], v7 offset:38912
    v_mul_f32 v241, v16, v241
    v_mfma_f32_16x16x32_bf16 v[184:187], a[128:131], v[124:127], v[184:187]
    s_waitcnt lgkmcnt(6)
    ds_read_b64_tr_b16 a[152:153], v7 offset:40960
    v_mul_f32 v242, v16, v242
    v_mfma_f32_16x16x32_bf16 v[176:179], a[132:135], v[132:135], v[176:179]
    ds_read_b64_tr_b16 a[154:155], v7 offset:43008
    v_mul_f32 v243, v16, v243
    v_mfma_f32_16x16x32_bf16 v[184:187], a[132:135], v[140:143], v[184:187]
    ds_read_b64_tr_b16 a[156:157], v7 offset:45056
    v_cvt_pk_bf16_f32 v208, v208, v209
    v_mfma_f32_16x16x32_bf16 v[176:179], a[136:139], v[212:215], v[176:179]
    s_lshl_b32 s77, s64, 8
    ds_read_b64_tr_b16 a[158:159], v7 offset:47104
    v_cvt_pk_bf16_f32 v209, v210, v211
    v_mfma_f32_16x16x32_bf16 v[184:187], a[136:139], v[52:55], v[184:187]
    s_waitcnt lgkmcnt(6)
    ds_read_b64_tr_b16 a[160:161], v18 offset:32768
    v_cvt_pk_bf16_f32 v210, v240, v241
    v_mfma_f32_16x16x32_bf16 v[176:179], a[140:143], v[244:247], v[176:179]
    ds_read_b64_tr_b16 a[162:163], v18 offset:34816
    v_cvt_pk_bf16_f32 v211, v242, v243
    v_mfma_f32_16x16x32_bf16 v[184:187], a[140:143], v[60:63], v[184:187]
    s_mov_b32 s89, 4096
    ds_read_b64_tr_b16 a[164:165], v18 offset:36864
    v_add_u32 v5, s97, v4
    v_mfma_f32_16x16x32_bf16 v[160:163], a[144:147], v[32:35], 0
    ds_read_b64_tr_b16 a[166:167], v18 offset:38912
    buffer_store_dwordx4 v[208:211], v3, s[60:63], s89 offen offset:0 sc1
    v_mfma_f32_16x16x32_bf16 v[164:167], a[144:147], v[40:43], 0
    s_waitcnt lgkmcnt(6)
    ds_read_b64_tr_b16 a[168:169], v18 offset:40960
    v_mul_f32 v216, v17, v216
    v_mfma_f32_16x16x32_bf16 v[160:163], a[148:151], v[68:71], v[160:163]
    s_waitcnt vmcnt(25)
    ds_read_b64_tr_b16 a[170:171], v18 offset:43008
    v_mul_f32 v217, v17, v217
    v_mfma_f32_16x16x32_bf16 v[164:167], a[148:151], v[76:79], v[164:167]
    s_barrier
    ds_read_b64_tr_b16 a[172:173], v18 offset:45056
    v_mul_f32 v218, v17, v218
    v_mfma_f32_16x16x32_bf16 v[160:163], a[152:155], v[84:87], v[160:163]
    s_add_u32 m0, s67, 65536
    ds_read_b64_tr_b16 a[174:175], v18 offset:47104
    v_mul_f32 v219, v17, v219
    v_mfma_f32_16x16x32_bf16 v[164:167], a[152:155], v[92:95], v[164:167]
    s_waitcnt lgkmcnt(6)
    s_mov_b32 s72, 768
    ds_read_b64_tr_b16 a[176:177], v19 offset:32768
    v_mul_f32 v248, v17, v248
    v_mfma_f32_16x16x32_bf16 v[160:163], a[156:159], v[100:103], v[160:163]
    ds_read_b64_tr_b16 a[178:179], v19 offset:34816
    buffer_load_dwordx4 v2, s[56:59], s72 offen offset:0 lds
    v_mul_f32 v249, v17, v249
    v_mfma_f32_16x16x32_bf16 v[164:167], a[156:159], v[108:111], v[164:167]
    ds_read_b64_tr_b16 a[180:181], v19 offset:36864
    v_mul_f32 v250, v17, v250
    v_mfma_f32_16x16x32_bf16 v[168:171], a[160:163], v[32:35], 0
    ds_read_b64_tr_b16 a[182:183], v19 offset:38912
    v_mul_f32 v251, v17, v251
    v_mfma_f32_16x16x32_bf16 v[172:175], a[160:163], v[40:43], 0
    s_waitcnt lgkmcnt(6)
    ds_read_b64_tr_b16 a[184:185], v19 offset:40960
    v_cvt_pk_bf16_f32 v216, v216, v217
    v_mfma_f32_16x16x32_bf16 v[168:171], a[164:167], v[68:71], v[168:171]
    ds_read_b64_tr_b16 a[186:187], v19 offset:43008
    v_cvt_pk_bf16_f32 v217, v218, v219
    v_mfma_f32_16x16x32_bf16 v[172:175], a[164:167], v[76:79], v[172:175]
    s_mov_b32 s73, 6912
    ds_read_b64_tr_b16 a[188:189], v19 offset:45056
    v_cvt_pk_bf16_f32 v218, v248, v249
    v_mfma_f32_16x16x32_bf16 v[168:171], a[168:171], v[84:87], v[168:171]
    ds_read_b64_tr_b16 a[190:191], v19 offset:47104
    v_cvt_pk_bf16_f32 v219, v250, v251
    v_mfma_f32_16x16x32_bf16 v[172:175], a[168:171], v[92:95], v[172:175]
    s_waitcnt lgkmcnt(6)
    ds_read_b64_tr_b16 a[128:129], v20 offset:32768
    buffer_load_dwordx4 v2, s[56:59], s73 offen offset:1024 lds
    v_mfma_f32_16x16x32_bf16 v[168:171], a[172:175], v[100:103], v[168:171]
    ds_read_b64_tr_b16 a[130:131], v20 offset:34816
    buffer_store_dwordx4 v[216:219], v3, s[60:63], s89 offen offset:2048 sc1
    v_mfma_f32_16x16x32_bf16 v[172:175], a[172:175], v[108:111], v[172:175]
    ds_read_b64_tr_b16 a[132:133], v20 offset:36864
    v_mul_f32 v144, v16, v144
    v_mfma_f32_16x16x32_bf16 v[224:227], a[176:179], v[32:35], 0
    s_waitcnt lgkmcnt(6)
    ds_read_b64_tr_b16 a[134:135], v20 offset:38912
    v_mul_f32 v145, v16, v145
    v_mfma_f32_16x16x32_bf16 v[228:231], a[176:179], v[40:43], 0
    s_mov_b32 s74, 13056
    ds_read_b64_tr_b16 a[136:137], v20 offset:40960
    v_mul_f32 v146, v16, v146
    v_mfma_f32_16x16x32_bf16 v[224:227], a[180:183], v[68:71], v[224:227]
    ds_read_b64_tr_b16 a[138:139], v20 offset:43008
    buffer_load_dwordx4 v2, s[56:59], s74 offen offset:2048 lds
    v_mul_f32 v147, v16, v147
    v_mfma_f32_16x16x32_bf16 v[228:231], a[180:183], v[76:79], v[228:231]
    s_waitcnt lgkmcnt(6)
    ds_read_b64_tr_b16 a[140:141], v20 offset:45056
    v_mul_f32 v176, v16, v176
    v_mfma_f32_16x16x32_bf16 v[224:227], a[184:187], v[84:87], v[224:227]
    ds_read_b64_tr_b16 a[142:143], v20 offset:47104
    v_mul_f32 v177, v16, v177
    v_mfma_f32_16x16x32_bf16 v[228:231], a[184:187], v[92:95], v[228:231]
    ds_read_b64_tr_b16 a[144:145], v7 offset:49152
    v_mul_f32 v178, v16, v178
    v_mfma_f32_16x16x32_bf16 v[224:227], a[188:191], v[100:103], v[224:227]
    s_waitcnt lgkmcnt(6)
    ds_read_b64_tr_b16 a[146:147], v7 offset:51200
    v_mul_f32 v179, v16, v179
    v_mfma_f32_16x16x32_bf16 v[228:231], a[188:191], v[108:111], v[228:231]
    s_mov_b32 s75, 19200
    ds_read_b64_tr_b16 a[148:149], v7 offset:53248
    v_cvt_pk_bf16_f32 v144, v144, v145
    v_mfma_f32_16x16x32_bf16 v[232:235], a[128:131], v[32:35], 0
    ds_read_b64_tr_b16 a[150:151], v7 offset:55296
    buffer_load_dwordx4 v2, s[56:59], s75 offen offset:3072 lds
    v_cvt_pk_bf16_f32 v145, v146, v147
    v_mfma_f32_16x16x32_bf16 v[236:239], a[128:131], v[40:43], 0
    s_waitcnt lgkmcnt(6)
    ds_read_b64_tr_b16 a[152:153], v7 offset:57344
    v_cvt_pk_bf16_f32 v146, v176, v177
    v_mfma_f32_16x16x32_bf16 v[232:235], a[132:135], v[68:71], v[232:235]
    s_waitcnt lgkmcnt(5)
    ds_read_b64_tr_b16 a[154:155], v7 offset:59392
    v_cvt_pk_bf16_f32 v147, v178, v179
    v_mfma_f32_16x16x32_bf16 v[236:239], a[132:135], v[76:79], v[236:239]
    s_mov_b32 s89, 4096
    ds_read_b64_tr_b16 a[156:157], v7 offset:61440
    v_mfma_f32_16x16x32_bf16 v[232:235], a[136:139], v[84:87], v[232:235]
    s_add_u32 m0, s67, 81920
    ds_read_b64_tr_b16 a[158:159], v7 offset:63488
    buffer_store_dwordx4 v[144:147], v3, s[60:63], s89 offen offset:1024 sc1
    v_mfma_f32_16x16x32_bf16 v[236:239], a[136:139], v[92:95], v[236:239]
    s_mov_b32 s72, 115456
    ds_read_b64_tr_b16 a[160:161], v18 offset:49152
    v_mul_f32 v152, v17, v152
    v_mfma_f32_16x16x32_bf16 v[232:235], a[140:143], v[100:103], v[232:235]
    ds_read_b64_tr_b16 a[162:163], v18 offset:51200
    buffer_load_dwordx4 v2, s[56:59], s72 offen offset:0 lds
    v_mul_f32 v153, v17, v153
    v_mfma_f32_16x16x32_bf16 v[236:239], a[140:143], v[108:111], v[236:239]
    s_waitcnt lgkmcnt(6)
    ds_read_b64_tr_b16 a[164:165], v18 offset:53248
    v_mul_f32 v154, v17, v154
    v_mfma_f32_16x16x32_bf16 v[160:163], a[144:147], v[116:119], v[160:163]
    ds_read_b64_tr_b16 a[166:167], v18 offset:55296
    v_mul_f32 v155, v17, v155
    v_mfma_f32_16x16x32_bf16 v[164:167], a[144:147], v[124:127], v[164:167]
    ds_read_b64_tr_b16 a[168:169], v18 offset:57344
    v_mul_f32 v184, v17, v184
    v_mfma_f32_16x16x32_bf16 v[160:163], a[148:151], v[132:135], v[160:163]
    s_waitcnt lgkmcnt(6)
    ds_read_b64_tr_b16 a[170:171], v18 offset:59392
    v_mul_f32 v185, v17, v185
    v_mfma_f32_16x16x32_bf16 v[164:167], a[148:151], v[140:143], v[164:167]
    s_mov_b32 s73, 121600
    ds_read_b64_tr_b16 a[172:173], v18 offset:61440
    v_mul_f32 v186, v17, v186
    v_mfma_f32_16x16x32_bf16 v[160:163], a[152:155], v[212:215], v[160:163]
    ds_read_b64_tr_b16 a[174:175], v18 offset:63488
    buffer_load_dwordx4 v2, s[56:59], s73 offen offset:1024 lds
    v_mul_f32 v187, v17, v187
    v_mfma_f32_16x16x32_bf16 v[164:167], a[152:155], v[52:55], v[164:167]
    s_waitcnt lgkmcnt(6)
    ds_read_b64_tr_b16 a[176:177], v19 offset:49152
    v_cvt_pk_bf16_f32 v152, v152, v153
    v_mfma_f32_16x16x32_bf16 v[160:163], a[156:159], v[244:247], v[160:163]
    ds_read_b64_tr_b16 a[178:179], v19 offset:51200
    v_cvt_pk_bf16_f32 v153, v154, v155
    v_mfma_f32_16x16x32_bf16 v[164:167], a[156:159], v[60:63], v[164:167]
    ds_read_b64_tr_b16 a[180:181], v19 offset:53248
    v_cvt_pk_bf16_f32 v154, v184, v185
    v_mfma_f32_16x16x32_bf16 v[168:171], a[160:163], v[116:119], v[168:171]
    s_waitcnt lgkmcnt(6)
    ds_read_b64_tr_b16 a[182:183], v19 offset:55296
    v_cvt_pk_bf16_f32 v155, v186, v187
    v_mfma_f32_16x16x32_bf16 v[172:175], a[160:163], v[124:127], v[172:175]
    s_mov_b32 s74, 127744
    ds_read_b64_tr_b16 a[184:185], v19 offset:57344
    v_mfma_f32_16x16x32_bf16 v[168:171], a[164:167], v[132:135], v[168:171]
    ds_read_b64_tr_b16 a[186:187], v19 offset:59392
    buffer_store_dwordx4 v[152:155], v3, s[60:63], s89 offen offset:3072 sc1
    v_mfma_f32_16x16x32_bf16 v[172:175], a[164:167], v[140:143], v[172:175]
    s_waitcnt lgkmcnt(6)
    ds_read_b64_tr_b16 a[188:189], v19 offset:61440
    buffer_load_dwordx4 v2, s[56:59], s74 offen offset:2048 lds
    v_mfma_f32_16x16x32_bf16 v[168:171], a[168:171], v[212:215], v[168:171]
    ds_read_b64_tr_b16 a[190:191], v19 offset:63488
    v_mfma_f32_16x16x32_bf16 v[172:175], a[168:171], v[52:55], v[172:175]
    ds_read_b64_tr_b16 a[128:129], v20 offset:49152
    v_mfma_f32_16x16x32_bf16 v[168:171], a[172:175], v[244:247], v[168:171]
    s_waitcnt lgkmcnt(6)
    ds_read_b64_tr_b16 a[130:131], v20 offset:51200
    buffer_load_dwordx4 v[192:195], v4, s[28:31], 0 offen offset:0
    v_mfma_f32_16x16x32_bf16 v[172:175], a[172:175], v[60:63], v[172:175]
    s_mov_b32 s75, 133888
    ds_read_b64_tr_b16 a[132:133], v20 offset:53248
    v_mfma_f32_16x16x32_bf16 v[224:227], a[176:179], v[116:119], v[224:227]
    ds_read_b64_tr_b16 a[134:135], v20 offset:55296
    buffer_load_dwordx4 v2, s[56:59], s75 offen offset:3072 lds
    v_mfma_f32_16x16x32_bf16 v[228:231], a[176:179], v[124:127], v[228:231]
    s_waitcnt lgkmcnt(6)
    ds_read_b64_tr_b16 a[136:137], v20 offset:57344
    v_mfma_f32_16x16x32_bf16 v[224:227], a[180:183], v[132:135], v[224:227]
    ds_read_b64_tr_b16 a[138:139], v20 offset:59392
    v_mfma_f32_16x16x32_bf16 v[228:231], a[180:183], v[140:143], v[228:231]
    ds_read_b64_tr_b16 a[140:141], v20 offset:61440
    v_mul_f32 v160, v16, v160
    v_mfma_f32_16x16x32_bf16 v[224:227], a[184:187], v[212:215], v[224:227]
    ds_read_b64_tr_b16 a[142:143], v20 offset:63488
    buffer_load_dwordx4 v[196:199], v5, s[28:31], 0 offen offset:512
    v_mul_f32 v161, v16, v161
    v_xor_b32 v7, 65536, v7
    v_mfma_f32_16x16x32_bf16 v[228:231], a[184:187], v[52:55], v[228:231]
    s_waitcnt lgkmcnt(6)
    ds_read_b64_tr_b16 a[144:145], v7 offset:0
    v_mul_f32 v162, v16, v162
    v_mfma_f32_16x16x32_bf16 v[224:227], a[188:191], v[244:247], v[224:227]
    ds_read_b64_tr_b16 a[146:147], v7 offset:2048
    v_mul_f32 v163, v16, v163
    v_mfma_f32_16x16x32_bf16 v[228:231], a[188:191], v[60:63], v[228:231]
    ds_read_b64_tr_b16 a[148:149], v7 offset:4096
    v_mul_f32 v168, v16, v168
    v_mfma_f32_16x16x32_bf16 v[232:235], a[128:131], v[116:119], v[232:235]
    ds_read_b64_tr_b16 a[150:151], v7 offset:6144
    v_mul_f32 v169, v16, v169
    v_mfma_f32_16x16x32_bf16 v[236:239], a[128:131], v[124:127], v[236:239]
    s_waitcnt lgkmcnt(6)
    ds_read_b64_tr_b16 a[152:153], v7 offset:8192
    v_mul_f32 v170, v16, v170
    v_mfma_f32_16x16x32_bf16 v[232:235], a[132:135], v[132:135], v[232:235]
    ds_read_b64_tr_b16 a[154:155], v7 offset:10240
    v_mul_f32 v171, v16, v171
    v_mfma_f32_16x16x32_bf16 v[236:239], a[132:135], v[140:143], v[236:239]
    ds_read_b64_tr_b16 a[156:157], v7 offset:12288
    v_cvt_pk_bf16_f32 v160, v160, v161
    v_mfma_f32_16x16x32_bf16 v[232:235], a[136:139], v[212:215], v[232:235]
    ds_read_b64_tr_b16 a[158:159], v7 offset:14336
    v_cvt_pk_bf16_f32 v161, v162, v163
    v_xor_b32 v18, 65536, v18
    v_mfma_f32_16x16x32_bf16 v[236:239], a[136:139], v[52:55], v[236:239]
    s_waitcnt lgkmcnt(6)
    ds_read_b64_tr_b16 a[160:161], v18 offset:0
    v_cvt_pk_bf16_f32 v162, v168, v169
    v_mfma_f32_16x16x32_bf16 v[232:235], a[140:143], v[244:247], v[232:235]
    s_mov_b32 s72, 0
    ds_read_b64_tr_b16 a[162:163], v18 offset:2048
    v_cvt_pk_bf16_f32 v163, v170, v171
    v_mfma_f32_16x16x32_bf16 v[236:239], a[140:143], v[60:63], v[236:239]
    s_mov_b32 s89, 8192
    ds_read_b64_tr_b16 a[164:165], v18 offset:4096
    v_mfma_f32_16x16x32_bf16 v[208:211], a[144:147], v[32:35], 0
    ds_read_b64_tr_b16 a[166:167], v18 offset:6144
    buffer_store_dwordx4 v[160:163], v3, s[60:63], s89 offen offset:0 sc1
    v_mfma_f32_16x16x32_bf16 v[216:219], a[144:147], v[40:43], 0
    s_waitcnt lgkmcnt(6)
    ds_read_b64_tr_b16 a[168:169], v18 offset:8192
    v_mul_f32 v164, v17, v164
    v_mfma_f32_16x16x32_bf16 v[208:211], a[148:151], v[68:71], v[208:211]
    s_waitcnt vmcnt(31)
    ds_read_b64_tr_b16 a[170:171], v18 offset:10240
    v_mul_f32 v165, v17, v165
    v_mfma_f32_16x16x32_bf16 v[216:219], a[148:151], v[76:79], v[216:219]
    s_barrier
    ds_read_b64_tr_b16 a[172:173], v18 offset:12288
    v_mul_f32 v166, v17, v166
    v_mfma_f32_16x16x32_bf16 v[208:211], a[152:155], v[84:87], v[208:211]
    ds_read_b64_tr_b16 a[174:175], v18 offset:14336
    v_mul_f32 v167, v17, v167
    v_xor_b32 v19, 65536, v19
    v_mfma_f32_16x16x32_bf16 v[216:219], a[152:155], v[92:95], v[216:219]
    s_waitcnt lgkmcnt(6)
    ds_read_b64_tr_b16 a[176:177], v19 offset:0
    v_mul_f32 v172, v17, v172
    v_mfma_f32_16x16x32_bf16 v[208:211], a[156:159], v[100:103], v[208:211]
    ds_read_b64_tr_b16 a[178:179], v19 offset:2048
    v_mul_f32 v173, v17, v173
    v_mfma_f32_16x16x32_bf16 v[216:219], a[156:159], v[108:111], v[216:219]
    ds_read_b64_tr_b16 a[180:181], v19 offset:4096
    v_mul_f32 v174, v17, v174
    v_mfma_f32_16x16x32_bf16 v[240:243], a[160:163], v[32:35], 0
    ds_read_b64_tr_b16 a[182:183], v19 offset:6144
    v_mul_f32 v175, v17, v175
    v_mfma_f32_16x16x32_bf16 v[248:251], a[160:163], v[40:43], 0
    s_waitcnt lgkmcnt(6)
    ds_read_b64_tr_b16 a[184:185], v19 offset:8192
    v_cvt_pk_bf16_f32 v164, v164, v165
    v_mfma_f32_16x16x32_bf16 v[240:243], a[164:167], v[68:71], v[240:243]
    ds_read_b64_tr_b16 a[186:187], v19 offset:10240
    v_cvt_pk_bf16_f32 v165, v166, v167
    v_mfma_f32_16x16x32_bf16 v[248:251], a[164:167], v[76:79], v[248:251]
    ds_read_b64_tr_b16 a[188:189], v19 offset:12288
    v_cvt_pk_bf16_f32 v166, v172, v173
    v_mfma_f32_16x16x32_bf16 v[240:243], a[168:171], v[84:87], v[240:243]
    ds_read_b64_tr_b16 a[190:191], v19 offset:14336
    v_cvt_pk_bf16_f32 v167, v174, v175
    v_xor_b32 v20, 65536, v20
    v_mfma_f32_16x16x32_bf16 v[248:251], a[168:171], v[92:95], v[248:251]
    s_waitcnt lgkmcnt(6)
    ds_read_b64_tr_b16 a[128:129], v20 offset:0
    v_mfma_f32_16x16x32_bf16 v[240:243], a[172:175], v[100:103], v[240:243]
    ds_read_b64_tr_b16 a[130:131], v20 offset:2048
    buffer_store_dwordx4 v[164:167], v3, s[60:63], s89 offen offset:2048 sc1
    v_mfma_f32_16x16x32_bf16 v[248:251], a[172:175], v[108:111], v[248:251]
    ds_read_b64_tr_b16 a[132:133], v20 offset:4096
    v_mul_f32 v224, v16, v224
    v_mfma_f32_16x16x32_bf16 v[144:147], a[176:179], v[32:35], 0
    ds_read_b64_tr_b16 a[134:135], v20 offset:6144
    v_mul_f32 v225, v16, v225
    v_mfma_f32_16x16x32_bf16 v[152:155], a[176:179], v[40:43], 0
    s_waitcnt lgkmcnt(6)
    ds_read_b64_tr_b16 a[136:137], v20 offset:8192
    v_mul_f32 v226, v16, v226
    v_mfma_f32_16x16x32_bf16 v[144:147], a[180:183], v[68:71], v[144:147]
    ds_read_b64_tr_b16 a[138:139], v20 offset:10240
    v_mul_f32 v227, v16, v227
    v_mfma_f32_16x16x32_bf16 v[152:155], a[180:183], v[76:79], v[152:155]
    ds_read_b64_tr_b16 a[140:141], v20 offset:12288
    v_mul_f32 v232, v16, v232
    v_mfma_f32_16x16x32_bf16 v[144:147], a[184:187], v[84:87], v[144:147]
    ds_read_b64_tr_b16 a[142:143], v20 offset:14336
    v_mul_f32 v233, v16, v233
    v_mfma_f32_16x16x32_bf16 v[152:155], a[184:187], v[92:95], v[152:155]
    s_waitcnt lgkmcnt(6)
    ds_read_b64_tr_b16 a[144:145], v7 offset:16384
    v_mul_f32 v234, v16, v234
    v_mfma_f32_16x16x32_bf16 v[144:147], a[188:191], v[100:103], v[144:147]
    ds_read_b64_tr_b16 a[146:147], v7 offset:18432
    v_mul_f32 v235, v16, v235
    v_mfma_f32_16x16x32_bf16 v[152:155], a[188:191], v[108:111], v[152:155]
    ds_read_b64_tr_b16 a[148:149], v7 offset:20480
    v_cvt_pk_bf16_f32 v224, v224, v225
    v_mfma_f32_16x16x32_bf16 v[176:179], a[128:131], v[32:35], 0
    ds_read_b64_tr_b16 a[150:151], v7 offset:22528
    v_cvt_pk_bf16_f32 v225, v226, v227
    v_mfma_f32_16x16x32_bf16 v[184:187], a[128:131], v[40:43], 0
    s_waitcnt lgkmcnt(6)
    ds_read_b64_tr_b16 a[152:153], v7 offset:24576
    v_cvt_pk_bf16_f32 v226, v232, v233
    v_mfma_f32_16x16x32_bf16 v[176:179], a[132:135], v[68:71], v[176:179]
    ds_read_b64_tr_b16 a[154:155], v7 offset:26624
    v_cvt_pk_bf16_f32 v227, v234, v235
    v_mfma_f32_16x16x32_bf16 v[184:187], a[132:135], v[76:79], v[184:187]
    s_mov_b32 s89, 8192
    ds_read_b64_tr_b16 a[156:157], v7 offset:28672
    v_mfma_f32_16x16x32_bf16 v[176:179], a[136:139], v[84:87], v[176:179]
    ds_read_b64_tr_b16 a[158:159], v7 offset:30720
    buffer_store_dwordx4 v[224:227], v3, s[60:63], s89 offen offset:1024 sc1
    v_mfma_f32_16x16x32_bf16 v[184:187], a[136:139], v[92:95], v[184:187]
    s_waitcnt lgkmcnt(6)
    ds_read_b64_tr_b16 a[160:161], v18 offset:16384
    v_mul_f32 v228, v17, v228
    v_mfma_f32_16x16x32_bf16 v[176:179], a[140:143], v[100:103], v[176:179]
    ds_read_b64_tr_b16 a[162:163], v18 offset:18432
    v_mul_f32 v229, v17, v229
    v_mfma_f32_16x16x32_bf16 v[184:187], a[140:143], v[108:111], v[184:187]
    ds_read_b64_tr_b16 a[164:165], v18 offset:20480
    v_mul_f32 v230, v17, v230
    v_mfma_f32_16x16x32_bf16 v[208:211], a[144:147], v[116:119], v[208:211]
    ds_read_b64_tr_b16 a[166:167], v18 offset:22528
    v_mul_f32 v231, v17, v231
    v_mfma_f32_16x16x32_bf16 v[216:219], a[144:147], v[124:127], v[216:219]
    s_waitcnt lgkmcnt(6)
    ds_read_b64_tr_b16 a[168:169], v18 offset:24576
    v_mul_f32 v236, v17, v236
    v_mfma_f32_16x16x32_bf16 v[208:211], a[148:151], v[132:135], v[208:211]
    ds_read_b64_tr_b16 a[170:171], v18 offset:26624
    v_mul_f32 v237, v17, v237
    v_mfma_f32_16x16x32_bf16 v[216:219], a[148:151], v[140:143], v[216:219]
    ds_read_b64_tr_b16 a[172:173], v18 offset:28672
    v_mul_f32 v238, v17, v238
    v_mfma_f32_16x16x32_bf16 v[208:211], a[152:155], v[212:215], v[208:211]
    ds_read_b64_tr_b16 a[174:175], v18 offset:30720
    v_mul_f32 v239, v17, v239
    v_mfma_f32_16x16x32_bf16 v[216:219], a[152:155], v[52:55], v[216:219]
    s_waitcnt lgkmcnt(6)
    ds_read_b64_tr_b16 a[176:177], v19 offset:16384
    v_cvt_pk_bf16_f32 v228, v228, v229
    v_mfma_f32_16x16x32_bf16 v[208:211], a[156:159], v[244:247], v[208:211]
    ds_read_b64_tr_b16 a[178:179], v19 offset:18432
    v_cvt_pk_bf16_f32 v229, v230, v231
    v_mfma_f32_16x16x32_bf16 v[216:219], a[156:159], v[60:63], v[216:219]
    ds_read_b64_tr_b16 a[180:181], v19 offset:20480
    v_cvt_pk_bf16_f32 v230, v236, v237
    v_mfma_f32_16x16x32_bf16 v[240:243], a[160:163], v[116:119], v[240:243]
    ds_read_b64_tr_b16 a[182:183], v19 offset:22528
    v_cvt_pk_bf16_f32 v231, v238, v239
    v_mfma_f32_16x16x32_bf16 v[248:251], a[160:163], v[124:127], v[248:251]
    s_waitcnt lgkmcnt(6)
    ds_read_b64_tr_b16 a[184:185], v19 offset:24576
    v_mfma_f32_16x16x32_bf16 v[240:243], a[164:167], v[132:135], v[240:243]
    ds_read_b64_tr_b16 a[186:187], v19 offset:26624
    buffer_store_dwordx4 v[228:231], v3, s[60:63], s89 offen offset:3072 sc1
    v_mfma_f32_16x16x32_bf16 v[248:251], a[164:167], v[140:143], v[248:251]
    ds_read_b64_tr_b16 a[188:189], v19 offset:28672
    v_mfma_f32_16x16x32_bf16 v[240:243], a[168:171], v[212:215], v[240:243]
    ds_read_b64_tr_b16 a[190:191], v19 offset:30720
    v_mfma_f32_16x16x32_bf16 v[248:251], a[168:171], v[52:55], v[248:251]
    s_waitcnt lgkmcnt(6)
    ds_read_b64_tr_b16 a[128:129], v20 offset:16384
    v_mfma_f32_16x16x32_bf16 v[240:243], a[172:175], v[244:247], v[240:243]
    ds_read_b64_tr_b16 a[130:131], v20 offset:18432
    v_mfma_f32_16x16x32_bf16 v[248:251], a[172:175], v[60:63], v[248:251]
    ds_read_b64_tr_b16 a[132:133], v20 offset:20480
    v_mfma_f32_16x16x32_bf16 v[144:147], a[176:179], v[116:119], v[144:147]
    ds_read_b64_tr_b16 a[134:135], v20 offset:22528
    v_mfma_f32_16x16x32_bf16 v[152:155], a[176:179], v[124:127], v[152:155]
    s_waitcnt lgkmcnt(6)
    ds_read_b64_tr_b16 a[136:137], v20 offset:24576
    v_mfma_f32_16x16x32_bf16 v[144:147], a[180:183], v[132:135], v[144:147]
    ds_read_b64_tr_b16 a[138:139], v20 offset:26624
    v_mfma_f32_16x16x32_bf16 v[152:155], a[180:183], v[140:143], v[152:155]
    ds_read_b64_tr_b16 a[140:141], v20 offset:28672
    v_mul_f32 v208, v16, v208
    v_mfma_f32_16x16x32_bf16 v[144:147], a[184:187], v[212:215], v[144:147]
    ds_read_b64_tr_b16 a[142:143], v20 offset:30720
    v_mul_f32 v209, v16, v209
    v_xor_b32 v7, 131072, v7
    v_mfma_f32_16x16x32_bf16 v[152:155], a[184:187], v[52:55], v[152:155]
    s_waitcnt lgkmcnt(6)
    ds_read_b64_tr_b16 a[144:145], v7 offset:0
    v_mul_f32 v210, v16, v210
    v_mfma_f32_16x16x32_bf16 v[144:147], a[188:191], v[244:247], v[144:147]
    ds_read_b64_tr_b16 a[146:147], v7 offset:2048
    v_mul_f32 v211, v16, v211
    v_mfma_f32_16x16x32_bf16 v[152:155], a[188:191], v[60:63], v[152:155]
    ds_read_b64_tr_b16 a[148:149], v7 offset:4096
    v_mul_f32 v240, v16, v240
    v_mfma_f32_16x16x32_bf16 v[176:179], a[128:131], v[116:119], v[176:179]
    ds_read_b64_tr_b16 a[150:151], v7 offset:6144
    v_mul_f32 v241, v16, v241
    v_mfma_f32_16x16x32_bf16 v[184:187], a[128:131], v[124:127], v[184:187]
    s_waitcnt lgkmcnt(6)
    ds_read_b64_tr_b16 a[152:153], v7 offset:8192
    v_mul_f32 v242, v16, v242
    v_mfma_f32_16x16x32_bf16 v[176:179], a[132:135], v[132:135], v[176:179]
    ds_read_b64_tr_b16 a[154:155], v7 offset:10240
    v_mul_f32 v243, v16, v243
    v_mfma_f32_16x16x32_bf16 v[184:187], a[132:135], v[140:143], v[184:187]
    ds_read_b64_tr_b16 a[156:157], v7 offset:12288
    v_cvt_pk_bf16_f32 v208, v208, v209
    v_mfma_f32_16x16x32_bf16 v[176:179], a[136:139], v[212:215], v[176:179]
    ds_read_b64_tr_b16 a[158:159], v7 offset:14336
    buffer_load_dword v205, v14, s[16:19], s77 offen sc1
    v_cvt_pk_bf16_f32 v209, v210, v211
    v_xor_b32 v18, 131072, v18
    v_mfma_f32_16x16x32_bf16 v[184:187], a[136:139], v[52:55], v[184:187]
    s_waitcnt lgkmcnt(6)
    ds_read_b64_tr_b16 a[160:161], v18 offset:0
    v_cvt_pk_bf16_f32 v210, v240, v241
    v_mfma_f32_16x16x32_bf16 v[176:179], a[140:143], v[244:247], v[176:179]
    ds_read_b64_tr_b16 a[162:163], v18 offset:2048
    v_cvt_pk_bf16_f32 v211, v242, v243
    v_mfma_f32_16x16x32_bf16 v[184:187], a[140:143], v[60:63], v[184:187]
    s_mov_b32 s89, 12288
    ds_read_b64_tr_b16 a[164:165], v18 offset:4096
    v_mfma_f32_16x16x32_bf16 v[160:163], a[144:147], v[32:35], 0
    ds_read_b64_tr_b16 a[166:167], v18 offset:6144
    buffer_store_dwordx4 v[208:211], v3, s[60:63], s89 offen offset:0 sc1
    v_mfma_f32_16x16x32_bf16 v[164:167], a[144:147], v[40:43], 0
    s_waitcnt lgkmcnt(6)
    ds_read_b64_tr_b16 a[168:169], v18 offset:8192
    v_mul_f32 v216, v17, v216
    v_mfma_f32_16x16x32_bf16 v[160:163], a[148:151], v[68:71], v[160:163]
    s_waitcnt vmcnt(26)
    ds_read_b64_tr_b16 a[170:171], v18 offset:10240
    v_mul_f32 v217, v17, v217
    v_mfma_f32_16x16x32_bf16 v[164:167], a[148:151], v[76:79], v[164:167]
    s_barrier
    ds_read_b64_tr_b16 a[172:173], v18 offset:12288
    v_mul_f32 v218, v17, v218
    v_mfma_f32_16x16x32_bf16 v[160:163], a[152:155], v[84:87], v[160:163]
    ds_read_b64_tr_b16 a[174:175], v18 offset:14336
    v_mul_f32 v219, v17, v219
    v_xor_b32 v19, 131072, v19
    v_mfma_f32_16x16x32_bf16 v[164:167], a[152:155], v[92:95], v[164:167]
    s_waitcnt lgkmcnt(6)
    ds_read_b64_tr_b16 a[176:177], v19 offset:0
    v_mul_f32 v248, v17, v248
    v_mfma_f32_16x16x32_bf16 v[160:163], a[156:159], v[100:103], v[160:163]
    ds_read_b64_tr_b16 a[178:179], v19 offset:2048
    v_mul_f32 v249, v17, v249
    v_mfma_f32_16x16x32_bf16 v[164:167], a[156:159], v[108:111], v[164:167]
    ds_read_b64_tr_b16 a[180:181], v19 offset:4096
    v_mul_f32 v250, v17, v250
    v_mfma_f32_16x16x32_bf16 v[168:171], a[160:163], v[32:35], 0
    ds_read_b64_tr_b16 a[182:183], v19 offset:6144
    v_mul_f32 v251, v17, v251
    v_mfma_f32_16x16x32_bf16 v[172:175], a[160:163], v[40:43], 0
    s_waitcnt lgkmcnt(6)
    ds_read_b64_tr_b16 a[184:185], v19 offset:8192
    v_cvt_pk_bf16_f32 v216, v216, v217
    v_mfma_f32_16x16x32_bf16 v[168:171], a[164:167], v[68:71], v[168:171]
    ds_read_b64_tr_b16 a[186:187], v19 offset:10240
    v_cvt_pk_bf16_f32 v217, v218, v219
    v_mfma_f32_16x16x32_bf16 v[172:175], a[164:167], v[76:79], v[172:175]
    ds_read_b64_tr_b16 a[188:189], v19 offset:12288
    v_cvt_pk_bf16_f32 v218, v248, v249
    v_mfma_f32_16x16x32_bf16 v[168:171], a[168:171], v[84:87], v[168:171]
    ds_read_b64_tr_b16 a[190:191], v19 offset:14336
    v_cvt_pk_bf16_f32 v219, v250, v251
    v_xor_b32 v20, 131072, v20
    v_mfma_f32_16x16x32_bf16 v[172:175], a[168:171], v[92:95], v[172:175]
    s_waitcnt lgkmcnt(6)
    ds_read_b64_tr_b16 a[128:129], v20 offset:0
    v_mfma_f32_16x16x32_bf16 v[168:171], a[172:175], v[100:103], v[168:171]
    ds_read_b64_tr_b16 a[130:131], v20 offset:2048
    buffer_store_dwordx4 v[216:219], v3, s[60:63], s89 offen offset:2048 sc1
    v_mfma_f32_16x16x32_bf16 v[172:175], a[172:175], v[108:111], v[172:175]
    ds_read_b64_tr_b16 a[132:133], v20 offset:4096
    v_mul_f32 v144, v16, v144
    v_mfma_f32_16x16x32_bf16 v[224:227], a[176:179], v[32:35], 0
    ds_read_b64_tr_b16 a[134:135], v20 offset:6144
    v_mul_f32 v145, v16, v145
    v_mfma_f32_16x16x32_bf16 v[228:231], a[176:179], v[40:43], 0
    s_waitcnt lgkmcnt(6)
    ds_read_b64_tr_b16 a[136:137], v20 offset:8192
    v_mul_f32 v146, v16, v146
    v_mfma_f32_16x16x32_bf16 v[224:227], a[180:183], v[68:71], v[224:227]
    ds_read_b64_tr_b16 a[138:139], v20 offset:10240
    v_mul_f32 v147, v16, v147
    v_mfma_f32_16x16x32_bf16 v[228:231], a[180:183], v[76:79], v[228:231]
    ds_read_b64_tr_b16 a[140:141], v20 offset:12288
    v_mul_f32 v176, v16, v176
    v_mfma_f32_16x16x32_bf16 v[224:227], a[184:187], v[84:87], v[224:227]
    ds_read_b64_tr_b16 a[142:143], v20 offset:14336
    v_mul_f32 v177, v16, v177
    v_mfma_f32_16x16x32_bf16 v[228:231], a[184:187], v[92:95], v[228:231]
    s_waitcnt lgkmcnt(6)
    ds_read_b64_tr_b16 a[144:145], v7 offset:16384
    v_mul_f32 v178, v16, v178
    v_mfma_f32_16x16x32_bf16 v[224:227], a[188:191], v[100:103], v[224:227]
    ds_read_b64_tr_b16 a[146:147], v7 offset:18432
    v_mul_f32 v179, v16, v179
    v_mfma_f32_16x16x32_bf16 v[228:231], a[188:191], v[108:111], v[228:231]
    ds_read_b64_tr_b16 a[148:149], v7 offset:20480
    v_cvt_pk_bf16_f32 v144, v144, v145
    v_mfma_f32_16x16x32_bf16 v[232:235], a[128:131], v[32:35], 0
    ds_read_b64_tr_b16 a[150:151], v7 offset:22528
    v_cvt_pk_bf16_f32 v145, v146, v147
    v_mfma_f32_16x16x32_bf16 v[236:239], a[128:131], v[40:43], 0
    s_waitcnt lgkmcnt(6)
    ds_read_b64_tr_b16 a[152:153], v7 offset:24576
    v_cvt_pk_bf16_f32 v146, v176, v177
    v_mfma_f32_16x16x32_bf16 v[232:235], a[132:135], v[68:71], v[232:235]
    ds_read_b64_tr_b16 a[154:155], v7 offset:26624
    v_cvt_pk_bf16_f32 v147, v178, v179
    v_mfma_f32_16x16x32_bf16 v[236:239], a[132:135], v[76:79], v[236:239]
    s_mov_b32 s89, 12288
    ds_read_b64_tr_b16 a[156:157], v7 offset:28672
    v_mfma_f32_16x16x32_bf16 v[232:235], a[136:139], v[84:87], v[232:235]
    s_waitcnt vmcnt(2)
    ds_read_b64_tr_b16 a[158:159], v7 offset:30720
    buffer_store_dwordx4 v[144:147], v3, s[60:63], s89 offen offset:1024 sc1
    v_cmp_ne_u32 vcc, 0, v205
    v_mfma_f32_16x16x32_bf16 v[236:239], a[136:139], v[92:95], v[236:239]
    s_waitcnt lgkmcnt(6)
    ds_read_b64_tr_b16 a[160:161], v18 offset:16384
    v_mul_f32 v152, v17, v152
    v_mfma_f32_16x16x32_bf16 v[232:235], a[140:143], v[100:103], v[232:235]
    s_andn2_b32 s73, vcc_lo, s72
    ds_read_b64_tr_b16 a[162:163], v18 offset:18432
    v_mul_f32 v153, v17, v153
    v_mfma_f32_16x16x32_bf16 v[236:239], a[140:143], v[108:111], v[236:239]
    s_and_b32 s73, s73, 65535
    ds_read_b64_tr_b16 a[164:165], v18 offset:20480
    v_mul_f32 v154, v17, v154
    v_mfma_f32_16x16x32_bf16 v[160:163], a[144:147], v[116:119], v[160:163]
    s_ff1_i32_b32 s96, s73
    ds_read_b64_tr_b16 a[166:167], v18 offset:22528
    v_mul_f32 v155, v17, v155
    v_mfma_f32_16x16x32_bf16 v[164:167], a[144:147], v[124:127], v[164:167]
    s_waitcnt lgkmcnt(6)
    s_mul_i32 s74, s96, 1839104
    ds_read_b64_tr_b16 a[168:169], v18 offset:24576
    v_mul_f32 v184, v17, v184
    v_mfma_f32_16x16x32_bf16 v[160:163], a[148:151], v[132:135], v[160:163]
    s_bitset1_b32 s72, s96
    ds_read_b64_tr_b16 a[170:171], v18 offset:26624
    v_mul_f32 v185, v17, v185
    v_mfma_f32_16x16x32_bf16 v[164:167], a[148:151], v[140:143], v[164:167]
    s_cmp_lg_u32 s73, 0
    ds_read_b64_tr_b16 a[172:173], v18 offset:28672
    v_mul_f32 v186, v17, v186
    v_mfma_f32_16x16x32_bf16 v[160:163], a[152:155], v[212:215], v[160:163]
    s_cselect_b32 s74, s74, 2147483648
    ds_read_b64_tr_b16 a[174:175], v18 offset:30720
    v_mul_f32 v187, v17, v187
    v_mfma_f32_16x16x32_bf16 v[164:167], a[152:155], v[52:55], v[164:167]
    s_waitcnt lgkmcnt(6)
    s_bitset0_b32 s73, s96
    ds_read_b64_tr_b16 a[176:177], v19 offset:16384
    buffer_load_dwordx4 v[36:39], v11, s[8:11], s74 offen sc1
    v_cvt_pk_bf16_f32 v152, v152, v153
    v_mfma_f32_16x16x32_bf16 v[160:163], a[156:159], v[244:247], v[160:163]
    ds_read_b64_tr_b16 a[178:179], v19 offset:18432
    v_cvt_pk_bf16_f32 v153, v154, v155
    v_mfma_f32_16x16x32_bf16 v[164:167], a[156:159], v[60:63], v[164:167]
    ds_read_b64_tr_b16 a[180:181], v19 offset:20480
    buffer_load_dwordx4 v[48:51], v12, s[8:11], s74 offen sc1
    v_cvt_pk_bf16_f32 v154, v184, v185
    v_mfma_f32_16x16x32_bf16 v[168:171], a[160:163], v[116:119], v[168:171]
    ds_read_b64_tr_b16 a[182:183], v19 offset:22528
    v_cvt_pk_bf16_f32 v155, v186, v187
    v_mfma_f32_16x16x32_bf16 v[172:175], a[160:163], v[124:127], v[172:175]
    s_waitcnt lgkmcnt(6)
    ds_read_b64_tr_b16 a[184:185], v19 offset:24576
    v_mfma_f32_16x16x32_bf16 v[168:171], a[164:167], v[132:135], v[168:171]
    ds_read_b64_tr_b16 a[186:187], v19 offset:26624
    buffer_store_dwordx4 v[152:155], v3, s[60:63], s89 offen offset:3072 sc1
    v_mfma_f32_16x16x32_bf16 v[172:175], a[164:167], v[140:143], v[172:175]
    ds_read_b64_tr_b16 a[188:189], v19 offset:28672
    v_mfma_f32_16x16x32_bf16 v[168:171], a[168:171], v[212:215], v[168:171]
    ds_read_b64_tr_b16 a[190:191], v19 offset:30720
    v_mfma_f32_16x16x32_bf16 v[172:175], a[168:171], v[52:55], v[172:175]
    s_waitcnt lgkmcnt(6)
    ds_read_b64_tr_b16 a[128:129], v20 offset:16384
    v_mfma_f32_16x16x32_bf16 v[168:171], a[172:175], v[244:247], v[168:171]
    ds_read_b64_tr_b16 a[130:131], v20 offset:18432
    v_mfma_f32_16x16x32_bf16 v[172:175], a[172:175], v[60:63], v[172:175]
    ds_read_b64_tr_b16 a[132:133], v20 offset:20480
    v_mfma_f32_16x16x32_bf16 v[224:227], a[176:179], v[116:119], v[224:227]
    ds_read_b64_tr_b16 a[134:135], v20 offset:22528
    v_mfma_f32_16x16x32_bf16 v[228:231], a[176:179], v[124:127], v[228:231]
    s_waitcnt lgkmcnt(6)
    ds_read_b64_tr_b16 a[136:137], v20 offset:24576
    v_mfma_f32_16x16x32_bf16 v[224:227], a[180:183], v[132:135], v[224:227]
    ds_read_b64_tr_b16 a[138:139], v20 offset:26624
    v_mfma_f32_16x16x32_bf16 v[228:231], a[180:183], v[140:143], v[228:231]
    s_waitcnt lgkmcnt(6)
    ds_read_b64_tr_b16 a[140:141], v20 offset:28672
    v_mul_f32 v160, v16, v160
    v_mfma_f32_16x16x32_bf16 v[224:227], a[184:187], v[212:215], v[224:227]
    s_ff1_i32_b32 s96, s73
    ds_read_b64_tr_b16 a[142:143], v20 offset:30720
    v_mul_f32 v161, v16, v161
    v_xor_b32 v7, 131072, v7
    v_mfma_f32_16x16x32_bf16 v[228:231], a[184:187], v[52:55], v[228:231]
    s_mul_i32 s74, s96, 1839104
    ds_read_b64_tr_b16 a[144:145], v7 offset:32768
    v_mul_f32 v162, v16, v162
    v_mfma_f32_16x16x32_bf16 v[224:227], a[188:191], v[244:247], v[224:227]
    s_bitset1_b32 s72, s96
    ds_read_b64_tr_b16 a[146:147], v7 offset:34816
    v_mul_f32 v163, v16, v163
    v_mfma_f32_16x16x32_bf16 v[228:231], a[188:191], v[60:63], v[228:231]
    s_waitcnt lgkmcnt(6)
    s_cmp_lg_u32 s73, 0
    ds_read_b64_tr_b16 a[148:149], v7 offset:36864
    v_mul_f32 v168, v16, v168
    v_mfma_f32_16x16x32_bf16 v[232:235], a[128:131], v[116:119], v[232:235]
    s_cselect_b32 s74, s74, 2147483648
    ds_read_b64_tr_b16 a[150:151], v7 offset:38912
    v_mul_f32 v169, v16, v169
    v_mfma_f32_16x16x32_bf16 v[236:239], a[128:131], v[124:127], v[236:239]
    s_bitset0_b32 s73, s96
    ds_read_b64_tr_b16 a[152:153], v7 offset:40960
    buffer_load_dwordx4 v[72:75], v11, s[8:11], s74 offen sc1
    v_mul_f32 v170, v16, v170
    v_mfma_f32_16x16x32_bf16 v[232:235], a[132:135], v[132:135], v[232:235]
    ds_read_b64_tr_b16 a[154:155], v7 offset:43008
    v_mul_f32 v171, v16, v171
    v_mfma_f32_16x16x32_bf16 v[236:239], a[132:135], v[140:143], v[236:239]
    s_waitcnt lgkmcnt(6)
    ds_read_b64_tr_b16 a[156:157], v7 offset:45056
    buffer_load_dwordx4 v[80:83], v12, s[8:11], s74 offen sc1
    v_cvt_pk_bf16_f32 v160, v160, v161
    v_mfma_f32_16x16x32_bf16 v[232:235], a[136:139], v[212:215], v[232:235]
    ds_read_b64_tr_b16 a[158:159], v7 offset:47104
    v_cvt_pk_bf16_f32 v161, v162, v163
    v_xor_b32 v18, 131072, v18
    v_mfma_f32_16x16x32_bf16 v[236:239], a[136:139], v[52:55], v[236:239]
    ds_read_b64_tr_b16 a[160:161], v18 offset:32768
    v_cvt_pk_bf16_f32 v162, v168, v169
    v_mfma_f32_16x16x32_bf16 v[232:235], a[140:143], v[244:247], v[232:235]
    s_waitcnt lgkmcnt(6)
    ds_read_b64_tr_b16 a[162:163], v18 offset:34816
    v_cvt_pk_bf16_f32 v163, v170, v171
    v_mfma_f32_16x16x32_bf16 v[236:239], a[140:143], v[60:63], v[236:239]
    s_mov_b32 s89, 16384
    ds_read_b64_tr_b16 a[164:165], v18 offset:36864
    v_mfma_f32_16x16x32_bf16 v[208:211], a[144:147], v[32:35], 0
    ds_read_b64_tr_b16 a[166:167], v18 offset:38912
    buffer_store_dwordx4 v[160:163], v3, s[60:63], s89 offen offset:0 sc1
    v_mfma_f32_16x16x32_bf16 v[216:219], a[144:147], v[40:43], 0
    s_waitcnt lgkmcnt(6)
    ds_read_b64_tr_b16 a[168:169], v18 offset:40960
    v_mul_f32 v164, v17, v164
    v_mfma_f32_16x16x32_bf16 v[208:211], a[148:151], v[68:71], v[208:211]
    s_waitcnt vmcnt(22)
    ds_read_b64_tr_b16 a[170:171], v18 offset:43008
    v_mul_f32 v165, v17, v165
    v_mfma_f32_16x16x32_bf16 v[216:219], a[148:151], v[76:79], v[216:219]
    s_barrier
    ds_read_b64_tr_b16 a[172:173], v18 offset:45056
    v_mul_f32 v166, v17, v166
    v_mfma_f32_16x16x32_bf16 v[208:211], a[152:155], v[84:87], v[208:211]
    ds_read_b64_tr_b16 a[174:175], v18 offset:47104
    v_mul_f32 v167, v17, v167
    v_xor_b32 v19, 131072, v19
    v_mfma_f32_16x16x32_bf16 v[216:219], a[152:155], v[92:95], v[216:219]
    s_waitcnt lgkmcnt(6)
    ds_read_b64_tr_b16 a[176:177], v19 offset:32768
    v_mul_f32 v172, v17, v172
    v_mfma_f32_16x16x32_bf16 v[208:211], a[156:159], v[100:103], v[208:211]
    ds_read_b64_tr_b16 a[178:179], v19 offset:34816
    v_mul_f32 v173, v17, v173
    v_mfma_f32_16x16x32_bf16 v[216:219], a[156:159], v[108:111], v[216:219]
    s_waitcnt lgkmcnt(6)
    ds_read_b64_tr_b16 a[180:181], v19 offset:36864
    v_mul_f32 v174, v17, v174
    v_mfma_f32_16x16x32_bf16 v[240:243], a[160:163], v[32:35], 0
    s_ff1_i32_b32 s96, s73
    ds_read_b64_tr_b16 a[182:183], v19 offset:38912
    v_mul_f32 v175, v17, v175
    v_mfma_f32_16x16x32_bf16 v[248:251], a[160:163], v[40:43], 0
    s_mul_i32 s74, s96, 1839104
    ds_read_b64_tr_b16 a[184:185], v19 offset:40960
    v_cvt_pk_bf16_f32 v164, v164, v165
    v_mfma_f32_16x16x32_bf16 v[240:243], a[164:167], v[68:71], v[240:243]
    s_bitset1_b32 s72, s96
    ds_read_b64_tr_b16 a[186:187], v19 offset:43008
    v_cvt_pk_bf16_f32 v165, v166, v167
    v_mfma_f32_16x16x32_bf16 v[248:251], a[164:167], v[76:79], v[248:251]
    s_waitcnt lgkmcnt(6)
    s_cmp_lg_u32 s73, 0
    ds_read_b64_tr_b16 a[188:189], v19 offset:45056
    v_cvt_pk_bf16_f32 v166, v172, v173
    v_mfma_f32_16x16x32_bf16 v[240:243], a[168:171], v[84:87], v[240:243]
    s_cselect_b32 s74, s74, 2147483648
    ds_read_b64_tr_b16 a[190:191], v19 offset:47104
    v_cvt_pk_bf16_f32 v167, v174, v175
    v_xor_b32 v20, 131072, v20
    v_mfma_f32_16x16x32_bf16 v[248:251], a[168:171], v[92:95], v[248:251]
    s_bitset0_b32 s73, s96
    ds_read_b64_tr_b16 a[128:129], v20 offset:32768
    buffer_load_dwordx4 v[88:91], v11, s[8:11], s74 offen sc1
    v_mfma_f32_16x16x32_bf16 v[240:243], a[172:175], v[100:103], v[240:243]
    ds_read_b64_tr_b16 a[130:131], v20 offset:34816
    buffer_store_dwordx4 v[164:167], v3, s[60:63], s89 offen offset:2048 sc1
    v_mfma_f32_16x16x32_bf16 v[248:251], a[172:175], v[108:111], v[248:251]
    s_waitcnt lgkmcnt(6)
    ds_read_b64_tr_b16 a[132:133], v20 offset:36864
    buffer_load_dwordx4 v[96:99], v12, s[8:11], s74 offen sc1
    v_mul_f32 v224, v16, v224
    v_mfma_f32_16x16x32_bf16 v[144:147], a[176:179], v[32:35], 0
    ds_read_b64_tr_b16 a[134:135], v20 offset:38912
    v_mul_f32 v225, v16, v225
    v_mfma_f32_16x16x32_bf16 v[152:155], a[176:179], v[40:43], 0
    ds_read_b64_tr_b16 a[136:137], v20 offset:40960
    v_mul_f32 v226, v16, v226
    v_mfma_f32_16x16x32_bf16 v[144:147], a[180:183], v[68:71], v[144:147]
    ds_read_b64_tr_b16 a[138:139], v20 offset:43008
    v_mul_f32 v227, v16, v227
    v_mfma_f32_16x16x32_bf16 v[152:155], a[180:183], v[76:79], v[152:155]
    s_waitcnt lgkmcnt(6)
    ds_read_b64_tr_b16 a[140:141], v20 offset:45056
    v_mul_f32 v232, v16, v232
    v_mfma_f32_16x16x32_bf16 v[144:147], a[184:187], v[84:87], v[144:147]
    ds_read_b64_tr_b16 a[142:143], v20 offset:47104
    buffer_load_dword v206, v14, s[16:19], s77 offen sc1
    v_mul_f32 v233, v16, v233
    v_mfma_f32_16x16x32_bf16 v[152:155], a[184:187], v[92:95], v[152:155]
    ds_read_b64_tr_b16 a[144:145], v7 offset:49152
    v_mul_f32 v234, v16, v234
    v_mfma_f32_16x16x32_bf16 v[144:147], a[188:191], v[100:103], v[144:147]
    ds_read_b64_tr_b16 a[146:147], v7 offset:51200
    v_mul_f32 v235, v16, v235
    v_mfma_f32_16x16x32_bf16 v[152:155], a[188:191], v[108:111], v[152:155]
    s_waitcnt lgkmcnt(6)
    ds_read_b64_tr_b16 a[148:149], v7 offset:53248
    v_cvt_pk_bf16_f32 v224, v224, v225
    v_mfma_f32_16x16x32_bf16 v[176:179], a[128:131], v[32:35], 0
    ds_read_b64_tr_b16 a[150:151], v7 offset:55296
    v_cvt_pk_bf16_f32 v225, v226, v227
    v_mfma_f32_16x16x32_bf16 v[184:187], a[128:131], v[40:43], 0
    ds_read_b64_tr_b16 a[152:153], v7 offset:57344
    v_cvt_pk_bf16_f32 v226, v232, v233
    v_mfma_f32_16x16x32_bf16 v[176:179], a[132:135], v[68:71], v[176:179]
    s_waitcnt lgkmcnt(6)
    ds_read_b64_tr_b16 a[154:155], v7 offset:59392
    v_cvt_pk_bf16_f32 v227, v234, v235
    v_mfma_f32_16x16x32_bf16 v[184:187], a[132:135], v[76:79], v[184:187]
    s_mov_b32 s89, 16384
    ds_read_b64_tr_b16 a[156:157], v7 offset:61440
    v_mfma_f32_16x16x32_bf16 v[176:179], a[136:139], v[84:87], v[176:179]
    s_ff1_i32_b32 s96, s73
    ds_read_b64_tr_b16 a[158:159], v7 offset:63488
    buffer_store_dwordx4 v[224:227], v3, s[60:63], s89 offen offset:1024 sc1
    v_mfma_f32_16x16x32_bf16 v[184:187], a[136:139], v[92:95], v[184:187]
    s_waitcnt lgkmcnt(6)
    s_mul_i32 s74, s96, 1839104
    ds_read_b64_tr_b16 a[160:161], v18 offset:49152
    v_mul_f32 v228, v17, v228
    v_mfma_f32_16x16x32_bf16 v[176:179], a[140:143], v[100:103], v[176:179]
    s_bitset1_b32 s72, s96
    ds_read_b64_tr_b16 a[162:163], v18 offset:51200
    v_mul_f32 v229, v17, v229
    v_mfma_f32_16x16x32_bf16 v[184:187], a[140:143], v[108:111], v[184:187]
    s_cmp_lg_u32 s73, 0
    ds_read_b64_tr_b16 a[164:165], v18 offset:53248
    v_mul_f32 v230, v17, v230
    v_mfma_f32_16x16x32_bf16 v[208:211], a[144:147], v[116:119], v[208:211]
    s_cselect_b32 s74, s74, 2147483648
    ds_read_b64_tr_b16 a[166:167], v18 offset:55296
    v_mul_f32 v231, v17, v231
    v_mfma_f32_16x16x32_bf16 v[216:219], a[144:147], v[124:127], v[216:219]
    s_waitcnt lgkmcnt(6)
    s_bitset0_b32 s73, s96
    ds_read_b64_tr_b16 a[168:169], v18 offset:57344
    buffer_load_dwordx4 v[104:107], v11, s[8:11], s74 offen sc1
    v_mul_f32 v236, v17, v236
    v_mfma_f32_16x16x32_bf16 v[208:211], a[148:151], v[132:135], v[208:211]
    ds_read_b64_tr_b16 a[170:171], v18 offset:59392
    v_mul_f32 v237, v17, v237
    v_mfma_f32_16x16x32_bf16 v[216:219], a[148:151], v[140:143], v[216:219]
    ds_read_b64_tr_b16 a[172:173], v18 offset:61440
    buffer_load_dwordx4 v[112:115], v12, s[8:11], s74 offen sc1
    v_mul_f32 v238, v17, v238
    v_mfma_f32_16x16x32_bf16 v[208:211], a[152:155], v[212:215], v[208:211]
    ds_read_b64_tr_b16 a[174:175], v18 offset:63488
    v_mul_f32 v239, v17, v239
    v_mfma_f32_16x16x32_bf16 v[216:219], a[152:155], v[52:55], v[216:219]
    s_waitcnt lgkmcnt(6)
    ds_read_b64_tr_b16 a[176:177], v19 offset:49152
    v_cvt_pk_bf16_f32 v228, v228, v229
    v_mfma_f32_16x16x32_bf16 v[208:211], a[156:159], v[244:247], v[208:211]
    ds_read_b64_tr_b16 a[178:179], v19 offset:51200
    v_cvt_pk_bf16_f32 v229, v230, v231
    v_mfma_f32_16x16x32_bf16 v[216:219], a[156:159], v[60:63], v[216:219]
    ds_read_b64_tr_b16 a[180:181], v19 offset:53248
    v_cvt_pk_bf16_f32 v230, v236, v237
    v_mfma_f32_16x16x32_bf16 v[240:243], a[160:163], v[116:119], v[240:243]
    ds_read_b64_tr_b16 a[182:183], v19 offset:55296
    v_cvt_pk_bf16_f32 v231, v238, v239
    v_mfma_f32_16x16x32_bf16 v[248:251], a[160:163], v[124:127], v[248:251]
    s_waitcnt lgkmcnt(6)
    ds_read_b64_tr_b16 a[184:185], v19 offset:57344
    v_mfma_f32_16x16x32_bf16 v[240:243], a[164:167], v[132:135], v[240:243]
    ds_read_b64_tr_b16 a[186:187], v19 offset:59392
    buffer_store_dwordx4 v[228:231], v3, s[60:63], s89 offen offset:3072 sc1
    v_mfma_f32_16x16x32_bf16 v[248:251], a[164:167], v[140:143], v[248:251]
    ds_read_b64_tr_b16 a[188:189], v19 offset:61440
    v_mfma_f32_16x16x32_bf16 v[240:243], a[168:171], v[212:215], v[240:243]
    ds_read_b64_tr_b16 a[190:191], v19 offset:63488
    v_mfma_f32_16x16x32_bf16 v[248:251], a[168:171], v[52:55], v[248:251]
    s_waitcnt lgkmcnt(6)
    ds_read_b64_tr_b16 a[128:129], v20 offset:49152
    v_mfma_f32_16x16x32_bf16 v[240:243], a[172:175], v[244:247], v[240:243]
    ds_read_b64_tr_b16 a[130:131], v20 offset:51200
    v_mfma_f32_16x16x32_bf16 v[248:251], a[172:175], v[60:63], v[248:251]
    ds_read_b64_tr_b16 a[132:133], v20 offset:53248
    v_mfma_f32_16x16x32_bf16 v[144:147], a[176:179], v[116:119], v[144:147]
    s_waitcnt vmcnt(4)
    ds_read_b64_tr_b16 a[134:135], v20 offset:55296
    v_cmp_ne_u32 vcc, 0, v206
    v_mfma_f32_16x16x32_bf16 v[152:155], a[176:179], v[124:127], v[152:155]
    s_waitcnt lgkmcnt(6)
    ds_read_b64_tr_b16 a[136:137], v20 offset:57344
    v_mfma_f32_16x16x32_bf16 v[144:147], a[180:183], v[132:135], v[144:147]
    s_andn2_b32 s73, vcc_lo, s72
    ds_read_b64_tr_b16 a[138:139], v20 offset:59392
    v_mfma_f32_16x16x32_bf16 v[152:155], a[180:183], v[140:143], v[152:155]
    s_and_b32 s73, s73, 65535
    ds_read_b64_tr_b16 a[140:141], v20 offset:61440
    v_mul_f32 v208, v16, v208
    v_mfma_f32_16x16x32_bf16 v[144:147], a[184:187], v[212:215], v[144:147]
    s_ff1_i32_b32 s96, s73
    ds_read_b64_tr_b16 a[142:143], v20 offset:63488
    v_mul_f32 v209, v16, v209
    v_xor_b32 v7, 65536, v7
    v_mfma_f32_16x16x32_bf16 v[152:155], a[184:187], v[52:55], v[152:155]
    s_waitcnt lgkmcnt(6)
    s_mul_i32 s74, s96, 1839104
    ds_read_b64_tr_b16 a[144:145], v7 offset:0
    v_mul_f32 v210, v16, v210
    v_mfma_f32_16x16x32_bf16 v[144:147], a[188:191], v[244:247], v[144:147]
    s_bitset1_b32 s72, s96
    ds_read_b64_tr_b16 a[146:147], v7 offset:2048
    v_mul_f32 v211, v16, v211
    v_mfma_f32_16x16x32_bf16 v[152:155], a[188:191], v[60:63], v[152:155]
    s_cmp_lg_u32 s73, 0
    ds_read_b64_tr_b16 a[148:149], v7 offset:4096
    v_mul_f32 v240, v16, v240
    v_mfma_f32_16x16x32_bf16 v[176:179], a[128:131], v[116:119], v[176:179]
    s_cselect_b32 s74, s74, 2147483648
    ds_read_b64_tr_b16 a[150:151], v7 offset:6144
    v_mul_f32 v241, v16, v241
    v_mfma_f32_16x16x32_bf16 v[184:187], a[128:131], v[124:127], v[184:187]
    s_waitcnt lgkmcnt(6)
    s_bitset0_b32 s73, s96
    ds_read_b64_tr_b16 a[152:153], v7 offset:8192
    buffer_load_dwordx4 v[120:123], v11, s[8:11], s74 offen sc1
    v_mul_f32 v242, v16, v242
    v_mfma_f32_16x16x32_bf16 v[176:179], a[132:135], v[132:135], v[176:179]
    ds_read_b64_tr_b16 a[154:155], v7 offset:10240
    v_mul_f32 v243, v16, v243
    v_mfma_f32_16x16x32_bf16 v[184:187], a[132:135], v[140:143], v[184:187]
    ds_read_b64_tr_b16 a[156:157], v7 offset:12288
    buffer_load_dwordx4 v[128:131], v12, s[8:11], s74 offen sc1
    v_cvt_pk_bf16_f32 v208, v208, v209
    v_mfma_f32_16x16x32_bf16 v[176:179], a[136:139], v[212:215], v[176:179]
    ds_read_b64_tr_b16 a[158:159], v7 offset:14336
    v_cvt_pk_bf16_f32 v209, v210, v211
    v_xor_b32 v18, 65536, v18
    v_mfma_f32_16x16x32_bf16 v[184:187], a[136:139], v[52:55], v[184:187]
    s_waitcnt lgkmcnt(6)
    ds_read_b64_tr_b16 a[160:161], v18 offset:0
    v_cvt_pk_bf16_f32 v210, v240, v241
    v_mfma_f32_16x16x32_bf16 v[176:179], a[140:143], v[244:247], v[176:179]
    ds_read_b64_tr_b16 a[162:163], v18 offset:2048
    v_cvt_pk_bf16_f32 v211, v242, v243
    v_mfma_f32_16x16x32_bf16 v[184:187], a[140:143], v[60:63], v[184:187]
    s_mov_b32 s89, 20480
    ds_read_b64_tr_b16 a[164:165], v18 offset:4096
    v_mfma_f32_16x16x32_bf16 v[160:163], a[144:147], v[32:35], 0
    ds_read_b64_tr_b16 a[166:167], v18 offset:6144
    buffer_store_dwordx4 v[208:211], v3, s[60:63], s89 offen offset:0 sc1
    v_mfma_f32_16x16x32_bf16 v[164:167], a[144:147], v[40:43], 0
    s_waitcnt lgkmcnt(6)
    ds_read_b64_tr_b16 a[168:169], v18 offset:8192
    v_mul_f32 v216, v17, v216
    v_mfma_f32_16x16x32_bf16 v[160:163], a[148:151], v[68:71], v[160:163]
    s_waitcnt vmcnt(26)
    ds_read_b64_tr_b16 a[170:171], v18 offset:10240
    v_mul_f32 v217, v17, v217
    v_mfma_f32_16x16x32_bf16 v[164:167], a[148:151], v[76:79], v[164:167]
    s_barrier
    ds_read_b64_tr_b16 a[172:173], v18 offset:12288
    v_mul_f32 v218, v17, v218
    v_mfma_f32_16x16x32_bf16 v[160:163], a[152:155], v[84:87], v[160:163]
    ds_read_b64_tr_b16 a[174:175], v18 offset:14336
    v_mul_f32 v219, v17, v219
    v_xor_b32 v19, 65536, v19
    v_mfma_f32_16x16x32_bf16 v[164:167], a[152:155], v[92:95], v[164:167]
    s_waitcnt lgkmcnt(6)
    ds_read_b64_tr_b16 a[176:177], v19 offset:0
    v_mul_f32 v248, v17, v248
    v_mfma_f32_16x16x32_bf16 v[160:163], a[156:159], v[100:103], v[160:163]
    s_ff1_i32_b32 s96, s73
    ds_read_b64_tr_b16 a[178:179], v19 offset:2048
    v_mul_f32 v249, v17, v249
    v_mfma_f32_16x16x32_bf16 v[164:167], a[156:159], v[108:111], v[164:167]
    s_mul_i32 s74, s96, 1839104
    ds_read_b64_tr_b16 a[180:181], v19 offset:4096
    v_mul_f32 v250, v17, v250
    v_mfma_f32_16x16x32_bf16 v[168:171], a[160:163], v[32:35], 0
    s_bitset1_b32 s72, s96
    ds_read_b64_tr_b16 a[182:183], v19 offset:6144
    v_mul_f32 v251, v17, v251
    v_mfma_f32_16x16x32_bf16 v[172:175], a[160:163], v[40:43], 0
    s_waitcnt lgkmcnt(6)
    s_cmp_lg_u32 s73, 0
    ds_read_b64_tr_b16 a[184:185], v19 offset:8192
    v_cvt_pk_bf16_f32 v216, v216, v217
    v_mfma_f32_16x16x32_bf16 v[168:171], a[164:167], v[68:71], v[168:171]
    s_cselect_b32 s74, s74, 2147483648
    ds_read_b64_tr_b16 a[186:187], v19 offset:10240
    v_cvt_pk_bf16_f32 v217, v218, v219
    v_mfma_f32_16x16x32_bf16 v[172:175], a[164:167], v[76:79], v[172:175]
    s_bitset0_b32 s73, s96
    ds_read_b64_tr_b16 a[188:189], v19 offset:12288
    buffer_load_dwordx4 v[136:139], v11, s[8:11], s74 offen sc1
    v_cvt_pk_bf16_f32 v218, v248, v249
    v_mfma_f32_16x16x32_bf16 v[168:171], a[168:171], v[84:87], v[168:171]
    ds_read_b64_tr_b16 a[190:191], v19 offset:14336
    v_cvt_pk_bf16_f32 v219, v250, v251
    v_xor_b32 v20, 65536, v20
    v_mfma_f32_16x16x32_bf16 v[172:175], a[168:171], v[92:95], v[172:175]
    s_waitcnt lgkmcnt(6)
    ds_read_b64_tr_b16 a[128:129], v20 offset:0
    buffer_load_dwordx4 v[44:47], v12, s[8:11], s74 offen sc1
    v_mfma_f32_16x16x32_bf16 v[168:171], a[172:175], v[100:103], v[168:171]
    ds_read_b64_tr_b16 a[130:131], v20 offset:2048
    buffer_store_dwordx4 v[216:219], v3, s[60:63], s89 offen offset:2048 sc1
    v_mfma_f32_16x16x32_bf16 v[172:175], a[172:175], v[108:111], v[172:175]
    ds_read_b64_tr_b16 a[132:133], v20 offset:4096
    v_mul_f32 v144, v16, v144
    v_mfma_f32_16x16x32_bf16 v[224:227], a[176:179], v[32:35], 0
    ds_read_b64_tr_b16 a[134:135], v20 offset:6144
    v_mul_f32 v145, v16, v145
    v_mfma_f32_16x16x32_bf16 v[228:231], a[176:179], v[40:43], 0
    s_waitcnt lgkmcnt(6)
    ds_read_b64_tr_b16 a[136:137], v20 offset:8192
    v_mul_f32 v146, v16, v146
    v_mfma_f32_16x16x32_bf16 v[224:227], a[180:183], v[68:71], v[224:227]
    ds_read_b64_tr_b16 a[138:139], v20 offset:10240
    v_mul_f32 v147, v16, v147
    v_mfma_f32_16x16x32_bf16 v[228:231], a[180:183], v[76:79], v[228:231]
    ds_read_b64_tr_b16 a[140:141], v20 offset:12288
    v_mul_f32 v176, v16, v176
    v_mfma_f32_16x16x32_bf16 v[224:227], a[184:187], v[84:87], v[224:227]
    ds_read_b64_tr_b16 a[142:143], v20 offset:14336
    v_mul_f32 v177, v16, v177
    v_mfma_f32_16x16x32_bf16 v[228:231], a[184:187], v[92:95], v[228:231]
    s_waitcnt lgkmcnt(6)
    ds_read_b64_tr_b16 a[144:145], v7 offset:16384
    v_mul_f32 v178, v16, v178
    v_mfma_f32_16x16x32_bf16 v[224:227], a[188:191], v[100:103], v[224:227]
    ds_read_b64_tr_b16 a[146:147], v7 offset:18432
    v_mul_f32 v179, v16, v179
    v_mfma_f32_16x16x32_bf16 v[228:231], a[188:191], v[108:111], v[228:231]
    s_waitcnt lgkmcnt(6)
    ds_read_b64_tr_b16 a[148:149], v7 offset:20480
    v_cvt_pk_bf16_f32 v144, v144, v145
    v_mfma_f32_16x16x32_bf16 v[232:235], a[128:131], v[32:35], 0
    s_ff1_i32_b32 s96, s73
    ds_read_b64_tr_b16 a[150:151], v7 offset:22528
    v_cvt_pk_bf16_f32 v145, v146, v147
    v_mfma_f32_16x16x32_bf16 v[236:239], a[128:131], v[40:43], 0
    s_mul_i32 s74, s96, 1839104
    ds_read_b64_tr_b16 a[152:153], v7 offset:24576
    v_cvt_pk_bf16_f32 v146, v176, v177
    v_mfma_f32_16x16x32_bf16 v[232:235], a[132:135], v[68:71], v[232:235]
    s_bitset1_b32 s72, s96
    ds_read_b64_tr_b16 a[154:155], v7 offset:26624
    v_cvt_pk_bf16_f32 v147, v178, v179
    v_mfma_f32_16x16x32_bf16 v[236:239], a[132:135], v[76:79], v[236:239]
    s_waitcnt lgkmcnt(6)
    s_mov_b32 s89, 20480
    s_cmp_lg_u32 s73, 0
    ds_read_b64_tr_b16 a[156:157], v7 offset:28672
    v_mfma_f32_16x16x32_bf16 v[232:235], a[136:139], v[84:87], v[232:235]
    s_cselect_b32 s74, s74, 2147483648
    ds_read_b64_tr_b16 a[158:159], v7 offset:30720
    buffer_store_dwordx4 v[144:147], v3, s[60:63], s89 offen offset:1024 sc1
    v_mfma_f32_16x16x32_bf16 v[236:239], a[136:139], v[92:95], v[236:239]
    s_bitset0_b32 s73, s96
    ds_read_b64_tr_b16 a[160:161], v18 offset:16384
    buffer_load_dwordx4 v[220:223], v11, s[8:11], s74 offen sc1
    v_mul_f32 v152, v17, v152
    v_mfma_f32_16x16x32_bf16 v[232:235], a[140:143], v[100:103], v[232:235]
    ds_read_b64_tr_b16 a[162:163], v18 offset:18432
    v_mul_f32 v153, v17, v153
    v_mfma_f32_16x16x32_bf16 v[236:239], a[140:143], v[108:111], v[236:239]
    s_waitcnt lgkmcnt(6)
    ds_read_b64_tr_b16 a[164:165], v18 offset:20480
    buffer_load_dwordx4 v[56:59], v12, s[8:11], s74 offen sc1
    v_mul_f32 v154, v17, v154
    v_mfma_f32_16x16x32_bf16 v[160:163], a[144:147], v[116:119], v[160:163]
    ds_read_b64_tr_b16 a[166:167], v18 offset:22528
    v_mul_f32 v155, v17, v155
    v_mfma_f32_16x16x32_bf16 v[164:167], a[144:147], v[124:127], v[164:167]
    ds_read_b64_tr_b16 a[168:169], v18 offset:24576
    v_mul_f32 v184, v17, v184
    v_mfma_f32_16x16x32_bf16 v[160:163], a[148:151], v[132:135], v[160:163]
    ds_read_b64_tr_b16 a[170:171], v18 offset:26624
    v_mul_f32 v185, v17, v185
    v_mfma_f32_16x16x32_bf16 v[164:167], a[148:151], v[140:143], v[164:167]
    s_waitcnt lgkmcnt(6)
    ds_read_b64_tr_b16 a[172:173], v18 offset:28672
    v_mul_f32 v186, v17, v186
    v_mfma_f32_16x16x32_bf16 v[160:163], a[152:155], v[212:215], v[160:163]
    ds_read_b64_tr_b16 a[174:175], v18 offset:30720
    v_mul_f32 v187, v17, v187
    v_mfma_f32_16x16x32_bf16 v[164:167], a[152:155], v[52:55], v[164:167]
    ds_read_b64_tr_b16 a[176:177], v19 offset:16384
    v_cvt_pk_bf16_f32 v152, v152, v153
    v_mfma_f32_16x16x32_bf16 v[160:163], a[156:159], v[244:247], v[160:163]
    ds_read_b64_tr_b16 a[178:179], v19 offset:18432
    v_cvt_pk_bf16_f32 v153, v154, v155
    v_mfma_f32_16x16x32_bf16 v[164:167], a[156:159], v[60:63], v[164:167]
    s_waitcnt lgkmcnt(6)
    ds_read_b64_tr_b16 a[180:181], v19 offset:20480
    v_cvt_pk_bf16_f32 v154, v184, v185
    v_mfma_f32_16x16x32_bf16 v[168:171], a[160:163], v[116:119], v[168:171]
    ds_read_b64_tr_b16 a[182:183], v19 offset:22528
    v_cvt_pk_bf16_f32 v155, v186, v187
    v_mfma_f32_16x16x32_bf16 v[172:175], a[160:163], v[124:127], v[172:175]
    s_waitcnt lgkmcnt(6)
    ds_read_b64_tr_b16 a[184:185], v19 offset:24576
    v_mfma_f32_16x16x32_bf16 v[168:171], a[164:167], v[132:135], v[168:171]
    s_ff1_i32_b32 s96, s73
    ds_read_b64_tr_b16 a[186:187], v19 offset:26624
    buffer_store_dwordx4 v[152:155], v3, s[60:63], s89 offen offset:3072 sc1
    v_mfma_f32_16x16x32_bf16 v[172:175], a[164:167], v[140:143], v[172:175]
    s_mul_i32 s74, s96, 1839104
    ds_read_b64_tr_b16 a[188:189], v19 offset:28672
    v_mfma_f32_16x16x32_bf16 v[168:171], a[168:171], v[212:215], v[168:171]
    s_bitset1_b32 s72, s96
    ds_read_b64_tr_b16 a[190:191], v19 offset:30720
    v_mfma_f32_16x16x32_bf16 v[172:175], a[168:171], v[52:55], v[172:175]
    s_waitcnt lgkmcnt(6)
    s_cmp_lg_u32 s73, 0
    ds_read_b64_tr_b16 a[128:129], v20 offset:16384
    v_mfma_f32_16x16x32_bf16 v[168:171], a[172:175], v[244:247], v[168:171]
    s_cselect_b32 s74, s74, 2147483648
    ds_read_b64_tr_b16 a[130:131], v20 offset:18432
    v_mfma_f32_16x16x32_bf16 v[172:175], a[172:175], v[60:63], v[172:175]
    s_bitset0_b32 s73, s96
    ds_read_b64_tr_b16 a[132:133], v20 offset:20480
    buffer_load_dwordx4 v[252:255], v11, s[8:11], s74 offen sc1
    v_mfma_f32_16x16x32_bf16 v[224:227], a[176:179], v[116:119], v[224:227]
    ds_read_b64_tr_b16 a[134:135], v20 offset:22528
    v_mfma_f32_16x16x32_bf16 v[228:231], a[176:179], v[124:127], v[228:231]
    s_waitcnt lgkmcnt(6)
    ds_read_b64_tr_b16 a[136:137], v20 offset:24576
    buffer_load_dwordx4 v[64:67], v12, s[8:11], s74 offen sc1
    v_mfma_f32_16x16x32_bf16 v[224:227], a[180:183], v[132:135], v[224:227]
    ds_read_b64_tr_b16 a[138:139], v20 offset:26624
    v_mfma_f32_16x16x32_bf16 v[228:231], a[180:183], v[140:143], v[228:231]
    ds_read_b64_tr_b16 a[140:141], v20 offset:28672
    v_mul_f32 v160, v16, v160
    v_mfma_f32_16x16x32_bf16 v[224:227], a[184:187], v[212:215], v[224:227]
    ds_read_b64_tr_b16 a[142:143], v20 offset:30720
    v_mul_f32 v161, v16, v161
    v_mfma_f32_16x16x32_bf16 v[228:231], a[184:187], v[52:55], v[228:231]
    s_waitcnt lgkmcnt(6)
    v_mul_f32 v162, v16, v162
    v_mfma_f32_16x16x32_bf16 v[224:227], a[188:191], v[244:247], v[224:227]
    v_mul_f32 v163, v16, v163
    v_mfma_f32_16x16x32_bf16 v[228:231], a[188:191], v[60:63], v[228:231]
    v_mul_f32 v168, v16, v168
    v_mfma_f32_16x16x32_bf16 v[232:235], a[128:131], v[116:119], v[232:235]
    v_mul_f32 v169, v16, v169
    v_mfma_f32_16x16x32_bf16 v[236:239], a[128:131], v[124:127], v[236:239]
    s_waitcnt lgkmcnt(2)
    v_mul_f32 v170, v16, v170
    v_mfma_f32_16x16x32_bf16 v[232:235], a[132:135], v[132:135], v[232:235]
    v_mul_f32 v171, v16, v171
    v_mfma_f32_16x16x32_bf16 v[236:239], a[132:135], v[140:143], v[236:239]
    v_cvt_pk_bf16_f32 v160, v160, v161
    v_mfma_f32_16x16x32_bf16 v[232:235], a[136:139], v[212:215], v[232:235]
    v_cvt_pk_bf16_f32 v161, v162, v163
    v_mfma_f32_16x16x32_bf16 v[236:239], a[136:139], v[52:55], v[236:239]
    s_waitcnt lgkmcnt(0)
    v_cvt_pk_bf16_f32 v162, v168, v169
    v_mfma_f32_16x16x32_bf16 v[232:235], a[140:143], v[244:247], v[232:235]
    v_cvt_pk_bf16_f32 v163, v170, v171
    v_mfma_f32_16x16x32_bf16 v[236:239], a[140:143], v[60:63], v[236:239]
    s_mov_b32 s89, 24576
    buffer_store_dwordx4 v[160:163], v3, s[60:63], s89 offen offset:0 sc1
    v_mul_f32 v164, v17, v164
    v_mul_f32 v165, v17, v165
    v_mul_f32 v166, v17, v166
    v_mul_f32 v167, v17, v167
    v_mul_f32 v172, v17, v172
    v_mul_f32 v173, v17, v173
    v_mul_f32 v174, v17, v174
    v_mul_f32 v175, v17, v175
    v_cvt_pk_bf16_f32 v164, v164, v165
    v_cvt_pk_bf16_f32 v165, v166, v167
    v_cvt_pk_bf16_f32 v166, v172, v173
    v_cvt_pk_bf16_f32 v167, v174, v175
    buffer_store_dwordx4 v[164:167], v3, s[60:63], s89 offen offset:2048 sc1
    v_mul_f32 v224, v16, v224
    v_mul_f32 v225, v16, v225
    v_mul_f32 v226, v16, v226
    v_mul_f32 v227, v16, v227
    v_mul_f32 v232, v16, v232
    v_mul_f32 v233, v16, v233
    v_mul_f32 v234, v16, v234
    v_mul_f32 v235, v16, v235
    v_cvt_pk_bf16_f32 v224, v224, v225
    v_cvt_pk_bf16_f32 v225, v226, v227
    v_cvt_pk_bf16_f32 v226, v232, v233
    v_cvt_pk_bf16_f32 v227, v234, v235
    s_mov_b32 s89, 24576
    buffer_store_dwordx4 v[224:227], v3, s[60:63], s89 offen offset:1024 sc1
    v_mul_f32 v228, v17, v228
    v_mul_f32 v229, v17, v229
    v_mul_f32 v230, v17, v230
    v_mul_f32 v231, v17, v231
    v_mul_f32 v236, v17, v236
    v_mul_f32 v237, v17, v237
    v_mul_f32 v238, v17, v238
    v_mul_f32 v239, v17, v239
    v_cvt_pk_bf16_f32 v228, v228, v229
    v_cvt_pk_bf16_f32 v229, v230, v231
    v_cvt_pk_bf16_f32 v230, v236, v237
    v_cvt_pk_bf16_f32 v231, v238, v239
    buffer_store_dwordx4 v[228:231], v3, s[60:63], s89 offen offset:3072 sc1
    s_lshl_b32 s74, s64, 2
    s_and_b32 s72, s72, 0xffff
    s_mov_b32 s75, 0
    v_accvgpr_read_b32 v208, a192
    v_accvgpr_read_b32 v209, a193
    v_accvgpr_read_b32 v210, a194
    v_accvgpr_read_b32 v211, a195
    v_accvgpr_read_b32 v216, a196
    v_accvgpr_read_b32 v217, a197
    v_accvgpr_read_b32 v218, a198
    v_accvgpr_read_b32 v219, a199
    v_accvgpr_read_b32 v240, a200
    v_accvgpr_read_b32 v241, a201
    v_accvgpr_read_b32 v242, a202
    v_accvgpr_read_b32 v243, a203
    v_accvgpr_read_b32 v248, a204
    v_accvgpr_read_b32 v249, a205
    v_accvgpr_read_b32 v250, a206
    v_accvgpr_read_b32 v251, a207
    v_mul_f32 v144, 0xbfb8aa3b, v208
    v_mul_f32 v145, 0xbfb8aa3b, v209
    v_mul_f32 v146, 0xbfb8aa3b, v210
    v_mul_f32 v147, 0xbfb8aa3b, v211
    v_mul_f32 v152, 0xbfb8aa3b, v216
    v_mul_f32 v153, 0xbfb8aa3b, v217
    v_mul_f32 v154, 0xbfb8aa3b, v218
    v_mul_f32 v155, 0xbfb8aa3b, v219
    v_mul_f32 v176, 0xbfb8aa3b, v240
    v_mul_f32 v177, 0xbfb8aa3b, v241
    v_mul_f32 v178, 0xbfb8aa3b, v242
    v_mul_f32 v179, 0xbfb8aa3b, v243
    v_mul_f32 v184, 0xbfb8aa3b, v248
    v_mul_f32 v185, 0xbfb8aa3b, v249
    v_mul_f32 v186, 0xbfb8aa3b, v250
    v_mul_f32 v187, 0xbfb8aa3b, v251
    v_exp_f32 v144, v144
    v_exp_f32 v145, v145
    v_exp_f32 v146, v146
    v_exp_f32 v147, v147
    v_exp_f32 v152, v152
    v_exp_f32 v153, v153
    v_exp_f32 v154, v154
    v_exp_f32 v155, v155
    v_exp_f32 v176, v176
    v_exp_f32 v177, v177
    v_exp_f32 v178, v178
    v_exp_f32 v179, v179
    v_exp_f32 v184, v184
    v_exp_f32 v185, v185
    v_exp_f32 v186, v186
    v_exp_f32 v187, v187
    v_add_f32 v144, 1.0, v144
    v_add_f32 v145, 1.0, v145
    v_add_f32 v146, 1.0, v146
    v_add_f32 v147, 1.0, v147
    v_add_f32 v152, 1.0, v152
    v_add_f32 v153, 1.0, v153
    v_add_f32 v154, 1.0, v154
    v_add_f32 v155, 1.0, v155
    v_add_f32 v176, 1.0, v176
    v_add_f32 v177, 1.0, v177
    v_add_f32 v178, 1.0, v178
    v_add_f32 v179, 1.0, v179
    v_add_f32 v184, 1.0, v184
    v_add_f32 v185, 1.0, v185
    v_add_f32 v186, 1.0, v186
    v_add_f32 v187, 1.0, v187
    v_rcp_f32 v144, v144
    v_rcp_f32 v145, v145
    v_rcp_f32 v146, v146
    v_rcp_f32 v147, v147
    v_rcp_f32 v152, v152
    v_rcp_f32 v153, v153
    v_rcp_f32 v154, v154
    v_rcp_f32 v155, v155
    v_rcp_f32 v176, v176
    v_rcp_f32 v177, v177
    v_rcp_f32 v178, v178
    v_rcp_f32 v179, v179
    v_rcp_f32 v184, v184
    v_rcp_f32 v185, v185
    v_rcp_f32 v186, v186
    v_rcp_f32 v187, v187
    v_mul_f32 v208, v208, v144
    v_mul_f32 v209, v209, v145
    v_mul_f32 v210, v210, v146
    v_mul_f32 v211, v211, v147
    v_mul_f32 v216, v216, v152
    v_mul_f32 v217, v217, v153
    v_mul_f32 v218, v218, v154
    v_mul_f32 v219, v219, v155
    v_mul_f32 v240, v240, v176
    v_mul_f32 v241, v241, v177
    v_mul_f32 v242, v242, v178
    v_mul_f32 v243, v243, v179
    v_mul_f32 v248, v248, v184
    v_mul_f32 v249, v249, v185
    v_mul_f32 v250, v250, v186
    v_mul_f32 v251, v251, v187
    s_waitcnt vmcnt(0)
    s_barrier
    buffer_store_dword v203, v204, s[16:19], s74 offen sc1
    buffer_load_dword v205, v14, s[16:19], s77 offen sc1
    v_mfma_f32_16x16x32_bf16 v[160:163], v[188:191], v[36:39], 0
    v_lshlrev_b32 v224, 16, v192
    v_and_b32 v225, 0xffff0000, v192
    v_mfma_f32_16x16x32_bf16 v[164:167], v[148:151], v[36:39], 0
    v_lshlrev_b32 v226, 16, v193
    v_and_b32 v227, 0xffff0000, v193
    v_mfma_f32_16x16x32_bf16 v[168:171], v[188:191], v[48:51], 0
    v_lshlrev_b32 v228, 16, v194
    v_and_b32 v229, 0xffff0000, v194
    v_mfma_f32_16x16x32_bf16 v[172:175], v[148:151], v[48:51], 0
    v_lshlrev_b32 v230, 16, v195
    v_and_b32 v231, 0xffff0000, v195
    v_mfma_f32_16x16x32_bf16 v[160:163], v[188:191], v[72:75], v[160:163]
    v_lshlrev_b32 v232, 16, v196
    v_and_b32 v233, 0xffff0000, v196
    v_mfma_f32_16x16x32_bf16 v[164:167], v[148:151], v[72:75], v[164:167]
    v_lshlrev_b32 v234, 16, v197
    v_and_b32 v235, 0xffff0000, v197
    v_mfma_f32_16x16x32_bf16 v[168:171], v[188:191], v[80:83], v[168:171]
    v_lshlrev_b32 v236, 16, v198
    v_and_b32 v237, 0xffff0000, v198
    v_mfma_f32_16x16x32_bf16 v[172:175], v[148:151], v[80:83], v[172:175]
    v_lshlrev_b32 v238, 16, v199
    v_and_b32 v239, 0xffff0000, v199
    v_mfma_f32_16x16x32_bf16 v[160:163], v[188:191], v[88:91], v[160:163]
    v_mfma_f32_16x16x32_bf16 v[164:167], v[148:151], v[88:91], v[164:167]
    v_mfma_f32_16x16x32_bf16 v[168:171], v[188:191], v[96:99], v[168:171]
    v_mfma_f32_16x16x32_bf16 v[172:175], v[148:151], v[96:99], v[172:175]
    v_mfma_f32_16x16x32_bf16 v[160:163], v[188:191], v[104:107], v[160:163]
    v_mfma_f32_16x16x32_bf16 v[164:167], v[148:151], v[104:107], v[164:167]
    v_mfma_f32_16x16x32_bf16 v[168:171], v[188:191], v[112:115], v[168:171]
    v_mfma_f32_16x16x32_bf16 v[172:175], v[148:151], v[112:115], v[172:175]
    v_mfma_f32_16x16x32_bf16 v[160:163], v[188:191], v[120:123], v[160:163]
    v_mfma_f32_16x16x32_bf16 v[164:167], v[148:151], v[120:123], v[164:167]
    v_mfma_f32_16x16x32_bf16 v[168:171], v[188:191], v[128:131], v[168:171]
    v_mfma_f32_16x16x32_bf16 v[172:175], v[148:151], v[128:131], v[172:175]
    v_mfma_f32_16x16x32_bf16 v[160:163], v[188:191], v[136:139], v[160:163]
    v_mfma_f32_16x16x32_bf16 v[164:167], v[148:151], v[136:139], v[164:167]
    v_mfma_f32_16x16x32_bf16 v[168:171], v[188:191], v[44:47], v[168:171]
    v_mfma_f32_16x16x32_bf16 v[172:175], v[148:151], v[44:47], v[172:175]
    v_mfma_f32_16x16x32_bf16 v[160:163], v[188:191], v[220:223], v[160:163]
    v_mfma_f32_16x16x32_bf16 v[164:167], v[148:151], v[220:223], v[164:167]
    v_mfma_f32_16x16x32_bf16 v[168:171], v[188:191], v[56:59], v[168:171]
    v_mfma_f32_16x16x32_bf16 v[172:175], v[148:151], v[56:59], v[172:175]
    v_mfma_f32_16x16x32_bf16 v[160:163], v[188:191], v[252:255], v[160:163]
    v_mfma_f32_16x16x32_bf16 v[164:167], v[148:151], v[252:255], v[164:167]
    v_mfma_f32_16x16x32_bf16 v[168:171], v[188:191], v[64:67], v[168:171]
    v_mfma_f32_16x16x32_bf16 v[172:175], v[148:151], v[64:67], v[172:175]
    s_mov_b32 s76, 0
    s_branch L_got
L_poll:
    buffer_load_dword v205, v14, s[16:19], s77 offen sc1
L_got:
    s_waitcnt vmcnt(0)
    v_cmp_ne_u32 vcc, 0, v205
    s_mov_b32 s73, s75
    s_nop 3
    s_andn2_b32 s75, vcc_lo, s72
    s_and_b32 s75, s75, 0xffff
    s_or_b32 s72, s72, s75
    s_bitcmp1_b32 s75, 0
    s_cbranch_scc0 L_skip0
    s_mov_b32 s96, 0
    buffer_load_dwordx4 a[0:3], v11, s[8:11], s96 offen sc1
    buffer_load_dwordx4 a[4:7], v12, s[8:11], s96 offen sc1
L_skip0:
    s_bitcmp1_b32 s75, 1
    s_cbranch_scc0 L_skip1
    s_mov_b32 s96, 1839104
    buffer_load_dwordx4 a[8:11], v11, s[8:11], s96 offen sc1
    buffer_load_dwordx4 a[12:15], v12, s[8:11], s96 offen sc1
L_skip1:
    s_bitcmp1_b32 s75, 2
    s_cbranch_scc0 L_skip2
    s_mov_b32 s96, 3678208
    buffer_load_dwordx4 a[16:19], v11, s[8:11], s96 offen sc1
    buffer_load_dwordx4 a[20:23], v12, s[8:11], s96 offen sc1
L_skip2:
    s_bitcmp1_b32 s75, 3
    s_cbranch_scc0 L_skip3
    s_mov_b32 s96, 5517312
    buffer_load_dwordx4 a[24:27], v11, s[8:11], s96 offen sc1
    buffer_load_dwordx4 a[28:31], v12, s[8:11], s96 offen sc1
L_skip3:
    s_bitcmp1_b32 s75, 4
    s_cbranch_scc0 L_skip4
    s_mov_b32 s96, 7356416
    buffer_load_dwordx4 a[32:35], v11, s[8:11], s96 offen sc1
    buffer_load_dwordx4 a[36:39], v12, s[8:11], s96 offen sc1
L_skip4:
    s_bitcmp1_b32 s75, 5
    s_cbranch_scc0 L_skip5
    s_mov_b32 s96, 9195520
    buffer_load_dwordx4 a[40:43], v11, s[8:11], s96 offen sc1
    buffer_load_dwordx4 a[44:47], v12, s[8:11], s96 offen sc1
L_skip5:
    s_bitcmp1_b32 s75, 6
    s_cbranch_scc0 L_skip6
    s_mov_b32 s96, 11034624
    buffer_load_dwordx4 a[48:51], v11, s[8:11], s96 offen sc1
    buffer_load_dwordx4 a[52:55], v12, s[8:11], s96 offen sc1
L_skip6:
    s_bitcmp1_b32 s75, 7
    s_cbranch_scc0 L_skip7
    s_mov_b32 s96, 12873728
    buffer_load_dwordx4 a[56:59], v11, s[8:11], s96 offen sc1
    buffer_load_dwordx4 a[60:63], v12, s[8:11], s96 offen sc1
L_skip7:
    s_bitcmp1_b32 s75, 8
    s_cbranch_scc0 L_skip8
    s_mov_b32 s96, 14712832
    buffer_load_dwordx4 a[64:67], v11, s[8:11], s96 offen sc1
    buffer_load_dwordx4 a[68:71], v12, s[8:11], s96 offen sc1
L_skip8:
    s_bitcmp1_b32 s75, 9
    s_cbranch_scc0 L_skip9
    s_mov_b32 s96, 16551936
    buffer_load_dwordx4 a[72:75], v11, s[8:11], s96 offen sc1
    buffer_load_dwordx4 a[76:79], v12, s[8:11], s96 offen sc1
L_skip9:
    s_bitcmp1_b32 s75, 10
    s_cbranch_scc0 L_skip10
    s_mov_b32 s96, 18391040
    buffer_load_dwordx4 a[80:83], v11, s[8:11], s96 offen sc1
    buffer_load_dwordx4 a[84:87], v12, s[8:11], s96 offen sc1
L_skip10:
    s_bitcmp1_b32 s75, 11
    s_cbranch_scc0 L_skip11
    s_mov_b32 s96, 20230144
    buffer_load_dwordx4 a[88:91], v11, s[8:11], s96 offen sc1
    buffer_load_dwordx4 a[92:95], v12, s[8:11], s96 offen sc1
L_skip11:
    s_bitcmp1_b32 s75, 12
    s_cbranch_scc0 L_skip12
    s_mov_b32 s96, 22069248
    buffer_load_dwordx4 a[96:99], v11, s[8:11], s96 offen sc1
    buffer_load_dwordx4 a[100:103], v12, s[8:11], s96 offen sc1
L_skip12:
    s_bitcmp1_b32 s75, 13
    s_cbranch_scc0 L_skip13
    s_mov_b32 s96, 23908352
    buffer_load_dwordx4 a[104:107], v11, s[8:11], s96 offen sc1
    buffer_load_dwordx4 a[108:111], v12, s[8:11], s96 offen sc1
L_skip13:
    s_bitcmp1_b32 s75, 14
    s_cbranch_scc0 L_skip14
    s_mov_b32 s96, 25747456
    buffer_load_dwordx4 a[112:115], v11, s[8:11], s96 offen sc1
    buffer_load_dwordx4 a[116:119], v12, s[8:11], s96 offen sc1
L_skip14:
    s_bitcmp1_b32 s75, 15
    s_cbranch_scc0 L_skip15
    s_mov_b32 s96, 27586560
    buffer_load_dwordx4 a[120:123], v11, s[8:11], s96 offen sc1
    buffer_load_dwordx4 a[124:127], v12, s[8:11], s96 offen sc1
L_skip15:
L_fold:
    s_bitcmp1_b32 s73, 0
    s_cbranch_scc0 L_skf0
    v_mfma_f32_16x16x32_bf16 v[160:163], v[188:191], a[0:3], v[160:163]
    v_mfma_f32_16x16x32_bf16 v[164:167], v[148:151], a[0:3], v[164:167]
    v_mfma_f32_16x16x32_bf16 v[168:171], v[188:191], a[4:7], v[168:171]
    v_mfma_f32_16x16x32_bf16 v[172:175], v[148:151], a[4:7], v[172:175]
L_skf0:
    s_bitcmp1_b32 s73, 1
    s_cbranch_scc0 L_skf1
    v_mfma_f32_16x16x32_bf16 v[160:163], v[188:191], a[8:11], v[160:163]
    v_mfma_f32_16x16x32_bf16 v[164:167], v[148:151], a[8:11], v[164:167]
    v_mfma_f32_16x16x32_bf16 v[168:171], v[188:191], a[12:15], v[168:171]
    v_mfma_f32_16x16x32_bf16 v[172:175], v[148:151], a[12:15], v[172:175]
L_skf1:
    s_bitcmp1_b32 s73, 2
    s_cbranch_scc0 L_skf2
    v_mfma_f32_16x16x32_bf16 v[160:163], v[188:191], a[16:19], v[160:163]
    v_mfma_f32_16x16x32_bf16 v[164:167], v[148:151], a[16:19], v[164:167]
    v_mfma_f32_16x16x32_bf16 v[168:171], v[188:191], a[20:23], v[168:171]
    v_mfma_f32_16x16x32_bf16 v[172:175], v[148:151], a[20:23], v[172:175]
L_skf2:
    s_bitcmp1_b32 s73, 3
    s_cbranch_scc0 L_skf3
    v_mfma_f32_16x16x32_bf16 v[160:163], v[188:191], a[24:27], v[160:163]
    v_mfma_f32_16x16x32_bf16 v[164:167], v[148:151], a[24:27], v[164:167]
    v_mfma_f32_16x16x32_bf16 v[168:171], v[188:191], a[28:31], v[168:171]
    v_mfma_f32_16x16x32_bf16 v[172:175], v[148:151], a[28:31], v[172:175]
L_skf3:
    s_bitcmp1_b32 s73, 4
    s_cbranch_scc0 L_skf4
    v_mfma_f32_16x16x32_bf16 v[160:163], v[188:191], a[32:35], v[160:163]
    v_mfma_f32_16x16x32_bf16 v[164:167], v[148:151], a[32:35], v[164:167]
    v_mfma_f32_16x16x32_bf16 v[168:171], v[188:191], a[36:39], v[168:171]
    v_mfma_f32_16x16x32_bf16 v[172:175], v[148:151], a[36:39], v[172:175]
L_skf4:
    s_bitcmp1_b32 s73, 5
    s_cbranch_scc0 L_skf5
    v_mfma_f32_16x16x32_bf16 v[160:163], v[188:191], a[40:43], v[160:163]
    v_mfma_f32_16x16x32_bf16 v[164:167], v[148:151], a[40:43], v[164:167]
    v_mfma_f32_16x16x32_bf16 v[168:171], v[188:191], a[44:47], v[168:171]
    v_mfma_f32_16x16x32_bf16 v[172:175], v[148:151], a[44:47], v[172:175]
L_skf5:
    s_bitcmp1_b32 s73, 6
    s_cbranch_scc0 L_skf6
    v_mfma_f32_16x16x32_bf16 v[160:163], v[188:191], a[48:51], v[160:163]
    v_mfma_f32_16x16x32_bf16 v[164:167], v[148:151], a[48:51], v[164:167]
    v_mfma_f32_16x16x32_bf16 v[168:171], v[188:191], a[52:55], v[168:171]
    v_mfma_f32_16x16x32_bf16 v[172:175], v[148:151], a[52:55], v[172:175]
L_skf6:
    s_bitcmp1_b32 s73, 7
    s_cbranch_scc0 L_skf7
    v_mfma_f32_16x16x32_bf16 v[160:163], v[188:191], a[56:59], v[160:163]
    v_mfma_f32_16x16x32_bf16 v[164:167], v[148:151], a[56:59], v[164:167]
    v_mfma_f32_16x16x32_bf16 v[168:171], v[188:191], a[60:63], v[168:171]
    v_mfma_f32_16x16x32_bf16 v[172:175], v[148:151], a[60:63], v[172:175]
L_skf7:
    s_bitcmp1_b32 s73, 8
    s_cbranch_scc0 L_skf8
    v_mfma_f32_16x16x32_bf16 v[160:163], v[188:191], a[64:67], v[160:163]
    v_mfma_f32_16x16x32_bf16 v[164:167], v[148:151], a[64:67], v[164:167]
    v_mfma_f32_16x16x32_bf16 v[168:171], v[188:191], a[68:71], v[168:171]
    v_mfma_f32_16x16x32_bf16 v[172:175], v[148:151], a[68:71], v[172:175]
L_skf8:
    s_bitcmp1_b32 s73, 9
    s_cbranch_scc0 L_skf9
    v_mfma_f32_16x16x32_bf16 v[160:163], v[188:191], a[72:75], v[160:163]
    v_mfma_f32_16x16x32_bf16 v[164:167], v[148:151], a[72:75], v[164:167]
    v_mfma_f32_16x16x32_bf16 v[168:171], v[188:191], a[76:79], v[168:171]
    v_mfma_f32_16x16x32_bf16 v[172:175], v[148:151], a[76:79], v[172:175]
L_skf9:
    s_bitcmp1_b32 s73, 10
    s_cbranch_scc0 L_skf10
    v_mfma_f32_16x16x32_bf16 v[160:163], v[188:191], a[80:83], v[160:163]
    v_mfma_f32_16x16x32_bf16 v[164:167], v[148:151], a[80:83], v[164:167]
    v_mfma_f32_16x16x32_bf16 v[168:171], v[188:191], a[84:87], v[168:171]
    v_mfma_f32_16x16x32_bf16 v[172:175], v[148:151], a[84:87], v[172:175]
L_skf10:
    s_bitcmp1_b32 s73, 11
    s_cbranch_scc0 L_skf11
    v_mfma_f32_16x16x32_bf16 v[160:163], v[188:191], a[88:91], v[160:163]
    v_mfma_f32_16x16x32_bf16 v[164:167], v[148:151], a[88:91], v[164:167]
    v_mfma_f32_16x16x32_bf16 v[168:171], v[188:191], a[92:95], v[168:171]
    v_mfma_f32_16x16x32_bf16 v[172:175], v[148:151], a[92:95], v[172:175]
L_skf11:
    s_bitcmp1_b32 s73, 12
    s_cbranch_scc0 L_skf12
    v_mfma_f32_16x16x32_bf16 v[160:163], v[188:191], a[96:99], v[160:163]
    v_mfma_f32_16x16x32_bf16 v[164:167], v[148:151], a[96:99], v[164:167]
    v_mfma_f32_16x16x32_bf16 v[168:171], v[188:191], a[100:103], v[168:171]
    v_mfma_f32_16x16x32_bf16 v[172:175], v[148:151], a[100:103], v[172:175]
L_skf12:
    s_bitcmp1_b32 s73, 13
    s_cbranch_scc0 L_skf13
    v_mfma_f32_16x16x32_bf16 v[160:163], v[188:191], a[104:107], v[160:163]
    v_mfma_f32_16x16x32_bf16 v[164:167], v[148:151], a[104:107], v[164:167]
    v_mfma_f32_16x16x32_bf16 v[168:171], v[188:191], a[108:111], v[168:171]
    v_mfma_f32_16x16x32_bf16 v[172:175], v[148:151], a[108:111], v[172:175]
L_skf13:
    s_bitcmp1_b32 s73, 14
    s_cbranch_scc0 L_skf14
    v_mfma_f32_16x16x32_bf16 v[160:163], v[188:191], a[112:115], v[160:163]
    v_mfma_f32_16x16x32_bf16 v[164:167], v[148:151], a[112:115], v[164:167]
    v_mfma_f32_16x16x32_bf16 v[168:171], v[188:191], a[116:119], v[168:171]
    v_mfma_f32_16x16x32_bf16 v[172:175], v[148:151], a[116:119], v[172:175]
L_skf14:
    s_bitcmp1_b32 s73, 15
    s_cbranch_scc0 L_skf15
    v_mfma_f32_16x16x32_bf16 v[160:163], v[188:191], a[120:123], v[160:163]
    v_mfma_f32_16x16x32_bf16 v[164:167], v[148:151], a[120:123], v[164:167]
    v_mfma_f32_16x16x32_bf16 v[168:171], v[188:191], a[124:127], v[168:171]
    v_mfma_f32_16x16x32_bf16 v[172:175], v[148:151], a[124:127], v[172:175]
L_skf15:
    s_cmp_eq_u32 s72, 0xffff
    s_cbranch_scc1 L_all
    s_sleep 1
    s_add_u32 s76, s76, 1
    s_cmp_lt_u32 s76, 0x40000
    s_cbranch_scc1 L_poll
    s_branch L_end
L_all:
    s_cmp_eq_u32 s75, 0
    s_cbranch_scc1 L_fini
    s_mov_b32 s73, s75
    s_mov_b32 s75, 0
    s_waitcnt vmcnt(0)
    s_branch L_fold
L_fini:
    s_nop 7
    v_fmac_f32 v224, v160, v208
    v_fmac_f32 v225, v161, v209
    v_fmac_f32 v226, v162, v210
    v_fmac_f32 v227, v163, v211
    v_fmac_f32 v228, v164, v216
    v_fmac_f32 v229, v165, v217
    v_fmac_f32 v230, v166, v218
    v_fmac_f32 v231, v167, v219
    v_cvt_pk_bf16_f32 v144, v224, v225
    v_cvt_pk_bf16_f32 v145, v226, v227
    v_cvt_pk_bf16_f32 v146, v228, v229
    v_cvt_pk_bf16_f32 v147, v230, v231
    buffer_store_dwordx4 v[144:147], v4, s[12:15], 0 offen offset:0
    v_fmac_f32 v232, v168, v240
    v_fmac_f32 v233, v169, v241
    v_fmac_f32 v234, v170, v242
    v_fmac_f32 v235, v171, v243
    v_fmac_f32 v236, v172, v248
    v_fmac_f32 v237, v173, v249
    v_fmac_f32 v238, v174, v250
    v_fmac_f32 v239, v175, v251
    v_cvt_pk_bf16_f32 v152, v232, v233
    v_cvt_pk_bf16_f32 v153, v234, v235
    v_cvt_pk_bf16_f32 v154, v236, v237
    v_cvt_pk_bf16_f32 v155, v238, v239
    buffer_store_dwordx4 v[152:155], v5, s[12:15], 0 offen offset:512
L_end:
    s_endpgm
L_slow_p0:
    s_sub_u32 s96, s70, 81920
    s_call_b64 s[78:79], L_rescale
    s_branch L_back_p0
L_slow_p1:
    s_sub_u32 s96, s70, 81920
    s_call_b64 s[78:79], L_rescale
    s_branch L_back_p1
L_slow_w0:
    s_sub_u32 s96, s70, 81920
    s_call_b64 s[78:79], L_rescale
    s_branch L_back_w0
L_slow_w1:
    s_sub_u32 s96, s70, 81920
    s_call_b64 s[78:79], L_rescale
    s_branch L_back_w1
L_slow_p30:
    s_sub_u32 s96, s70, 49152
    s_call_b64 s[78:79], L_rescale
    s_branch L_back_p30
L_slow_p31:
    s_call_b64 s[78:79], L_rescale2
    v_mov_b32 v244, v144
    v_mov_b32 v245, v145
    v_mov_b32 v246, v146
    v_mov_b32 v247, v147
    v_mov_b32 v252, v152
    v_mov_b32 v253, v153
    v_mov_b32 v254, v154
    v_mov_b32 v255, v155
    v_mov_b32 v60, v176
    v_mov_b32 v61, v177
    v_mov_b32 v62, v178
    v_mov_b32 v63, v179
    v_mov_b32 v64, v184
    v_mov_b32 v65, v185
    v_mov_b32 v66, v186
    v_mov_b32 v67, v187
    s_branch L_back_p31
L_rescale:
    s_nop 15
    v_subrev_u32 v28, s88, v3
    v_bfe_u32 v29, v28, 4, 4
    v_lshlrev_b32 v29, 9, v29
    v_bfe_u32 v30, v28, 8, 1
    v_lshl_add_u32 v29, v30, 5, v29
    v_lshrrev_b32 v30, 9, v28
    v_lshl_add_u32 v29, v30, 4, v29
    s_and_b32 vcc_lo, s66, 1
    s_lshl_b32 vcc_lo, vcc_lo, 14
    s_add_u32 s96, s96, vcc_lo
    buffer_load_dwordx4 v[160:163], v29, s[48:51], s96 offen offset:0
    buffer_load_dwordx4 v[164:167], v29, s[48:51], s96 offen offset:64
    buffer_load_dwordx4 v[168:171], v29, s[48:51], s96 offen offset:128
    buffer_load_dwordx4 v[172:175], v29, s[48:51], s96 offen offset:192
    s_waitcnt vmcnt(0)
    v_mfma_f32_16x16x32_bf16 v[148:151], v[160:163], v[212:215], v[208:211]
    v_mfma_f32_16x16x32_bf16 v[156:159], v[160:163], v[220:223], v[216:219]
    v_mfma_f32_16x16x32_bf16 v[180:183], v[160:163], v[52:55], v[240:243]
    v_mfma_f32_16x16x32_bf16 v[188:191], v[160:163], v[56:59], v[248:251]
    v_mfma_f32_16x16x32_bf16 v[148:151], v[164:167], v[244:247], v[148:151]
    v_mfma_f32_16x16x32_bf16 v[156:159], v[164:167], v[252:255], v[156:159]
    v_mfma_f32_16x16x32_bf16 v[180:183], v[164:167], v[60:63], v[180:183]
    v_mfma_f32_16x16x32_bf16 v[188:191], v[164:167], v[64:67], v[188:191]
    v_mfma_f32_16x16x32_bf16 v[148:151], v[168:171], v[32:35], v[148:151]
    v_mfma_f32_16x16x32_bf16 v[156:159], v[168:171], v[36:39], v[156:159]
    v_mfma_f32_16x16x32_bf16 v[180:183], v[168:171], v[68:71], v[180:183]
    v_mfma_f32_16x16x32_bf16 v[188:191], v[168:171], v[72:75], v[188:191]
    v_mfma_f32_16x16x32_bf16 v[148:151], v[172:175], v[40:43], v[148:151]
    v_mfma_f32_16x16x32_bf16 v[156:159], v[172:175], v[48:51], v[156:159]
    v_mfma_f32_16x16x32_bf16 v[180:183], v[172:175], v[76:79], v[180:183]
    v_mfma_f32_16x16x32_bf16 v[188:191], v[172:175], v[80:83], v[188:191]
    buffer_load_dwordx4 v[160:163], v29, s[48:51], s96 offen offset:256
    buffer_load_dwordx4 v[164:167], v29, s[48:51], s96 offen offset:320
    buffer_load_dwordx4 v[168:171], v29, s[48:51], s96 offen offset:384
    buffer_load_dwordx4 v[172:175], v29, s[48:51], s96 offen offset:448
    s_waitcnt vmcnt(0)
    v_mfma_f32_16x16x32_bf16 v[148:151], v[160:163], v[84:87], v[148:151]
    v_mfma_f32_16x16x32_bf16 v[156:159], v[160:163], v[88:91], v[156:159]
    v_mfma_f32_16x16x32_bf16 v[180:183], v[160:163], v[116:119], v[180:183]
    v_mfma_f32_16x16x32_bf16 v[188:191], v[160:163], v[120:123], v[188:191]
    v_mfma_f32_16x16x32_bf16 v[148:151], v[164:167], v[92:95], v[148:151]
    v_mfma_f32_16x16x32_bf16 v[156:159], v[164:167], v[96:99], v[156:159]
    v_mfma_f32_16x16x32_bf16 v[180:183], v[164:167], v[124:127], v[180:183]
    v_mfma_f32_16x16x32_bf16 v[188:191], v[164:167], v[128:131], v[188:191]
    v_mfma_f32_16x16x32_bf16 v[148:151], v[168:171], v[100:103], v[148:151]
    v_mfma_f32_16x16x32_bf16 v[156:159], v[168:171], v[104:107], v[156:159]
    v_mfma_f32_16x16x32_bf16 v[180:183], v[168:171], v[132:135], v[180:183]
    v_mfma_f32_16x16x32_bf16 v[188:191], v[168:171], v[136:139], v[188:191]
    v_mfma_f32_16x16x32_bf16 v[148:151], v[172:175], v[108:111], v[148:151]
    v_mfma_f32_16x16x32_bf16 v[156:159], v[172:175], v[112:115], v[156:159]
    v_mfma_f32_16x16x32_bf16 v[180:183], v[172:175], v[140:143], v[180:183]
    v_mfma_f32_16x16x32_bf16 v[188:191], v[172:175], v[44:47], v[188:191]
    s_add_u32 s96, s96, 8192
    buffer_load_dwordx4 v[160:163], v29, s[48:51], s96 offen offset:0
    buffer_load_dwordx4 v[164:167], v29, s[48:51], s96 offen offset:64
    buffer_load_dwordx4 v[168:171], v29, s[48:51], s96 offen offset:128
    buffer_load_dwordx4 v[172:175], v29, s[48:51], s96 offen offset:192
    s_waitcnt vmcnt(0)
    v_mfma_f32_16x16x32_bf16 v[144:147], v[160:163], v[212:215], v[208:211]
    v_mfma_f32_16x16x32_bf16 v[152:155], v[160:163], v[220:223], v[216:219]
    v_mfma_f32_16x16x32_bf16 v[176:179], v[160:163], v[52:55], v[240:243]
    v_mfma_f32_16x16x32_bf16 v[184:187], v[160:163], v[56:59], v[248:251]
    v_mfma_f32_16x16x32_bf16 v[144:147], v[164:167], v[244:247], v[144:147]
    v_mfma_f32_16x16x32_bf16 v[152:155], v[164:167], v[252:255], v[152:155]
    v_mfma_f32_16x16x32_bf16 v[176:179], v[164:167], v[60:63], v[176:179]
    v_mfma_f32_16x16x32_bf16 v[184:187], v[164:167], v[64:67], v[184:187]
    v_mfma_f32_16x16x32_bf16 v[144:147], v[168:171], v[32:35], v[144:147]
    v_mfma_f32_16x16x32_bf16 v[152:155], v[168:171], v[36:39], v[152:155]
    v_mfma_f32_16x16x32_bf16 v[176:179], v[168:171], v[68:71], v[176:179]
    v_mfma_f32_16x16x32_bf16 v[184:187], v[168:171], v[72:75], v[184:187]
    v_mfma_f32_16x16x32_bf16 v[144:147], v[172:175], v[40:43], v[144:147]
    v_mfma_f32_16x16x32_bf16 v[152:155], v[172:175], v[48:51], v[152:155]
    v_mfma_f32_16x16x32_bf16 v[176:179], v[172:175], v[76:79], v[176:179]
    v_mfma_f32_16x16x32_bf16 v[184:187], v[172:175], v[80:83], v[184:187]
    buffer_load_dwordx4 v[160:163], v29, s[48:51], s96 offen offset:256
    buffer_load_dwordx4 v[164:167], v29, s[48:51], s96 offen offset:320
    buffer_load_dwordx4 v[168:171], v29, s[48:51], s96 offen offset:384
    buffer_load_dwordx4 v[172:175], v29, s[48:51], s96 offen offset:448
    s_waitcnt vmcnt(0)
    v_mfma_f32_16x16x32_bf16 v[144:147], v[160:163], v[84:87], v[144:147]
    v_mfma_f32_16x16x32_bf16 v[152:155], v[160:163], v[88:91], v[152:155]
    v_mfma_f32_16x16x32_bf16 v[176:179], v[160:163], v[116:119], v[176:179]
    v_mfma_f32_16x16x32_bf16 v[184:187], v[160:163], v[120:123], v[184:187]
    v_mfma_f32_16x16x32_bf16 v[144:147], v[164:167], v[92:95], v[144:147]
    v_mfma_f32_16x16x32_bf16 v[152:155], v[164:167], v[96:99], v[152:155]
    v_mfma_f32_16x16x32_bf16 v[176:179], v[164:167], v[124:127], v[176:179]
    v_mfma_f32_16x16x32_bf16 v[184:187], v[164:167], v[128:131], v[184:187]
    v_mfma_f32_16x16x32_bf16 v[144:147], v[168:171], v[100:103], v[144:147]
    v_mfma_f32_16x16x32_bf16 v[152:155], v[168:171], v[104:107], v[152:155]
    v_mfma_f32_16x16x32_bf16 v[176:179], v[168:171], v[132:135], v[176:179]
    v_mfma_f32_16x16x32_bf16 v[184:187], v[168:171], v[136:139], v[184:187]
    v_mfma_f32_16x16x32_bf16 v[144:147], v[172:175], v[108:111], v[144:147]
    v_mfma_f32_16x16x32_bf16 v[152:155], v[172:175], v[112:115], v[152:155]
    v_mfma_f32_16x16x32_bf16 v[176:179], v[172:175], v[140:143], v[176:179]
    v_mfma_f32_16x16x32_bf16 v[184:187], v[172:175], v[44:47], v[184:187]
L_rescale2:
    s_nop 15
    v_max3_f32 v16, v148, v149, v150
    v_max3_f32 v16, v16, v151, v144
    v_max3_f32 v16, v16, v145, v146
    v_max3_f32 v16, v16, v147, 0
    v_mov_b32 v28, v16
    s_nop 1
    v_permlane32_swap_b32 v16, v28
    s_nop 1
    v_max_f32 v16, v16, v28
    v_mov_b32 v28, v16
    s_nop 1
    v_permlane16_swap_b32 v16, v28
    s_nop 1
    v_max_f32 v16, v16, v28
    v_exp_f32_e64 v28, -v16
    s_nop 0
    v_sub_f32 v148, v148, v16
    v_sub_f32 v149, v149, v16
    v_sub_f32 v150, v150, v16
    v_sub_f32 v151, v151, v16
    v_sub_f32 v144, v144, v16
    v_sub_f32 v145, v145, v16
    v_sub_f32 v146, v146, v16
    v_sub_f32 v147, v147, v16
    v_sub_f32 v208, v208, v16
    v_sub_f32 v209, v209, v16
    v_sub_f32 v210, v210, v16
    v_sub_f32 v211, v211, v16
    v_mul_f32 v24, v24, v28
    v_accvgpr_read_b32 v160, a0
    v_accvgpr_read_b32 v161, a1
    v_accvgpr_read_b32 v162, a2
    v_accvgpr_read_b32 v163, a3
    v_mul_f32 v160, v160, v28
    v_mul_f32 v161, v161, v28
    v_mul_f32 v162, v162, v28
    v_mul_f32 v163, v163, v28
    v_accvgpr_write_b32 a0, v160
    v_accvgpr_write_b32 a1, v161
    v_accvgpr_write_b32 a2, v162
    v_accvgpr_write_b32 a3, v163
    v_accvgpr_read_b32 v160, a4
    v_accvgpr_read_b32 v161, a5
    v_accvgpr_read_b32 v162, a6
    v_accvgpr_read_b32 v163, a7
    v_mul_f32 v160, v160, v28
    v_mul_f32 v161, v161, v28
    v_mul_f32 v162, v162, v28
    v_mul_f32 v163, v163, v28
    v_accvgpr_write_b32 a4, v160
    v_accvgpr_write_b32 a5, v161
    v_accvgpr_write_b32 a6, v162
    v_accvgpr_write_b32 a7, v163
    v_accvgpr_read_b32 v160, a8
    v_accvgpr_read_b32 v161, a9
    v_accvgpr_read_b32 v162, a10
    v_accvgpr_read_b32 v163, a11
    v_mul_f32 v160, v160, v28
    v_mul_f32 v161, v161, v28
    v_mul_f32 v162, v162, v28
    v_mul_f32 v163, v163, v28
    v_accvgpr_write_b32 a8, v160
    v_accvgpr_write_b32 a9, v161
    v_accvgpr_write_b32 a10, v162
    v_accvgpr_write_b32 a11, v163
    v_accvgpr_read_b32 v160, a12
    v_accvgpr_read_b32 v161, a13
    v_accvgpr_read_b32 v162, a14
    v_accvgpr_read_b32 v163, a15
    v_mul_f32 v160, v160, v28
    v_mul_f32 v161, v161, v28
    v_mul_f32 v162, v162, v28
    v_mul_f32 v163, v163, v28
    v_accvgpr_write_b32 a12, v160
    v_accvgpr_write_b32 a13, v161
    v_accvgpr_write_b32 a14, v162
    v_accvgpr_write_b32 a15, v163
    v_accvgpr_read_b32 v160, a16
    v_accvgpr_read_b32 v161, a17
    v_accvgpr_read_b32 v162, a18
    v_accvgpr_read_b32 v163, a19
    v_mul_f32 v160, v160, v28
    v_mul_f32 v161, v161, v28
    v_mul_f32 v162, v162, v28
    v_mul_f32 v163, v163, v28
    v_accvgpr_write_b32 a16, v160
    v_accvgpr_write_b32 a17, v161
    v_accvgpr_write_b32 a18, v162
    v_accvgpr_write_b32 a19, v163
    v_accvgpr_read_b32 v160, a20
    v_accvgpr_read_b32 v161, a21
    v_accvgpr_read_b32 v162, a22
    v_accvgpr_read_b32 v163, a23
    v_mul_f32 v160, v160, v28
    v_mul_f32 v161, v161, v28
    v_mul_f32 v162, v162, v28
    v_mul_f32 v163, v163, v28
    v_accvgpr_write_b32 a20, v160
    v_accvgpr_write_b32 a21, v161
    v_accvgpr_write_b32 a22, v162
    v_accvgpr_write_b32 a23, v163
    v_accvgpr_read_b32 v160, a24
    v_accvgpr_read_b32 v161, a25
    v_accvgpr_read_b32 v162, a26
    v_accvgpr_read_b32 v163, a27
    v_mul_f32 v160, v160, v28
    v_mul_f32 v161, v161, v28
    v_mul_f32 v162, v162, v28
    v_mul_f32 v163, v163, v28
    v_accvgpr_write_b32 a24, v160
    v_accvgpr_write_b32 a25, v161
    v_accvgpr_write_b32 a26, v162
    v_accvgpr_write_b32 a27, v163
    v_accvgpr_read_b32 v160, a28
    v_accvgpr_read_b32 v161, a29
    v_accvgpr_read_b32 v162, a30
    v_accvgpr_read_b32 v163, a31
    v_mul_f32 v160, v160, v28
    v_mul_f32 v161, v161, v28
    v_mul_f32 v162, v162, v28
    v_mul_f32 v163, v163, v28
    v_accvgpr_write_b32 a28, v160
    v_accvgpr_write_b32 a29, v161
    v_accvgpr_write_b32 a30, v162
    v_accvgpr_write_b32 a31, v163
    v_accvgpr_read_b32 v160, a32
    v_accvgpr_read_b32 v161, a33
    v_accvgpr_read_b32 v162, a34
    v_accvgpr_read_b32 v163, a35
    v_mul_f32 v160, v160, v28
    v_mul_f32 v161, v161, v28
    v_mul_f32 v162, v162, v28
    v_mul_f32 v163, v163, v28
    v_accvgpr_write_b32 a32, v160
    v_accvgpr_write_b32 a33, v161
    v_accvgpr_write_b32 a34, v162
    v_accvgpr_write_b32 a35, v163
    v_accvgpr_read_b32 v160, a36
    v_accvgpr_read_b32 v161, a37
    v_accvgpr_read_b32 v162, a38
    v_accvgpr_read_b32 v163, a39
    v_mul_f32 v160, v160, v28
    v_mul_f32 v161, v161, v28
    v_mul_f32 v162, v162, v28
    v_mul_f32 v163, v163, v28
    v_accvgpr_write_b32 a36, v160
    v_accvgpr_write_b32 a37, v161
    v_accvgpr_write_b32 a38, v162
    v_accvgpr_write_b32 a39, v163
    v_accvgpr_read_b32 v160, a40
    v_accvgpr_read_b32 v161, a41
    v_accvgpr_read_b32 v162, a42
    v_accvgpr_read_b32 v163, a43
    v_mul_f32 v160, v160, v28
    v_mul_f32 v161, v161, v28
    v_mul_f32 v162, v162, v28
    v_mul_f32 v163, v163, v28
    v_accvgpr_write_b32 a40, v160
    v_accvgpr_write_b32 a41, v161
    v_accvgpr_write_b32 a42, v162
    v_accvgpr_write_b32 a43, v163
    v_accvgpr_read_b32 v160, a44
    v_accvgpr_read_b32 v161, a45
    v_accvgpr_read_b32 v162, a46
    v_accvgpr_read_b32 v163, a47
    v_mul_f32 v160, v160, v28
    v_mul_f32 v161, v161, v28
    v_mul_f32 v162, v162, v28
    v_mul_f32 v163, v163, v28
    v_accvgpr_write_b32 a44, v160
    v_accvgpr_write_b32 a45, v161
    v_accvgpr_write_b32 a46, v162
    v_accvgpr_write_b32 a47, v163
    v_accvgpr_read_b32 v160, a48
    v_accvgpr_read_b32 v161, a49
    v_accvgpr_read_b32 v162, a50
    v_accvgpr_read_b32 v163, a51
    v_mul_f32 v160, v160, v28
    v_mul_f32 v161, v161, v28
    v_mul_f32 v162, v162, v28
    v_mul_f32 v163, v163, v28
    v_accvgpr_write_b32 a48, v160
    v_accvgpr_write_b32 a49, v161
    v_accvgpr_write_b32 a50, v162
    v_accvgpr_write_b32 a51, v163
    v_accvgpr_read_b32 v160, a52
    v_accvgpr_read_b32 v161, a53
    v_accvgpr_read_b32 v162, a54
    v_accvgpr_read_b32 v163, a55
    v_mul_f32 v160, v160, v28
    v_mul_f32 v161, v161, v28
    v_mul_f32 v162, v162, v28
    v_mul_f32 v163, v163, v28
    v_accvgpr_write_b32 a52, v160
    v_accvgpr_write_b32 a53, v161
    v_accvgpr_write_b32 a54, v162
    v_accvgpr_write_b32 a55, v163
    v_accvgpr_read_b32 v160, a56
    v_accvgpr_read_b32 v161, a57
    v_accvgpr_read_b32 v162, a58
    v_accvgpr_read_b32 v163, a59
    v_mul_f32 v160, v160, v28
    v_mul_f32 v161, v161, v28
    v_mul_f32 v162, v162, v28
    v_mul_f32 v163, v163, v28
    v_accvgpr_write_b32 a56, v160
    v_accvgpr_write_b32 a57, v161
    v_accvgpr_write_b32 a58, v162
    v_accvgpr_write_b32 a59, v163
    v_accvgpr_read_b32 v160, a60
    v_accvgpr_read_b32 v161, a61
    v_accvgpr_read_b32 v162, a62
    v_accvgpr_read_b32 v163, a63
    v_mul_f32 v160, v160, v28
    v_mul_f32 v161, v161, v28
    v_mul_f32 v162, v162, v28
    v_mul_f32 v163, v163, v28
    v_accvgpr_write_b32 a60, v160
    v_accvgpr_write_b32 a61, v161
    v_accvgpr_write_b32 a62, v162
    v_accvgpr_write_b32 a63, v163
    v_exp_f32 v148, v148
    v_exp_f32 v149, v149
    v_exp_f32 v150, v150
    v_exp_f32 v151, v151
    v_exp_f32 v144, v144
    v_exp_f32 v145, v145
    v_exp_f32 v146, v146
    v_exp_f32 v147, v147
    s_nop 0
    v_add_f32 v28, v148, v149
    v_add_f32 v28, v28, v150
    v_add_f32 v28, v28, v151
    v_add_f32 v28, v28, v144
    v_add_f32 v28, v28, v145
    v_add_f32 v28, v28, v146
    v_add_f32 v28, v28, v147
    v_cvt_pk_bf16_f32 v160, v148, v149
    v_cvt_pk_bf16_f32 v161, v150, v151
    v_max3_f32 v16, v156, v157, v158
    v_max3_f32 v16, v16, v159, v152
    v_max3_f32 v16, v16, v153, v154
    v_max3_f32 v16, v16, v155, 0
    v_mov_b32 v29, v16
    s_nop 1
    v_permlane32_swap_b32 v16, v29
    s_nop 1
    v_max_f32 v16, v16, v29
    v_mov_b32 v29, v16
    s_nop 1
    v_permlane16_swap_b32 v16, v29
    s_nop 1
    v_max_f32 v16, v16, v29
    v_exp_f32_e64 v29, -v16
    s_nop 0
    v_sub_f32 v156, v156, v16
    v_sub_f32 v157, v157, v16
    v_sub_f32 v158, v158, v16
    v_sub_f32 v159, v159, v16
    v_sub_f32 v152, v152, v16
    v_sub_f32 v153, v153, v16
    v_sub_f32 v154, v154, v16
    v_sub_f32 v155, v155, v16
    v_sub_f32 v216, v216, v16
    v_sub_f32 v217, v217, v16
    v_sub_f32 v218, v218, v16
    v_sub_f32 v219, v219, v16
    v_mul_f32 v25, v25, v29
    v_accvgpr_read_b32 v164, a64
    v_accvgpr_read_b32 v165, a65
    v_accvgpr_read_b32 v166, a66
    v_accvgpr_read_b32 v167, a67
    v_mul_f32 v164, v164, v29
    v_mul_f32 v165, v165, v29
    v_mul_f32 v166, v166, v29
    v_mul_f32 v167, v167, v29
    v_accvgpr_write_b32 a64, v164
    v_accvgpr_write_b32 a65, v165
    v_accvgpr_write_b32 a66, v166
    v_accvgpr_write_b32 a67, v167
    v_accvgpr_read_b32 v164, a68
    v_accvgpr_read_b32 v165, a69
    v_accvgpr_read_b32 v166, a70
    v_accvgpr_read_b32 v167, a71
    v_mul_f32 v164, v164, v29
    v_mul_f32 v165, v165, v29
    v_mul_f32 v166, v166, v29
    v_mul_f32 v167, v167, v29
    v_accvgpr_write_b32 a68, v164
    v_accvgpr_write_b32 a69, v165
    v_accvgpr_write_b32 a70, v166
    v_accvgpr_write_b32 a71, v167
    v_accvgpr_read_b32 v164, a72
    v_accvgpr_read_b32 v165, a73
    v_accvgpr_read_b32 v166, a74
    v_accvgpr_read_b32 v167, a75
    v_mul_f32 v164, v164, v29
    v_mul_f32 v165, v165, v29
    v_mul_f32 v166, v166, v29
    v_mul_f32 v167, v167, v29
    v_accvgpr_write_b32 a72, v164
    v_accvgpr_write_b32 a73, v165
    v_accvgpr_write_b32 a74, v166
    v_accvgpr_write_b32 a75, v167
    v_accvgpr_read_b32 v164, a76
    v_accvgpr_read_b32 v165, a77
    v_accvgpr_read_b32 v166, a78
    v_accvgpr_read_b32 v167, a79
    v_mul_f32 v164, v164, v29
    v_mul_f32 v165, v165, v29
    v_mul_f32 v166, v166, v29
    v_mul_f32 v167, v167, v29
    v_accvgpr_write_b32 a76, v164
    v_accvgpr_write_b32 a77, v165
    v_accvgpr_write_b32 a78, v166
    v_accvgpr_write_b32 a79, v167
    v_accvgpr_read_b32 v164, a80
    v_accvgpr_read_b32 v165, a81
    v_accvgpr_read_b32 v166, a82
    v_accvgpr_read_b32 v167, a83
    v_mul_f32 v164, v164, v29
    v_mul_f32 v165, v165, v29
    v_mul_f32 v166, v166, v29
    v_mul_f32 v167, v167, v29
    v_accvgpr_write_b32 a80, v164
    v_accvgpr_write_b32 a81, v165
    v_accvgpr_write_b32 a82, v166
    v_accvgpr_write_b32 a83, v167
    v_accvgpr_read_b32 v164, a84
    v_accvgpr_read_b32 v165, a85
    v_accvgpr_read_b32 v166, a86
    v_accvgpr_read_b32 v167, a87
    v_mul_f32 v164, v164, v29
    v_mul_f32 v165, v165, v29
    v_mul_f32 v166, v166, v29
    v_mul_f32 v167, v167, v29
    v_accvgpr_write_b32 a84, v164
    v_accvgpr_write_b32 a85, v165
    v_accvgpr_write_b32 a86, v166
    v_accvgpr_write_b32 a87, v167
    v_accvgpr_read_b32 v164, a88
    v_accvgpr_read_b32 v165, a89
    v_accvgpr_read_b32 v166, a90
    v_accvgpr_read_b32 v167, a91
    v_mul_f32 v164, v164, v29
    v_mul_f32 v165, v165, v29
    v_mul_f32 v166, v166, v29
    v_mul_f32 v167, v167, v29
    v_accvgpr_write_b32 a88, v164
    v_accvgpr_write_b32 a89, v165
    v_accvgpr_write_b32 a90, v166
    v_accvgpr_write_b32 a91, v167
    v_accvgpr_read_b32 v164, a92
    v_accvgpr_read_b32 v165, a93
    v_accvgpr_read_b32 v166, a94
    v_accvgpr_read_b32 v167, a95
    v_mul_f32 v164, v164, v29
    v_mul_f32 v165, v165, v29
    v_mul_f32 v166, v166, v29
    v_mul_f32 v167, v167, v29
    v_accvgpr_write_b32 a92, v164
    v_accvgpr_write_b32 a93, v165
    v_accvgpr_write_b32 a94, v166
    v_accvgpr_write_b32 a95, v167
    v_accvgpr_read_b32 v164, a96
    v_accvgpr_read_b32 v165, a97
    v_accvgpr_read_b32 v166, a98
    v_accvgpr_read_b32 v167, a99
    v_mul_f32 v164, v164, v29
    v_mul_f32 v165, v165, v29
    v_mul_f32 v166, v166, v29
    v_mul_f32 v167, v167, v29
    v_accvgpr_write_b32 a96, v164
    v_accvgpr_write_b32 a97, v165
    v_accvgpr_write_b32 a98, v166
    v_accvgpr_write_b32 a99, v167
    v_accvgpr_read_b32 v164, a100
    v_accvgpr_read_b32 v165, a101
    v_accvgpr_read_b32 v166, a102
    v_accvgpr_read_b32 v167, a103
    v_mul_f32 v164, v164, v29
    v_mul_f32 v165, v165, v29
    v_mul_f32 v166, v166, v29
    v_mul_f32 v167, v167, v29
    v_accvgpr_write_b32 a100, v164
    v_accvgpr_write_b32 a101, v165
    v_accvgpr_write_b32 a102, v166
    v_accvgpr_write_b32 a103, v167
    v_accvgpr_read_b32 v164, a104
    v_accvgpr_read_b32 v165, a105
    v_accvgpr_read_b32 v166, a106
    v_accvgpr_read_b32 v167, a107
    v_mul_f32 v164, v164, v29
    v_mul_f32 v165, v165, v29
    v_mul_f32 v166, v166, v29
    v_mul_f32 v167, v167, v29
    v_accvgpr_write_b32 a104, v164
    v_accvgpr_write_b32 a105, v165
    v_accvgpr_write_b32 a106, v166
    v_accvgpr_write_b32 a107, v167
    v_accvgpr_read_b32 v164, a108
    v_accvgpr_read_b32 v165, a109
    v_accvgpr_read_b32 v166, a110
    v_accvgpr_read_b32 v167, a111
    v_mul_f32 v164, v164, v29
    v_mul_f32 v165, v165, v29
    v_mul_f32 v166, v166, v29
    v_mul_f32 v167, v167, v29
    v_accvgpr_write_b32 a108, v164
    v_accvgpr_write_b32 a109, v165
    v_accvgpr_write_b32 a110, v166
    v_accvgpr_write_b32 a111, v167
    v_accvgpr_read_b32 v164, a112
    v_accvgpr_read_b32 v165, a113
    v_accvgpr_read_b32 v166, a114
    v_accvgpr_read_b32 v167, a115
    v_mul_f32 v164, v164, v29
    v_mul_f32 v165, v165, v29
    v_mul_f32 v166, v166, v29
    v_mul_f32 v167, v167, v29
    v_accvgpr_write_b32 a112, v164
    v_accvgpr_write_b32 a113, v165
    v_accvgpr_write_b32 a114, v166
    v_accvgpr_write_b32 a115, v167
    v_accvgpr_read_b32 v164, a116
    v_accvgpr_read_b32 v165, a117
    v_accvgpr_read_b32 v166, a118
    v_accvgpr_read_b32 v167, a119
    v_mul_f32 v164, v164, v29
    v_mul_f32 v165, v165, v29
    v_mul_f32 v166, v166, v29
    v_mul_f32 v167, v167, v29
    v_accvgpr_write_b32 a116, v164
    v_accvgpr_write_b32 a117, v165
    v_accvgpr_write_b32 a118, v166
    v_accvgpr_write_b32 a119, v167
    v_accvgpr_read_b32 v164, a120
    v_accvgpr_read_b32 v165, a121
    v_accvgpr_read_b32 v166, a122
    v_accvgpr_read_b32 v167, a123
    v_mul_f32 v164, v164, v29
    v_mul_f32 v165, v165, v29
    v_mul_f32 v166, v166, v29
    v_mul_f32 v167, v167, v29
    v_accvgpr_write_b32 a120, v164
    v_accvgpr_write_b32 a121, v165
    v_accvgpr_write_b32 a122, v166
    v_accvgpr_write_b32 a123, v167
    v_accvgpr_read_b32 v164, a124
    v_accvgpr_read_b32 v165, a125
    v_accvgpr_read_b32 v166, a126
    v_accvgpr_read_b32 v167, a127
    v_mul_f32 v164, v164, v29
    v_mul_f32 v165, v165, v29
    v_mul_f32 v166, v166, v29
    v_mul_f32 v167, v167, v29
    v_accvgpr_write_b32 a124, v164
    v_accvgpr_write_b32 a125, v165
    v_accvgpr_write_b32 a126, v166
    v_accvgpr_write_b32 a127, v167
    v_exp_f32 v156, v156
    v_exp_f32 v157, v157
    v_exp_f32 v158, v158
    v_exp_f32 v159, v159
    v_exp_f32 v152, v152
    v_exp_f32 v153, v153
    v_exp_f32 v154, v154
    v_exp_f32 v155, v155
    s_nop 0
    v_add_f32 v29, v156, v157
    v_add_f32 v29, v29, v158
    v_add_f32 v29, v29, v159
    v_add_f32 v29, v29, v152
    v_add_f32 v29, v29, v153
    v_add_f32 v29, v29, v154
    v_add_f32 v29, v29, v155
    v_cvt_pk_bf16_f32 v164, v156, v157
    v_cvt_pk_bf16_f32 v165, v158, v159
    v_max3_f32 v16, v180, v181, v182
    v_max3_f32 v16, v16, v183, v176
    v_max3_f32 v16, v16, v177, v178
    v_max3_f32 v16, v16, v179, 0
    v_mov_b32 v30, v16
    s_nop 1
    v_permlane32_swap_b32 v16, v30
    s_nop 1
    v_max_f32 v16, v16, v30
    v_mov_b32 v30, v16
    s_nop 1
    v_permlane16_swap_b32 v16, v30
    s_nop 1
    v_max_f32 v16, v16, v30
    v_exp_f32_e64 v30, -v16
    s_nop 0
    v_sub_f32 v180, v180, v16
    v_sub_f32 v181, v181, v16
    v_sub_f32 v182, v182, v16
    v_sub_f32 v183, v183, v16
    v_sub_f32 v176, v176, v16
    v_sub_f32 v177, v177, v16
    v_sub_f32 v178, v178, v16
    v_sub_f32 v179, v179, v16
    v_sub_f32 v240, v240, v16
    v_sub_f32 v241, v241, v16
    v_sub_f32 v242, v242, v16
    v_sub_f32 v243, v243, v16
    v_mul_f32 v26, v26, v30
    v_accvgpr_read_b32 v168, a128
    v_accvgpr_read_b32 v169, a129
    v_accvgpr_read_b32 v170, a130
    v_accvgpr_read_b32 v171, a131
    v_mul_f32 v168, v168, v30
    v_mul_f32 v169, v169, v30
    v_mul_f32 v170, v170, v30
    v_mul_f32 v171, v171, v30
    v_accvgpr_write_b32 a128, v168
    v_accvgpr_write_b32 a129, v169
    v_accvgpr_write_b32 a130, v170
    v_accvgpr_write_b32 a131, v171
    v_accvgpr_read_b32 v168, a132
    v_accvgpr_read_b32 v169, a133
    v_accvgpr_read_b32 v170, a134
    v_accvgpr_read_b32 v171, a135
    v_mul_f32 v168, v168, v30
    v_mul_f32 v169, v169, v30
    v_mul_f32 v170, v170, v30
    v_mul_f32 v171, v171, v30
    v_accvgpr_write_b32 a132, v168
    v_accvgpr_write_b32 a133, v169
    v_accvgpr_write_b32 a134, v170
    v_accvgpr_write_b32 a135, v171
    v_accvgpr_read_b32 v168, a136
    v_accvgpr_read_b32 v169, a137
    v_accvgpr_read_b32 v170, a138
    v_accvgpr_read_b32 v171, a139
    v_mul_f32 v168, v168, v30
    v_mul_f32 v169, v169, v30
    v_mul_f32 v170, v170, v30
    v_mul_f32 v171, v171, v30
    v_accvgpr_write_b32 a136, v168
    v_accvgpr_write_b32 a137, v169
    v_accvgpr_write_b32 a138, v170
    v_accvgpr_write_b32 a139, v171
    v_accvgpr_read_b32 v168, a140
    v_accvgpr_read_b32 v169, a141
    v_accvgpr_read_b32 v170, a142
    v_accvgpr_read_b32 v171, a143
    v_mul_f32 v168, v168, v30
    v_mul_f32 v169, v169, v30
    v_mul_f32 v170, v170, v30
    v_mul_f32 v171, v171, v30
    v_accvgpr_write_b32 a140, v168
    v_accvgpr_write_b32 a141, v169
    v_accvgpr_write_b32 a142, v170
    v_accvgpr_write_b32 a143, v171
    v_accvgpr_read_b32 v168, a144
    v_accvgpr_read_b32 v169, a145
    v_accvgpr_read_b32 v170, a146
    v_accvgpr_read_b32 v171, a147
    v_mul_f32 v168, v168, v30
    v_mul_f32 v169, v169, v30
    v_mul_f32 v170, v170, v30
    v_mul_f32 v171, v171, v30
    v_accvgpr_write_b32 a144, v168
    v_accvgpr_write_b32 a145, v169
    v_accvgpr_write_b32 a146, v170
    v_accvgpr_write_b32 a147, v171
    v_accvgpr_read_b32 v168, a148
    v_accvgpr_read_b32 v169, a149
    v_accvgpr_read_b32 v170, a150
    v_accvgpr_read_b32 v171, a151
    v_mul_f32 v168, v168, v30
    v_mul_f32 v169, v169, v30
    v_mul_f32 v170, v170, v30
    v_mul_f32 v171, v171, v30
    v_accvgpr_write_b32 a148, v168
    v_accvgpr_write_b32 a149, v169
    v_accvgpr_write_b32 a150, v170
    v_accvgpr_write_b32 a151, v171
    v_accvgpr_read_b32 v168, a152
    v_accvgpr_read_b32 v169, a153
    v_accvgpr_read_b32 v170, a154
    v_accvgpr_read_b32 v171, a155
    v_mul_f32 v168, v168, v30
    v_mul_f32 v169, v169, v30
    v_mul_f32 v170, v170, v30
    v_mul_f32 v171, v171, v30
    v_accvgpr_write_b32 a152, v168
    v_accvgpr_write_b32 a153, v169
    v_accvgpr_write_b32 a154, v170
    v_accvgpr_write_b32 a155, v171
    v_accvgpr_read_b32 v168, a156
    v_accvgpr_read_b32 v169, a157
    v_accvgpr_read_b32 v170, a158
    v_accvgpr_read_b32 v171, a159
    v_mul_f32 v168, v168, v30
    v_mul_f32 v169, v169, v30
    v_mul_f32 v170, v170, v30
    v_mul_f32 v171, v171, v30
    v_accvgpr_write_b32 a156, v168
    v_accvgpr_write_b32 a157, v169
    v_accvgpr_write_b32 a158, v170
    v_accvgpr_write_b32 a159, v171
    v_accvgpr_read_b32 v168, a160
    v_accvgpr_read_b32 v169, a161
    v_accvgpr_read_b32 v170, a162
    v_accvgpr_read_b32 v171, a163
    v_mul_f32 v168, v168, v30
    v_mul_f32 v169, v169, v30
    v_mul_f32 v170, v170, v30
    v_mul_f32 v171, v171, v30
    v_accvgpr_write_b32 a160, v168
    v_accvgpr_write_b32 a161, v169
    v_accvgpr_write_b32 a162, v170
    v_accvgpr_write_b32 a163, v171
    v_accvgpr_read_b32 v168, a164
    v_accvgpr_read_b32 v169, a165
    v_accvgpr_read_b32 v170, a166
    v_accvgpr_read_b32 v171, a167
    v_mul_f32 v168, v168, v30
    v_mul_f32 v169, v169, v30
    v_mul_f32 v170, v170, v30
    v_mul_f32 v171, v171, v30
    v_accvgpr_write_b32 a164, v168
    v_accvgpr_write_b32 a165, v169
    v_accvgpr_write_b32 a166, v170
    v_accvgpr_write_b32 a167, v171
    v_accvgpr_read_b32 v168, a168
    v_accvgpr_read_b32 v169, a169
    v_accvgpr_read_b32 v170, a170
    v_accvgpr_read_b32 v171, a171
    v_mul_f32 v168, v168, v30
    v_mul_f32 v169, v169, v30
    v_mul_f32 v170, v170, v30
    v_mul_f32 v171, v171, v30
    v_accvgpr_write_b32 a168, v168
    v_accvgpr_write_b32 a169, v169
    v_accvgpr_write_b32 a170, v170
    v_accvgpr_write_b32 a171, v171
    v_accvgpr_read_b32 v168, a172
    v_accvgpr_read_b32 v169, a173
    v_accvgpr_read_b32 v170, a174
    v_accvgpr_read_b32 v171, a175
    v_mul_f32 v168, v168, v30
    v_mul_f32 v169, v169, v30
    v_mul_f32 v170, v170, v30
    v_mul_f32 v171, v171, v30
    v_accvgpr_write_b32 a172, v168
    v_accvgpr_write_b32 a173, v169
    v_accvgpr_write_b32 a174, v170
    v_accvgpr_write_b32 a175, v171
    v_accvgpr_read_b32 v168, a176
    v_accvgpr_read_b32 v169, a177
    v_accvgpr_read_b32 v170, a178
    v_accvgpr_read_b32 v171, a179
    v_mul_f32 v168, v168, v30
    v_mul_f32 v169, v169, v30
    v_mul_f32 v170, v170, v30
    v_mul_f32 v171, v171, v30
    v_accvgpr_write_b32 a176, v168
    v_accvgpr_write_b32 a177, v169
    v_accvgpr_write_b32 a178, v170
    v_accvgpr_write_b32 a179, v171
    v_accvgpr_read_b32 v168, a180
    v_accvgpr_read_b32 v169, a181
    v_accvgpr_read_b32 v170, a182
    v_accvgpr_read_b32 v171, a183
    v_mul_f32 v168, v168, v30
    v_mul_f32 v169, v169, v30
    v_mul_f32 v170, v170, v30
    v_mul_f32 v171, v171, v30
    v_accvgpr_write_b32 a180, v168
    v_accvgpr_write_b32 a181, v169
    v_accvgpr_write_b32 a182, v170
    v_accvgpr_write_b32 a183, v171
    v_accvgpr_read_b32 v168, a184
    v_accvgpr_read_b32 v169, a185
    v_accvgpr_read_b32 v170, a186
    v_accvgpr_read_b32 v171, a187
    v_mul_f32 v168, v168, v30
    v_mul_f32 v169, v169, v30
    v_mul_f32 v170, v170, v30
    v_mul_f32 v171, v171, v30
    v_accvgpr_write_b32 a184, v168
    v_accvgpr_write_b32 a185, v169
    v_accvgpr_write_b32 a186, v170
    v_accvgpr_write_b32 a187, v171
    v_accvgpr_read_b32 v168, a188
    v_accvgpr_read_b32 v169, a189
    v_accvgpr_read_b32 v170, a190
    v_accvgpr_read_b32 v171, a191
    v_mul_f32 v168, v168, v30
    v_mul_f32 v169, v169, v30
    v_mul_f32 v170, v170, v30
    v_mul_f32 v171, v171, v30
    v_accvgpr_write_b32 a188, v168
    v_accvgpr_write_b32 a189, v169
    v_accvgpr_write_b32 a190, v170
    v_accvgpr_write_b32 a191, v171
    v_exp_f32 v180, v180
    v_exp_f32 v181, v181
    v_exp_f32 v182, v182
    v_exp_f32 v183, v183
    v_exp_f32 v176, v176
    v_exp_f32 v177, v177
    v_exp_f32 v178, v178
    v_exp_f32 v179, v179
    s_nop 0
    v_add_f32 v30, v180, v181
    v_add_f32 v30, v30, v182
    v_add_f32 v30, v30, v183
    v_add_f32 v30, v30, v176
    v_add_f32 v30, v30, v177
    v_add_f32 v30, v30, v178
    v_add_f32 v30, v30, v179
    v_cvt_pk_bf16_f32 v168, v180, v181
    v_cvt_pk_bf16_f32 v169, v182, v183
    v_max3_f32 v16, v188, v189, v190
    v_max3_f32 v16, v16, v191, v184
    v_max3_f32 v16, v16, v185, v186
    v_max3_f32 v16, v16, v187, 0
    v_mov_b32 v31, v16
    s_nop 1
    v_permlane32_swap_b32 v16, v31
    s_nop 1
    v_max_f32 v16, v16, v31
    v_mov_b32 v31, v16
    s_nop 1
    v_permlane16_swap_b32 v16, v31
    s_nop 1
    v_max_f32 v16, v16, v31
    v_exp_f32_e64 v31, -v16
    s_nop 0
    v_sub_f32 v188, v188, v16
    v_sub_f32 v189, v189, v16
    v_sub_f32 v190, v190, v16
    v_sub_f32 v191, v191, v16
    v_sub_f32 v184, v184, v16
    v_sub_f32 v185, v185, v16
    v_sub_f32 v186, v186, v16
    v_sub_f32 v187, v187, v16
    v_sub_f32 v248, v248, v16
    v_sub_f32 v249, v249, v16
    v_sub_f32 v250, v250, v16
    v_sub_f32 v251, v251, v16
    v_mul_f32 v27, v27, v31
    v_accvgpr_read_b32 v172, a192
    v_accvgpr_read_b32 v173, a193
    v_accvgpr_read_b32 v174, a194
    v_accvgpr_read_b32 v175, a195
    v_mul_f32 v172, v172, v31
    v_mul_f32 v173, v173, v31
    v_mul_f32 v174, v174, v31
    v_mul_f32 v175, v175, v31
    v_accvgpr_write_b32 a192, v172
    v_accvgpr_write_b32 a193, v173
    v_accvgpr_write_b32 a194, v174
    v_accvgpr_write_b32 a195, v175
    v_accvgpr_read_b32 v172, a196
    v_accvgpr_read_b32 v173, a197
    v_accvgpr_read_b32 v174, a198
    v_accvgpr_read_b32 v175, a199
    v_mul_f32 v172, v172, v31
    v_mul_f32 v173, v173, v31
    v_mul_f32 v174, v174, v31
    v_mul_f32 v175, v175, v31
    v_accvgpr_write_b32 a196, v172
    v_accvgpr_write_b32 a197, v173
    v_accvgpr_write_b32 a198, v174
    v_accvgpr_write_b32 a199, v175
    v_accvgpr_read_b32 v172, a200
    v_accvgpr_read_b32 v173, a201
    v_accvgpr_read_b32 v174, a202
    v_accvgpr_read_b32 v175, a203
    v_mul_f32 v172, v172, v31
    v_mul_f32 v173, v173, v31
    v_mul_f32 v174, v174, v31
    v_mul_f32 v175, v175, v31
    v_accvgpr_write_b32 a200, v172
    v_accvgpr_write_b32 a201, v173
    v_accvgpr_write_b32 a202, v174
    v_accvgpr_write_b32 a203, v175
    v_accvgpr_read_b32 v172, a204
    v_accvgpr_read_b32 v173, a205
    v_accvgpr_read_b32 v174, a206
    v_accvgpr_read_b32 v175, a207
    v_mul_f32 v172, v172, v31
    v_mul_f32 v173, v173, v31
    v_mul_f32 v174, v174, v31
    v_mul_f32 v175, v175, v31
    v_accvgpr_write_b32 a204, v172
    v_accvgpr_write_b32 a205, v173
    v_accvgpr_write_b32 a206, v174
    v_accvgpr_write_b32 a207, v175
    v_accvgpr_read_b32 v172, a208
    v_accvgpr_read_b32 v173, a209
    v_accvgpr_read_b32 v174, a210
    v_accvgpr_read_b32 v175, a211
    v_mul_f32 v172, v172, v31
    v_mul_f32 v173, v173, v31
    v_mul_f32 v174, v174, v31
    v_mul_f32 v175, v175, v31
    v_accvgpr_write_b32 a208, v172
    v_accvgpr_write_b32 a209, v173
    v_accvgpr_write_b32 a210, v174
    v_accvgpr_write_b32 a211, v175
    v_accvgpr_read_b32 v172, a212
    v_accvgpr_read_b32 v173, a213
    v_accvgpr_read_b32 v174, a214
    v_accvgpr_read_b32 v175, a215
    v_mul_f32 v172, v172, v31
    v_mul_f32 v173, v173, v31
    v_mul_f32 v174, v174, v31
    v_mul_f32 v175, v175, v31
    v_accvgpr_write_b32 a212, v172
    v_accvgpr_write_b32 a213, v173
    v_accvgpr_write_b32 a214, v174
    v_accvgpr_write_b32 a215, v175
    v_accvgpr_read_b32 v172, a216
    v_accvgpr_read_b32 v173, a217
    v_accvgpr_read_b32 v174, a218
    v_accvgpr_read_b32 v175, a219
    v_mul_f32 v172, v172, v31
    v_mul_f32 v173, v173, v31
    v_mul_f32 v174, v174, v31
    v_mul_f32 v175, v175, v31
    v_accvgpr_write_b32 a216, v172
    v_accvgpr_write_b32 a217, v173
    v_accvgpr_write_b32 a218, v174
    v_accvgpr_write_b32 a219, v175
    v_accvgpr_read_b32 v172, a220
    v_accvgpr_read_b32 v173, a221
    v_accvgpr_read_b32 v174, a222
    v_accvgpr_read_b32 v175, a223
    v_mul_f32 v172, v172, v31
    v_mul_f32 v173, v173, v31
    v_mul_f32 v174, v174, v31
    v_mul_f32 v175, v175, v31
    v_accvgpr_write_b32 a220, v172
    v_accvgpr_write_b32 a221, v173
    v_accvgpr_write_b32 a222, v174
    v_accvgpr_write_b32 a223, v175
    v_accvgpr_read_b32 v172, a224
    v_accvgpr_read_b32 v173, a225
    v_accvgpr_read_b32 v174, a226
    v_accvgpr_read_b32 v175, a227
    v_mul_f32 v172, v172, v31
    v_mul_f32 v173, v173, v31
    v_mul_f32 v174, v174, v31
    v_mul_f32 v175, v175, v31
    v_accvgpr_write_b32 a224, v172
    v_accvgpr_write_b32 a225, v173
    v_accvgpr_write_b32 a226, v174
    v_accvgpr_write_b32 a227, v175
    v_accvgpr_read_b32 v172, a228
    v_accvgpr_read_b32 v173, a229
    v_accvgpr_read_b32 v174, a230
    v_accvgpr_read_b32 v175, a231
    v_mul_f32 v172, v172, v31
    v_mul_f32 v173, v173, v31
    v_mul_f32 v174, v174, v31
    v_mul_f32 v175, v175, v31
    v_accvgpr_write_b32 a228, v172
    v_accvgpr_write_b32 a229, v173
    v_accvgpr_write_b32 a230, v174
    v_accvgpr_write_b32 a231, v175
    v_accvgpr_read_b32 v172, a232
    v_accvgpr_read_b32 v173, a233
    v_accvgpr_read_b32 v174, a234
    v_accvgpr_read_b32 v175, a235
    v_mul_f32 v172, v172, v31
    v_mul_f32 v173, v173, v31
    v_mul_f32 v174, v174, v31
    v_mul_f32 v175, v175, v31
    v_accvgpr_write_b32 a232, v172
    v_accvgpr_write_b32 a233, v173
    v_accvgpr_write_b32 a234, v174
    v_accvgpr_write_b32 a235, v175
    v_accvgpr_read_b32 v172, a236
    v_accvgpr_read_b32 v173, a237
    v_accvgpr_read_b32 v174, a238
    v_accvgpr_read_b32 v175, a239
    v_mul_f32 v172, v172, v31
    v_mul_f32 v173, v173, v31
    v_mul_f32 v174, v174, v31
    v_mul_f32 v175, v175, v31
    v_accvgpr_write_b32 a236, v172
    v_accvgpr_write_b32 a237, v173
    v_accvgpr_write_b32 a238, v174
    v_accvgpr_write_b32 a239, v175
    v_accvgpr_read_b32 v172, a240
    v_accvgpr_read_b32 v173, a241
    v_accvgpr_read_b32 v174, a242
    v_accvgpr_read_b32 v175, a243
    v_mul_f32 v172, v172, v31
    v_mul_f32 v173, v173, v31
    v_mul_f32 v174, v174, v31
    v_mul_f32 v175, v175, v31
    v_accvgpr_write_b32 a240, v172
    v_accvgpr_write_b32 a241, v173
    v_accvgpr_write_b32 a242, v174
    v_accvgpr_write_b32 a243, v175
    v_accvgpr_read_b32 v172, a244
    v_accvgpr_read_b32 v173, a245
    v_accvgpr_read_b32 v174, a246
    v_accvgpr_read_b32 v175, a247
    v_mul_f32 v172, v172, v31
    v_mul_f32 v173, v173, v31
    v_mul_f32 v174, v174, v31
    v_mul_f32 v175, v175, v31
    v_accvgpr_write_b32 a244, v172
    v_accvgpr_write_b32 a245, v173
    v_accvgpr_write_b32 a246, v174
    v_accvgpr_write_b32 a247, v175
    v_accvgpr_read_b32 v172, a248
    v_accvgpr_read_b32 v173, a249
    v_accvgpr_read_b32 v174, a250
    v_accvgpr_read_b32 v175, a251
    v_mul_f32 v172, v172, v31
    v_mul_f32 v173, v173, v31
    v_mul_f32 v174, v174, v31
    v_mul_f32 v175, v175, v31
    v_accvgpr_write_b32 a248, v172
    v_accvgpr_write_b32 a249, v173
    v_accvgpr_write_b32 a250, v174
    v_accvgpr_write_b32 a251, v175
    v_accvgpr_read_b32 v172, a252
    v_accvgpr_read_b32 v173, a253
    v_accvgpr_read_b32 v174, a254
    v_accvgpr_read_b32 v175, a255
    v_mul_f32 v172, v172, v31
    v_mul_f32 v173, v173, v31
    v_mul_f32 v174, v174, v31
    v_mul_f32 v175, v175, v31
    v_accvgpr_write_b32 a252, v172
    v_accvgpr_write_b32 a253, v173
    v_accvgpr_write_b32 a254, v174
    v_accvgpr_write_b32 a255, v175
    v_exp_f32 v188, v188
    v_exp_f32 v189, v189
    v_exp_f32 v190, v190
    v_exp_f32 v191, v191
    v_exp_f32 v184, v184
    v_exp_f32 v185, v185
    v_exp_f32 v186, v186
    v_exp_f32 v187, v187
    s_nop 0
    v_add_f32 v31, v188, v189
    v_add_f32 v31, v31, v190
    v_add_f32 v31, v31, v191
    v_add_f32 v31, v31, v184
    v_add_f32 v31, v31, v185
    v_add_f32 v31, v31, v186
    v_add_f32 v31, v31, v187
    v_cvt_pk_bf16_f32 v172, v188, v189
    v_cvt_pk_bf16_f32 v173, v190, v191
    s_nop 3
    s_setpc_b64 s[78:79]
L_mfix:
    s_nop 15
    v_max_f32 v144, 0, v182
    v_exp_f32_e64 v145, -v144
    v_sub_f32 v144, v182, v144
    v_exp_f32 v180, v144
    v_mul_f32 v24, v24, v145
    v_accvgpr_read_b32 v152, a0
    v_accvgpr_read_b32 v153, a1
    v_accvgpr_read_b32 v154, a2
    v_accvgpr_read_b32 v155, a3
    v_mul_f32 v152, v152, v145
    v_mul_f32 v153, v153, v145
    v_mul_f32 v154, v154, v145
    v_mul_f32 v155, v155, v145
    v_accvgpr_write_b32 a0, v152
    v_accvgpr_write_b32 a1, v153
    v_accvgpr_write_b32 a2, v154
    v_accvgpr_write_b32 a3, v155
    v_accvgpr_read_b32 v152, a4
    v_accvgpr_read_b32 v153, a5
    v_accvgpr_read_b32 v154, a6
    v_accvgpr_read_b32 v155, a7
    v_mul_f32 v152, v152, v145
    v_mul_f32 v153, v153, v145
    v_mul_f32 v154, v154, v145
    v_mul_f32 v155, v155, v145
    v_accvgpr_write_b32 a4, v152
    v_accvgpr_write_b32 a5, v153
    v_accvgpr_write_b32 a6, v154
    v_accvgpr_write_b32 a7, v155
    v_accvgpr_read_b32 v152, a8
    v_accvgpr_read_b32 v153, a9
    v_accvgpr_read_b32 v154, a10
    v_accvgpr_read_b32 v155, a11
    v_mul_f32 v152, v152, v145
    v_mul_f32 v153, v153, v145
    v_mul_f32 v154, v154, v145
    v_mul_f32 v155, v155, v145
    v_accvgpr_write_b32 a8, v152
    v_accvgpr_write_b32 a9, v153
    v_accvgpr_write_b32 a10, v154
    v_accvgpr_write_b32 a11, v155
    v_accvgpr_read_b32 v152, a12
    v_accvgpr_read_b32 v153, a13
    v_accvgpr_read_b32 v154, a14
    v_accvgpr_read_b32 v155, a15
    v_mul_f32 v152, v152, v145
    v_mul_f32 v153, v153, v145
    v_mul_f32 v154, v154, v145
    v_mul_f32 v155, v155, v145
    v_accvgpr_write_b32 a12, v152
    v_accvgpr_write_b32 a13, v153
    v_accvgpr_write_b32 a14, v154
    v_accvgpr_write_b32 a15, v155
    v_accvgpr_read_b32 v152, a16
    v_accvgpr_read_b32 v153, a17
    v_accvgpr_read_b32 v154, a18
    v_accvgpr_read_b32 v155, a19
    v_mul_f32 v152, v152, v145
    v_mul_f32 v153, v153, v145
    v_mul_f32 v154, v154, v145
    v_mul_f32 v155, v155, v145
    v_accvgpr_write_b32 a16, v152
    v_accvgpr_write_b32 a17, v153
    v_accvgpr_write_b32 a18, v154
    v_accvgpr_write_b32 a19, v155
    v_accvgpr_read_b32 v152, a20
    v_accvgpr_read_b32 v153, a21
    v_accvgpr_read_b32 v154, a22
    v_accvgpr_read_b32 v155, a23
    v_mul_f32 v152, v152, v145
    v_mul_f32 v153, v153, v145
    v_mul_f32 v154, v154, v145
    v_mul_f32 v155, v155, v145
    v_accvgpr_write_b32 a20, v152
    v_accvgpr_write_b32 a21, v153
    v_accvgpr_write_b32 a22, v154
    v_accvgpr_write_b32 a23, v155
    v_accvgpr_read_b32 v152, a24
    v_accvgpr_read_b32 v153, a25
    v_accvgpr_read_b32 v154, a26
    v_accvgpr_read_b32 v155, a27
    v_mul_f32 v152, v152, v145
    v_mul_f32 v153, v153, v145
    v_mul_f32 v154, v154, v145
    v_mul_f32 v155, v155, v145
    v_accvgpr_write_b32 a24, v152
    v_accvgpr_write_b32 a25, v153
    v_accvgpr_write_b32 a26, v154
    v_accvgpr_write_b32 a27, v155
    v_accvgpr_read_b32 v152, a28
    v_accvgpr_read_b32 v153, a29
    v_accvgpr_read_b32 v154, a30
    v_accvgpr_read_b32 v155, a31
    v_mul_f32 v152, v152, v145
    v_mul_f32 v153, v153, v145
    v_mul_f32 v154, v154, v145
    v_mul_f32 v155, v155, v145
    v_accvgpr_write_b32 a28, v152
    v_accvgpr_write_b32 a29, v153
    v_accvgpr_write_b32 a30, v154
    v_accvgpr_write_b32 a31, v155
    v_accvgpr_read_b32 v152, a32
    v_accvgpr_read_b32 v153, a33
    v_accvgpr_read_b32 v154, a34
    v_accvgpr_read_b32 v155, a35
    v_mul_f32 v152, v152, v145
    v_mul_f32 v153, v153, v145
    v_mul_f32 v154, v154, v145
    v_mul_f32 v155, v155, v145
    v_accvgpr_write_b32 a32, v152
    v_accvgpr_write_b32 a33, v153
    v_accvgpr_write_b32 a34, v154
    v_accvgpr_write_b32 a35, v155
    v_accvgpr_read_b32 v152, a36
    v_accvgpr_read_b32 v153, a37
    v_accvgpr_read_b32 v154, a38
    v_accvgpr_read_b32 v155, a39
    v_mul_f32 v152, v152, v145
    v_mul_f32 v153, v153, v145
    v_mul_f32 v154, v154, v145
    v_mul_f32 v155, v155, v145
    v_accvgpr_write_b32 a36, v152
    v_accvgpr_write_b32 a37, v153
    v_accvgpr_write_b32 a38, v154
    v_accvgpr_write_b32 a39, v155
    v_accvgpr_read_b32 v152, a40
    v_accvgpr_read_b32 v153, a41
    v_accvgpr_read_b32 v154, a42
    v_accvgpr_read_b32 v155, a43
    v_mul_f32 v152, v152, v145
    v_mul_f32 v153, v153, v145
    v_mul_f32 v154, v154, v145
    v_mul_f32 v155, v155, v145
    v_accvgpr_write_b32 a40, v152
    v_accvgpr_write_b32 a41, v153
    v_accvgpr_write_b32 a42, v154
    v_accvgpr_write_b32 a43, v155
    v_accvgpr_read_b32 v152, a44
    v_accvgpr_read_b32 v153, a45
    v_accvgpr_read_b32 v154, a46
    v_accvgpr_read_b32 v155, a47
    v_mul_f32 v152, v152, v145
    v_mul_f32 v153, v153, v145
    v_mul_f32 v154, v154, v145
    v_mul_f32 v155, v155, v145
    v_accvgpr_write_b32 a44, v152
    v_accvgpr_write_b32 a45, v153
    v_accvgpr_write_b32 a46, v154
    v_accvgpr_write_b32 a47, v155
    v_accvgpr_read_b32 v152, a48
    v_accvgpr_read_b32 v153, a49
    v_accvgpr_read_b32 v154, a50
    v_accvgpr_read_b32 v155, a51
    v_mul_f32 v152, v152, v145
    v_mul_f32 v153, v153, v145
    v_mul_f32 v154, v154, v145
    v_mul_f32 v155, v155, v145
    v_accvgpr_write_b32 a48, v152
    v_accvgpr_write_b32 a49, v153
    v_accvgpr_write_b32 a50, v154
    v_accvgpr_write_b32 a51, v155
    v_accvgpr_read_b32 v152, a52
    v_accvgpr_read_b32 v153, a53
    v_accvgpr_read_b32 v154, a54
    v_accvgpr_read_b32 v155, a55
    v_mul_f32 v152, v152, v145
    v_mul_f32 v153, v153, v145
    v_mul_f32 v154, v154, v145
    v_mul_f32 v155, v155, v145
    v_accvgpr_write_b32 a52, v152
    v_accvgpr_write_b32 a53, v153
    v_accvgpr_write_b32 a54, v154
    v_accvgpr_write_b32 a55, v155
    v_accvgpr_read_b32 v152, a56
    v_accvgpr_read_b32 v153, a57
    v_accvgpr_read_b32 v154, a58
    v_accvgpr_read_b32 v155, a59
    v_mul_f32 v152, v152, v145
    v_mul_f32 v153, v153, v145
    v_mul_f32 v154, v154, v145
    v_mul_f32 v155, v155, v145
    v_accvgpr_write_b32 a56, v152
    v_accvgpr_write_b32 a57, v153
    v_accvgpr_write_b32 a58, v154
    v_accvgpr_write_b32 a59, v155
    v_accvgpr_read_b32 v152, a60
    v_accvgpr_read_b32 v153, a61
    v_accvgpr_read_b32 v154, a62
    v_accvgpr_read_b32 v155, a63
    v_mul_f32 v152, v152, v145
    v_mul_f32 v153, v153, v145
    v_mul_f32 v154, v154, v145
    v_mul_f32 v155, v155, v145
    v_accvgpr_write_b32 a60, v152
    v_accvgpr_write_b32 a61, v153
    v_accvgpr_write_b32 a62, v154
    v_accvgpr_write_b32 a63, v155
    v_max_f32 v144, 0, v183
    v_exp_f32_e64 v145, -v144
    v_sub_f32 v144, v183, v144
    v_exp_f32 v181, v144
    v_mul_f32 v25, v25, v145
    v_accvgpr_read_b32 v152, a64
    v_accvgpr_read_b32 v153, a65
    v_accvgpr_read_b32 v154, a66
    v_accvgpr_read_b32 v155, a67
    v_mul_f32 v152, v152, v145
    v_mul_f32 v153, v153, v145
    v_mul_f32 v154, v154, v145
    v_mul_f32 v155, v155, v145
    v_accvgpr_write_b32 a64, v152
    v_accvgpr_write_b32 a65, v153
    v_accvgpr_write_b32 a66, v154
    v_accvgpr_write_b32 a67, v155
    v_accvgpr_read_b32 v152, a68
    v_accvgpr_read_b32 v153, a69
    v_accvgpr_read_b32 v154, a70
    v_accvgpr_read_b32 v155, a71
    v_mul_f32 v152, v152, v145
    v_mul_f32 v153, v153, v145
    v_mul_f32 v154, v154, v145
    v_mul_f32 v155, v155, v145
    v_accvgpr_write_b32 a68, v152
    v_accvgpr_write_b32 a69, v153
    v_accvgpr_write_b32 a70, v154
    v_accvgpr_write_b32 a71, v155
    v_accvgpr_read_b32 v152, a72
    v_accvgpr_read_b32 v153, a73
    v_accvgpr_read_b32 v154, a74
    v_accvgpr_read_b32 v155, a75
    v_mul_f32 v152, v152, v145
    v_mul_f32 v153, v153, v145
    v_mul_f32 v154, v154, v145
    v_mul_f32 v155, v155, v145
    v_accvgpr_write_b32 a72, v152
    v_accvgpr_write_b32 a73, v153
    v_accvgpr_write_b32 a74, v154
    v_accvgpr_write_b32 a75, v155
    v_accvgpr_read_b32 v152, a76
    v_accvgpr_read_b32 v153, a77
    v_accvgpr_read_b32 v154, a78
    v_accvgpr_read_b32 v155, a79
    v_mul_f32 v152, v152, v145
    v_mul_f32 v153, v153, v145
    v_mul_f32 v154, v154, v145
    v_mul_f32 v155, v155, v145
    v_accvgpr_write_b32 a76, v152
    v_accvgpr_write_b32 a77, v153
    v_accvgpr_write_b32 a78, v154
    v_accvgpr_write_b32 a79, v155
    v_accvgpr_read_b32 v152, a80
    v_accvgpr_read_b32 v153, a81
    v_accvgpr_read_b32 v154, a82
    v_accvgpr_read_b32 v155, a83
    v_mul_f32 v152, v152, v145
    v_mul_f32 v153, v153, v145
    v_mul_f32 v154, v154, v145
    v_mul_f32 v155, v155, v145
    v_accvgpr_write_b32 a80, v152
    v_accvgpr_write_b32 a81, v153
    v_accvgpr_write_b32 a82, v154
    v_accvgpr_write_b32 a83, v155
    v_accvgpr_read_b32 v152, a84
    v_accvgpr_read_b32 v153, a85
    v_accvgpr_read_b32 v154, a86
    v_accvgpr_read_b32 v155, a87
    v_mul_f32 v152, v152, v145
    v_mul_f32 v153, v153, v145
    v_mul_f32 v154, v154, v145
    v_mul_f32 v155, v155, v145
    v_accvgpr_write_b32 a84, v152
    v_accvgpr_write_b32 a85, v153
    v_accvgpr_write_b32 a86, v154
    v_accvgpr_write_b32 a87, v155
    v_accvgpr_read_b32 v152, a88
    v_accvgpr_read_b32 v153, a89
    v_accvgpr_read_b32 v154, a90
    v_accvgpr_read_b32 v155, a91
    v_mul_f32 v152, v152, v145
    v_mul_f32 v153, v153, v145
    v_mul_f32 v154, v154, v145
    v_mul_f32 v155, v155, v145
    v_accvgpr_write_b32 a88, v152
    v_accvgpr_write_b32 a89, v153
    v_accvgpr_write_b32 a90, v154
    v_accvgpr_write_b32 a91, v155
    v_accvgpr_read_b32 v152, a92
    v_accvgpr_read_b32 v153, a93
    v_accvgpr_read_b32 v154, a94
    v_accvgpr_read_b32 v155, a95
    v_mul_f32 v152, v152, v145
    v_mul_f32 v153, v153, v145
    v_mul_f32 v154, v154, v145
    v_mul_f32 v155, v155, v145
    v_accvgpr_write_b32 a92, v152
    v_accvgpr_write_b32 a93, v153
    v_accvgpr_write_b32 a94, v154
    v_accvgpr_write_b32 a95, v155
    v_accvgpr_read_b32 v152, a96
    v_accvgpr_read_b32 v153, a97
    v_accvgpr_read_b32 v154, a98
    v_accvgpr_read_b32 v155, a99
    v_mul_f32 v152, v152, v145
    v_mul_f32 v153, v153, v145
    v_mul_f32 v154, v154, v145
    v_mul_f32 v155, v155, v145
    v_accvgpr_write_b32 a96, v152
    v_accvgpr_write_b32 a97, v153
    v_accvgpr_write_b32 a98, v154
    v_accvgpr_write_b32 a99, v155
    v_accvgpr_read_b32 v152, a100
    v_accvgpr_read_b32 v153, a101
    v_accvgpr_read_b32 v154, a102
    v_accvgpr_read_b32 v155, a103
    v_mul_f32 v152, v152, v145
    v_mul_f32 v153, v153, v145
    v_mul_f32 v154, v154, v145
    v_mul_f32 v155, v155, v145
    v_accvgpr_write_b32 a100, v152
    v_accvgpr_write_b32 a101, v153
    v_accvgpr_write_b32 a102, v154
    v_accvgpr_write_b32 a103, v155
    v_accvgpr_read_b32 v152, a104
    v_accvgpr_read_b32 v153, a105
    v_accvgpr_read_b32 v154, a106
    v_accvgpr_read_b32 v155, a107
    v_mul_f32 v152, v152, v145
    v_mul_f32 v153, v153, v145
    v_mul_f32 v154, v154, v145
    v_mul_f32 v155, v155, v145
    v_accvgpr_write_b32 a104, v152
    v_accvgpr_write_b32 a105, v153
    v_accvgpr_write_b32 a106, v154
    v_accvgpr_write_b32 a107, v155
    v_accvgpr_read_b32 v152, a108
    v_accvgpr_read_b32 v153, a109
    v_accvgpr_read_b32 v154, a110
    v_accvgpr_read_b32 v155, a111
    v_mul_f32 v152, v152, v145
    v_mul_f32 v153, v153, v145
    v_mul_f32 v154, v154, v145
    v_mul_f32 v155, v155, v145
    v_accvgpr_write_b32 a108, v152
    v_accvgpr_write_b32 a109, v153
    v_accvgpr_write_b32 a110, v154
    v_accvgpr_write_b32 a111, v155
    v_accvgpr_read_b32 v152, a112
    v_accvgpr_read_b32 v153, a113
    v_accvgpr_read_b32 v154, a114
    v_accvgpr_read_b32 v155, a115
    v_mul_f32 v152, v152, v145
    v_mul_f32 v153, v153, v145
    v_mul_f32 v154, v154, v145
    v_mul_f32 v155, v155, v145
    v_accvgpr_write_b32 a112, v152
    v_accvgpr_write_b32 a113, v153
    v_accvgpr_write_b32 a114, v154
    v_accvgpr_write_b32 a115, v155
    v_accvgpr_read_b32 v152, a116
    v_accvgpr_read_b32 v153, a117
    v_accvgpr_read_b32 v154, a118
    v_accvgpr_read_b32 v155, a119
    v_mul_f32 v152, v152, v145
    v_mul_f32 v153, v153, v145
    v_mul_f32 v154, v154, v145
    v_mul_f32 v155, v155, v145
    v_accvgpr_write_b32 a116, v152
    v_accvgpr_write_b32 a117, v153
    v_accvgpr_write_b32 a118, v154
    v_accvgpr_write_b32 a119, v155
    v_accvgpr_read_b32 v152, a120
    v_accvgpr_read_b32 v153, a121
    v_accvgpr_read_b32 v154, a122
    v_accvgpr_read_b32 v155, a123
    v_mul_f32 v152, v152, v145
    v_mul_f32 v153, v153, v145
    v_mul_f32 v154, v154, v145
    v_mul_f32 v155, v155, v145
    v_accvgpr_write_b32 a120, v152
    v_accvgpr_write_b32 a121, v153
    v_accvgpr_write_b32 a122, v154
    v_accvgpr_write_b32 a123, v155
    v_accvgpr_read_b32 v152, a124
    v_accvgpr_read_b32 v153, a125
    v_accvgpr_read_b32 v154, a126
    v_accvgpr_read_b32 v155, a127
    v_mul_f32 v152, v152, v145
    v_mul_f32 v153, v153, v145
    v_mul_f32 v154, v154, v145
    v_mul_f32 v155, v155, v145
    v_accvgpr_write_b32 a124, v152
    v_accvgpr_write_b32 a125, v153
    v_accvgpr_write_b32 a126, v154
    v_accvgpr_write_b32 a127, v155
    s_nop 3
    s_branch L_mback
L_dlate:
    s_mov_b32 s76, 0
L_dpoll:
    buffer_load_dword v205, off, s[4:7], s95 sc1
    s_waitcnt vmcnt(0)
    v_readfirstlane_b32 s96, v205
    s_nop 3
    s_cmp_eq_u32 s96, 0xffff
    s_cbranch_scc1 L_dback
    s_sleep 8
    s_add_u32 s76, s76, 1
    s_cmp_lt_u32 s76, 0x40000
    s_cbranch_scc1 L_dpoll
    s_branch L_dback
L_k1_last:
    s_endpgm
.section .rodata,"a"
.p2align 6
.amdhsa_kernel recurrent_scan__mha_block_cached__glu_gated_glu__prompt_kernel
  .amdhsa_next_free_vgpr 512
  .amdhsa_next_free_sgpr 102
  .amdhsa_accum_offset 256
  .amdhsa_group_segment_fixed_size 0
  .amdhsa_kernarg_size 96
  .amdhsa_user_sgpr_count 2
  .amdhsa_user_sgpr_kernarg_segment_ptr 1
  .amdhsa_system_sgpr_workgroup_id_x 1
.end_amdhsa_kernel
```
